```python
import torch

def _softmax(x, axis=-1):
    return torch.softmax(x, dim=axis)
def _gelu(x):
    return torch.nn.functional.gelu(x, approximate="tanh")
def _silu(x):
    return torch.nn.functional.silu(x)
def _sigmoid(x):
    return torch.sigmoid(x)
def _layernorm(x, axis=-1, eps=1e-5):
    m = x.mean(dim=axis, keepdim=True)
    v = x.var(dim=axis, keepdim=True, unbiased=False)
    return (x - m) / torch.sqrt(v + eps)
def _scatter_add(tgt, idx, src, axis=0):
    return tgt.clone().index_add_(axis, idx, src)
def _segment_sum(src, seg, n):
    out = torch.zeros((n,) + src.shape[1:], dtype=src.dtype)
    return out.index_add_(0, seg, src)
def _pad(x, pw):
    flat = tuple(v for pair in reversed(pw) for v in pair)
    return torch.nn.functional.pad(x, flat)

kernel_name = 'concat_heads__ssm_conv_s5__compressed_kv_cla__prompt'

def setup_inputs():

    _w = (lambda a: (lambda t: t.to(torch.bfloat16) if t.is_floating_point() else t)(torch.as_tensor(a)))
    def _A_setup():
        B, S, D = 1, 2048, 512
        P = D
        Lambda_re = -0.5 * (lambda _x: torch.exp(torch.as_tensor(_x)))((lambda *s: torch.randn(*s, dtype=torch.bfloat16) * 0.2)(P))
        Lambda_im = (lambda *s: torch.randn(*s, dtype=torch.bfloat16) * 0.4)(P) * 1.0
        B_re = (lambda *s: torch.randn(*s, dtype=torch.bfloat16) * 0.2)(P, D) * (D ** -0.5)
        B_im = (lambda *s: torch.randn(*s, dtype=torch.bfloat16) * 0.2)(P, D) * (D ** -0.5)
        C_re = (lambda *s: torch.randn(*s, dtype=torch.bfloat16) * 0.2)(D, P) * (P ** -0.5)
        C_im = (lambda *s: torch.randn(*s, dtype=torch.bfloat16) * 0.2)(D, P) * (P ** -0.5)
        log_dt = (lambda *s: torch.randn(*s, dtype=torch.bfloat16) * 0.2)(P) * 0.3 - 2.0
        Dskip = (lambda *s: torch.randn(*s, dtype=torch.bfloat16) * 0.05)(D)
        return {
            "x": _w((lambda *s: torch.randn(*s, dtype=torch.bfloat16) * 0.05)(B, S, D)),
            "Lambda_re": _w(Lambda_re),
            "Lambda_im": _w(Lambda_im),
            "B_re": _w(B_re),
            "B_im": _w(B_im),
            "C_re": _w(C_re),
            "C_im": _w(C_im),
            "log_dt": _w(log_dt),
            "Dskip": _w(Dskip),
        }
    _A_in = _A_setup()

    def _B_setup():
        B, H, Sq, Sk, D, M = 1, 32, 2048, 2048, 128, 512
        Dc = 4 * D
        return {
            "x": _w((lambda *s: torch.randn(*s, dtype=torch.bfloat16) * 3.2)(B, Sq, M)),
            "c_kv": _w((lambda *s: torch.randn(*s, dtype=torch.bfloat16) * 0.1)(B, Sk, Dc)),
            "w_q": _w((lambda *s: torch.randn(*s, dtype=torch.bfloat16) * 6.4)(M, H, D) * (M ** -0.5)),
            "w_uk": _w((lambda *s: torch.randn(*s, dtype=torch.bfloat16) * 6.4)(Dc, H, D) * (Dc ** -0.5)),
            "w_uv": _w((lambda *s: torch.randn(*s, dtype=torch.bfloat16) * 0.1)(Dc, H, D) * (Dc ** -0.5)),
            "w_o": _w((lambda *s: torch.randn(*s, dtype=torch.bfloat16) * 0.1)(H, D, M) * ((H * D) ** -0.5)),
        }
    _B_in = _B_setup()

    return {
        "A_x": _A_in["x"],
        "A_Lambda_re": _A_in["Lambda_re"],
        "A_Lambda_im": _A_in["Lambda_im"],
        "A_B_re": _A_in["B_re"],
        "A_B_im": _A_in["B_im"],
        "A_C_re": _A_in["C_re"],
        "A_C_im": _A_in["C_im"],
        "A_log_dt": _A_in["log_dt"],
        "A_Dskip": _A_in["Dskip"],
        "B_x": _B_in["x"],
        "B_c_kv": _B_in["c_kv"],
        "B_w_q": _B_in["w_q"],
        "B_w_uk": _B_in["w_uk"],
        "B_w_uv": _B_in["w_uv"],
        "B_w_o": _B_in["w_o"],
    }

def reference(A_x, A_Lambda_re, A_Lambda_im, A_B_re, A_B_im, A_C_re, A_C_im, A_log_dt, A_Dskip, B_x, B_c_kv, B_w_q, B_w_uk, B_w_uv, B_w_o):
    def _A_ref(x, Lambda_re, Lambda_im, B_re, B_im, C_re, C_im, log_dt, Dskip):
        Bsz, L, H = x.shape
        Lam = Lambda_re + 1j * Lambda_im
        Bmat = B_re + 1j * B_im
        Cmat = C_re + 1j * C_im
        dt = torch.exp(log_dt)
        Lam_bar = torch.exp(dt * Lam)
        B_bar = ((Lam_bar - 1.0) / Lam)[:, None] * Bmat
        Bu = torch.einsum("bld,pd->blp", x + 0j, B_bar)
        h = torch.zeros_like(Bu[:, 0, :])
        hs = []
        for t in range(L):
            h = Lam_bar[None, :] * h + Bu[:, t, :]
            hs.append(h)
        hseq = torch.stack(hs, 1)
        y = 2.0 * torch.einsum("blp,dp->bld", hseq, Cmat).real + x * Dskip[None, None, :]
        return y

    def _B_ref(x, c_kv, w_q, w_uk, w_uv, w_o):
        B, Sq, M = x.shape[0], x.shape[1], x.shape[2]
        Sk = c_kv.shape[1]
        H, D = w_q.shape[1], w_q.shape[2]
        q = torch.einsum("bqm,mhd->bhqd", x, w_q)
        k = torch.einsum("bkc,chd->bhkd", c_kv, w_uk)
        v = torch.einsum("bkc,chd->bhkd", c_kv, w_uv)
        scores = torch.einsum("bhqd,bhkd->bhqk", q, k) * (D ** -0.5)
        off = Sk - Sq
        qi = torch.arange(Sq)[:, None]
        kj = torch.arange(Sk)[None, :]
        cmask = kj <= (qi + off)
        scores = torch.where(cmask[None, None], scores, -1e9)
        p = _softmax(scores, axis=-1)
        ctx = torch.einsum("bhqk,bhkd->bhqd", p, v)
        return torch.einsum("bhqd,hdm->bqm", ctx, w_o)

    a = _A_ref(A_x, A_Lambda_re, A_Lambda_im, A_B_re, A_B_im, A_C_re, A_C_im, A_log_dt, A_Dskip)
    b = _B_ref(B_x, B_c_kv, B_w_q, B_w_uk, B_w_uv, B_w_o)
    return torch.concatenate([a, b], axis=-1)
```

```asm
; @launch grid=(256,1,1) block=(256,1,1) lds=163840
.amdgcn_target "amdgcn-amd-amdhsa--gfx950"
.text
.p2align 12
KA_base:
.globl concat_heads__ssm_conv_s5__compressed_kv_cla__prompt_kernel
.p2align 8
.type concat_heads__ssm_conv_s5__compressed_kv_cla__prompt_kernel,@function
concat_heads__ssm_conv_s5__compressed_kv_cla__prompt_kernel:
    s_cmp_ge_u32 s2, 256
    s_cbranch_scc1 KA_end
    s_getpc_b64 s[52:53]
KA_pc:
    s_mov_b32 s54, KA_codeend-KA_pc
    s_mov_b32 s55, 0x20000
    s_and_b32 s67, s2, 0xf8
    s_lshl_b32 s67, s67, 4
    v_lshlrev_b32 v30, 12, v0
    buffer_load_dword v64, v30, s[52:55], s67 offen
    s_load_dwordx2 s[4:5], s[0:1], 80
    s_load_dwordx2 s[8:9], s[0:1], 96
    s_load_dwordx2 s[12:13], s[0:1], 104
    s_load_dwordx2 s[16:17], s[0:1], 0
    s_load_dwordx4 s[20:23], s[0:1], 24
    s_load_dwordx2 s[24:25], s[0:1], 72
    s_load_dwordx2 s[28:29], s[0:1], 88
    s_load_dwordx2 s[32:33], s[0:1], 112
    s_load_dwordx4 s[36:39], s[0:1], 40
    s_load_dwordx2 s[40:41], s[0:1], 136
    s_load_dwordx2 s[82:83], s[0:1], 128
    s_load_dwordx4 s[56:59], s[0:1], 8
    s_load_dwordx2 s[60:61], s[0:1], 56
    v_lshlrev_b32 v88, 16, v0
    v_lshrrev_b32 v30, 6, v0
    v_and_b32 v0, 63, v0
    v_readfirstlane_b32 s62, v30
    s_and_b32 s67, s2, 7
    s_lshr_b32 s68, s2, 3
    s_add_u32 s69, s68, 0
    s_and_b32 s69, s69, 3
    s_lshl_b32 s63, s67, 2
    s_add_u32 s63, s63, s69
    s_lshr_b32 s64, s68, 2
    s_lshl_b32 s71, s62, 12
    v_lshrrev_b32 v30, 5, v0
    v_lshlrev_b32 v30, 1, v30
    v_and_b32 v31, 3, v0
    v_xor_b32 v30, v30, v31
    v_lshlrev_b32 v30, 4, v30
    v_lshrrev_b32 v31, 2, v0
    v_lshl_add_u32 v4, v31, 13, v30
    v_lshl_add_u32 v1, v31, 10, v30
    s_and_b32 s67, s63, 1
    s_lshl_b32 s67, s67, 17
    s_lshl_b32 s72, s64, 18
    s_add_u32 s72, s72, s67
    s_xor_b32 s100, s72, 0x20000
    s_lshl_b32 s67, s62, 15
    s_add_u32 s72, s72, s67
    s_lshl_b32 s73, s62, 17
    s_lshl_b32 s67, s63, 8
    s_add_u32 s73, s73, s67
    s_and_b32 s67, s63, 3
    s_cmp_eq_u32 s67, 1
    s_mov_b32 s96, 0x64206420
    s_cselect_b32 s96, s96, 0x30630630
    s_lshl_b32 s67, s64, 2
    s_lshr_b32 s96, s96, s67
    s_bfe_u32 s67, s63, 65537
    s_mul_i32 s67, s67, 4
    s_add_u32 s96, s96, s67
    s_lshr_b32 s67, s63, 2
    s_mul_i32 s67, s67, 1
    s_add_u32 s96, s96, s67
    s_and_b32 s96, s96, 7
    s_lshl_b32 s96, s96, 7
    s_lshr_b32 s67, s62, 1
    s_lshl_b32 s67, s67, 14
    s_add_u32 s100, s100, s67
    s_and_b32 s67, s62, 1
    s_lshl_b32 s67, s67, 8
    s_add_u32 s67, s67, s96
    s_and_b32 s68, s67, 1023
    s_add_u32 s99, s100, s68
    s_addk_i32 s67, 128
    s_and_b32 s67, s67, 1023
    s_add_u32 s100, s100, s67
    s_mov_b32 s6, 2097152
    s_mov_b32 s7, 0x20000
    s_mov_b32 s10, 4194304
    s_mov_b32 s11, 0x20000
    s_mov_b32 s14, 4194304
    s_mov_b32 s15, 0x20000
    s_waitcnt lgkmcnt(0)
    s_add_u32 s79, s72, s96
    s_add_u32 m0, s71, 0
    s_nop 0
    buffer_load_dwordx4 v1, s[4:7], s79 offen lds
    s_addk_i32 m0, 960
    s_nop 0
    buffer_load_dwordx4 v1, s[4:7], s79 offen offset:64 lds
    s_addk_i32 s79, 16384
    s_addk_i32 m0, 1088
    s_nop 0
    buffer_load_dwordx4 v1, s[4:7], s79 offen lds
    s_addk_i32 m0, 960
    s_nop 0
    buffer_load_dwordx4 v1, s[4:7], s79 offen offset:64 lds
    s_lshl_b32 s79, s96, 12
    s_add_u32 s79, s79, s73
    s_addk_i32 m0, 13376
    s_nop 0
    buffer_load_dwordx4 v4, s[8:11], s79 offen lds
    s_addk_i32 m0, 960
    s_nop 0
    buffer_load_dwordx4 v4, s[8:11], s79 offen offset:64 lds
    s_addk_i32 m0, 960
    s_nop 0
    buffer_load_dwordx4 v4, s[8:11], s79 offen offset:128 lds
    s_addk_i32 m0, 960
    s_nop 0
    buffer_load_dwordx4 v4, s[8:11], s79 offen offset:192 lds
    s_addk_i32 m0, 13504
    s_nop 0
    buffer_load_dwordx4 v4, s[12:15], s79 offen lds
    s_addk_i32 m0, 960
    s_nop 0
    buffer_load_dwordx4 v4, s[12:15], s79 offen offset:64 lds
    s_addk_i32 m0, 960
    s_nop 0
    buffer_load_dwordx4 v4, s[12:15], s79 offen offset:128 lds
    s_addk_i32 m0, 960
    s_nop 0
    buffer_load_dwordx4 v4, s[12:15], s79 offen offset:192 lds
    s_and_b32 s67, s2, 7
    s_lshr_b32 s68, s2, 3
    s_lshr_b32 s65, s67, 1
    s_lshl_b32 s65, s65, 2
    s_lshr_b32 s69, s68, 3
    s_add_u32 s65, s65, s69
    s_and_b32 s66, s67, 1
    s_lshl_b32 s66, s66, 3
    s_and_b32 s69, s68, 7
    s_add_u32 s66, s66, s69
    v_and_b32 v30, 15, v0
    s_and_b32 s69, s62, 1
    s_lshl_b32 s69, s69, 4
    s_lshl_b32 s70, s66, 5
    s_add_u32 s69, s69, s70
    v_add_lshl_u32 v31, v30, s69, 1
    global_load_ushort v28, v31, s[56:57]
    global_load_ushort v29, v31, s[58:59]
    global_load_ushort v26, v31, s[60:61]
    s_add_u32 s48, s40, 71368704
    s_addc_u32 s49, s41, 0
    s_mov_b32 s50, 32768
    s_mov_b32 s51, 0x20000
    v_lshlrev_b32 v22, 4, v0
    v_mov_b32 v80, 0
    v_mov_b32 v81, 0
    v_mov_b32 v82, 0
    v_mov_b32 v83, 0
    s_lshl_b32 s67, s2, 2
    s_add_u32 s67, s67, s62
    s_lshl_b32 s67, s67, 10
    buffer_store_dwordx4 v[80:83], v22, s[48:51], s67 offen sc1
    s_mov_b32 s56, s82
    s_mov_b32 s57, s83
    s_cmp_eq_u32 s62, 0
    s_cselect_b32 s83, 1, 0
    s_cselect_b32 s58, 32, 0
    s_cselect_b32 s50, 32768, 0
    s_mov_b32 s59, 0x20000
    v_mov_b32 v89, 1
    s_mov_b32 s3, 0
    s_cmp_ge_u32 s62, 2
    s_cselect_b32 s20, s22, s20
    s_cselect_b32 s21, s23, s21
    s_bitcmp1_b32 s62, 0
    s_cselect_b32 s36, s38, s36
    s_cselect_b32 s37, s39, s37
    s_mov_b32 s18, 2097152
    s_mov_b32 s19, 0x20000
    s_mov_b32 s22, 524288
    s_mov_b32 s23, 0x20000
    s_mov_b32 s26, 2097152
    s_mov_b32 s27, 0x20000
    s_mov_b32 s30, 4194304
    s_mov_b32 s31, 0x20000
    s_mov_b32 s34, 4194304
    s_mov_b32 s35, 0x20000
    s_mov_b32 s38, 524288
    s_mov_b32 s39, 0x20000
    s_mov_b32 s42, 71401472
    s_mov_b32 s43, 0x20000
    s_mov_b32 s54, 65536
    s_mov_b32 s55, 0x20000
    s_add_u32 s52, s40, 71303168
    s_addc_u32 s53, s41, 0
    s_mul_i32 s74, s63, 1081344
    s_add_u32 s44, s40, s74
    s_addc_u32 s45, s41, 0
    s_lshl_b32 s67, s64, 16
    s_sub_u32 s46, 1048576, s67
    s_and_b32 s67, s62, 1
    s_lshl_b32 s67, s67, 15
    s_add_u32 s46, s46, s67
    s_mov_b32 s47, 0x20000
    s_lshl_b32 s67, s64, 17
    s_add_u32 s74, s74, s67
    s_and_b32 s67, s63, 1
    s_lshl_b32 s67, s67, 16
    s_sub_u32 s101, s74, s67
    s_add_u32 s74, s74, s67
    s_add_u32 s97, s65, s66
    s_mul_i32 s97, s97, 1
    s_and_b32 s97, s97, 3
    s_lshl_b32 s97, s97, 8
    s_mul_i32 s98, s64, 4
    s_mul_i32 s67, s63, 4
    s_add_u32 s98, s98, s67
    s_lshr_b32 s67, s63, 2
    s_mul_i32 s67, s67, 1
    s_add_u32 s98, s98, s67
    s_and_b32 s98, s98, 7
    s_lshl_b32 s98, s98, 7
    s_lshl_b32 s75, s65, 17
    s_lshr_b32 s67, s62, 1
    s_lshl_b32 s67, s67, 16
    s_add_u32 s75, s75, s67
    s_and_b32 s67, s62, 1
    s_lshl_b32 s68, s67, 13
    s_add_u32 s75, s75, s68
    s_lshl_b32 s76, s66, 15
    s_lshl_b32 s68, s67, 14
    s_add_u32 s76, s76, s68
    s_lshl_b32 s67, s62, 15
    s_sub_u32 s94, 114688, s67
    s_lshl_b32 s67, s62, 14
    s_lshl_b32 s77, s64, 17
    s_sub_u32 s78, 1966080, s77
    s_add_u32 s77, s77, s67
    s_add_u32 s78, s78, s67
    s_mov_b32 s95, 0x3e0293ee
    s_mov_b32 s82, 0x59800000
    v_lshrrev_b32 v31, 4, v0
    v_mul_u32_u24 v3, 12288, v31
    v_add_u32 v3, v3, v1
    s_lshr_b32 s67, s62, 1
    s_lshl_b32 s67, s67, 2
    v_add_u32 v23, s67, v31
    v_bfe_u32 v5, v0, 3, 1
    v_lshlrev_b32 v5, 1, v5
    v_xor_b32 v5, v5, v31
    v_lshl_add_u32 v5, v30, 2, v5
    v_lshlrev_b32 v5, 4, v5
    v_add_u32 v6, 0x10000, v5
    v_add_u32 v7, 0x20000, v5
    v_lshrrev_b32 v14, 5, v0
    v_lshlrev_b32 v14, 12, v14
    v_bfe_u32 v15, v0, 4, 1
    v_mul_u32_u24 v15, 544, v15
    v_add_u32 v14, v14, v15
    v_bfe_u32 v15, v0, 2, 2
    v_lshl_add_u32 v14, v15, 6, v14
    v_and_b32 v15, 3, v0
    v_lshl_add_u32 v14, v15, 3, v14
    s_lshl_b32 s67, s62, 10
    v_add_u32 v14, s67, v14
    v_add_u32 v15, 0x10000, v14
    v_add_u32 v16, 0x20000, v14
    v_xor_b32 v17, 32, v14
    v_xor_b32 v18, 32, v15
    v_xor_b32 v19, 32, v16
    s_lshr_b32 s67, s62, 1
    s_lshl_b32 s67, s67, 13
    v_add_u32 v8, s67, v5
    v_add_u32 v9, s67, v6
    v_add_u32 v10, s67, v7
    s_and_b32 s67, s62, 1
    s_lshl_b32 s67, s67, 12
    v_add_u32 v11, s67, v5
    v_add_u32 v12, s67, v6
    v_add_u32 v13, s67, v7
    v_lshl_add_u32 v20, s62, 10, v22
    v_add_u32 v2, 4096, v20
    v_lshl_add_u32 v21, s62, 11, v22
    v_add_u32 v21, 40960, v21
    s_addk_i32 s96, 128
    s_and_b32 s96, s96, 1023
    s_add_u32 s79, s72, s96
    s_addk_i32 m0, 13504
    s_nop 0
    buffer_load_dwordx4 v1, s[4:7], s79 offen lds
    s_addk_i32 m0, 960
    s_nop 0
    buffer_load_dwordx4 v1, s[4:7], s79 offen offset:64 lds
    s_addk_i32 s79, 16384
    s_addk_i32 m0, 1088
    s_nop 0
    buffer_load_dwordx4 v1, s[4:7], s79 offen lds
    s_addk_i32 m0, 960
    s_nop 0
    buffer_load_dwordx4 v1, s[4:7], s79 offen offset:64 lds
HOPSITE:
    s_mov_b64 exec, 0
    s_cmp_eq_u32 s62, 0
    s_cbranch_scc1 PG_0
    s_cmp_eq_u32 s62, 1
    s_cbranch_scc1 PG_1
    s_cmp_eq_u32 s62, 2
    s_cbranch_scc1 PG_2
    s_branch PG_3
PG_done:
    s_mov_b64 exec, -1
    s_lshl_b32 s79, s96, 12
    s_add_u32 s79, s79, s73
    s_add_u32 m0, s71, 65536
    s_nop 0
    buffer_load_dwordx4 v4, s[8:11], s79 offen lds
    s_addk_i32 m0, 960
    s_nop 0
    buffer_load_dwordx4 v4, s[8:11], s79 offen offset:64 lds
    s_addk_i32 m0, 960
    s_nop 0
    buffer_load_dwordx4 v4, s[8:11], s79 offen offset:128 lds
    s_addk_i32 m0, 960
    s_nop 0
    buffer_load_dwordx4 v4, s[8:11], s79 offen offset:192 lds
    s_addk_i32 m0, 13504
    s_nop 0
    buffer_load_dwordx4 v4, s[12:15], s79 offen lds
    s_addk_i32 m0, 960
    s_nop 0
    buffer_load_dwordx4 v4, s[12:15], s79 offen offset:64 lds
    s_addk_i32 m0, 960
    s_nop 0
    buffer_load_dwordx4 v4, s[12:15], s79 offen offset:128 lds
    s_addk_i32 m0, 960
    s_nop 0
    buffer_load_dwordx4 v4, s[12:15], s79 offen offset:192 lds
    s_branch KA_main
KA_pad:
.fill ((2880 - (KA_pad - KA_base)) & 4095) / 4, 4, 0xbf800000
KA_main:
    s_waitcnt vmcnt(16)
    s_barrier
    ds_read_b128 v[32:35], v5 offset:0
    ds_read_b64_tr_b16 a[0:1], v14 offset:16384
    ds_read_b64_tr_b16 a[2:3], v14 offset:16640
    ds_read_b128 v[36:39], v5 offset:1024
    ds_read_b64_tr_b16 a[16:17], v14 offset:24576
    ds_read_b64_tr_b16 a[18:19], v14 offset:24832
    ds_read_b64_tr_b16 a[20:21], v17 offset:24576
    ds_read_b64_tr_b16 a[22:23], v17 offset:24832
    ds_read_b64_tr_b16 a[4:5], v17 offset:16384
    ds_read_b64_tr_b16 a[6:7], v17 offset:16640
    ds_read_b64_tr_b16 a[8:9], v14 offset:32768
    ds_read_b64_tr_b16 a[10:11], v14 offset:33024
    ds_read_b64_tr_b16 a[24:25], v14 offset:40960
    ds_read_b64_tr_b16 a[26:27], v14 offset:41216
    s_waitcnt lgkmcnt(11)
    v_mfma_f32_16x16x32_bf16 v[96:99], a[0:3], v[32:35], 0
    ds_read_b64_tr_b16 a[28:29], v17 offset:40960
    ds_read_b64_tr_b16 a[30:31], v17 offset:41216
    ds_read_b64_tr_b16 a[12:13], v17 offset:32768
    ds_read_b64_tr_b16 a[14:15], v17 offset:33024
    s_waitcnt lgkmcnt(12)
    v_mfma_f32_16x16x32_bf16 v[96:99], a[16:19], v[36:39], v[96:99]
    ds_read_b128 v[40:43], v5 offset:2048
    ds_read_b128 v[44:47], v5 offset:3072
    s_waitcnt lgkmcnt(12)
    v_mfma_f32_16x16x32_bf16 v[100:103], a[20:23], v[36:39], 0
    ds_read_b128 v[48:51], v5 offset:4096
    ds_read_b128 v[52:55], v5 offset:5120
    s_waitcnt lgkmcnt(12)
    v_mfma_f32_16x16x32_bf16 v[100:103], a[4:7], v[32:35], v[100:103]
    ds_read_b128 v[56:59], v5 offset:6144
    ds_read_b128 v[60:63], v5 offset:7168
    s_waitcnt lgkmcnt(12)
    v_mfma_f32_16x16x32_bf16 v[112:115], v[32:35], a[8:11], 0
    s_waitcnt lgkmcnt(10)
    v_mfma_f32_16x16x32_bf16 v[112:115], v[36:39], a[24:27], v[112:115]
    s_waitcnt lgkmcnt(8)
    v_mfma_f32_16x16x32_bf16 v[120:123], v[36:39], a[28:31], 0
    s_waitcnt lgkmcnt(6)
    v_mfma_f32_16x16x32_bf16 v[120:123], v[32:35], a[12:15], v[120:123]
    s_waitcnt lgkmcnt(4)
    ds_read_b128 v[32:35], v5 offset:8192
    ds_read_b128 v[36:39], v5 offset:9216
    v_mfma_f32_16x16x32_bf16 v[124:127], v[40:43], a[12:15], 0
    v_mfma_f32_16x16x32_bf16 v[124:127], v[44:47], a[28:31], v[124:127]
    v_mfma_f32_16x16x32_bf16 v[116:119], v[44:47], a[24:27], 0
    v_mfma_f32_16x16x32_bf16 v[116:119], v[40:43], a[8:11], v[116:119]
    v_mfma_f32_16x16x32_bf16 v[108:111], a[4:7], v[40:43], 0
    v_mfma_f32_16x16x32_bf16 v[108:111], a[20:23], v[44:47], v[108:111]
    v_mfma_f32_16x16x32_bf16 v[104:107], a[16:19], v[44:47], 0
    v_mfma_f32_16x16x32_bf16 v[104:107], a[0:3], v[40:43], v[104:107]
    s_waitcnt lgkmcnt(4)
    ds_read_b128 v[40:43], v5 offset:10240
    ds_read_b128 v[44:47], v5 offset:11264
    v_mfma_f32_16x16x32_bf16 v[128:131], a[0:3], v[48:51], 0
    v_mfma_f32_16x16x32_bf16 v[128:131], a[16:19], v[52:55], v[128:131]
    v_mfma_f32_16x16x32_bf16 v[132:135], a[20:23], v[52:55], 0
    v_mfma_f32_16x16x32_bf16 v[132:135], a[4:7], v[48:51], v[132:135]
    v_mfma_f32_16x16x32_bf16 v[144:147], v[48:51], a[8:11], 0
    v_mfma_f32_16x16x32_bf16 v[144:147], v[52:55], a[24:27], v[144:147]
    v_mfma_f32_16x16x32_bf16 v[152:155], v[52:55], a[28:31], 0
    v_mfma_f32_16x16x32_bf16 v[152:155], v[48:51], a[12:15], v[152:155]
    s_waitcnt lgkmcnt(4)
    ds_read_b128 v[48:51], v5 offset:12288
    ds_read_b128 v[52:55], v5 offset:13312
    v_mfma_f32_16x16x32_bf16 v[156:159], v[56:59], a[12:15], 0
    v_mfma_f32_16x16x32_bf16 v[156:159], v[60:63], a[28:31], v[156:159]
    v_mfma_f32_16x16x32_bf16 v[148:151], v[60:63], a[24:27], 0
    v_mfma_f32_16x16x32_bf16 v[148:151], v[56:59], a[8:11], v[148:151]
    s_addk_i32 s96, 128
    s_and_b32 s96, s96, 1023
    s_add_u32 s79, s72, s96
    v_mfma_f32_16x16x32_bf16 v[140:143], a[4:7], v[56:59], 0
    s_add_u32 m0, s71, 98304
    v_mfma_f32_16x16x32_bf16 v[140:143], a[20:23], v[60:63], v[140:143]
    v_mfma_f32_16x16x32_bf16 v[136:139], a[16:19], v[60:63], 0
    buffer_load_dwordx4 v1, s[4:7], s79 offen lds
    s_addk_i32 m0, 960
    v_mfma_f32_16x16x32_bf16 v[136:139], a[0:3], v[56:59], v[136:139]
    s_waitcnt lgkmcnt(4)
    ds_read_b128 v[56:59], v5 offset:14336
    ds_read_b128 v[60:63], v5 offset:15360
    v_mfma_f32_16x16x32_bf16 v[160:163], a[0:3], v[32:35], 0
    buffer_load_dwordx4 v1, s[4:7], s79 offen offset:64 lds
    v_mfma_f32_16x16x32_bf16 v[160:163], a[16:19], v[36:39], v[160:163]
    s_addk_i32 s79, 16384
    s_addk_i32 m0, 1088
    v_mfma_f32_16x16x32_bf16 v[164:167], a[20:23], v[36:39], 0
    v_mfma_f32_16x16x32_bf16 v[164:167], a[4:7], v[32:35], v[164:167]
    buffer_load_dwordx4 v1, s[4:7], s79 offen lds
    s_addk_i32 m0, 960
    v_mfma_f32_16x16x32_bf16 v[176:179], v[32:35], a[8:11], 0
    v_mfma_f32_16x16x32_bf16 v[176:179], v[36:39], a[24:27], v[176:179]
    buffer_load_dwordx4 v1, s[4:7], s79 offen offset:64 lds
    v_mfma_f32_16x16x32_bf16 v[184:187], v[36:39], a[28:31], 0
    s_lshl_b32 s79, s96, 12
    s_add_u32 s79, s79, s73
    s_addk_i32 m0, 13376
    v_mfma_f32_16x16x32_bf16 v[184:187], v[32:35], a[12:15], v[184:187]
    s_waitcnt lgkmcnt(4)
    v_mfma_f32_16x16x32_bf16 v[188:191], v[40:43], a[12:15], 0
    buffer_load_dwordx4 v4, s[8:11], s79 offen lds
    s_addk_i32 m0, 960
    v_mfma_f32_16x16x32_bf16 v[188:191], v[44:47], a[28:31], v[188:191]
    v_mfma_f32_16x16x32_bf16 v[180:183], v[44:47], a[24:27], 0
    buffer_load_dwordx4 v4, s[8:11], s79 offen offset:64 lds
    v_mfma_f32_16x16x32_bf16 v[180:183], v[40:43], a[8:11], v[180:183]
    s_addk_i32 m0, 960
    v_mfma_f32_16x16x32_bf16 v[172:175], a[4:7], v[40:43], 0
    v_mfma_f32_16x16x32_bf16 v[172:175], a[20:23], v[44:47], v[172:175]
    buffer_load_dwordx4 v4, s[8:11], s79 offen offset:128 lds
    s_addk_i32 m0, 960
    s_waitcnt vmcnt(7) lgkmcnt(0)
    s_barrier
    v_mfma_f32_16x16x32_bf16 v[168:171], a[16:19], v[44:47], 0
    ds_read_b128 v[32:35], v5 offset:49152
    v_lshl_add_u32 v90, s2, 2, v88
    v_mfma_f32_16x16x32_bf16 v[168:171], a[0:3], v[40:43], v[168:171]
    buffer_load_dwordx4 v4, s[8:11], s79 offen offset:192 lds
    v_mfma_f32_16x16x32_bf16 v[192:195], a[0:3], v[48:51], 0
    buffer_store_dword v89, v90, s[56:59], 0 offen sc1
    s_addk_i32 m0, 13504
    v_mfma_f32_16x16x32_bf16 v[192:195], a[16:19], v[52:55], v[192:195]
    ds_read_b64_tr_b16 a[32:33], v15 offset:0
    ds_read_b64_tr_b16 a[34:35], v15 offset:256
    v_mfma_f32_16x16x32_bf16 v[196:199], a[20:23], v[52:55], 0
    buffer_load_dwordx4 v4, s[12:15], s79 offen lds
    s_addk_i32 m0, 960
    v_mfma_f32_16x16x32_bf16 v[196:199], a[4:7], v[48:51], v[196:199]
    ds_read_b128 v[36:39], v5 offset:50176
    ds_read_b64_tr_b16 a[48:49], v15 offset:8192
    v_mfma_f32_16x16x32_bf16 v[208:211], v[48:51], a[8:11], 0
    buffer_load_dwordx4 v4, s[12:15], s79 offen offset:64 lds
    v_mfma_f32_16x16x32_bf16 v[208:211], v[52:55], a[24:27], v[208:211]
    s_addk_i32 m0, 960
    ds_read_b64_tr_b16 a[50:51], v15 offset:8448
    ds_read_b64_tr_b16 a[52:53], v18 offset:8192
    v_mfma_f32_16x16x32_bf16 v[216:219], v[52:55], a[28:31], 0
    ds_read_b64_tr_b16 a[54:55], v18 offset:8448
    ds_read_b64_tr_b16 a[36:37], v18 offset:0
    v_mfma_f32_16x16x32_bf16 v[216:219], v[48:51], a[12:15], v[216:219]
    buffer_load_dwordx4 v4, s[12:15], s79 offen offset:128 lds
    s_addk_i32 m0, 960
    v_mfma_f32_16x16x32_bf16 v[220:223], v[56:59], a[12:15], 0
    ds_read_b64_tr_b16 a[38:39], v18 offset:256
    ds_read_b64_tr_b16 a[40:41], v15 offset:16384
    v_mfma_f32_16x16x32_bf16 v[220:223], v[60:63], a[28:31], v[220:223]
    buffer_load_dwordx4 v4, s[12:15], s79 offen offset:192 lds
    v_mfma_f32_16x16x32_bf16 v[212:215], v[60:63], a[24:27], 0
    ds_read_b64_tr_b16 a[42:43], v15 offset:16640
    ds_read_b64_tr_b16 a[56:57], v15 offset:24576
    ds_read_b64_tr_b16 a[58:59], v15 offset:24832
    ds_read_b64_tr_b16 a[60:61], v18 offset:24576
    ds_read_b64_tr_b16 a[62:63], v18 offset:24832
    ds_read_b64_tr_b16 a[44:45], v18 offset:16384
    ds_read_b64_tr_b16 a[46:47], v18 offset:16640
    v_mfma_f32_16x16x32_bf16 v[212:215], v[56:59], a[8:11], v[212:215]
    ds_read_b128 v[40:43], v5 offset:51200
    ds_read_b128 v[44:47], v5 offset:52224
    v_mfma_f32_16x16x32_bf16 v[204:207], a[4:7], v[56:59], 0
    ds_read_b128 v[48:51], v5 offset:53248
    ds_read_b128 v[52:55], v5 offset:54272
    v_mfma_f32_16x16x32_bf16 v[204:207], a[20:23], v[60:63], v[204:207]
    v_mfma_f32_16x16x32_bf16 v[200:203], a[16:19], v[60:63], 0
    v_mfma_f32_16x16x32_bf16 v[200:203], a[0:3], v[56:59], v[200:203]
    s_waitcnt lgkmcnt(4)
    ds_read_b128 v[56:59], v5 offset:55296
    ds_read_b128 v[60:63], v5 offset:56320
    v_mfma_f32_16x16x32_bf16 v[96:99], a[32:35], v[32:35], v[96:99]
PG_0:
    s_cbranch_execz PG_4
    v_mfma_f32_16x16x32_bf16 v[96:99], a[48:51], v[36:39], v[96:99]
    s_addk_i32 s96, 128
    s_and_b32 s96, s96, 1023
    s_add_u32 s79, s72, s96
    v_mfma_f32_16x16x32_bf16 v[100:103], a[52:55], v[36:39], v[100:103]
    s_addk_i32 m0, 13504
    v_mfma_f32_16x16x32_bf16 v[100:103], a[36:39], v[32:35], v[100:103]
    v_mfma_f32_16x16x32_bf16 v[112:115], v[32:35], a[40:43], v[112:115]
    buffer_load_dwordx4 v1, s[4:7], s79 offen lds
    v_mfma_f32_16x16x32_bf16 v[112:115], v[36:39], a[56:59], v[112:115]
    s_addk_i32 m0, 960
    v_mfma_f32_16x16x32_bf16 v[120:123], v[36:39], a[60:63], v[120:123]
    v_mfma_f32_16x16x32_bf16 v[120:123], v[32:35], a[44:47], v[120:123]
    s_waitcnt lgkmcnt(4)
    ds_read_b128 v[32:35], v5 offset:57344
    ds_read_b128 v[36:39], v5 offset:58368
    v_mfma_f32_16x16x32_bf16 v[124:127], v[40:43], a[44:47], v[124:127]
    buffer_load_dwordx4 v1, s[4:7], s79 offen offset:64 lds
    s_addk_i32 s79, 16384
    s_addk_i32 m0, 1088
    v_mfma_f32_16x16x32_bf16 v[124:127], v[44:47], a[60:63], v[124:127]
    v_mfma_f32_16x16x32_bf16 v[116:119], v[44:47], a[56:59], v[116:119]
    buffer_load_dwordx4 v1, s[4:7], s79 offen lds
    v_mfma_f32_16x16x32_bf16 v[116:119], v[40:43], a[40:43], v[116:119]
    s_addk_i32 m0, 960
    v_mfma_f32_16x16x32_bf16 v[108:111], a[36:39], v[40:43], v[108:111]
    v_mfma_f32_16x16x32_bf16 v[108:111], a[52:55], v[44:47], v[108:111]
    buffer_load_dwordx4 v1, s[4:7], s79 offen offset:64 lds
    v_mfma_f32_16x16x32_bf16 v[104:107], a[48:51], v[44:47], v[104:107]
    s_lshl_b32 s79, s96, 12
    s_add_u32 s79, s79, s73
    s_add_u32 m0, s71, 0
    v_mfma_f32_16x16x32_bf16 v[104:107], a[32:35], v[40:43], v[104:107]
    s_waitcnt lgkmcnt(4)
    ds_read_b128 v[40:43], v5 offset:59392
    ds_read_b128 v[44:47], v5 offset:60416
    v_mfma_f32_16x16x32_bf16 v[128:131], a[32:35], v[48:51], v[128:131]
    buffer_load_dwordx4 v4, s[8:11], s79 offen lds
    v_mfma_f32_16x16x32_bf16 v[128:131], a[48:51], v[52:55], v[128:131]
    s_addk_i32 m0, 960
    v_mfma_f32_16x16x32_bf16 v[132:135], a[52:55], v[52:55], v[132:135]
    v_mfma_f32_16x16x32_bf16 v[132:135], a[36:39], v[48:51], v[132:135]
    buffer_load_dwordx4 v4, s[8:11], s79 offen offset:64 lds
    v_mfma_f32_16x16x32_bf16 v[144:147], v[48:51], a[40:43], v[144:147]
    s_addk_i32 m0, 960
    v_mfma_f32_16x16x32_bf16 v[144:147], v[52:55], a[56:59], v[144:147]
    v_mfma_f32_16x16x32_bf16 v[152:155], v[52:55], a[60:63], v[152:155]
    buffer_load_dwordx4 v4, s[8:11], s79 offen offset:128 lds
    v_mfma_f32_16x16x32_bf16 v[152:155], v[48:51], a[44:47], v[152:155]
    s_waitcnt lgkmcnt(4)
    s_addk_i32 m0, 960
    ds_read_b128 v[48:51], v5 offset:61440
    v_mfma_f32_16x16x32_bf16 v[156:159], v[56:59], a[44:47], v[156:159]
    ds_read_b128 v[52:55], v5 offset:62464
    v_mfma_f32_16x16x32_bf16 v[156:159], v[60:63], a[60:63], v[156:159]
    buffer_load_dwordx4 v4, s[8:11], s79 offen offset:192 lds
    v_mfma_f32_16x16x32_bf16 v[148:151], v[60:63], a[56:59], v[148:151]
    s_addk_i32 m0, 13504
    v_mfma_f32_16x16x32_bf16 v[148:151], v[56:59], a[40:43], v[148:151]
    v_mfma_f32_16x16x32_bf16 v[140:143], a[36:39], v[56:59], v[140:143]
    buffer_load_dwordx4 v4, s[12:15], s79 offen lds
    v_mfma_f32_16x16x32_bf16 v[140:143], a[52:55], v[60:63], v[140:143]
    s_addk_i32 m0, 960
    v_mfma_f32_16x16x32_bf16 v[136:139], a[48:51], v[60:63], v[136:139]
    v_mfma_f32_16x16x32_bf16 v[136:139], a[32:35], v[56:59], v[136:139]
    s_waitcnt lgkmcnt(4)
    ds_read_b128 v[56:59], v5 offset:63488
    ds_read_b128 v[60:63], v5 offset:64512
    v_mfma_f32_16x16x32_bf16 v[160:163], a[32:35], v[32:35], v[160:163]
    buffer_load_dwordx4 v4, s[12:15], s79 offen offset:64 lds
    v_mfma_f32_16x16x32_bf16 v[160:163], a[48:51], v[36:39], v[160:163]
    s_addk_i32 m0, 960
    v_mfma_f32_16x16x32_bf16 v[164:167], a[52:55], v[36:39], v[164:167]
    v_mfma_f32_16x16x32_bf16 v[164:167], a[36:39], v[32:35], v[164:167]
    buffer_load_dwordx4 v4, s[12:15], s79 offen offset:128 lds
    v_mfma_f32_16x16x32_bf16 v[176:179], v[32:35], a[40:43], v[176:179]
    s_addk_i32 m0, 960
    v_mfma_f32_16x16x32_bf16 v[176:179], v[36:39], a[56:59], v[176:179]
    v_mfma_f32_16x16x32_bf16 v[184:187], v[36:39], a[60:63], v[184:187]
    buffer_load_dwordx4 v4, s[12:15], s79 offen offset:192 lds
    v_mfma_f32_16x16x32_bf16 v[184:187], v[32:35], a[44:47], v[184:187]
    s_waitcnt lgkmcnt(4)
    v_mfma_f32_16x16x32_bf16 v[188:191], v[40:43], a[44:47], v[188:191]
    v_mfma_f32_16x16x32_bf16 v[188:191], v[44:47], a[60:63], v[188:191]
    v_mfma_f32_16x16x32_bf16 v[180:183], v[44:47], a[56:59], v[180:183]
    v_mfma_f32_16x16x32_bf16 v[180:183], v[40:43], a[40:43], v[180:183]
    v_mfma_f32_16x16x32_bf16 v[172:175], a[36:39], v[40:43], v[172:175]
    v_mfma_f32_16x16x32_bf16 v[172:175], a[52:55], v[44:47], v[172:175]
    s_waitcnt vmcnt(12) lgkmcnt(0)
    s_barrier
    v_mfma_f32_16x16x32_bf16 v[168:171], a[48:51], v[44:47], v[168:171]
    s_addk_i32 s96, 128
    s_and_b32 s96, s96, 1023
    s_add_u32 s79, s72, s96
    v_mfma_f32_16x16x32_bf16 v[168:171], a[32:35], v[40:43], v[168:171]
    s_addk_i32 m0, 13504
    ds_read_b128 v[32:35], v6 offset:32768
    ds_read_b64_tr_b16 a[64:65], v15 offset:49152
    v_mfma_f32_16x16x32_bf16 v[192:195], a[32:35], v[48:51], v[192:195]
    ds_read_b64_tr_b16 a[66:67], v15 offset:49408
    ds_read_b128 v[36:39], v6 offset:33792
    v_mfma_f32_16x16x32_bf16 v[192:195], a[48:51], v[52:55], v[192:195]
    buffer_load_dwordx4 v1, s[4:7], s79 offen lds
    v_mfma_f32_16x16x32_bf16 v[196:199], a[52:55], v[52:55], v[196:199]
    s_addk_i32 m0, 960
    ds_read_b64_tr_b16 a[80:81], v15 offset:57344
    ds_read_b64_tr_b16 a[82:83], v15 offset:57600
    v_mfma_f32_16x16x32_bf16 v[196:199], a[36:39], v[48:51], v[196:199]
    ds_read_b64_tr_b16 a[84:85], v18 offset:57344
    ds_read_b64_tr_b16 a[86:87], v18 offset:57600
    v_mfma_f32_16x16x32_bf16 v[208:211], v[48:51], a[40:43], v[208:211]
    buffer_load_dwordx4 v1, s[4:7], s79 offen offset:64 lds
    v_mfma_f32_16x16x32_bf16 v[208:211], v[52:55], a[56:59], v[208:211]
    s_addk_i32 s79, 16384
    s_addk_i32 m0, 1088
    ds_read_b64_tr_b16 a[68:69], v18 offset:49152
    v_mfma_f32_16x16x32_bf16 v[216:219], v[52:55], a[60:63], v[216:219]
    ds_read_b64_tr_b16 a[70:71], v18 offset:49408
    ds_read_b64_tr_b16 a[72:73], v16 offset:0
    v_mfma_f32_16x16x32_bf16 v[216:219], v[48:51], a[44:47], v[216:219]
    buffer_load_dwordx4 v1, s[4:7], s79 offen lds
    v_mfma_f32_16x16x32_bf16 v[220:223], v[56:59], a[44:47], v[220:223]
    s_addk_i32 m0, 960
    ds_read_b64_tr_b16 a[74:75], v16 offset:256
    ds_read_b64_tr_b16 a[88:89], v16 offset:8192
    v_mfma_f32_16x16x32_bf16 v[220:223], v[60:63], a[60:63], v[220:223]
    ds_read_b64_tr_b16 a[90:91], v16 offset:8448
    ds_read_b64_tr_b16 a[92:93], v19 offset:8192
    v_mfma_f32_16x16x32_bf16 v[212:215], v[60:63], a[56:59], v[212:215]
    ds_read_b64_tr_b16 a[94:95], v19 offset:8448
    ds_read_b64_tr_b16 a[76:77], v19 offset:0
    ds_read_b64_tr_b16 a[78:79], v19 offset:256
    v_mfma_f32_16x16x32_bf16 v[212:215], v[56:59], a[40:43], v[212:215]
    buffer_load_dwordx4 v1, s[4:7], s79 offen offset:64 lds
    v_mfma_f32_16x16x32_bf16 v[204:207], a[36:39], v[56:59], v[204:207]
    s_lshl_b32 s79, s96, 12
    s_add_u32 s79, s79, s73
    s_addk_i32 m0, 13376
    v_mfma_f32_16x16x32_bf16 v[204:207], a[52:55], v[60:63], v[204:207]
    ds_read_b128 v[40:43], v6 offset:34816
    ds_read_b128 v[44:47], v6 offset:35840
    v_mfma_f32_16x16x32_bf16 v[200:203], a[48:51], v[60:63], v[200:203]
    buffer_load_dwordx4 v4, s[8:11], s79 offen lds
    v_mfma_f32_16x16x32_bf16 v[200:203], a[32:35], v[56:59], v[200:203]
    s_waitcnt lgkmcnt(2)
    s_addk_i32 m0, 960
    ds_read_b128 v[48:51], v6 offset:36864
    v_mfma_f32_16x16x32_bf16 v[96:99], a[64:67], v[32:35], v[96:99]
    ds_read_b128 v[52:55], v6 offset:37888
    ds_read_b128 v[56:59], v6 offset:38912
    v_mfma_f32_16x16x32_bf16 v[96:99], a[80:83], v[36:39], v[96:99]
    buffer_load_dwordx4 v4, s[8:11], s79 offen offset:64 lds
    v_mfma_f32_16x16x32_bf16 v[100:103], a[84:87], v[36:39], v[100:103]
    s_addk_i32 m0, 960
    ds_read_b128 v[60:63], v6 offset:39936
    v_mfma_f32_16x16x32_bf16 v[100:103], a[68:71], v[32:35], v[100:103]
    v_mfma_f32_16x16x32_bf16 v[112:115], v[32:35], a[72:75], v[112:115]
    buffer_load_dwordx4 v4, s[8:11], s79 offen offset:128 lds
    v_mfma_f32_16x16x32_bf16 v[112:115], v[36:39], a[88:91], v[112:115]
    s_addk_i32 m0, 960
    v_mfma_f32_16x16x32_bf16 v[120:123], v[36:39], a[92:95], v[120:123]
    v_mfma_f32_16x16x32_bf16 v[120:123], v[32:35], a[76:79], v[120:123]
    s_waitcnt lgkmcnt(4)
    ds_read_b128 v[32:35], v6 offset:40960
    ds_read_b128 v[36:39], v6 offset:41984
    v_mfma_f32_16x16x32_bf16 v[124:127], v[40:43], a[76:79], v[124:127]
    buffer_load_dwordx4 v4, s[8:11], s79 offen offset:192 lds
    v_mfma_f32_16x16x32_bf16 v[124:127], v[44:47], a[92:95], v[124:127]
    s_addk_i32 m0, 13504
    v_mfma_f32_16x16x32_bf16 v[116:119], v[44:47], a[88:91], v[116:119]
    v_mfma_f32_16x16x32_bf16 v[116:119], v[40:43], a[72:75], v[116:119]
    buffer_load_dwordx4 v4, s[12:15], s79 offen lds
    v_mfma_f32_16x16x32_bf16 v[108:111], a[68:71], v[40:43], v[108:111]
    s_addk_i32 m0, 960
    v_mfma_f32_16x16x32_bf16 v[108:111], a[84:87], v[44:47], v[108:111]
    v_mfma_f32_16x16x32_bf16 v[104:107], a[80:83], v[44:47], v[104:107]
    buffer_load_dwordx4 v4, s[12:15], s79 offen offset:64 lds
    v_mfma_f32_16x16x32_bf16 v[104:107], a[64:67], v[40:43], v[104:107]
    s_waitcnt lgkmcnt(4)
    s_addk_i32 m0, 960
    ds_read_b128 v[40:43], v6 offset:43008
    v_mfma_f32_16x16x32_bf16 v[128:131], a[64:67], v[48:51], v[128:131]
    ds_read_b128 v[44:47], v6 offset:44032
    v_mfma_f32_16x16x32_bf16 v[128:131], a[80:83], v[52:55], v[128:131]
    buffer_load_dwordx4 v4, s[12:15], s79 offen offset:128 lds
    v_mfma_f32_16x16x32_bf16 v[132:135], a[84:87], v[52:55], v[132:135]
    s_addk_i32 m0, 960
    v_mfma_f32_16x16x32_bf16 v[132:135], a[68:71], v[48:51], v[132:135]
    v_mfma_f32_16x16x32_bf16 v[144:147], v[48:51], a[72:75], v[144:147]
    buffer_load_dwordx4 v4, s[12:15], s79 offen offset:192 lds
    v_mfma_f32_16x16x32_bf16 v[144:147], v[52:55], a[88:91], v[144:147]
    s_addk_i32 s96, 128
    s_and_b32 s96, s96, 1023
    s_add_u32 s79, s72, s96
    v_mfma_f32_16x16x32_bf16 v[152:155], v[52:55], a[92:95], v[152:155]
    s_addk_i32 m0, 13504
    v_mfma_f32_16x16x32_bf16 v[152:155], v[48:51], a[76:79], v[152:155]
    s_waitcnt lgkmcnt(4)
    ds_read_b128 v[48:51], v6 offset:45056
    ds_read_b128 v[52:55], v6 offset:46080
    v_mfma_f32_16x16x32_bf16 v[156:159], v[56:59], a[76:79], v[156:159]
    buffer_load_dwordx4 v1, s[4:7], s79 offen lds
    v_mfma_f32_16x16x32_bf16 v[156:159], v[60:63], a[92:95], v[156:159]
    s_addk_i32 m0, 960
    v_mfma_f32_16x16x32_bf16 v[148:151], v[60:63], a[88:91], v[148:151]
    v_mfma_f32_16x16x32_bf16 v[148:151], v[56:59], a[72:75], v[148:151]
    v_mfma_f32_16x16x32_bf16 v[140:143], a[68:71], v[56:59], v[140:143]
    buffer_load_dwordx4 v1, s[4:7], s79 offen offset:64 lds
    v_mfma_f32_16x16x32_bf16 v[140:143], a[84:87], v[60:63], v[140:143]
    s_addk_i32 s79, 16384
    s_addk_i32 m0, 1088
    v_mfma_f32_16x16x32_bf16 v[136:139], a[80:83], v[60:63], v[136:139]
    v_mfma_f32_16x16x32_bf16 v[136:139], a[64:67], v[56:59], v[136:139]
    s_waitcnt lgkmcnt(4)
    ds_read_b128 v[56:59], v6 offset:47104
    ds_read_b128 v[60:63], v6 offset:48128
    v_mfma_f32_16x16x32_bf16 v[160:163], a[64:67], v[32:35], v[160:163]
    buffer_load_dwordx4 v1, s[4:7], s79 offen lds
    v_mfma_f32_16x16x32_bf16 v[160:163], a[80:83], v[36:39], v[160:163]
    s_addk_i32 m0, 960
    v_mfma_f32_16x16x32_bf16 v[164:167], a[84:87], v[36:39], v[164:167]
    v_mfma_f32_16x16x32_bf16 v[164:167], a[68:71], v[32:35], v[164:167]
    buffer_load_dwordx4 v1, s[4:7], s79 offen offset:64 lds
    v_mfma_f32_16x16x32_bf16 v[176:179], v[32:35], a[72:75], v[176:179]
    v_mfma_f32_16x16x32_bf16 v[176:179], v[36:39], a[88:91], v[176:179]
    v_mfma_f32_16x16x32_bf16 v[184:187], v[36:39], a[92:95], v[184:187]
    v_mfma_f32_16x16x32_bf16 v[184:187], v[32:35], a[76:79], v[184:187]
    s_waitcnt lgkmcnt(4)
    v_mfma_f32_16x16x32_bf16 v[188:191], v[40:43], a[76:79], v[188:191]
    v_mfma_f32_16x16x32_bf16 v[188:191], v[44:47], a[92:95], v[188:191]
    v_mfma_f32_16x16x32_bf16 v[180:183], v[44:47], a[88:91], v[180:183]
    v_mfma_f32_16x16x32_bf16 v[180:183], v[40:43], a[72:75], v[180:183]
    v_mfma_f32_16x16x32_bf16 v[172:175], a[68:71], v[40:43], v[172:175]
    v_mfma_f32_16x16x32_bf16 v[172:175], a[84:87], v[44:47], v[172:175]
    s_waitcnt vmcnt(16) lgkmcnt(0)
    s_barrier
    v_mfma_f32_16x16x32_bf16 v[168:171], a[80:83], v[44:47], v[168:171]
    s_lshl_b32 s79, s96, 12
    s_add_u32 s79, s79, s73
    s_addk_i32 m0, 13376
    v_mfma_f32_16x16x32_bf16 v[168:171], a[64:67], v[40:43], v[168:171]
    ds_read_b128 v[32:35], v7 offset:16384
    ds_read_b64_tr_b16 a[96:97], v14 offset:0
    v_mfma_f32_16x16x32_bf16 v[192:195], a[64:67], v[48:51], v[192:195]
    buffer_load_dwordx4 v4, s[8:11], s79 offen lds
    v_mfma_f32_16x16x32_bf16 v[192:195], a[80:83], v[52:55], v[192:195]
    s_addk_i32 m0, 960
    ds_read_b64_tr_b16 a[98:99], v14 offset:256
    ds_read_b128 v[36:39], v7 offset:17408
    v_mfma_f32_16x16x32_bf16 v[196:199], a[84:87], v[52:55], v[196:199]
    ds_read_b64_tr_b16 a[112:113], v14 offset:8192
    ds_read_b64_tr_b16 a[114:115], v14 offset:8448
    v_mfma_f32_16x16x32_bf16 v[196:199], a[68:71], v[48:51], v[196:199]
    buffer_load_dwordx4 v4, s[8:11], s79 offen offset:64 lds
    v_mfma_f32_16x16x32_bf16 v[208:211], v[48:51], a[72:75], v[208:211]
    s_addk_i32 m0, 960
    ds_read_b64_tr_b16 a[116:117], v17 offset:8192
    ds_read_b64_tr_b16 a[118:119], v17 offset:8448
    v_mfma_f32_16x16x32_bf16 v[208:211], v[52:55], a[88:91], v[208:211]
    ds_read_b64_tr_b16 a[100:101], v17 offset:0
    ds_read_b64_tr_b16 a[102:103], v17 offset:256
    v_mfma_f32_16x16x32_bf16 v[216:219], v[52:55], a[92:95], v[216:219]
    ds_read_b64_tr_b16 a[104:105], v14 offset:16384
    ds_read_b64_tr_b16 a[106:107], v14 offset:16640
    v_mfma_f32_16x16x32_bf16 v[216:219], v[48:51], a[76:79], v[216:219]
    ds_read_b64_tr_b16 a[120:121], v14 offset:24576
    ds_read_b64_tr_b16 a[122:123], v14 offset:24832
    v_mfma_f32_16x16x32_bf16 v[220:223], v[56:59], a[76:79], v[220:223]
    ds_read_b64_tr_b16 a[124:125], v17 offset:24576
    ds_read_b64_tr_b16 a[126:127], v17 offset:24832
    v_mfma_f32_16x16x32_bf16 v[220:223], v[60:63], a[92:95], v[220:223]
    ds_read_b64_tr_b16 a[108:109], v17 offset:16384
    ds_read_b64_tr_b16 a[110:111], v17 offset:16640
    v_mfma_f32_16x16x32_bf16 v[212:215], v[60:63], a[88:91], v[212:215]
    buffer_load_dwordx4 v4, s[8:11], s79 offen offset:128 lds
    v_mfma_f32_16x16x32_bf16 v[212:215], v[56:59], a[72:75], v[212:215]
    s_addk_i32 m0, 960
    ds_read_b128 v[40:43], v7 offset:18432
    ds_read_b128 v[44:47], v7 offset:19456
    v_mfma_f32_16x16x32_bf16 v[204:207], a[68:71], v[56:59], v[204:207]
    ds_read_b128 v[48:51], v7 offset:20480
    ds_read_b128 v[52:55], v7 offset:21504
    v_mfma_f32_16x16x32_bf16 v[204:207], a[84:87], v[60:63], v[204:207]
    buffer_load_dwordx4 v4, s[8:11], s79 offen offset:192 lds
    v_mfma_f32_16x16x32_bf16 v[200:203], a[80:83], v[60:63], v[200:203]
    s_addk_i32 m0, 13504
    v_mfma_f32_16x16x32_bf16 v[200:203], a[64:67], v[56:59], v[200:203]
    s_waitcnt lgkmcnt(4)
    ds_read_b128 v[56:59], v7 offset:22528
    ds_read_b128 v[60:63], v7 offset:23552
    v_mfma_f32_16x16x32_bf16 v[96:99], a[96:99], v[32:35], v[96:99]
    buffer_load_dwordx4 v4, s[12:15], s79 offen lds
    v_mfma_f32_16x16x32_bf16 v[96:99], a[112:115], v[36:39], v[96:99]
    s_addk_i32 m0, 960
    v_mfma_f32_16x16x32_bf16 v[100:103], a[116:119], v[36:39], v[100:103]
    v_mfma_f32_16x16x32_bf16 v[100:103], a[100:103], v[32:35], v[100:103]
    v_mfma_f32_16x16x32_bf16 v[112:115], v[32:35], a[104:107], v[112:115]
    v_mfma_f32_16x16x32_bf16 v[112:115], v[36:39], a[120:123], v[112:115]
    buffer_load_dwordx4 v4, s[12:15], s79 offen offset:64 lds
    v_mfma_f32_16x16x32_bf16 v[120:123], v[36:39], a[124:127], v[120:123]
    s_addk_i32 m0, 960
    v_mfma_f32_16x16x32_bf16 v[120:123], v[32:35], a[108:111], v[120:123]
    s_waitcnt lgkmcnt(4)
    ds_read_b128 v[32:35], v7 offset:24576
    ds_read_b128 v[36:39], v7 offset:25600
    v_mfma_f32_16x16x32_bf16 v[124:127], v[40:43], a[108:111], v[124:127]
    v_mfma_f32_16x16x32_bf16 v[124:127], v[44:47], a[124:127], v[124:127]
    v_mfma_f32_16x16x32_bf16 v[116:119], v[44:47], a[120:123], v[116:119]
    buffer_load_dwordx4 v4, s[12:15], s79 offen offset:128 lds
    v_mfma_f32_16x16x32_bf16 v[116:119], v[40:43], a[104:107], v[116:119]
    s_addk_i32 m0, 960
    v_mfma_f32_16x16x32_bf16 v[108:111], a[100:103], v[40:43], v[108:111]
    v_mfma_f32_16x16x32_bf16 v[108:111], a[116:119], v[44:47], v[108:111]
    v_mfma_f32_16x16x32_bf16 v[104:107], a[112:115], v[44:47], v[104:107]
    v_mfma_f32_16x16x32_bf16 v[104:107], a[96:99], v[40:43], v[104:107]
    s_waitcnt lgkmcnt(4)
    ds_read_b128 v[40:43], v7 offset:26624
    ds_read_b128 v[44:47], v7 offset:27648
    v_mfma_f32_16x16x32_bf16 v[128:131], a[96:99], v[48:51], v[128:131]
    buffer_load_dwordx4 v4, s[12:15], s79 offen offset:192 lds
    v_mfma_f32_16x16x32_bf16 v[128:131], a[112:115], v[52:55], v[128:131]
    s_addk_i32 s96, 128
    s_and_b32 s96, s96, 1023
    s_add_u32 s79, s72, s96
    v_mfma_f32_16x16x32_bf16 v[132:135], a[116:119], v[52:55], v[132:135]
    s_addk_i32 m0, 13504
    v_mfma_f32_16x16x32_bf16 v[132:135], a[100:103], v[48:51], v[132:135]
    v_mfma_f32_16x16x32_bf16 v[144:147], v[48:51], a[104:107], v[144:147]
    s_and_b32 s67, s63, 3
    s_cmp_lg_u32 s67, 3
    s_cbranch_scc1 TCL_0
    s_and_b32 s67, s2, 7
    s_lshl_b32 s67, s67, 3
    s_add_u32 s67, s67, s64
    s_lshl_b32 s67, s67, 2
    s_add_u32 s67, s67, s62
    s_lshl_b32 s67, s67, 13
    v_lshlrev_b32 v30, 7, v0
    buffer_load_dword v69, v30, s[28:31], s67 offen
TCL_0:
    v_mfma_f32_16x16x32_bf16 v[144:147], v[52:55], a[120:123], v[144:147]
    buffer_load_dwordx4 v1, s[4:7], s79 offen lds
    v_mfma_f32_16x16x32_bf16 v[152:155], v[52:55], a[124:127], v[152:155]
    s_add_u32 m0, s71, 132032
    v_mfma_f32_16x16x32_bf16 v[152:155], v[48:51], a[108:111], v[152:155]
    s_waitcnt lgkmcnt(4)
    ds_read_b128 v[48:51], v7 offset:28672
    ds_read_b128 v[52:55], v7 offset:29696
    v_mfma_f32_16x16x32_bf16 v[156:159], v[56:59], a[108:111], v[156:159]
    buffer_load_dwordx4 v1, s[4:7], s79 offen offset:64 lds
    v_mfma_f32_16x16x32_bf16 v[156:159], v[60:63], a[124:127], v[156:159]
    s_addk_i32 s79, 16384
    s_addk_i32 m0, 1088
    v_mfma_f32_16x16x32_bf16 v[148:151], v[60:63], a[120:123], v[148:151]
    v_mfma_f32_16x16x32_bf16 v[148:151], v[56:59], a[104:107], v[148:151]
    v_mfma_f32_16x16x32_bf16 v[140:143], a[100:103], v[56:59], v[140:143]
    v_mfma_f32_16x16x32_bf16 v[140:143], a[116:119], v[60:63], v[140:143]
    buffer_load_dwordx4 v1, s[4:7], s79 offen lds
    v_mfma_f32_16x16x32_bf16 v[136:139], a[112:115], v[60:63], v[136:139]
    s_addk_i32 m0, 960
    v_mfma_f32_16x16x32_bf16 v[136:139], a[96:99], v[56:59], v[136:139]
    s_waitcnt lgkmcnt(4)
    ds_read_b128 v[56:59], v7 offset:30720
    ds_read_b128 v[60:63], v7 offset:31744
    v_mfma_f32_16x16x32_bf16 v[160:163], a[96:99], v[32:35], v[160:163]
    v_mfma_f32_16x16x32_bf16 v[160:163], a[112:115], v[36:39], v[160:163]
    buffer_load_dwordx4 v1, s[4:7], s79 offen offset:64 lds
    v_mfma_f32_16x16x32_bf16 v[164:167], a[116:119], v[36:39], v[164:167]
    v_mfma_f32_16x16x32_bf16 v[164:167], a[100:103], v[32:35], v[164:167]
    v_mfma_f32_16x16x32_bf16 v[176:179], v[32:35], a[104:107], v[176:179]
    v_mfma_f32_16x16x32_bf16 v[176:179], v[36:39], a[120:123], v[176:179]
    v_mfma_f32_16x16x32_bf16 v[184:187], v[36:39], a[124:127], v[184:187]
    v_mfma_f32_16x16x32_bf16 v[184:187], v[32:35], a[108:111], v[184:187]
    s_waitcnt lgkmcnt(4)
    v_mfma_f32_16x16x32_bf16 v[188:191], v[40:43], a[108:111], v[188:191]
    v_mfma_f32_16x16x32_bf16 v[188:191], v[44:47], a[124:127], v[188:191]
    v_mfma_f32_16x16x32_bf16 v[180:183], v[44:47], a[120:123], v[180:183]
    v_mfma_f32_16x16x32_bf16 v[180:183], v[40:43], a[104:107], v[180:183]
    v_mfma_f32_16x16x32_bf16 v[172:175], a[100:103], v[40:43], v[172:175]
    v_mfma_f32_16x16x32_bf16 v[172:175], a[116:119], v[44:47], v[172:175]
    s_waitcnt vmcnt(16) lgkmcnt(0)
    s_barrier
    v_mfma_f32_16x16x32_bf16 v[168:171], a[112:115], v[44:47], v[168:171]
    s_lshl_b32 s79, s96, 12
    s_add_u32 s79, s79, s73
    s_addk_i32 m0, 13376
    v_mfma_f32_16x16x32_bf16 v[168:171], a[96:99], v[40:43], v[168:171]
    ds_read_b128 v[32:35], v5 offset:32768
    ds_read_b64_tr_b16 a[128:129], v14 offset:49152
    v_mfma_f32_16x16x32_bf16 v[192:195], a[96:99], v[48:51], v[192:195]
    buffer_load_dwordx4 v4, s[8:11], s79 offen lds
    v_mfma_f32_16x16x32_bf16 v[192:195], a[112:115], v[52:55], v[192:195]
    s_addk_i32 m0, 960
    ds_read_b64_tr_b16 a[130:131], v14 offset:49408
    ds_read_b128 v[36:39], v5 offset:33792
    v_mfma_f32_16x16x32_bf16 v[196:199], a[116:119], v[52:55], v[196:199]
    ds_read_b64_tr_b16 a[144:145], v14 offset:57344
    ds_read_b64_tr_b16 a[146:147], v14 offset:57600
    v_mfma_f32_16x16x32_bf16 v[196:199], a[100:103], v[48:51], v[196:199]
    buffer_load_dwordx4 v4, s[8:11], s79 offen offset:64 lds
    v_mfma_f32_16x16x32_bf16 v[208:211], v[48:51], a[104:107], v[208:211]
    s_addk_i32 m0, 960
    ds_read_b64_tr_b16 a[148:149], v17 offset:57344
    ds_read_b64_tr_b16 a[150:151], v17 offset:57600
    v_mfma_f32_16x16x32_bf16 v[208:211], v[52:55], a[120:123], v[208:211]
    ds_read_b64_tr_b16 a[132:133], v17 offset:49152
    ds_read_b64_tr_b16 a[134:135], v17 offset:49408
    v_mfma_f32_16x16x32_bf16 v[216:219], v[52:55], a[124:127], v[216:219]
    ds_read_b64_tr_b16 a[136:137], v15 offset:0
    ds_read_b64_tr_b16 a[138:139], v15 offset:256
    v_mfma_f32_16x16x32_bf16 v[216:219], v[48:51], a[108:111], v[216:219]
    ds_read_b64_tr_b16 a[152:153], v15 offset:8192
    ds_read_b64_tr_b16 a[154:155], v15 offset:8448
    v_mfma_f32_16x16x32_bf16 v[220:223], v[56:59], a[108:111], v[220:223]
    ds_read_b64_tr_b16 a[156:157], v18 offset:8192
    ds_read_b64_tr_b16 a[158:159], v18 offset:8448
    v_mfma_f32_16x16x32_bf16 v[220:223], v[60:63], a[124:127], v[220:223]
    ds_read_b64_tr_b16 a[140:141], v18 offset:0
    ds_read_b64_tr_b16 a[142:143], v18 offset:256
    v_mfma_f32_16x16x32_bf16 v[212:215], v[60:63], a[120:123], v[212:215]
    buffer_load_dwordx4 v4, s[8:11], s79 offen offset:128 lds
    v_mfma_f32_16x16x32_bf16 v[212:215], v[56:59], a[104:107], v[212:215]
    s_addk_i32 m0, 960
    ds_read_b128 v[40:43], v5 offset:34816
    ds_read_b128 v[44:47], v5 offset:35840
    v_mfma_f32_16x16x32_bf16 v[204:207], a[100:103], v[56:59], v[204:207]
    ds_read_b128 v[48:51], v5 offset:36864
    ds_read_b128 v[52:55], v5 offset:37888
    v_mfma_f32_16x16x32_bf16 v[204:207], a[116:119], v[60:63], v[204:207]
    buffer_load_dwordx4 v4, s[8:11], s79 offen offset:192 lds
    v_mfma_f32_16x16x32_bf16 v[200:203], a[112:115], v[60:63], v[200:203]
    s_add_u32 m0, s71, 0
    v_mfma_f32_16x16x32_bf16 v[200:203], a[96:99], v[56:59], v[200:203]
    s_waitcnt lgkmcnt(4)
    ds_read_b128 v[56:59], v5 offset:38912
    ds_read_b128 v[60:63], v5 offset:39936
    v_mfma_f32_16x16x32_bf16 v[96:99], a[128:131], v[32:35], v[96:99]
    buffer_load_dwordx4 v4, s[12:15], s79 offen lds
    v_mfma_f32_16x16x32_bf16 v[96:99], a[144:147], v[36:39], v[96:99]
    s_addk_i32 m0, 960
    v_mfma_f32_16x16x32_bf16 v[100:103], a[148:151], v[36:39], v[100:103]
    v_mfma_f32_16x16x32_bf16 v[100:103], a[132:135], v[32:35], v[100:103]
    v_mfma_f32_16x16x32_bf16 v[112:115], v[32:35], a[136:139], v[112:115]
    v_mfma_f32_16x16x32_bf16 v[112:115], v[36:39], a[152:155], v[112:115]
    buffer_load_dwordx4 v4, s[12:15], s79 offen offset:64 lds
    v_mfma_f32_16x16x32_bf16 v[120:123], v[36:39], a[156:159], v[120:123]
    s_addk_i32 m0, 960
    v_mfma_f32_16x16x32_bf16 v[120:123], v[32:35], a[140:143], v[120:123]
    s_waitcnt lgkmcnt(4)
    ds_read_b128 v[32:35], v5 offset:40960
    ds_read_b128 v[36:39], v5 offset:41984
    v_mfma_f32_16x16x32_bf16 v[124:127], v[40:43], a[140:143], v[124:127]
    v_mfma_f32_16x16x32_bf16 v[124:127], v[44:47], a[156:159], v[124:127]
    v_mfma_f32_16x16x32_bf16 v[116:119], v[44:47], a[152:155], v[116:119]
    buffer_load_dwordx4 v4, s[12:15], s79 offen offset:128 lds
    v_mfma_f32_16x16x32_bf16 v[116:119], v[40:43], a[136:139], v[116:119]
    s_addk_i32 m0, 960
    v_mfma_f32_16x16x32_bf16 v[108:111], a[132:135], v[40:43], v[108:111]
    v_mfma_f32_16x16x32_bf16 v[108:111], a[148:151], v[44:47], v[108:111]
    v_mfma_f32_16x16x32_bf16 v[104:107], a[144:147], v[44:47], v[104:107]
    v_mfma_f32_16x16x32_bf16 v[104:107], a[128:131], v[40:43], v[104:107]
    s_waitcnt lgkmcnt(4)
    ds_read_b128 v[40:43], v5 offset:43008
    ds_read_b128 v[44:47], v5 offset:44032
    v_mfma_f32_16x16x32_bf16 v[128:131], a[128:131], v[48:51], v[128:131]
    buffer_load_dwordx4 v4, s[12:15], s79 offen offset:192 lds
    v_mfma_f32_16x16x32_bf16 v[128:131], a[144:147], v[52:55], v[128:131]
    s_addk_i32 s96, 128
    s_and_b32 s96, s96, 1023
    s_add_u32 s79, s72, s96
    v_mfma_f32_16x16x32_bf16 v[132:135], a[148:151], v[52:55], v[132:135]
    s_addk_i32 m0, 13504
    v_mfma_f32_16x16x32_bf16 v[132:135], a[132:135], v[48:51], v[132:135]
    v_mfma_f32_16x16x32_bf16 v[144:147], v[48:51], a[136:139], v[144:147]
    buffer_load_dwordx4 v1, s[4:7], s79 offen lds
    v_mfma_f32_16x16x32_bf16 v[144:147], v[52:55], a[152:155], v[144:147]
    s_addk_i32 m0, 960
    v_mfma_f32_16x16x32_bf16 v[152:155], v[52:55], a[156:159], v[152:155]
    v_mfma_f32_16x16x32_bf16 v[152:155], v[48:51], a[140:143], v[152:155]
    s_waitcnt lgkmcnt(4)
    ds_read_b128 v[48:51], v5 offset:45056
    ds_read_b128 v[52:55], v5 offset:46080
    v_mfma_f32_16x16x32_bf16 v[156:159], v[56:59], a[140:143], v[156:159]
    buffer_load_dwordx4 v1, s[4:7], s79 offen offset:64 lds
    v_mfma_f32_16x16x32_bf16 v[156:159], v[60:63], a[156:159], v[156:159]
    s_addk_i32 s79, 16384
    s_addk_i32 m0, 1088
    v_mfma_f32_16x16x32_bf16 v[148:151], v[60:63], a[152:155], v[148:151]
    v_mfma_f32_16x16x32_bf16 v[148:151], v[56:59], a[136:139], v[148:151]
    v_mfma_f32_16x16x32_bf16 v[140:143], a[132:135], v[56:59], v[140:143]
    v_mfma_f32_16x16x32_bf16 v[140:143], a[148:151], v[60:63], v[140:143]
    buffer_load_dwordx4 v1, s[4:7], s79 offen lds
    v_mfma_f32_16x16x32_bf16 v[136:139], a[144:147], v[60:63], v[136:139]
    s_addk_i32 m0, 960
    v_mfma_f32_16x16x32_bf16 v[136:139], a[128:131], v[56:59], v[136:139]
    s_waitcnt lgkmcnt(4)
    ds_read_b128 v[56:59], v5 offset:47104
    ds_read_b128 v[60:63], v5 offset:48128
    v_mfma_f32_16x16x32_bf16 v[160:163], a[128:131], v[32:35], v[160:163]
    v_mfma_f32_16x16x32_bf16 v[160:163], a[144:147], v[36:39], v[160:163]
    buffer_load_dwordx4 v1, s[4:7], s79 offen offset:64 lds
    v_mfma_f32_16x16x32_bf16 v[164:167], a[148:151], v[36:39], v[164:167]
    v_mfma_f32_16x16x32_bf16 v[164:167], a[132:135], v[32:35], v[164:167]
    v_mfma_f32_16x16x32_bf16 v[176:179], v[32:35], a[136:139], v[176:179]
    v_mfma_f32_16x16x32_bf16 v[176:179], v[36:39], a[152:155], v[176:179]
    v_mfma_f32_16x16x32_bf16 v[184:187], v[36:39], a[156:159], v[184:187]
    v_mfma_f32_16x16x32_bf16 v[184:187], v[32:35], a[140:143], v[184:187]
    s_waitcnt lgkmcnt(4)
    v_mfma_f32_16x16x32_bf16 v[188:191], v[40:43], a[140:143], v[188:191]
    s_and_b32 s67, s63, 3
    s_cmp_lg_u32 s67, 2
    s_cbranch_scc1 TCL_1
    s_and_b32 s67, s2, 7
    s_lshl_b32 s67, s67, 3
    s_add_u32 s67, s67, s64
    s_lshl_b32 s67, s67, 2
    s_add_u32 s67, s67, s62
    s_lshl_b32 s67, s67, 13
    s_add_u32 s67, s67, 2097152
    v_lshlrev_b32 v30, 7, v0
    s_waitcnt vmcnt(16)
    buffer_load_dword v69, v30, s[28:31], s67 offen
TCL_1:
    v_mfma_f32_16x16x32_bf16 v[188:191], v[44:47], a[156:159], v[188:191]
    v_mfma_f32_16x16x32_bf16 v[180:183], v[44:47], a[152:155], v[180:183]
    v_mfma_f32_16x16x32_bf16 v[180:183], v[40:43], a[136:139], v[180:183]
    v_mfma_f32_16x16x32_bf16 v[172:175], a[132:135], v[40:43], v[172:175]
    v_mfma_f32_16x16x32_bf16 v[172:175], a[148:151], v[44:47], v[172:175]
    s_waitcnt vmcnt(16) lgkmcnt(0)
    s_barrier
    v_mfma_f32_16x16x32_bf16 v[168:171], a[144:147], v[44:47], v[168:171]
    s_lshl_b32 s79, s96, 12
    s_add_u32 s79, s79, s73
    s_add_u32 m0, s71, 32768
    v_mfma_f32_16x16x32_bf16 v[168:171], a[128:131], v[40:43], v[168:171]
    ds_read_b128 v[32:35], v6 offset:16384
    ds_read_b64_tr_b16 a[160:161], v15 offset:32768
    v_mfma_f32_16x16x32_bf16 v[192:195], a[128:131], v[48:51], v[192:195]
    buffer_load_dwordx4 v4, s[8:11], s79 offen lds
    v_mfma_f32_16x16x32_bf16 v[192:195], a[144:147], v[52:55], v[192:195]
    s_addk_i32 m0, 960
    ds_read_b64_tr_b16 a[162:163], v15 offset:33024
    ds_read_b128 v[36:39], v6 offset:17408
    v_mfma_f32_16x16x32_bf16 v[196:199], a[148:151], v[52:55], v[196:199]
    ds_read_b64_tr_b16 a[176:177], v15 offset:40960
    ds_read_b64_tr_b16 a[178:179], v15 offset:41216
    v_mfma_f32_16x16x32_bf16 v[196:199], a[132:135], v[48:51], v[196:199]
    buffer_load_dwordx4 v4, s[8:11], s79 offen offset:64 lds
    v_mfma_f32_16x16x32_bf16 v[208:211], v[48:51], a[136:139], v[208:211]
    s_addk_i32 m0, 960
    ds_read_b64_tr_b16 a[180:181], v18 offset:40960
    ds_read_b64_tr_b16 a[182:183], v18 offset:41216
    v_mfma_f32_16x16x32_bf16 v[208:211], v[52:55], a[152:155], v[208:211]
    ds_read_b64_tr_b16 a[164:165], v18 offset:32768
    ds_read_b64_tr_b16 a[166:167], v18 offset:33024
    v_mfma_f32_16x16x32_bf16 v[216:219], v[52:55], a[156:159], v[216:219]
    ds_read_b64_tr_b16 a[168:169], v15 offset:49152
    ds_read_b64_tr_b16 a[170:171], v15 offset:49408
    v_mfma_f32_16x16x32_bf16 v[216:219], v[48:51], a[140:143], v[216:219]
    ds_read_b64_tr_b16 a[184:185], v15 offset:57344
    ds_read_b64_tr_b16 a[186:187], v15 offset:57600
    v_mfma_f32_16x16x32_bf16 v[220:223], v[56:59], a[140:143], v[220:223]
    ds_read_b64_tr_b16 a[188:189], v18 offset:57344
    ds_read_b64_tr_b16 a[190:191], v18 offset:57600
    v_mfma_f32_16x16x32_bf16 v[220:223], v[60:63], a[156:159], v[220:223]
    ds_read_b64_tr_b16 a[172:173], v18 offset:49152
    ds_read_b64_tr_b16 a[174:175], v18 offset:49408
    v_mfma_f32_16x16x32_bf16 v[212:215], v[60:63], a[152:155], v[212:215]
    buffer_load_dwordx4 v4, s[8:11], s79 offen offset:128 lds
    v_mfma_f32_16x16x32_bf16 v[212:215], v[56:59], a[136:139], v[212:215]
    s_addk_i32 m0, 960
    ds_read_b128 v[40:43], v6 offset:18432
    ds_read_b128 v[44:47], v6 offset:19456
    v_mfma_f32_16x16x32_bf16 v[204:207], a[132:135], v[56:59], v[204:207]
    ds_read_b128 v[48:51], v6 offset:20480
    ds_read_b128 v[52:55], v6 offset:21504
    v_mfma_f32_16x16x32_bf16 v[204:207], a[148:151], v[60:63], v[204:207]
PG_1:
    s_cbranch_execz PG_5
    buffer_load_dwordx4 v4, s[8:11], s79 offen offset:192 lds
    v_mfma_f32_16x16x32_bf16 v[200:203], a[144:147], v[60:63], v[200:203]
    s_addk_i32 m0, 13504
    v_mfma_f32_16x16x32_bf16 v[200:203], a[128:131], v[56:59], v[200:203]
    s_waitcnt lgkmcnt(4)
    ds_read_b128 v[56:59], v6 offset:22528
    ds_read_b128 v[60:63], v6 offset:23552
    v_mfma_f32_16x16x32_bf16 v[96:99], a[160:163], v[32:35], v[96:99]
    buffer_load_dwordx4 v4, s[12:15], s79 offen lds
    v_mfma_f32_16x16x32_bf16 v[96:99], a[176:179], v[36:39], v[96:99]
    s_addk_i32 m0, 960
    v_mfma_f32_16x16x32_bf16 v[100:103], a[180:183], v[36:39], v[100:103]
    v_mfma_f32_16x16x32_bf16 v[100:103], a[164:167], v[32:35], v[100:103]
    v_mfma_f32_16x16x32_bf16 v[112:115], v[32:35], a[168:171], v[112:115]
    v_mfma_f32_16x16x32_bf16 v[112:115], v[36:39], a[184:187], v[112:115]
    buffer_load_dwordx4 v4, s[12:15], s79 offen offset:64 lds
    v_mfma_f32_16x16x32_bf16 v[120:123], v[36:39], a[188:191], v[120:123]
    s_addk_i32 m0, 960
    v_mfma_f32_16x16x32_bf16 v[120:123], v[32:35], a[172:175], v[120:123]
    s_waitcnt lgkmcnt(4)
    ds_read_b128 v[32:35], v6 offset:24576
    ds_read_b128 v[36:39], v6 offset:25600
    v_mfma_f32_16x16x32_bf16 v[124:127], v[40:43], a[172:175], v[124:127]
    v_mfma_f32_16x16x32_bf16 v[124:127], v[44:47], a[188:191], v[124:127]
    v_mfma_f32_16x16x32_bf16 v[116:119], v[44:47], a[184:187], v[116:119]
    buffer_load_dwordx4 v4, s[12:15], s79 offen offset:128 lds
    v_mfma_f32_16x16x32_bf16 v[116:119], v[40:43], a[168:171], v[116:119]
    s_addk_i32 m0, 960
    v_mfma_f32_16x16x32_bf16 v[108:111], a[164:167], v[40:43], v[108:111]
    v_mfma_f32_16x16x32_bf16 v[108:111], a[180:183], v[44:47], v[108:111]
    v_mfma_f32_16x16x32_bf16 v[104:107], a[176:179], v[44:47], v[104:107]
    v_mfma_f32_16x16x32_bf16 v[104:107], a[160:163], v[40:43], v[104:107]
    s_waitcnt lgkmcnt(4)
    ds_read_b128 v[40:43], v6 offset:26624
    ds_read_b128 v[44:47], v6 offset:27648
    v_mfma_f32_16x16x32_bf16 v[128:131], a[160:163], v[48:51], v[128:131]
    buffer_load_dwordx4 v4, s[12:15], s79 offen offset:192 lds
    v_mfma_f32_16x16x32_bf16 v[128:131], a[176:179], v[52:55], v[128:131]
    s_add_u32 s79, s99, 0
    s_addk_i32 m0, 13504
    v_mfma_f32_16x16x32_bf16 v[132:135], a[180:183], v[52:55], v[132:135]
    v_mfma_f32_16x16x32_bf16 v[132:135], a[164:167], v[48:51], v[132:135]
    buffer_load_dwordx4 v1, s[4:7], s79 offen lds
    v_mfma_f32_16x16x32_bf16 v[144:147], v[48:51], a[168:171], v[144:147]
    s_addk_i32 m0, 960
    v_mfma_f32_16x16x32_bf16 v[144:147], v[52:55], a[184:187], v[144:147]
    v_mfma_f32_16x16x32_bf16 v[152:155], v[52:55], a[188:191], v[152:155]
    v_mfma_f32_16x16x32_bf16 v[152:155], v[48:51], a[172:175], v[152:155]
    s_waitcnt lgkmcnt(4)
    ds_read_b128 v[48:51], v6 offset:28672
    ds_read_b128 v[52:55], v6 offset:29696
    v_mfma_f32_16x16x32_bf16 v[156:159], v[56:59], a[172:175], v[156:159]
    buffer_load_dwordx4 v1, s[4:7], s79 offen offset:64 lds
    v_mfma_f32_16x16x32_bf16 v[156:159], v[60:63], a[188:191], v[156:159]
    s_add_u32 s79, s100, 0
    s_addk_i32 m0, 1088
    v_mfma_f32_16x16x32_bf16 v[148:151], v[60:63], a[184:187], v[148:151]
    v_mfma_f32_16x16x32_bf16 v[148:151], v[56:59], a[168:171], v[148:151]
    v_mfma_f32_16x16x32_bf16 v[140:143], a[164:167], v[56:59], v[140:143]
    v_mfma_f32_16x16x32_bf16 v[140:143], a[180:183], v[60:63], v[140:143]
    buffer_load_dwordx4 v1, s[4:7], s79 offen lds
    v_mfma_f32_16x16x32_bf16 v[136:139], a[176:179], v[60:63], v[136:139]
    s_addk_i32 m0, 960
    v_mfma_f32_16x16x32_bf16 v[136:139], a[160:163], v[56:59], v[136:139]
    s_waitcnt lgkmcnt(4)
    ds_read_b128 v[56:59], v6 offset:30720
    ds_read_b128 v[60:63], v6 offset:31744
    v_mfma_f32_16x16x32_bf16 v[160:163], a[160:163], v[32:35], v[160:163]
    v_mfma_f32_16x16x32_bf16 v[160:163], a[176:179], v[36:39], v[160:163]
    buffer_load_dwordx4 v1, s[4:7], s79 offen offset:64 lds
    v_mfma_f32_16x16x32_bf16 v[164:167], a[180:183], v[36:39], v[164:167]
    v_mfma_f32_16x16x32_bf16 v[164:167], a[164:167], v[32:35], v[164:167]
    v_mfma_f32_16x16x32_bf16 v[176:179], v[32:35], a[168:171], v[176:179]
    v_mfma_f32_16x16x32_bf16 v[176:179], v[36:39], a[184:187], v[176:179]
    v_mfma_f32_16x16x32_bf16 v[184:187], v[36:39], a[188:191], v[184:187]
    v_mfma_f32_16x16x32_bf16 v[184:187], v[32:35], a[172:175], v[184:187]
    s_waitcnt lgkmcnt(4)
    v_mfma_f32_16x16x32_bf16 v[188:191], v[40:43], a[172:175], v[188:191]
    v_mfma_f32_16x16x32_bf16 v[188:191], v[44:47], a[188:191], v[188:191]
    v_mfma_f32_16x16x32_bf16 v[180:183], v[44:47], a[184:187], v[180:183]
    v_mfma_f32_16x16x32_bf16 v[180:183], v[40:43], a[168:171], v[180:183]
    v_mfma_f32_16x16x32_bf16 v[172:175], a[164:167], v[40:43], v[172:175]
    v_mfma_f32_16x16x32_bf16 v[172:175], a[180:183], v[44:47], v[172:175]
    s_waitcnt vmcnt(16) lgkmcnt(0)
    s_barrier
    v_mfma_f32_16x16x32_bf16 v[168:171], a[176:179], v[44:47], v[168:171]
    s_xor_b32 s79, s99, 512
    s_add_u32 s79, s79, 0
    s_addk_i32 m0, 13376
    v_mfma_f32_16x16x32_bf16 v[168:171], a[160:163], v[40:43], v[168:171]
    ds_read_b128 v[32:35], v7 offset:0
    ds_read_b64_tr_b16 a[192:193], v16 offset:16384
    v_mfma_f32_16x16x32_bf16 v[192:195], a[160:163], v[48:51], v[192:195]
    buffer_load_dwordx4 v1, s[4:7], s79 offen lds
    v_mfma_f32_16x16x32_bf16 v[192:195], a[176:179], v[52:55], v[192:195]
    s_addk_i32 m0, 960
    ds_read_b64_tr_b16 a[194:195], v16 offset:16640
    ds_read_b128 v[36:39], v7 offset:1024
    v_mfma_f32_16x16x32_bf16 v[196:199], a[180:183], v[52:55], v[196:199]
    ds_read_b64_tr_b16 a[208:209], v16 offset:24576
    ds_read_b64_tr_b16 a[210:211], v16 offset:24832
    v_mfma_f32_16x16x32_bf16 v[196:199], a[164:167], v[48:51], v[196:199]
    buffer_load_dwordx4 v1, s[4:7], s79 offen offset:64 lds
    v_mfma_f32_16x16x32_bf16 v[208:211], v[48:51], a[168:171], v[208:211]
    s_xor_b32 s79, s100, 512
    s_add_u32 s79, s79, 0
    s_addk_i32 m0, 1088
    v_mfma_f32_16x16x32_bf16 v[208:211], v[52:55], a[184:187], v[208:211]
    ds_read_b64_tr_b16 a[212:213], v19 offset:24576
    ds_read_b64_tr_b16 a[214:215], v19 offset:24832
    v_mfma_f32_16x16x32_bf16 v[216:219], v[52:55], a[188:191], v[216:219]
    ds_read_b64_tr_b16 a[196:197], v19 offset:16384
    ds_read_b64_tr_b16 a[198:199], v19 offset:16640
    v_mfma_f32_16x16x32_bf16 v[216:219], v[48:51], a[172:175], v[216:219]
    ds_read_b64_tr_b16 a[200:201], v14 offset:0
    ds_read_b64_tr_b16 a[202:203], v14 offset:256
    v_mfma_f32_16x16x32_bf16 v[220:223], v[56:59], a[172:175], v[220:223]
    ds_read_b64_tr_b16 a[216:217], v14 offset:8192
    ds_read_b64_tr_b16 a[218:219], v14 offset:8448
    v_mfma_f32_16x16x32_bf16 v[220:223], v[60:63], a[188:191], v[220:223]
    ds_read_b64_tr_b16 a[220:221], v17 offset:8192
    ds_read_b64_tr_b16 a[222:223], v17 offset:8448
    v_mfma_f32_16x16x32_bf16 v[212:215], v[60:63], a[184:187], v[212:215]
    ds_read_b64_tr_b16 a[204:205], v17 offset:0
    ds_read_b64_tr_b16 a[206:207], v17 offset:256
    v_mfma_f32_16x16x32_bf16 v[212:215], v[56:59], a[168:171], v[212:215]
    buffer_load_dwordx4 v1, s[4:7], s79 offen lds
    v_mfma_f32_16x16x32_bf16 v[204:207], a[164:167], v[56:59], v[204:207]
    s_addk_i32 m0, 960
    ds_read_b128 v[40:43], v7 offset:2048
    ds_read_b128 v[44:47], v7 offset:3072
    v_mfma_f32_16x16x32_bf16 v[204:207], a[180:183], v[60:63], v[204:207]
    ds_read_b128 v[48:51], v7 offset:4096
    ds_read_b128 v[52:55], v7 offset:5120
    v_mfma_f32_16x16x32_bf16 v[200:203], a[176:179], v[60:63], v[200:203]
    buffer_load_dwordx4 v1, s[4:7], s79 offen offset:64 lds
    v_mfma_f32_16x16x32_bf16 v[200:203], a[160:163], v[56:59], v[200:203]
    s_waitcnt lgkmcnt(4)
    s_add_u32 s79, s75, s97
    s_addk_i32 m0, 13376
    v_mfma_f32_16x16x32_bf16 v[96:99], a[192:195], v[32:35], v[96:99]
    s_and_b32 s67, s63, 3
    s_cmp_lg_u32 s67, 0
    s_cbranch_scc1 TCL_2
    s_and_b32 s67, s2, 7
    s_lshl_b32 s67, s67, 3
    s_add_u32 s67, s67, s64
    s_lshl_b32 s67, s67, 2
    s_add_u32 s67, s67, s62
    s_lshl_b32 s67, s67, 13
    v_lshlrev_b32 v30, 7, v0
    s_waitcnt vmcnt(16)
    buffer_load_dword v69, v30, s[24:27], s67 offen
TCL_2:
    v_mfma_f32_16x16x32_bf16 v[96:99], a[208:211], v[36:39], v[96:99]
    buffer_load_dwordx4 v3, s[16:19], s79 offen lds
    v_mfma_f32_16x16x32_bf16 v[100:103], a[212:215], v[36:39], v[100:103]
    s_add_u32 m0, s71, 99264
    ds_read_b128 v[56:59], v7 offset:6144
    ds_read_b128 v[60:63], v7 offset:7168
    v_mfma_f32_16x16x32_bf16 v[100:103], a[196:199], v[32:35], v[100:103]
    v_mfma_f32_16x16x32_bf16 v[112:115], v[32:35], a[200:203], v[112:115]
    v_mfma_f32_16x16x32_bf16 v[112:115], v[36:39], a[216:219], v[112:115]
    buffer_load_dwordx4 v3, s[16:19], s79 offen offset:64 lds
    v_mfma_f32_16x16x32_bf16 v[120:123], v[36:39], a[220:223], v[120:123]
    s_addk_i32 s79, 4096
    s_addk_i32 m0, 1088
    v_mfma_f32_16x16x32_bf16 v[120:123], v[32:35], a[204:207], v[120:123]
    s_waitcnt lgkmcnt(4)
    ds_read_b128 v[32:35], v7 offset:8192
    ds_read_b128 v[36:39], v7 offset:9216
    v_mfma_f32_16x16x32_bf16 v[124:127], v[40:43], a[204:207], v[124:127]
    v_mfma_f32_16x16x32_bf16 v[124:127], v[44:47], a[220:223], v[124:127]
    v_mfma_f32_16x16x32_bf16 v[116:119], v[44:47], a[216:219], v[116:119]
    buffer_load_dwordx4 v3, s[16:19], s79 offen lds
    v_mfma_f32_16x16x32_bf16 v[116:119], v[40:43], a[200:203], v[116:119]
    s_addk_i32 m0, 960
    v_mfma_f32_16x16x32_bf16 v[108:111], a[196:199], v[40:43], v[108:111]
    v_mfma_f32_16x16x32_bf16 v[108:111], a[212:215], v[44:47], v[108:111]
    v_mfma_f32_16x16x32_bf16 v[104:107], a[208:211], v[44:47], v[104:107]
    v_mfma_f32_16x16x32_bf16 v[104:107], a[192:195], v[40:43], v[104:107]
    s_waitcnt lgkmcnt(4)
    ds_read_b128 v[40:43], v7 offset:10240
    ds_read_b128 v[44:47], v7 offset:11264
    v_mfma_f32_16x16x32_bf16 v[128:131], a[192:195], v[48:51], v[128:131]
    buffer_load_dwordx4 v3, s[16:19], s79 offen offset:64 lds
    v_mfma_f32_16x16x32_bf16 v[128:131], a[208:211], v[52:55], v[128:131]
    s_add_u32 s79, s76, s97
    s_addk_i32 m0, 13376
    v_mfma_f32_16x16x32_bf16 v[132:135], a[212:215], v[52:55], v[132:135]
    v_mfma_f32_16x16x32_bf16 v[132:135], a[196:199], v[48:51], v[132:135]
    buffer_load_dwordx4 v1, s[20:23], s79 offen lds
    v_mfma_f32_16x16x32_bf16 v[144:147], v[48:51], a[200:203], v[144:147]
    s_addk_i32 m0, 960
    v_mfma_f32_16x16x32_bf16 v[144:147], v[52:55], a[216:219], v[144:147]
    v_mfma_f32_16x16x32_bf16 v[152:155], v[52:55], a[220:223], v[152:155]
    v_mfma_f32_16x16x32_bf16 v[152:155], v[48:51], a[204:207], v[152:155]
    s_waitcnt lgkmcnt(4)
    ds_read_b128 v[48:51], v7 offset:12288
    ds_read_b128 v[52:55], v7 offset:13312
    v_mfma_f32_16x16x32_bf16 v[156:159], v[56:59], a[204:207], v[156:159]
    buffer_load_dwordx4 v1, s[20:23], s79 offen offset:64 lds
    v_mfma_f32_16x16x32_bf16 v[156:159], v[60:63], a[220:223], v[156:159]
    s_addk_i32 m0, 960
    v_mfma_f32_16x16x32_bf16 v[148:151], v[60:63], a[216:219], v[148:151]
    v_mfma_f32_16x16x32_bf16 v[148:151], v[56:59], a[200:203], v[148:151]
    v_mfma_f32_16x16x32_bf16 v[140:143], a[196:199], v[56:59], v[140:143]
    v_mfma_f32_16x16x32_bf16 v[140:143], a[212:215], v[60:63], v[140:143]
    buffer_load_dwordx4 v1, s[20:23], s79 offen offset:128 lds
    v_mfma_f32_16x16x32_bf16 v[136:139], a[208:211], v[60:63], v[136:139]
    s_addk_i32 m0, 960
    v_mfma_f32_16x16x32_bf16 v[136:139], a[192:195], v[56:59], v[136:139]
    s_waitcnt lgkmcnt(4)
    ds_read_b128 v[56:59], v7 offset:14336
    ds_read_b128 v[60:63], v7 offset:15360
    v_mfma_f32_16x16x32_bf16 v[160:163], a[192:195], v[32:35], v[160:163]
    v_mfma_f32_16x16x32_bf16 v[160:163], a[208:211], v[36:39], v[160:163]
    buffer_load_dwordx4 v1, s[20:23], s79 offen offset:192 lds
    v_mfma_f32_16x16x32_bf16 v[164:167], a[212:215], v[36:39], v[164:167]
    v_mfma_f32_16x16x32_bf16 v[164:167], a[196:199], v[32:35], v[164:167]
    v_mfma_f32_16x16x32_bf16 v[176:179], v[32:35], a[200:203], v[176:179]
    v_mfma_f32_16x16x32_bf16 v[176:179], v[36:39], a[216:219], v[176:179]
    v_mfma_f32_16x16x32_bf16 v[184:187], v[36:39], a[220:223], v[184:187]
    v_mfma_f32_16x16x32_bf16 v[184:187], v[32:35], a[204:207], v[184:187]
    s_waitcnt lgkmcnt(4)
    v_mfma_f32_16x16x32_bf16 v[188:191], v[40:43], a[204:207], v[188:191]
    v_mfma_f32_16x16x32_bf16 v[188:191], v[44:47], a[220:223], v[188:191]
    v_mfma_f32_16x16x32_bf16 v[180:183], v[44:47], a[216:219], v[180:183]
    v_mfma_f32_16x16x32_bf16 v[180:183], v[40:43], a[200:203], v[180:183]
    v_mfma_f32_16x16x32_bf16 v[172:175], a[196:199], v[40:43], v[172:175]
    v_mfma_f32_16x16x32_bf16 v[172:175], a[212:215], v[44:47], v[172:175]
    s_waitcnt vmcnt(16) lgkmcnt(0)
    s_barrier
    v_mfma_f32_16x16x32_bf16 v[168:171], a[208:211], v[44:47], v[168:171]
    s_add_u32 s79, s75, s97
    s_addk_i32 s79, 128
    s_addk_i32 m0, 13504
    v_mfma_f32_16x16x32_bf16 v[168:171], a[192:195], v[40:43], v[168:171]
    ds_read_b128 v[32:35], v5 offset:16384
    ds_read_b64_tr_b16 a[224:225], v14 offset:32768
    v_mfma_f32_16x16x32_bf16 v[192:195], a[192:195], v[48:51], v[192:195]
    buffer_load_dwordx4 v3, s[16:19], s79 offen lds
    v_mfma_f32_16x16x32_bf16 v[192:195], a[208:211], v[52:55], v[192:195]
    s_addk_i32 m0, 960
    ds_read_b64_tr_b16 a[226:227], v14 offset:33024
    ds_read_b128 v[36:39], v5 offset:17408
    v_mfma_f32_16x16x32_bf16 v[196:199], a[212:215], v[52:55], v[196:199]
    ds_read_b64_tr_b16 a[240:241], v14 offset:40960
    ds_read_b64_tr_b16 a[242:243], v14 offset:41216
    v_mfma_f32_16x16x32_bf16 v[196:199], a[196:199], v[48:51], v[196:199]
    buffer_load_dwordx4 v3, s[16:19], s79 offen offset:64 lds
    v_mfma_f32_16x16x32_bf16 v[208:211], v[48:51], a[200:203], v[208:211]
    s_addk_i32 s79, 4096
    s_addk_i32 m0, 1088
    ds_read_b64_tr_b16 a[244:245], v17 offset:40960
    v_mfma_f32_16x16x32_bf16 v[208:211], v[52:55], a[216:219], v[208:211]
    ds_read_b64_tr_b16 a[246:247], v17 offset:41216
    ds_read_b64_tr_b16 a[228:229], v17 offset:32768
    v_mfma_f32_16x16x32_bf16 v[216:219], v[52:55], a[220:223], v[216:219]
    ds_read_b64_tr_b16 a[230:231], v17 offset:33024
    ds_read_b64_tr_b16 a[232:233], v14 offset:49152
    v_mfma_f32_16x16x32_bf16 v[216:219], v[48:51], a[204:207], v[216:219]
    ds_read_b64_tr_b16 a[234:235], v14 offset:49408
    ds_read_b64_tr_b16 a[248:249], v14 offset:57344
    v_mfma_f32_16x16x32_bf16 v[220:223], v[56:59], a[204:207], v[220:223]
    ds_read_b64_tr_b16 a[250:251], v14 offset:57600
    ds_read_b64_tr_b16 a[252:253], v17 offset:57344
    v_mfma_f32_16x16x32_bf16 v[220:223], v[60:63], a[220:223], v[220:223]
    ds_read_b64_tr_b16 a[254:255], v17 offset:57600
    ds_read_b64_tr_b16 a[236:237], v17 offset:49152
    v_mfma_f32_16x16x32_bf16 v[212:215], v[60:63], a[216:219], v[212:215]
    ds_read_b64_tr_b16 a[238:239], v17 offset:49408
    ds_read_b128 v[40:43], v5 offset:18432
    v_mfma_f32_16x16x32_bf16 v[212:215], v[56:59], a[200:203], v[212:215]
    buffer_load_dwordx4 v3, s[16:19], s79 offen lds
    v_mfma_f32_16x16x32_bf16 v[204:207], a[196:199], v[56:59], v[204:207]
    s_addk_i32 m0, 960
    ds_read_b128 v[44:47], v5 offset:19456
    ds_read_b128 v[48:51], v5 offset:20480
    v_mfma_f32_16x16x32_bf16 v[204:207], a[212:215], v[60:63], v[204:207]
    ds_read_b128 v[52:55], v5 offset:21504
    v_mfma_f32_16x16x32_bf16 v[200:203], a[208:211], v[60:63], v[200:203]
    buffer_load_dwordx4 v3, s[16:19], s79 offen offset:64 lds
    v_mfma_f32_16x16x32_bf16 v[200:203], a[192:195], v[56:59], v[200:203]
    s_waitcnt lgkmcnt(4)
    s_addk_i32 s97, 256
    s_and_b32 s97, s97, 1023
    v_mfma_f32_16x16x32_bf16 v[96:99], a[224:227], v[32:35], v[96:99]
    s_add_u32 s79, s75, s97
    s_addk_i32 m0, 13376
    ds_read_b128 v[56:59], v5 offset:22528
    v_mfma_f32_16x16x32_bf16 v[96:99], a[240:243], v[36:39], v[96:99]
    ds_read_b128 v[60:63], v5 offset:23552
    v_mfma_f32_16x16x32_bf16 v[100:103], a[244:247], v[36:39], v[100:103]
    buffer_load_dwordx4 v3, s[16:19], s79 offen lds
    v_mfma_f32_16x16x32_bf16 v[100:103], a[228:231], v[32:35], v[100:103]
    s_addk_i32 m0, 960
    v_mfma_f32_16x16x32_bf16 v[112:115], v[32:35], a[232:235], v[112:115]
    v_mfma_f32_16x16x32_bf16 v[112:115], v[36:39], a[248:251], v[112:115]
    buffer_load_dwordx4 v3, s[16:19], s79 offen offset:64 lds
    v_mfma_f32_16x16x32_bf16 v[120:123], v[36:39], a[252:255], v[120:123]
    s_addk_i32 s79, 4096
    s_addk_i32 m0, 1088
    v_mfma_f32_16x16x32_bf16 v[120:123], v[32:35], a[236:239], v[120:123]
    s_waitcnt lgkmcnt(4)
    ds_read_b128 v[32:35], v5 offset:24576
    ds_read_b128 v[36:39], v5 offset:25600
    v_mfma_f32_16x16x32_bf16 v[124:127], v[40:43], a[236:239], v[124:127]
    v_mfma_f32_16x16x32_bf16 v[124:127], v[44:47], a[252:255], v[124:127]
    v_mfma_f32_16x16x32_bf16 v[116:119], v[44:47], a[248:251], v[116:119]
    buffer_load_dwordx4 v3, s[16:19], s79 offen lds
    v_mfma_f32_16x16x32_bf16 v[116:119], v[40:43], a[232:235], v[116:119]
    s_addk_i32 m0, 960
    v_mfma_f32_16x16x32_bf16 v[108:111], a[228:231], v[40:43], v[108:111]
    v_mfma_f32_16x16x32_bf16 v[108:111], a[244:247], v[44:47], v[108:111]
    v_mfma_f32_16x16x32_bf16 v[104:107], a[240:243], v[44:47], v[104:107]
    v_mfma_f32_16x16x32_bf16 v[104:107], a[224:227], v[40:43], v[104:107]
    s_waitcnt lgkmcnt(4)
    ds_read_b128 v[40:43], v5 offset:26624
    ds_read_b128 v[44:47], v5 offset:27648
    v_mfma_f32_16x16x32_bf16 v[128:131], a[224:227], v[48:51], v[128:131]
    buffer_load_dwordx4 v3, s[16:19], s79 offen offset:64 lds
    v_mfma_f32_16x16x32_bf16 v[128:131], a[240:243], v[52:55], v[128:131]
    s_add_u32 s79, s76, s97
    s_add_u32 m0, s71, 0
    v_mfma_f32_16x16x32_bf16 v[132:135], a[244:247], v[52:55], v[132:135]
    v_mfma_f32_16x16x32_bf16 v[132:135], a[228:231], v[48:51], v[132:135]
    buffer_load_dwordx4 v1, s[20:23], s79 offen lds
    v_mfma_f32_16x16x32_bf16 v[144:147], v[48:51], a[232:235], v[144:147]
    s_addk_i32 m0, 960
    v_mfma_f32_16x16x32_bf16 v[144:147], v[52:55], a[248:251], v[144:147]
    v_mfma_f32_16x16x32_bf16 v[152:155], v[52:55], a[252:255], v[152:155]
    v_mfma_f32_16x16x32_bf16 v[152:155], v[48:51], a[236:239], v[152:155]
    s_waitcnt lgkmcnt(4)
    ds_read_b128 v[48:51], v5 offset:28672
    ds_read_b128 v[52:55], v5 offset:29696
    v_mfma_f32_16x16x32_bf16 v[156:159], v[56:59], a[236:239], v[156:159]
    buffer_load_dwordx4 v1, s[20:23], s79 offen offset:64 lds
    v_mfma_f32_16x16x32_bf16 v[156:159], v[60:63], a[252:255], v[156:159]
    s_addk_i32 m0, 960
    v_mfma_f32_16x16x32_bf16 v[148:151], v[60:63], a[248:251], v[148:151]
    v_mfma_f32_16x16x32_bf16 v[148:151], v[56:59], a[232:235], v[148:151]
    v_mfma_f32_16x16x32_bf16 v[140:143], a[228:231], v[56:59], v[140:143]
    v_mfma_f32_16x16x32_bf16 v[140:143], a[244:247], v[60:63], v[140:143]
    buffer_load_dwordx4 v1, s[20:23], s79 offen offset:128 lds
    v_mfma_f32_16x16x32_bf16 v[136:139], a[240:243], v[60:63], v[136:139]
    s_addk_i32 m0, 960
    v_mfma_f32_16x16x32_bf16 v[136:139], a[224:227], v[56:59], v[136:139]
    s_waitcnt lgkmcnt(4)
    ds_read_b128 v[56:59], v5 offset:30720
    ds_read_b128 v[60:63], v5 offset:31744
    v_mfma_f32_16x16x32_bf16 v[160:163], a[224:227], v[32:35], v[160:163]
    v_mfma_f32_16x16x32_bf16 v[160:163], a[240:243], v[36:39], v[160:163]
    buffer_load_dwordx4 v1, s[20:23], s79 offen offset:192 lds
    v_mfma_f32_16x16x32_bf16 v[164:167], a[244:247], v[36:39], v[164:167]
    v_mfma_f32_16x16x32_bf16 v[164:167], a[228:231], v[32:35], v[164:167]
    v_mfma_f32_16x16x32_bf16 v[176:179], v[32:35], a[232:235], v[176:179]
    v_mfma_f32_16x16x32_bf16 v[176:179], v[36:39], a[248:251], v[176:179]
    v_mfma_f32_16x16x32_bf16 v[184:187], v[36:39], a[252:255], v[184:187]
    v_mfma_f32_16x16x32_bf16 v[184:187], v[32:35], a[236:239], v[184:187]
    s_waitcnt lgkmcnt(4)
    v_mfma_f32_16x16x32_bf16 v[188:191], v[40:43], a[236:239], v[188:191]
    v_mfma_f32_16x16x32_bf16 v[188:191], v[44:47], a[252:255], v[188:191]
    v_mfma_f32_16x16x32_bf16 v[180:183], v[44:47], a[248:251], v[180:183]
    v_mfma_f32_16x16x32_bf16 v[180:183], v[40:43], a[232:235], v[180:183]
    v_mfma_f32_16x16x32_bf16 v[172:175], a[228:231], v[40:43], v[172:175]
    v_mfma_f32_16x16x32_bf16 v[172:175], a[244:247], v[44:47], v[172:175]
    s_waitcnt vmcnt(20) lgkmcnt(0)
    s_barrier
    v_mfma_f32_16x16x32_bf16 v[168:171], a[240:243], v[44:47], v[168:171]
    s_add_u32 s79, s75, s97
    s_addk_i32 s79, 128
    s_addk_i32 m0, 13504
    v_mfma_f32_16x16x32_bf16 v[168:171], a[224:227], v[40:43], v[168:171]
    ds_read_b128 v[32:35], v6 offset:0
    ds_read_b128 v[36:39], v6 offset:1024
    v_mfma_f32_16x16x32_bf16 v[192:195], a[224:227], v[48:51], v[192:195]
    buffer_load_dwordx4 v3, s[16:19], s79 offen lds
    v_mfma_f32_16x16x32_bf16 v[192:195], a[240:243], v[52:55], v[192:195]
    ds_read_b128 v[40:43], v6 offset:2048
    ds_read_b128 v[44:47], v6 offset:3072
    v_mfma_f32_16x16x32_bf16 v[196:199], a[244:247], v[52:55], v[196:199]
    s_addk_i32 m0, 960
    v_mfma_f32_16x16x32_bf16 v[196:199], a[228:231], v[48:51], v[196:199]
    v_mfma_f32_16x16x32_bf16 v[208:211], v[48:51], a[232:235], v[208:211]
    v_mfma_f32_16x16x32_bf16 v[208:211], v[52:55], a[248:251], v[208:211]
    v_mfma_f32_16x16x32_bf16 v[216:219], v[52:55], a[252:255], v[216:219]
    buffer_load_dwordx4 v3, s[16:19], s79 offen offset:64 lds
    v_mfma_f32_16x16x32_bf16 v[216:219], v[48:51], a[236:239], v[216:219]
    ds_read_b128 v[48:51], v6 offset:8192
    ds_read_b128 v[52:55], v6 offset:9216
    v_mfma_f32_16x16x32_bf16 v[220:223], v[56:59], a[236:239], v[220:223]
    v_mfma_f32_16x16x32_bf16 v[220:223], v[60:63], a[252:255], v[220:223]
    v_mfma_f32_16x16x32_bf16 v[212:215], v[60:63], a[248:251], v[212:215]
    s_addk_i32 s79, 4096
    s_addk_i32 m0, 1088
    v_mfma_f32_16x16x32_bf16 v[212:215], v[56:59], a[232:235], v[212:215]
    v_mfma_f32_16x16x32_bf16 v[204:207], a[228:231], v[56:59], v[204:207]
    v_mfma_f32_16x16x32_bf16 v[204:207], a[244:247], v[60:63], v[204:207]
    v_mfma_f32_16x16x32_bf16 v[200:203], a[240:243], v[60:63], v[200:203]
    buffer_load_dwordx4 v3, s[16:19], s79 offen lds
    v_mfma_f32_16x16x32_bf16 v[200:203], a[224:227], v[56:59], v[200:203]
    s_waitcnt lgkmcnt(2)
    ds_read_b128 v[56:59], v6 offset:10240
    ds_read_b128 v[60:63], v6 offset:11264
    v_mfma_f32_16x16x32_bf16 v[224:227], a[0:3], v[32:35], 0
    v_mfma_f32_16x16x32_bf16 v[224:227], a[16:19], v[36:39], v[224:227]
    v_mfma_f32_16x16x32_bf16 v[224:227], a[32:35], v[40:43], v[224:227]
    s_addk_i32 m0, 960
    v_mfma_f32_16x16x32_bf16 v[224:227], a[48:51], v[44:47], v[224:227]
    v_mfma_f32_16x16x32_bf16 v[228:231], a[52:55], v[44:47], 0
    v_mul_f32 v128, s95, v128
    v_mul_f32 v129, s95, v129
    v_mfma_f32_16x16x32_bf16 v[228:231], a[36:39], v[40:43], v[228:231]
    v_cvt_pk_bf16_f32 v128, v128, v129
    v_mul_f32 v130, s95, v130
    v_mfma_f32_16x16x32_bf16 v[228:231], a[20:23], v[36:39], v[228:231]
    buffer_load_dwordx4 v3, s[16:19], s79 offen offset:64 lds
    v_mfma_f32_16x16x32_bf16 v[228:231], a[4:7], v[32:35], v[228:231]
    v_mul_f32 v131, s95, v131
    v_cvt_pk_bf16_f32 v129, v130, v131
    v_mfma_f32_16x16x32_bf16 v[240:243], v[32:35], a[8:11], 0
    v_mul_f32 v132, s95, v132
    v_mfma_f32_16x16x32_bf16 v[240:243], v[36:39], a[24:27], v[240:243]
    v_mfma_f32_16x16x32_bf16 v[240:243], v[40:43], a[40:43], v[240:243]
    s_add_u32 s79, s99, 32768
    s_addk_i32 m0, 13376
    v_mul_f32 v133, s95, v133
    v_mfma_f32_16x16x32_bf16 v[240:243], v[44:47], a[56:59], v[240:243]
    v_cvt_pk_bf16_f32 v130, v132, v133
    v_mfma_f32_16x16x32_bf16 v[248:251], v[44:47], a[60:63], 0
    v_mul_f32 v134, s95, v134
    v_mfma_f32_16x16x32_bf16 v[248:251], v[40:43], a[44:47], v[248:251]
    v_mul_f32 v135, s95, v135
    v_mfma_f32_16x16x32_bf16 v[248:251], v[36:39], a[28:31], v[248:251]
    buffer_load_dwordx4 v1, s[4:7], s79 offen lds
    v_mfma_f32_16x16x32_bf16 v[248:251], v[32:35], a[12:15], v[248:251]
    s_waitcnt lgkmcnt(0)
    v_cvt_pk_bf16_f32 v131, v134, v135
    s_add_u32 s80, s74, 16384
    v_mfma_f32_16x16x32_bf16 v[252:255], v[48:51], a[12:15], 0
    ds_read_b128 v[32:35], v6 offset:4096
    ds_read_b128 v[36:39], v6 offset:5120
    v_mfma_f32_16x16x32_bf16 v[252:255], v[52:55], a[28:31], v[252:255]
    buffer_store_dwordx4 v[128:131], v20, s[40:43], s80 offen offset:0 sc1
    v_mfma_f32_16x16x32_bf16 v[252:255], v[56:59], a[44:47], v[252:255]
    s_addk_i32 m0, 960
    ds_read_b128 v[40:43], v6 offset:6144
    ds_read_b128 v[44:47], v6 offset:7168
    v_mfma_f32_16x16x32_bf16 v[252:255], v[60:63], a[60:63], v[252:255]
    v_mul_f32 v136, s95, v136
    v_mfma_f32_16x16x32_bf16 v[244:247], v[60:63], a[56:59], 0
    v_mul_f32 v137, s95, v137
    v_mfma_f32_16x16x32_bf16 v[244:247], v[56:59], a[40:43], v[244:247]
    v_cvt_pk_bf16_f32 v136, v136, v137
    v_mfma_f32_16x16x32_bf16 v[244:247], v[52:55], a[24:27], v[244:247]
    buffer_load_dwordx4 v1, s[4:7], s79 offen offset:64 lds
    v_mfma_f32_16x16x32_bf16 v[244:247], v[48:51], a[8:11], v[244:247]
    v_mul_f32 v138, s95, v138
    v_mfma_f32_16x16x32_bf16 v[236:239], a[4:7], v[48:51], 0
    v_mul_f32 v139, s95, v139
    v_mfma_f32_16x16x32_bf16 v[236:239], a[20:23], v[52:55], v[236:239]
    v_cvt_pk_bf16_f32 v137, v138, v139
    v_mfma_f32_16x16x32_bf16 v[236:239], a[36:39], v[56:59], v[236:239]
    s_add_u32 s79, s100, 32768
    s_addk_i32 m0, 1088
    v_mul_f32 v140, s95, v140
    v_mfma_f32_16x16x32_bf16 v[236:239], a[52:55], v[60:63], v[236:239]
    v_mul_f32 v141, s95, v141
    v_mfma_f32_16x16x32_bf16 v[232:235], a[48:51], v[60:63], 0
    v_cvt_pk_bf16_f32 v138, v140, v141
    v_mfma_f32_16x16x32_bf16 v[232:235], a[32:35], v[56:59], v[232:235]
    v_mul_f32 v142, s95, v142
    v_mfma_f32_16x16x32_bf16 v[232:235], a[16:19], v[52:55], v[232:235]
    buffer_load_dwordx4 v1, s[4:7], s79 offen lds
    v_mfma_f32_16x16x32_bf16 v[232:235], a[0:3], v[48:51], v[232:235]
    s_waitcnt lgkmcnt(0)
    ds_read_b128 v[48:51], v6 offset:12288
    v_mul_f32 v143, s95, v143
    v_mfma_f32_16x16x32_bf16 v[224:227], a[64:67], v[32:35], v[224:227]
    ds_read_b128 v[52:55], v6 offset:13312
    v_cvt_pk_bf16_f32 v139, v142, v143
    v_mfma_f32_16x16x32_bf16 v[224:227], a[80:83], v[36:39], v[224:227]
    buffer_store_dwordx4 v[136:139], v2, s[40:43], s80 offen offset:0 sc1
    v_mfma_f32_16x16x32_bf16 v[224:227], a[96:99], v[40:43], v[224:227]
    s_addk_i32 m0, 960
    ds_read_b128 v[56:59], v6 offset:14336
    ds_read_b128 v[60:63], v6 offset:15360
    v_mfma_f32_16x16x32_bf16 v[224:227], a[112:115], v[44:47], v[224:227]
    v_mul_f32 v144, s82, v144
    v_mfma_f32_16x16x32_bf16 v[228:231], a[116:119], v[44:47], v[228:231]
    v_mul_f32 v145, s82, v145
    v_mfma_f32_16x16x32_bf16 v[228:231], a[100:103], v[40:43], v[228:231]
    v_cvt_pk_bf16_f32 v144, v144, v145
    v_mfma_f32_16x16x32_bf16 v[228:231], a[84:87], v[36:39], v[228:231]
    buffer_load_dwordx4 v1, s[4:7], s79 offen offset:64 lds
    v_mfma_f32_16x16x32_bf16 v[228:231], a[68:71], v[32:35], v[228:231]
    v_mul_f32 v146, s82, v146
    v_mfma_f32_16x16x32_bf16 v[240:243], v[32:35], a[72:75], v[240:243]
    v_mul_f32 v147, s82, v147
    v_mfma_f32_16x16x32_bf16 v[240:243], v[36:39], a[88:91], v[240:243]
    v_cvt_pk_bf16_f32 v145, v146, v147
    v_mfma_f32_16x16x32_bf16 v[240:243], v[40:43], a[104:107], v[240:243]
    s_xor_b32 s79, s99, 512
    s_add_u32 s79, s79, 32768
    s_addk_i32 m0, 13376
    v_mfma_f32_16x16x32_bf16 v[240:243], v[44:47], a[120:123], v[240:243]
    v_mul_f32 v148, s82, v148
    v_mul_f32 v149, s82, v149
    v_mfma_f32_16x16x32_bf16 v[248:251], v[44:47], a[124:127], v[248:251]
    v_cvt_pk_bf16_f32 v146, v148, v149
    v_mfma_f32_16x16x32_bf16 v[248:251], v[40:43], a[108:111], v[248:251]
    v_mfma_f32_16x16x32_bf16 v[248:251], v[36:39], a[92:95], v[248:251]
    buffer_load_dwordx4 v1, s[4:7], s79 offen lds
    v_mfma_f32_16x16x32_bf16 v[248:251], v[32:35], a[76:79], v[248:251]
    s_waitcnt lgkmcnt(0)
    v_mul_f32 v150, s82, v150
    v_mul_f32 v151, s82, v151
    v_mfma_f32_16x16x32_bf16 v[252:255], v[48:51], a[76:79], v[252:255]
    ds_read_b128 v[32:35], v6 offset:16384
    v_cvt_pk_bf16_f32 v147, v150, v151
    v_mfma_f32_16x16x32_bf16 v[252:255], v[52:55], a[92:95], v[252:255]
    buffer_store_dwordx4 v[144:147], v21, s[40:43], s80 offen offset:0 sc1
    v_mfma_f32_16x16x32_bf16 v[252:255], v[56:59], a[108:111], v[252:255]
    s_addk_i32 m0, 960
    ds_read_b128 v[36:39], v6 offset:17408
    ds_read_b128 v[40:43], v6 offset:18432
    v_mfma_f32_16x16x32_bf16 v[252:255], v[60:63], a[124:127], v[252:255]
    ds_read_b128 v[44:47], v6 offset:19456
    v_mul_f32 v152, s82, v152
    v_mfma_f32_16x16x32_bf16 v[244:247], v[60:63], a[120:123], v[244:247]
    v_mul_f32 v153, s82, v153
    v_mfma_f32_16x16x32_bf16 v[244:247], v[56:59], a[104:107], v[244:247]
    v_mfma_f32_16x16x32_bf16 v[244:247], v[52:55], a[88:91], v[244:247]
    buffer_load_dwordx4 v1, s[4:7], s79 offen offset:64 lds
    v_mfma_f32_16x16x32_bf16 v[244:247], v[48:51], a[72:75], v[244:247]
    v_cvt_pk_bf16_f32 v152, v152, v153
    v_mul_f32 v154, s82, v154
    v_mfma_f32_16x16x32_bf16 v[236:239], a[68:71], v[48:51], v[236:239]
    v_mul_f32 v155, s82, v155
    v_mfma_f32_16x16x32_bf16 v[236:239], a[84:87], v[52:55], v[236:239]
    v_cvt_pk_bf16_f32 v153, v154, v155
    v_mfma_f32_16x16x32_bf16 v[236:239], a[100:103], v[56:59], v[236:239]
    s_xor_b32 s79, s100, 512
    s_add_u32 s79, s79, 32768
    s_addk_i32 m0, 1088
    v_mfma_f32_16x16x32_bf16 v[236:239], a[116:119], v[60:63], v[236:239]
    v_mul_f32 v156, s82, v156
    v_mul_f32 v157, s82, v157
    v_mfma_f32_16x16x32_bf16 v[232:235], a[112:115], v[60:63], v[232:235]
    v_mfma_f32_16x16x32_bf16 v[232:235], a[96:99], v[56:59], v[232:235]
    v_cvt_pk_bf16_f32 v154, v156, v157
    v_mfma_f32_16x16x32_bf16 v[232:235], a[80:83], v[52:55], v[232:235]
    buffer_load_dwordx4 v1, s[4:7], s79 offen lds
    v_mfma_f32_16x16x32_bf16 v[232:235], a[64:67], v[48:51], v[232:235]
    s_waitcnt lgkmcnt(0)
    v_mul_f32 v158, s82, v158
    v_mul_f32 v159, s82, v159
    v_mfma_f32_16x16x32_bf16 v[224:227], a[128:131], v[32:35], v[224:227]
    ds_read_b128 v[48:51], v6 offset:24576
    v_cvt_pk_bf16_f32 v155, v158, v159
    v_mfma_f32_16x16x32_bf16 v[224:227], a[144:147], v[36:39], v[224:227]
    buffer_store_dwordx4 v[152:155], v21, s[40:43], s80 offen offset:1024 sc1
    v_mfma_f32_16x16x32_bf16 v[224:227], a[160:163], v[40:43], v[224:227]
    s_addk_i32 m0, 960
    ds_read_b128 v[52:55], v6 offset:25600
    ds_read_b128 v[56:59], v6 offset:26624
    v_mfma_f32_16x16x32_bf16 v[224:227], a[176:179], v[44:47], v[224:227]
    ds_read_b128 v[60:63], v6 offset:27648
    v_mfma_f32_16x16x32_bf16 v[228:231], a[180:183], v[44:47], v[228:231]
    v_mfma_f32_16x16x32_bf16 v[228:231], a[164:167], v[40:43], v[228:231]
    v_mfma_f32_16x16x32_bf16 v[228:231], a[148:151], v[36:39], v[228:231]
    v_mul_f32 v96, s95, v96
    v_mul_f32 v97, s95, v97
    v_mfma_f32_16x16x32_bf16 v[228:231], a[132:135], v[32:35], v[228:231]
    buffer_load_dwordx4 v1, s[4:7], s79 offen offset:64 lds
    v_mfma_f32_16x16x32_bf16 v[240:243], v[32:35], a[136:139], v[240:243]
    v_cvt_pk_bf16_f32 v96, v96, v97
    v_mul_f32 v98, s95, v98
    v_mfma_f32_16x16x32_bf16 v[240:243], v[36:39], a[152:155], v[240:243]
PG_2:
    s_cbranch_execz PG_6
    v_mul_f32 v99, s95, v99
    v_cvt_pk_bf16_f32 v97, v98, v99
    v_mfma_f32_16x16x32_bf16 v[240:243], v[40:43], a[168:171], v[240:243]
    v_mul_f32 v100, s95, v100
    v_mfma_f32_16x16x32_bf16 v[240:243], v[44:47], a[184:187], v[240:243]
    v_mfma_f32_16x16x32_bf16 v[248:251], v[44:47], a[188:191], v[248:251]
    v_mul_f32 v101, s95, v101
    v_mfma_f32_16x16x32_bf16 v[248:251], v[40:43], a[172:175], v[248:251]
    v_cvt_pk_bf16_f32 v98, v100, v101
    v_mfma_f32_16x16x32_bf16 v[248:251], v[36:39], a[156:159], v[248:251]
    v_mul_f32 v102, s95, v102
    v_mfma_f32_16x16x32_bf16 v[248:251], v[32:35], a[140:143], v[248:251]
    s_waitcnt lgkmcnt(0)
    ds_read_b128 v[32:35], v6 offset:20480
    v_mul_f32 v103, s95, v103
    v_mfma_f32_16x16x32_bf16 v[252:255], v[48:51], a[140:143], v[252:255]
    ds_read_b128 v[36:39], v6 offset:21504
    v_cvt_pk_bf16_f32 v99, v102, v103
    v_mfma_f32_16x16x32_bf16 v[252:255], v[52:55], a[156:159], v[252:255]
    s_add_u32 s80, s74, 0
    ds_read_b128 v[40:43], v6 offset:22528
    ds_read_b128 v[44:47], v6 offset:23552
    v_mfma_f32_16x16x32_bf16 v[252:255], v[56:59], a[172:175], v[252:255]
    v_mfma_f32_16x16x32_bf16 v[252:255], v[60:63], a[188:191], v[252:255]
    buffer_store_dwordx4 v[96:99], v20, s[40:43], s80 offen offset:0 sc1
    v_mfma_f32_16x16x32_bf16 v[244:247], v[60:63], a[184:187], v[244:247]
    v_mfma_f32_16x16x32_bf16 v[244:247], v[56:59], a[168:171], v[244:247]
    v_mul_f32 v104, s95, v104
    v_mfma_f32_16x16x32_bf16 v[244:247], v[52:55], a[152:155], v[244:247]
    v_mul_f32 v105, s95, v105
    v_mfma_f32_16x16x32_bf16 v[244:247], v[48:51], a[136:139], v[244:247]
    v_cvt_pk_bf16_f32 v104, v104, v105
    v_mfma_f32_16x16x32_bf16 v[236:239], a[132:135], v[48:51], v[236:239]
    v_mul_f32 v106, s95, v106
    v_mfma_f32_16x16x32_bf16 v[236:239], a[148:151], v[52:55], v[236:239]
    v_mfma_f32_16x16x32_bf16 v[236:239], a[164:167], v[56:59], v[236:239]
    v_mul_f32 v107, s95, v107
    v_mfma_f32_16x16x32_bf16 v[236:239], a[180:183], v[60:63], v[236:239]
    v_cvt_pk_bf16_f32 v105, v106, v107
    v_mfma_f32_16x16x32_bf16 v[232:235], a[176:179], v[60:63], v[232:235]
    v_mul_f32 v108, s95, v108
    v_mfma_f32_16x16x32_bf16 v[232:235], a[160:163], v[56:59], v[232:235]
    v_mul_f32 v109, s95, v109
    v_mfma_f32_16x16x32_bf16 v[232:235], a[144:147], v[52:55], v[232:235]
    v_cvt_pk_bf16_f32 v106, v108, v109
    v_mfma_f32_16x16x32_bf16 v[232:235], a[128:131], v[48:51], v[232:235]
    s_waitcnt lgkmcnt(0)
    ds_read_b128 v[48:51], v6 offset:28672
    v_mul_f32 v110, s95, v110
    v_mfma_f32_16x16x32_bf16 v[224:227], a[192:195], v[32:35], v[224:227]
    ds_read_b128 v[52:55], v6 offset:29696
    v_mul_f32 v111, s95, v111
    v_mfma_f32_16x16x32_bf16 v[224:227], a[208:211], v[36:39], v[224:227]
    ds_read_b128 v[56:59], v6 offset:30720
    ds_read_b128 v[60:63], v6 offset:31744
    v_mfma_f32_16x16x32_bf16 v[224:227], a[224:227], v[40:43], v[224:227]
    v_cvt_pk_bf16_f32 v107, v110, v111
    v_mfma_f32_16x16x32_bf16 v[224:227], a[240:243], v[44:47], v[224:227]
    buffer_store_dwordx4 v[104:107], v2, s[40:43], s80 offen offset:0 sc1
    v_mfma_f32_16x16x32_bf16 v[228:231], a[244:247], v[44:47], v[228:231]
    v_mfma_f32_16x16x32_bf16 v[228:231], a[228:231], v[40:43], v[228:231]
    v_mul_f32 v112, s82, v112
    v_mfma_f32_16x16x32_bf16 v[228:231], a[212:215], v[36:39], v[228:231]
    v_mul_f32 v113, s82, v113
    v_mfma_f32_16x16x32_bf16 v[228:231], a[196:199], v[32:35], v[228:231]
    v_cvt_pk_bf16_f32 v112, v112, v113
    v_mfma_f32_16x16x32_bf16 v[240:243], v[32:35], a[200:203], v[240:243]
    v_mfma_f32_16x16x32_bf16 v[240:243], v[36:39], a[216:219], v[240:243]
    v_mul_f32 v114, s82, v114
    v_mfma_f32_16x16x32_bf16 v[240:243], v[40:43], a[232:235], v[240:243]
    v_mul_f32 v115, s82, v115
    v_mfma_f32_16x16x32_bf16 v[240:243], v[44:47], a[248:251], v[240:243]
    v_cvt_pk_bf16_f32 v113, v114, v115
    v_mfma_f32_16x16x32_bf16 v[248:251], v[44:47], a[252:255], v[248:251]
    v_mul_f32 v116, s82, v116
    v_mfma_f32_16x16x32_bf16 v[248:251], v[40:43], a[236:239], v[248:251]
    v_mul_f32 v117, s82, v117
    v_mfma_f32_16x16x32_bf16 v[248:251], v[36:39], a[220:223], v[248:251]
    v_cvt_pk_bf16_f32 v114, v116, v117
    v_mfma_f32_16x16x32_bf16 v[248:251], v[32:35], a[204:207], v[248:251]
    s_waitcnt lgkmcnt(0)
    v_mfma_f32_16x16x32_bf16 v[252:255], v[48:51], a[204:207], v[252:255]
    v_mul_f32 v118, s82, v118
    v_mfma_f32_16x16x32_bf16 v[252:255], v[52:55], a[220:223], v[252:255]
    s_waitcnt vmcnt(26) lgkmcnt(0)
    s_barrier
    v_mfma_f32_16x16x32_bf16 v[252:255], v[56:59], a[236:239], v[252:255]
    s_addk_i32 s97, 256
    s_and_b32 s97, s97, 1023
    s_add_u32 s79, s75, s97
    v_mfma_f32_16x16x32_bf16 v[252:255], v[60:63], a[252:255], v[252:255]
    s_addk_i32 m0, 13376
    v_mul_f32 v119, s82, v119
    v_cvt_pk_bf16_f32 v115, v118, v119
    v_mfma_f32_16x16x32_bf16 v[244:247], v[60:63], a[248:251], v[244:247]
    buffer_store_dwordx4 v[112:115], v21, s[40:43], s80 offen offset:0 sc1
    v_mfma_f32_16x16x32_bf16 v[244:247], v[56:59], a[232:235], v[244:247]
    buffer_load_dwordx4 v3, s[16:19], s79 offen lds
    v_mfma_f32_16x16x32_bf16 v[244:247], v[52:55], a[216:219], v[244:247]
    s_addk_i32 m0, 960
    ds_read_b128 v[64:67], v9 offset:32768
    ds_read_b128 v[32:35], v12 offset:49152
    v_mfma_f32_16x16x32_bf16 v[244:247], v[48:51], a[200:203], v[244:247]
    ds_read_b128 v[68:71], v9 offset:33792
    ds_read_b128 v[36:39], v12 offset:50176
    v_mfma_f32_16x16x32_bf16 v[236:239], a[196:199], v[48:51], v[236:239]
    buffer_load_dwordx4 v3, s[16:19], s79 offen offset:64 lds
    v_mfma_f32_16x16x32_bf16 v[236:239], a[212:215], v[52:55], v[236:239]
    s_addk_i32 s79, 4096
    ds_read_b128 v[44:47], v12 offset:58368
    ds_read_b128 v[40:43], v12 offset:57344
    v_mfma_f32_16x16x32_bf16 v[236:239], a[228:231], v[56:59], v[236:239]
    s_addk_i32 m0, 1088
    v_mul_f32 v120, s82, v120
    v_mul_f32 v121, s82, v121
    v_mfma_f32_16x16x32_bf16 v[236:239], a[244:247], v[60:63], v[236:239]
    ds_read_b128 v[72:75], v9 offset:34816
    v_cvt_pk_bf16_f32 v120, v120, v121
    v_mfma_f32_16x16x32_bf16 v[232:235], a[240:243], v[60:63], v[232:235]
    buffer_load_dwordx4 v3, s[16:19], s79 offen lds
    v_mfma_f32_16x16x32_bf16 v[232:235], a[224:227], v[56:59], v[232:235]
    s_addk_i32 m0, 960
    ds_read_b128 v[76:79], v9 offset:35840
    v_mul_f32 v122, s82, v122
    v_mfma_f32_16x16x32_bf16 v[232:235], a[208:211], v[52:55], v[232:235]
    v_mul_f32 v123, s82, v123
    v_cvt_pk_bf16_f32 v121, v122, v123
    v_mfma_f32_16x16x32_bf16 v[232:235], a[192:195], v[48:51], v[232:235]
    s_waitcnt lgkmcnt(2)
    ds_read_b128 v[80:83], v9 offset:36864
    v_mul_f32 v124, s82, v124
    v_mfma_f32_16x16x32_bf16 v[128:131], v[64:67], v[32:35], 0
    buffer_load_dwordx4 v3, s[16:19], s79 offen offset:64 lds
    v_mfma_f32_16x16x32_bf16 v[128:131], v[68:71], v[36:39], v[128:131]
    s_add_u32 s79, s76, s97
    ds_read_b128 v[84:87], v9 offset:37888
    v_mul_f32 v125, s82, v125
    v_mfma_f32_16x16x32_bf16 v[144:147], v[68:71], v[44:47], 0
    s_addk_i32 m0, 13376
    v_cvt_pk_bf16_f32 v122, v124, v125
    v_mul_f32 v126, s82, v126
    v_mfma_f32_16x16x32_bf16 v[144:147], v[64:67], v[40:43], v[144:147]
    s_waitcnt lgkmcnt(2)
    ds_read_b128 v[64:67], v9 offset:38912
    ds_read_b128 v[68:71], v9 offset:39936
    v_mfma_f32_16x16x32_bf16 v[148:151], v[72:75], v[40:43], 0
    buffer_load_dwordx4 v1, s[20:23], s79 offen lds
    v_mfma_f32_16x16x32_bf16 v[148:151], v[76:79], v[44:47], v[148:151]
    s_addk_i32 m0, 960
    v_mul_f32 v127, s82, v127
    v_cvt_pk_bf16_f32 v123, v126, v127
    v_mfma_f32_16x16x32_bf16 v[132:135], v[76:79], v[36:39], 0
    buffer_store_dwordx4 v[120:123], v21, s[40:43], s80 offen offset:1024 sc1
    v_mfma_f32_16x16x32_bf16 v[132:135], v[72:75], v[32:35], v[132:135]
    s_waitcnt lgkmcnt(2)
    ds_read_b128 v[72:75], v10 offset:0
    ds_read_b128 v[48:51], v12 offset:51200
    v_mfma_f32_16x16x32_bf16 v[136:139], v[80:83], v[32:35], 0
    buffer_load_dwordx4 v1, s[20:23], s79 offen offset:64 lds
    v_mfma_f32_16x16x32_bf16 v[136:139], v[84:87], v[36:39], v[136:139]
    s_addk_i32 m0, 960
    ds_read_b128 v[76:79], v10 offset:1024
    ds_read_b128 v[52:55], v12 offset:52224
    v_mfma_f32_16x16x32_bf16 v[152:155], v[84:87], v[44:47], 0
    ds_read_b128 v[60:63], v12 offset:60416
    ds_read_b128 v[56:59], v12 offset:59392
    v_mfma_f32_16x16x32_bf16 v[152:155], v[80:83], v[40:43], v[152:155]
    s_waitcnt lgkmcnt(6)
    ds_read_b128 v[80:83], v10 offset:2048
    ds_read_b128 v[84:87], v10 offset:3072
    v_mfma_f32_16x16x32_bf16 v[156:159], v[64:67], v[40:43], 0
    buffer_load_dwordx4 v1, s[20:23], s79 offen offset:128 lds
    v_mfma_f32_16x16x32_bf16 v[156:159], v[68:71], v[44:47], v[156:159]
    s_addk_i32 m0, 960
    v_mfma_f32_16x16x32_bf16 v[140:143], v[68:71], v[36:39], 0
    v_mfma_f32_16x16x32_bf16 v[140:143], v[64:67], v[32:35], v[140:143]
    s_waitcnt lgkmcnt(2)
    ds_read_b128 v[64:67], v10 offset:4096
    ds_read_b128 v[68:71], v10 offset:5120
    v_mfma_f32_16x16x32_bf16 v[128:131], v[72:75], v[48:51], v[128:131]
    buffer_load_dwordx4 v1, s[20:23], s79 offen offset:192 lds
    v_mfma_f32_16x16x32_bf16 v[128:131], v[76:79], v[52:55], v[128:131]
    v_mfma_f32_16x16x32_bf16 v[144:147], v[76:79], v[60:63], v[144:147]
    v_mfma_f32_16x16x32_bf16 v[144:147], v[72:75], v[56:59], v[144:147]
    s_waitcnt lgkmcnt(2)
    ds_read_b128 v[72:75], v10 offset:6144
    ds_read_b128 v[76:79], v10 offset:7168
    v_mfma_f32_16x16x32_bf16 v[148:151], v[80:83], v[56:59], v[148:151]
    v_mfma_f32_16x16x32_bf16 v[148:151], v[84:87], v[60:63], v[148:151]
    v_mfma_f32_16x16x32_bf16 v[132:135], v[84:87], v[52:55], v[132:135]
    v_mfma_f32_16x16x32_bf16 v[132:135], v[80:83], v[48:51], v[132:135]
    s_waitcnt vmcnt(24) lgkmcnt(0)
    s_barrier
    v_mfma_f32_16x16x32_bf16 v[136:139], v[64:67], v[48:51], v[136:139]
    s_add_u32 s79, s75, s97
    s_addk_i32 s79, 128
    s_addk_i32 m0, 13504
    v_mfma_f32_16x16x32_bf16 v[136:139], v[68:71], v[52:55], v[136:139]
    ds_read_b128 v[80:83], v10 offset:16384
    ds_read_b128 v[32:35], v11 offset:0
    v_mfma_f32_16x16x32_bf16 v[152:155], v[68:71], v[60:63], v[152:155]
    ds_read_b128 v[84:87], v10 offset:17408
    ds_read_b128 v[36:39], v11 offset:1024
    ds_read_b128 v[44:47], v11 offset:9216
    ds_read_b128 v[40:43], v11 offset:8192
    v_mfma_f32_16x16x32_bf16 v[152:155], v[64:67], v[56:59], v[152:155]
    buffer_load_dwordx4 v3, s[16:19], s79 offen lds
    s_addk_i32 m0, 960
    v_mfma_f32_16x16x32_bf16 v[156:159], v[72:75], v[56:59], v[156:159]
    ds_read_b128 v[64:67], v10 offset:18432
    ds_read_b128 v[68:71], v10 offset:19456
    v_mfma_f32_16x16x32_bf16 v[156:159], v[76:79], v[60:63], v[156:159]
    buffer_load_dwordx4 v3, s[16:19], s79 offen offset:64 lds
    v_mfma_f32_16x16x32_bf16 v[140:143], v[76:79], v[52:55], v[140:143]
    s_addk_i32 s79, 4096
    s_addk_i32 m0, 1088
    v_mfma_f32_16x16x32_bf16 v[140:143], v[72:75], v[48:51], v[140:143]
    s_waitcnt lgkmcnt(2)
    ds_read_b128 v[72:75], v10 offset:20480
    ds_read_b128 v[76:79], v10 offset:21504
    v_mfma_f32_16x16x32_bf16 v[128:131], v[80:83], v[32:35], v[128:131]
    buffer_load_dwordx4 v3, s[16:19], s79 offen lds
    s_addk_i32 m0, 960
    v_mfma_f32_16x16x32_bf16 v[128:131], v[84:87], v[36:39], v[128:131]
    v_mfma_f32_16x16x32_bf16 v[144:147], v[84:87], v[44:47], v[144:147]
    buffer_load_dwordx4 v3, s[16:19], s79 offen offset:64 lds
    v_mfma_f32_16x16x32_bf16 v[144:147], v[80:83], v[40:43], v[144:147]
    s_waitcnt lgkmcnt(2)
    s_addk_i32 s97, 256
    s_and_b32 s97, s97, 1023
    s_add_u32 s79, s75, s97
    s_addk_i32 m0, 13376
    v_mfma_f32_16x16x32_bf16 v[148:151], v[64:67], v[40:43], v[148:151]
    ds_read_b128 v[80:83], v10 offset:22528
    ds_read_b128 v[84:87], v10 offset:23552
    v_mfma_f32_16x16x32_bf16 v[148:151], v[68:71], v[44:47], v[148:151]
    buffer_load_dwordx4 v3, s[16:19], s79 offen lds
    s_addk_i32 m0, 960
    v_mfma_f32_16x16x32_bf16 v[132:135], v[68:71], v[36:39], v[132:135]
    v_mfma_f32_16x16x32_bf16 v[132:135], v[64:67], v[32:35], v[132:135]
    s_waitcnt lgkmcnt(2)
    ds_read_b128 v[64:67], v8 offset:16384
    ds_read_b128 v[48:51], v11 offset:2048
    v_mfma_f32_16x16x32_bf16 v[136:139], v[72:75], v[32:35], v[136:139]
    buffer_load_dwordx4 v3, s[16:19], s79 offen offset:64 lds
    s_addk_i32 s79, 4096
    s_addk_i32 m0, 1088
    v_mfma_f32_16x16x32_bf16 v[136:139], v[76:79], v[36:39], v[136:139]
    ds_read_b128 v[68:71], v8 offset:17408
    ds_read_b128 v[52:55], v11 offset:3072
    v_mfma_f32_16x16x32_bf16 v[152:155], v[76:79], v[44:47], v[152:155]
    buffer_load_dwordx4 v3, s[16:19], s79 offen lds
    ds_read_b128 v[60:63], v11 offset:11264
    ds_read_b128 v[56:59], v11 offset:10240
    s_addk_i32 m0, 960
    v_mfma_f32_16x16x32_bf16 v[152:155], v[72:75], v[40:43], v[152:155]
    s_waitcnt lgkmcnt(6)
    ds_read_b128 v[72:75], v8 offset:18432
    ds_read_b128 v[76:79], v8 offset:19456
    v_mfma_f32_16x16x32_bf16 v[156:159], v[80:83], v[40:43], v[156:159]
    buffer_load_dwordx4 v3, s[16:19], s79 offen offset:64 lds
    v_mfma_f32_16x16x32_bf16 v[156:159], v[84:87], v[44:47], v[156:159]
    s_add_u32 s79, s76, s97
    s_addk_i32 m0, 13376
    v_mfma_f32_16x16x32_bf16 v[140:143], v[84:87], v[36:39], v[140:143]
    v_mfma_f32_16x16x32_bf16 v[140:143], v[80:83], v[32:35], v[140:143]
    s_waitcnt lgkmcnt(2)
    buffer_load_dwordx4 v1, s[20:23], s79 offen lds
    s_addk_i32 m0, 960
    v_mfma_f32_16x16x32_bf16 v[128:131], v[64:67], v[48:51], v[128:131]
    ds_read_b128 v[80:83], v8 offset:20480
    ds_read_b128 v[84:87], v8 offset:21504
    v_mfma_f32_16x16x32_bf16 v[128:131], v[68:71], v[52:55], v[128:131]
    buffer_load_dwordx4 v1, s[20:23], s79 offen offset:64 lds
    v_mfma_f32_16x16x32_bf16 v[144:147], v[68:71], v[60:63], v[144:147]
    s_addk_i32 m0, 960
    v_mfma_f32_16x16x32_bf16 v[144:147], v[64:67], v[56:59], v[144:147]
    s_waitcnt lgkmcnt(2)
    ds_read_b128 v[64:67], v8 offset:22528
    ds_read_b128 v[68:71], v8 offset:23552
    v_mfma_f32_16x16x32_bf16 v[148:151], v[72:75], v[56:59], v[148:151]
    buffer_load_dwordx4 v1, s[20:23], s79 offen offset:128 lds
    s_addk_i32 m0, 960
    v_mfma_f32_16x16x32_bf16 v[148:151], v[76:79], v[60:63], v[148:151]
    v_mfma_f32_16x16x32_bf16 v[132:135], v[76:79], v[52:55], v[132:135]
    buffer_load_dwordx4 v1, s[20:23], s79 offen offset:192 lds
    v_mfma_f32_16x16x32_bf16 v[132:135], v[72:75], v[48:51], v[132:135]
    s_waitcnt lgkmcnt(2)
    v_mfma_f32_16x16x32_bf16 v[136:139], v[80:83], v[48:51], v[136:139]
    s_waitcnt vmcnt(24) lgkmcnt(0)
    s_barrier
    v_mfma_f32_16x16x32_bf16 v[136:139], v[84:87], v[52:55], v[136:139]
    s_add_u32 s79, s75, s97
    ds_read_b128 v[32:35], v5 offset:32768
    ds_read_b128 v[36:39], v5 offset:33792
    v_mfma_f32_16x16x32_bf16 v[152:155], v[84:87], v[60:63], v[152:155]
    s_addk_i32 s79, 128
    ds_read_b128 v[40:43], v5 offset:34816
    ds_read_b128 v[44:47], v5 offset:35840
    s_addk_i32 m0, 13504
    v_mfma_f32_16x16x32_bf16 v[152:155], v[80:83], v[56:59], v[152:155]
    v_mfma_f32_16x16x32_bf16 v[156:159], v[64:67], v[56:59], v[156:159]
    buffer_load_dwordx4 v3, s[16:19], s79 offen lds
    v_mfma_f32_16x16x32_bf16 v[156:159], v[68:71], v[60:63], v[156:159]
    s_addk_i32 m0, 960
    v_mul_f32 v160, s95, v160
    v_mul_f32 v161, s95, v161
    v_mfma_f32_16x16x32_bf16 v[140:143], v[68:71], v[52:55], v[140:143]
    v_cvt_pk_bf16_f32 v160, v160, v161
    v_mul_f32 v162, s95, v162
    v_mfma_f32_16x16x32_bf16 v[140:143], v[64:67], v[48:51], v[140:143]
    s_waitcnt lgkmcnt(0)
    v_mul_f32 v163, s95, v163
    v_cvt_pk_bf16_f32 v161, v162, v163
    v_mfma_f32_16x16x32_bf16 v[96:99], a[0:3], v[32:35], 0
    ds_read_b128 v[48:51], v5 offset:40960
    ds_read_b128 v[52:55], v5 offset:41984
    v_mfma_f32_16x16x32_bf16 v[96:99], a[16:19], v[36:39], v[96:99]
    buffer_load_dwordx4 v3, s[16:19], s79 offen offset:64 lds
    v_mfma_f32_16x16x32_bf16 v[96:99], a[32:35], v[40:43], v[96:99]
    v_mul_f32 v164, s95, v164
    v_mul_f32 v165, s95, v165
    v_mfma_f32_16x16x32_bf16 v[96:99], a[48:51], v[44:47], v[96:99]
    ds_read_b128 v[56:59], v5 offset:43008
    v_cvt_pk_bf16_f32 v162, v164, v165
    v_mfma_f32_16x16x32_bf16 v[100:103], a[52:55], v[44:47], 0
    ds_read_b128 v[60:63], v5 offset:44032
    v_mul_f32 v166, s95, v166
    v_mfma_f32_16x16x32_bf16 v[100:103], a[36:39], v[40:43], v[100:103]
    s_addk_i32 s79, 4096
    s_addk_i32 m0, 1088
    v_mul_f32 v167, s95, v167
    v_mfma_f32_16x16x32_bf16 v[100:103], a[20:23], v[36:39], v[100:103]
    v_mfma_f32_16x16x32_bf16 v[100:103], a[4:7], v[32:35], v[100:103]
    v_cvt_pk_bf16_f32 v163, v166, v167
    v_mfma_f32_16x16x32_bf16 v[112:115], v[32:35], a[8:11], 0
    s_add_u32 s80, s74, 32768
    v_mfma_f32_16x16x32_bf16 v[112:115], v[36:39], a[24:27], v[112:115]
    buffer_load_dwordx4 v3, s[16:19], s79 offen lds
    v_mfma_f32_16x16x32_bf16 v[112:115], v[40:43], a[40:43], v[112:115]
    buffer_store_dwordx4 v[160:163], v20, s[40:43], s80 offen offset:0 sc1
    v_mfma_f32_16x16x32_bf16 v[112:115], v[44:47], a[56:59], v[112:115]
    v_mul_f32 v168, s95, v168
    v_mfma_f32_16x16x32_bf16 v[120:123], v[44:47], a[60:63], 0
    v_mfma_f32_16x16x32_bf16 v[120:123], v[40:43], a[44:47], v[120:123]
    s_addk_i32 m0, 960
    v_mul_f32 v169, s95, v169
    v_mfma_f32_16x16x32_bf16 v[120:123], v[36:39], a[28:31], v[120:123]
    v_cvt_pk_bf16_f32 v168, v168, v169
    v_mfma_f32_16x16x32_bf16 v[120:123], v[32:35], a[12:15], v[120:123]
    s_waitcnt lgkmcnt(0)
    ds_read_b128 v[32:35], v5 offset:36864
    v_mul_f32 v170, s95, v170
    v_mfma_f32_16x16x32_bf16 v[124:127], v[48:51], a[12:15], 0
    ds_read_b128 v[36:39], v5 offset:37888
    v_mul_f32 v171, s95, v171
    v_mfma_f32_16x16x32_bf16 v[124:127], v[52:55], a[28:31], v[124:127]
    buffer_load_dwordx4 v3, s[16:19], s79 offen offset:64 lds
    v_mfma_f32_16x16x32_bf16 v[124:127], v[56:59], a[44:47], v[124:127]
    ds_read_b128 v[40:43], v5 offset:38912
    v_cvt_pk_bf16_f32 v169, v170, v171
    v_mfma_f32_16x16x32_bf16 v[124:127], v[60:63], a[60:63], v[124:127]
    ds_read_b128 v[44:47], v5 offset:39936
    v_mul_f32 v172, s95, v172
    v_mfma_f32_16x16x32_bf16 v[116:119], v[60:63], a[56:59], 0
    v_mul_f32 v173, s95, v173
    v_mfma_f32_16x16x32_bf16 v[116:119], v[56:59], a[40:43], v[116:119]
    s_add_u32 s79, s99, 65536
    s_add_u32 m0, s71, 0
    v_cvt_pk_bf16_f32 v170, v172, v173
    v_mfma_f32_16x16x32_bf16 v[116:119], v[52:55], a[24:27], v[116:119]
    v_mul_f32 v174, s95, v174
    v_mfma_f32_16x16x32_bf16 v[116:119], v[48:51], a[8:11], v[116:119]
    v_mul_f32 v175, s95, v175
    v_mfma_f32_16x16x32_bf16 v[108:111], a[4:7], v[48:51], 0
    v_mfma_f32_16x16x32_bf16 v[108:111], a[20:23], v[52:55], v[108:111]
    buffer_load_dwordx4 v1, s[4:7], s79 offen lds
    v_mfma_f32_16x16x32_bf16 v[108:111], a[36:39], v[56:59], v[108:111]
    v_cvt_pk_bf16_f32 v171, v174, v175
    v_mfma_f32_16x16x32_bf16 v[108:111], a[52:55], v[60:63], v[108:111]
    buffer_store_dwordx4 v[168:171], v2, s[40:43], s80 offen offset:0 sc1
    v_mfma_f32_16x16x32_bf16 v[104:107], a[48:51], v[60:63], 0
    v_mul_f32 v176, s82, v176
    v_mfma_f32_16x16x32_bf16 v[104:107], a[32:35], v[56:59], v[104:107]
    s_addk_i32 m0, 960
    v_mul_f32 v177, s82, v177
    v_mfma_f32_16x16x32_bf16 v[104:107], a[16:19], v[52:55], v[104:107]
    v_cvt_pk_bf16_f32 v176, v176, v177
    v_mfma_f32_16x16x32_bf16 v[104:107], a[0:3], v[48:51], v[104:107]
    s_waitcnt lgkmcnt(0)
    ds_read_b128 v[48:51], v5 offset:45056
    ds_read_b128 v[52:55], v5 offset:46080
    v_mfma_f32_16x16x32_bf16 v[96:99], a[64:67], v[32:35], v[96:99]
    ds_read_b128 v[56:59], v5 offset:47104
    v_mul_f32 v178, s82, v178
    v_mfma_f32_16x16x32_bf16 v[96:99], a[80:83], v[36:39], v[96:99]
    buffer_load_dwordx4 v1, s[4:7], s79 offen offset:64 lds
    v_mfma_f32_16x16x32_bf16 v[96:99], a[96:99], v[40:43], v[96:99]
    v_mul_f32 v179, s82, v179
    v_cvt_pk_bf16_f32 v177, v178, v179
    v_mfma_f32_16x16x32_bf16 v[96:99], a[112:115], v[44:47], v[96:99]
    ds_read_b128 v[60:63], v5 offset:48128
    v_mul_f32 v180, s82, v180
    v_mfma_f32_16x16x32_bf16 v[100:103], a[116:119], v[44:47], v[100:103]
    v_mul_f32 v181, s82, v181
    v_mfma_f32_16x16x32_bf16 v[100:103], a[100:103], v[40:43], v[100:103]
    s_add_u32 s79, s100, 65536
    s_addk_i32 m0, 1088
    v_mfma_f32_16x16x32_bf16 v[100:103], a[84:87], v[36:39], v[100:103]
    v_cvt_pk_bf16_f32 v178, v180, v181
    v_mfma_f32_16x16x32_bf16 v[100:103], a[68:71], v[32:35], v[100:103]
    v_mul_f32 v182, s82, v182
    v_mfma_f32_16x16x32_bf16 v[112:115], v[32:35], a[72:75], v[112:115]
    v_mul_f32 v183, s82, v183
    v_mfma_f32_16x16x32_bf16 v[112:115], v[36:39], a[88:91], v[112:115]
    buffer_load_dwordx4 v1, s[4:7], s79 offen lds
    v_mfma_f32_16x16x32_bf16 v[112:115], v[40:43], a[104:107], v[112:115]
    v_cvt_pk_bf16_f32 v179, v182, v183
    v_mfma_f32_16x16x32_bf16 v[112:115], v[44:47], a[120:123], v[112:115]
    buffer_store_dwordx4 v[176:179], v21, s[40:43], s80 offen offset:0 sc1
    v_mfma_f32_16x16x32_bf16 v[120:123], v[44:47], a[124:127], v[120:123]
    v_lshlrev_b32 v28, 16, v28
    v_lshlrev_b32 v29, 16, v29
    v_mfma_f32_16x16x32_bf16 v[120:123], v[40:43], a[108:111], v[120:123]
    s_addk_i32 m0, 960
    v_lshlrev_b32 v26, 16, v26
    v_mul_f32 v184, s82, v184
    v_mfma_f32_16x16x32_bf16 v[120:123], v[36:39], a[92:95], v[120:123]
    v_mul_f32 v26, 0x3fb8aa3b, v26
    v_mul_f32 v185, s82, v185
    v_mfma_f32_16x16x32_bf16 v[120:123], v[32:35], a[76:79], v[120:123]
    s_waitcnt lgkmcnt(0)
    ds_read_b128 v[32:35], v5 offset:49152
    v_cvt_pk_bf16_f32 v184, v184, v185
    v_mfma_f32_16x16x32_bf16 v[124:127], v[48:51], a[76:79], v[124:127]
    v_exp_f32 v26, v26
    v_mfma_f32_16x16x32_bf16 v[124:127], v[52:55], a[92:95], v[124:127]
    buffer_load_dwordx4 v1, s[4:7], s79 offen offset:64 lds
    v_mfma_f32_16x16x32_bf16 v[124:127], v[56:59], a[108:111], v[124:127]
    v_mul_f32 v186, s82, v186
    v_and_b32 v90, 7, v0
    v_mfma_f32_16x16x32_bf16 v[124:127], v[60:63], a[124:127], v[124:127]
    v_mul_f32 v187, s82, v187
    v_cvt_pk_bf16_f32 v26, v26, v26
    v_mfma_f32_16x16x32_bf16 v[116:119], v[60:63], a[120:123], v[116:119]
    v_cvt_pk_bf16_f32 v185, v186, v187
    v_mul_f32 v188, s82, v188
    v_mfma_f32_16x16x32_bf16 v[116:119], v[56:59], a[104:107], v[116:119]
    s_xor_b32 s79, s99, 512
    ds_read_b128 v[36:39], v5 offset:50176
    v_lshlrev_b32 v26, 16, v26
    v_mfma_f32_16x16x32_bf16 v[116:119], v[52:55], a[88:91], v[116:119]
    s_add_u32 s79, s79, 65536
    ds_read_b128 v[40:43], v5 offset:51200
    ds_read_b128 v[44:47], v5 offset:52224
    v_mfma_f32_16x16x32_bf16 v[116:119], v[48:51], a[72:75], v[116:119]
    s_addk_i32 m0, 13376
    v_mul_f32 v189, s82, v189
    v_mul_f32 v27, v26, v29
    v_mfma_f32_16x16x32_bf16 v[108:111], a[68:71], v[48:51], v[108:111]
    v_cvt_pk_bf16_f32 v186, v188, v189
    v_mul_f32 v26, v26, v28
    v_mfma_f32_16x16x32_bf16 v[108:111], a[84:87], v[52:55], v[108:111]
    v_mul_f32 v27, 0x3e22f983, v27
    v_mul_f32 v190, s82, v190
    v_mfma_f32_16x16x32_bf16 v[108:111], a[100:103], v[56:59], v[108:111]
    buffer_load_dwordx4 v1, s[4:7], s79 offen lds
    v_mfma_f32_16x16x32_bf16 v[108:111], a[116:119], v[60:63], v[108:111]
    v_mul_f32 v191, s82, v191
    v_mul_f32 v26, 0x3fb8aa3b, v26
    v_mfma_f32_16x16x32_bf16 v[104:107], a[112:115], v[60:63], v[104:107]
    v_cvt_pk_bf16_f32 v187, v190, v191
    v_lshlrev_b32 v90, 2, v90
    v_mfma_f32_16x16x32_bf16 v[104:107], a[96:99], v[56:59], v[104:107]
    buffer_store_dwordx4 v[184:187], v21, s[40:43], s80 offen offset:1024 sc1
    v_mfma_f32_16x16x32_bf16 v[104:107], a[80:83], v[52:55], v[104:107]
    buffer_load_dword v91, v90, s[56:59], 0 offen sc1
    v_mfma_f32_16x16x32_bf16 v[104:107], a[64:67], v[48:51], v[104:107]
    s_waitcnt lgkmcnt(0)
    s_addk_i32 m0, 960
    ds_read_b128 v[48:51], v5 offset:57344
    v_mfma_f32_16x16x32_bf16 v[96:99], a[128:131], v[32:35], v[96:99]
    v_mul_f32 v192, s95, v192
    v_mul_f32 v193, s95, v193
    v_mfma_f32_16x16x32_bf16 v[96:99], a[144:147], v[36:39], v[96:99]
    buffer_load_dwordx4 v1, s[4:7], s79 offen offset:64 lds
    v_mfma_f32_16x16x32_bf16 v[96:99], a[160:163], v[40:43], v[96:99]
    v_cvt_pk_bf16_f32 v192, v192, v193
    v_mul_f32 v194, s95, v194
    v_mfma_f32_16x16x32_bf16 v[96:99], a[176:179], v[44:47], v[96:99]
    ds_read_b128 v[52:55], v5 offset:58368
    v_mul_f32 v195, s95, v195
    v_mfma_f32_16x16x32_bf16 v[100:103], a[180:183], v[44:47], v[100:103]
    ds_read_b128 v[56:59], v5 offset:59392
    v_cvt_pk_bf16_f32 v193, v194, v195
    v_mfma_f32_16x16x32_bf16 v[100:103], a[164:167], v[40:43], v[100:103]
    s_xor_b32 s79, s100, 512
    ds_read_b128 v[60:63], v5 offset:60416
    s_add_u32 s79, s79, 65536
    v_mfma_f32_16x16x32_bf16 v[100:103], a[148:151], v[36:39], v[100:103]
    s_addk_i32 m0, 1088
    v_mul_f32 v196, s95, v196
    v_mul_f32 v197, s95, v197
    v_mfma_f32_16x16x32_bf16 v[100:103], a[132:135], v[32:35], v[100:103]
    v_mfma_f32_16x16x32_bf16 v[112:115], v[32:35], a[136:139], v[112:115]
    v_cvt_pk_bf16_f32 v194, v196, v197
    v_mfma_f32_16x16x32_bf16 v[112:115], v[36:39], a[152:155], v[112:115]
    buffer_load_dwordx4 v1, s[4:7], s79 offen lds
    v_mfma_f32_16x16x32_bf16 v[112:115], v[40:43], a[168:171], v[112:115]
    v_mul_f32 v198, s95, v198
    v_mul_f32 v199, s95, v199
    v_mfma_f32_16x16x32_bf16 v[112:115], v[44:47], a[184:187], v[112:115]
    v_cvt_pk_bf16_f32 v195, v198, v199
    v_mfma_f32_16x16x32_bf16 v[120:123], v[44:47], a[188:191], v[120:123]
    v_mfma_f32_16x16x32_bf16 v[120:123], v[40:43], a[172:175], v[120:123]
    s_addk_i32 m0, 960
    s_add_u32 s80, s74, 49152
    v_mfma_f32_16x16x32_bf16 v[120:123], v[36:39], a[156:159], v[120:123]
    buffer_store_dwordx4 v[192:195], v20, s[40:43], s80 offen offset:0 sc1
    v_mfma_f32_16x16x32_bf16 v[120:123], v[32:35], a[140:143], v[120:123]
    s_waitcnt lgkmcnt(0)
    ds_read_b128 v[32:35], v5 offset:53248
    ds_read_b128 v[36:39], v5 offset:54272
    v_mfma_f32_16x16x32_bf16 v[124:127], v[48:51], a[140:143], v[124:127]
    ds_read_b128 v[40:43], v5 offset:55296
    v_mul_f32 v200, s95, v200
    v_mfma_f32_16x16x32_bf16 v[124:127], v[52:55], a[156:159], v[124:127]
    buffer_load_dwordx4 v1, s[4:7], s79 offen offset:64 lds
    v_mfma_f32_16x16x32_bf16 v[124:127], v[56:59], a[172:175], v[124:127]
    ds_read_b128 v[44:47], v5 offset:56320
    v_mul_f32 v201, s95, v201
    v_mfma_f32_16x16x32_bf16 v[124:127], v[60:63], a[188:191], v[124:127]
    v_cvt_pk_bf16_f32 v200, v200, v201
    v_mfma_f32_16x16x32_bf16 v[116:119], v[60:63], a[184:187], v[116:119]
    v_mul_f32 v202, s95, v202
    v_mfma_f32_16x16x32_bf16 v[116:119], v[56:59], a[168:171], v[116:119]
    v_mfma_f32_16x16x32_bf16 v[116:119], v[52:55], a[152:155], v[116:119]
    v_mul_f32 v203, s95, v203
    v_mfma_f32_16x16x32_bf16 v[116:119], v[48:51], a[136:139], v[116:119]
    v_cvt_pk_bf16_f32 v201, v202, v203
    v_mfma_f32_16x16x32_bf16 v[108:111], a[132:135], v[48:51], v[108:111]
    v_mul_f32 v204, s95, v204
    v_mfma_f32_16x16x32_bf16 v[108:111], a[148:151], v[52:55], v[108:111]
    v_mul_f32 v205, s95, v205
    v_mfma_f32_16x16x32_bf16 v[108:111], a[164:167], v[56:59], v[108:111]
    v_mfma_f32_16x16x32_bf16 v[108:111], a[180:183], v[60:63], v[108:111]
    v_cvt_pk_bf16_f32 v202, v204, v205
    v_mfma_f32_16x16x32_bf16 v[104:107], a[176:179], v[60:63], v[104:107]
    v_mul_f32 v206, s95, v206
    v_mfma_f32_16x16x32_bf16 v[104:107], a[160:163], v[56:59], v[104:107]
    v_mul_f32 v207, s95, v207
    v_mfma_f32_16x16x32_bf16 v[104:107], a[144:147], v[52:55], v[104:107]
    v_cvt_pk_bf16_f32 v203, v206, v207
    v_mfma_f32_16x16x32_bf16 v[104:107], a[128:131], v[48:51], v[104:107]
    s_waitcnt lgkmcnt(0)
    ds_read_b128 v[48:51], v5 offset:61440
    ds_read_b128 v[52:55], v5 offset:62464
    v_mfma_f32_16x16x32_bf16 v[96:99], a[192:195], v[32:35], v[96:99]
    buffer_store_dwordx4 v[200:203], v2, s[40:43], s80 offen offset:0 sc1
    v_mfma_f32_16x16x32_bf16 v[96:99], a[208:211], v[36:39], v[96:99]
    ds_read_b128 v[56:59], v5 offset:63488
    ds_read_b128 v[60:63], v5 offset:64512
    v_mfma_f32_16x16x32_bf16 v[96:99], a[224:227], v[40:43], v[96:99]
    v_mul_f32 v208, s82, v208
    v_mfma_f32_16x16x32_bf16 v[96:99], a[240:243], v[44:47], v[96:99]
    v_mul_f32 v209, s82, v209
    v_mfma_f32_16x16x32_bf16 v[100:103], a[244:247], v[44:47], v[100:103]
    v_mfma_f32_16x16x32_bf16 v[100:103], a[228:231], v[40:43], v[100:103]
    v_cvt_pk_bf16_f32 v208, v208, v209
    v_mfma_f32_16x16x32_bf16 v[100:103], a[212:215], v[36:39], v[100:103]
    v_mul_f32 v210, s82, v210
    v_mfma_f32_16x16x32_bf16 v[100:103], a[196:199], v[32:35], v[100:103]
    v_mul_f32 v211, s82, v211
    v_mfma_f32_16x16x32_bf16 v[112:115], v[32:35], a[200:203], v[112:115]
    v_cvt_pk_bf16_f32 v209, v210, v211
    v_mfma_f32_16x16x32_bf16 v[112:115], v[36:39], a[216:219], v[112:115]
    v_mfma_f32_16x16x32_bf16 v[112:115], v[40:43], a[232:235], v[112:115]
    v_mul_f32 v212, s82, v212
    v_mfma_f32_16x16x32_bf16 v[112:115], v[44:47], a[248:251], v[112:115]
    v_mul_f32 v213, s82, v213
    v_mfma_f32_16x16x32_bf16 v[120:123], v[44:47], a[252:255], v[120:123]
    v_cvt_pk_bf16_f32 v210, v212, v213
    v_mfma_f32_16x16x32_bf16 v[120:123], v[40:43], a[236:239], v[120:123]
    v_mfma_f32_16x16x32_bf16 v[120:123], v[36:39], a[220:223], v[120:123]
    v_mul_f32 v214, s82, v214
    v_mfma_f32_16x16x32_bf16 v[120:123], v[32:35], a[204:207], v[120:123]
    s_waitcnt lgkmcnt(0)
    v_mul_f32 v215, s82, v215
    v_mfma_f32_16x16x32_bf16 v[124:127], v[48:51], a[204:207], v[124:127]
    v_cvt_pk_bf16_f32 v211, v214, v215
    v_mfma_f32_16x16x32_bf16 v[124:127], v[52:55], a[220:223], v[124:127]
    s_waitcnt vmcnt(27) lgkmcnt(0)
    s_barrier
    v_mfma_f32_16x16x32_bf16 v[124:127], v[56:59], a[236:239], v[124:127]
    s_add_u32 s79, s99, 98304
    s_addk_i32 m0, 29760
    ds_read_b128 v[64:67], v9 offset:0
    v_mfma_f32_16x16x32_bf16 v[124:127], v[60:63], a[252:255], v[124:127]
    buffer_store_dwordx4 v[208:211], v21, s[40:43], s80 offen offset:0 sc1
    v_mfma_f32_16x16x32_bf16 v[116:119], v[60:63], a[248:251], v[116:119]
PG_3:
    s_cbranch_execz PG_7
    buffer_load_dwordx4 v1, s[4:7], s79 offen lds
    v_mfma_f32_16x16x32_bf16 v[116:119], v[56:59], a[232:235], v[116:119]
    ds_read_b128 v[32:35], v12 offset:16384
    v_mul_f32 v216, s82, v216
    v_mfma_f32_16x16x32_bf16 v[116:119], v[52:55], a[216:219], v[116:119]
    s_addk_i32 m0, 960
    ds_read_b128 v[68:71], v9 offset:1024
    ds_read_b128 v[36:39], v12 offset:17408
    v_mfma_f32_16x16x32_bf16 v[116:119], v[48:51], a[200:203], v[116:119]
    ds_read_b128 v[44:47], v12 offset:25600
    ds_read_b128 v[40:43], v12 offset:24576
    v_mfma_f32_16x16x32_bf16 v[108:111], a[196:199], v[48:51], v[108:111]
    v_mul_f32 v217, s82, v217
    v_cvt_pk_bf16_f32 v216, v216, v217
    v_mfma_f32_16x16x32_bf16 v[108:111], a[212:215], v[52:55], v[108:111]
    ds_read_b128 v[72:75], v9 offset:2048
    v_mul_f32 v218, s82, v218
    v_mfma_f32_16x16x32_bf16 v[108:111], a[228:231], v[56:59], v[108:111]
    buffer_load_dwordx4 v1, s[4:7], s79 offen offset:64 lds
    v_mfma_f32_16x16x32_bf16 v[108:111], a[244:247], v[60:63], v[108:111]
    ds_read_b128 v[76:79], v9 offset:3072
    v_mul_f32 v219, s82, v219
    v_mfma_f32_16x16x32_bf16 v[104:107], a[240:243], v[60:63], v[104:107]
    v_cvt_pk_bf16_f32 v217, v218, v219
    v_mul_f32 v220, s82, v220
    v_mfma_f32_16x16x32_bf16 v[104:107], a[224:227], v[56:59], v[104:107]
    ds_read_b128 v[80:83], v9 offset:4096
    ds_read_b128 v[84:87], v9 offset:5120
    v_mfma_f32_16x16x32_bf16 v[104:107], a[208:211], v[52:55], v[104:107]
    s_add_u32 s79, s100, 98304
    s_addk_i32 m0, 1088
    v_mul_f32 v221, s82, v221
    v_mfma_f32_16x16x32_bf16 v[104:107], a[192:195], v[48:51], v[104:107]
    s_waitcnt lgkmcnt(4)
    v_cvt_pk_bf16_f32 v218, v220, v221
    v_mul_f32 v222, s82, v222
    v_mfma_f32_16x16x32_bf16 v[128:131], v[64:67], v[32:35], v[128:131]
    v_mul_f32 v223, s82, v223
    v_mfma_f32_16x16x32_bf16 v[128:131], v[68:71], v[36:39], v[128:131]
    v_mfma_f32_16x16x32_bf16 v[144:147], v[68:71], v[44:47], v[144:147]
    buffer_load_dwordx4 v1, s[4:7], s79 offen lds
    v_mfma_f32_16x16x32_bf16 v[144:147], v[64:67], v[40:43], v[144:147]
    s_waitcnt lgkmcnt(2)
    ds_read_b128 v[64:67], v9 offset:6144
    ds_read_b128 v[68:71], v9 offset:7168
    v_mfma_f32_16x16x32_bf16 v[148:151], v[72:75], v[40:43], v[148:151]
    v_cvt_pk_bf16_f32 v219, v222, v223
    v_mfma_f32_16x16x32_bf16 v[148:151], v[76:79], v[44:47], v[148:151]
    buffer_store_dwordx4 v[216:219], v21, s[40:43], s80 offen offset:1024 sc1
    v_mfma_f32_16x16x32_bf16 v[132:135], v[76:79], v[36:39], v[132:135]
    s_addk_i32 m0, 960
    v_mfma_f32_16x16x32_bf16 v[132:135], v[72:75], v[32:35], v[132:135]
    s_waitcnt lgkmcnt(2)
    ds_read_b128 v[72:75], v9 offset:32768
    ds_read_b128 v[48:51], v12 offset:18432
    v_mfma_f32_16x16x32_bf16 v[136:139], v[80:83], v[32:35], v[136:139]
    ds_read_b128 v[76:79], v9 offset:33792
    ds_read_b128 v[52:55], v12 offset:19456
    v_mfma_f32_16x16x32_bf16 v[136:139], v[84:87], v[36:39], v[136:139]
    ds_read_b128 v[60:63], v12 offset:27648
    ds_read_b128 v[56:59], v12 offset:26624
    v_mfma_f32_16x16x32_bf16 v[152:155], v[84:87], v[44:47], v[152:155]
    buffer_load_dwordx4 v1, s[4:7], s79 offen offset:64 lds
    v_mfma_f32_16x16x32_bf16 v[152:155], v[80:83], v[40:43], v[152:155]
    s_waitcnt lgkmcnt(6)
    ds_read_b128 v[80:83], v9 offset:34816
    ds_read_b128 v[84:87], v9 offset:35840
    v_mfma_f32_16x16x32_bf16 v[156:159], v[64:67], v[40:43], v[156:159]
    v_mfma_f32_16x16x32_bf16 v[156:159], v[68:71], v[44:47], v[156:159]
    v_mfma_f32_16x16x32_bf16 v[140:143], v[68:71], v[36:39], v[140:143]
    v_mfma_f32_16x16x32_bf16 v[140:143], v[64:67], v[32:35], v[140:143]
    s_waitcnt lgkmcnt(2)
    ds_read_b128 v[64:67], v9 offset:36864
    ds_read_b128 v[68:71], v9 offset:37888
    v_mfma_f32_16x16x32_bf16 v[128:131], v[72:75], v[48:51], v[128:131]
    v_mfma_f32_16x16x32_bf16 v[128:131], v[76:79], v[52:55], v[128:131]
    v_mfma_f32_16x16x32_bf16 v[144:147], v[76:79], v[60:63], v[144:147]
    v_mfma_f32_16x16x32_bf16 v[144:147], v[72:75], v[56:59], v[144:147]
    s_waitcnt lgkmcnt(2)
    ds_read_b128 v[72:75], v9 offset:38912
    ds_read_b128 v[76:79], v9 offset:39936
    v_mfma_f32_16x16x32_bf16 v[148:151], v[80:83], v[56:59], v[148:151]
    v_mfma_f32_16x16x32_bf16 v[148:151], v[84:87], v[60:63], v[148:151]
    v_mfma_f32_16x16x32_bf16 v[132:135], v[84:87], v[52:55], v[132:135]
    v_mfma_f32_16x16x32_bf16 v[132:135], v[80:83], v[48:51], v[132:135]
    s_waitcnt vmcnt(20) lgkmcnt(0)
    s_barrier
    v_mfma_f32_16x16x32_bf16 v[136:139], v[64:67], v[48:51], v[136:139]
    s_xor_b32 s79, s99, 512
    s_add_u32 s79, s79, 98304
    s_addk_i32 m0, 13376
    v_mfma_f32_16x16x32_bf16 v[136:139], v[68:71], v[52:55], v[136:139]
    ds_read_b128 v[80:83], v9 offset:49152
    ds_read_b128 v[32:35], v13 offset:0
    v_mfma_f32_16x16x32_bf16 v[152:155], v[68:71], v[60:63], v[152:155]
    ds_read_b128 v[84:87], v9 offset:50176
    ds_read_b128 v[36:39], v13 offset:1024
    ds_read_b128 v[44:47], v13 offset:9216
    ds_read_b128 v[40:43], v13 offset:8192
    v_mfma_f32_16x16x32_bf16 v[152:155], v[64:67], v[56:59], v[152:155]
    buffer_load_dwordx4 v1, s[4:7], s79 offen lds
    s_addk_i32 m0, 960
    v_mfma_f32_16x16x32_bf16 v[156:159], v[72:75], v[56:59], v[156:159]
    ds_read_b128 v[64:67], v9 offset:51200
    ds_read_b128 v[68:71], v9 offset:52224
    v_mfma_f32_16x16x32_bf16 v[156:159], v[76:79], v[60:63], v[156:159]
    buffer_load_dwordx4 v1, s[4:7], s79 offen offset:64 lds
    v_mfma_f32_16x16x32_bf16 v[140:143], v[76:79], v[52:55], v[140:143]
    s_xor_b32 s79, s100, 512
    s_add_u32 s79, s79, 98304
    s_addk_i32 m0, 1088
    v_mfma_f32_16x16x32_bf16 v[140:143], v[72:75], v[48:51], v[140:143]
    s_waitcnt lgkmcnt(2)
    ds_read_b128 v[72:75], v9 offset:53248
    ds_read_b128 v[76:79], v9 offset:54272
    v_mfma_f32_16x16x32_bf16 v[128:131], v[80:83], v[32:35], v[128:131]
    buffer_load_dwordx4 v1, s[4:7], s79 offen lds
    s_addk_i32 m0, 960
    v_mfma_f32_16x16x32_bf16 v[128:131], v[84:87], v[36:39], v[128:131]
    v_mfma_f32_16x16x32_bf16 v[144:147], v[84:87], v[44:47], v[144:147]
    buffer_load_dwordx4 v1, s[4:7], s79 offen offset:64 lds
    v_mfma_f32_16x16x32_bf16 v[144:147], v[80:83], v[40:43], v[144:147]
    s_waitcnt lgkmcnt(2)
    s_add_u32 s79, s77, s98
    s_addk_i32 m0, 13376
    v_mfma_f32_16x16x32_bf16 v[148:151], v[64:67], v[40:43], v[148:151]
    ds_read_b128 v[80:83], v9 offset:55296
    ds_read_b128 v[84:87], v9 offset:56320
    v_mfma_f32_16x16x32_bf16 v[148:151], v[68:71], v[44:47], v[148:151]
    buffer_load_dwordx4 v1, s[24:27], s79 offen lds
    s_addk_i32 m0, 960
    v_mfma_f32_16x16x32_bf16 v[132:135], v[68:71], v[36:39], v[132:135]
    v_mfma_f32_16x16x32_bf16 v[132:135], v[64:67], v[32:35], v[132:135]
    s_waitcnt lgkmcnt(2)
    ds_read_b128 v[64:67], v10 offset:16384
    ds_read_b128 v[48:51], v13 offset:2048
    v_mfma_f32_16x16x32_bf16 v[136:139], v[72:75], v[32:35], v[136:139]
    buffer_load_dwordx4 v1, s[24:27], s79 offen offset:64 lds
    s_add_u32 s79, s79, s94
    s_addk_i32 m0, 1088
    v_mfma_f32_16x16x32_bf16 v[136:139], v[76:79], v[36:39], v[136:139]
    ds_read_b128 v[68:71], v10 offset:17408
    ds_read_b128 v[52:55], v13 offset:3072
    v_mfma_f32_16x16x32_bf16 v[152:155], v[76:79], v[44:47], v[152:155]
    buffer_load_dwordx4 v1, s[24:27], s79 offen lds
    ds_read_b128 v[60:63], v13 offset:11264
    ds_read_b128 v[56:59], v13 offset:10240
    s_addk_i32 m0, 960
    v_mfma_f32_16x16x32_bf16 v[152:155], v[72:75], v[40:43], v[152:155]
    s_waitcnt lgkmcnt(6)
    ds_read_b128 v[72:75], v10 offset:18432
    ds_read_b128 v[76:79], v10 offset:19456
    v_mfma_f32_16x16x32_bf16 v[156:159], v[80:83], v[40:43], v[156:159]
    buffer_load_dwordx4 v1, s[24:27], s79 offen offset:64 lds
    v_mfma_f32_16x16x32_bf16 v[156:159], v[84:87], v[44:47], v[156:159]
    s_lshl_b32 s79, s98, 12
    s_add_u32 s79, s79, s73
    s_addk_i32 m0, 13376
    v_mfma_f32_16x16x32_bf16 v[140:143], v[84:87], v[36:39], v[140:143]
    v_mfma_f32_16x16x32_bf16 v[140:143], v[80:83], v[32:35], v[140:143]
    s_waitcnt lgkmcnt(2)
    buffer_load_dwordx4 v4, s[28:31], s79 offen lds
    s_addk_i32 m0, 960
    v_mfma_f32_16x16x32_bf16 v[128:131], v[64:67], v[48:51], v[128:131]
    ds_read_b128 v[80:83], v10 offset:20480
    ds_read_b128 v[84:87], v10 offset:21504
    v_mfma_f32_16x16x32_bf16 v[128:131], v[68:71], v[52:55], v[128:131]
    buffer_load_dwordx4 v4, s[28:31], s79 offen offset:64 lds
    v_mfma_f32_16x16x32_bf16 v[144:147], v[68:71], v[60:63], v[144:147]
    s_addk_i32 m0, 960
    v_mfma_f32_16x16x32_bf16 v[144:147], v[64:67], v[56:59], v[144:147]
    s_waitcnt lgkmcnt(2)
    ds_read_b128 v[64:67], v10 offset:22528
    ds_read_b128 v[68:71], v10 offset:23552
    v_mfma_f32_16x16x32_bf16 v[148:151], v[72:75], v[56:59], v[148:151]
    buffer_load_dwordx4 v4, s[28:31], s79 offen offset:128 lds
    s_addk_i32 m0, 960
    v_mfma_f32_16x16x32_bf16 v[148:151], v[76:79], v[60:63], v[148:151]
    v_mfma_f32_16x16x32_bf16 v[132:135], v[76:79], v[52:55], v[132:135]
    buffer_load_dwordx4 v4, s[28:31], s79 offen offset:192 lds
    v_mfma_f32_16x16x32_bf16 v[132:135], v[72:75], v[48:51], v[132:135]
    s_waitcnt lgkmcnt(2)
    v_mfma_f32_16x16x32_bf16 v[136:139], v[80:83], v[48:51], v[136:139]
    s_waitcnt vmcnt(19) lgkmcnt(0)
    s_barrier
    v_mfma_f32_16x16x32_bf16 v[136:139], v[84:87], v[52:55], v[136:139]
    s_add_u32 s79, s78, s98
    ds_read_b128 v[32:35], v5 offset:0
    ds_read_b128 v[36:39], v5 offset:1024
    v_mfma_f32_16x16x32_bf16 v[152:155], v[84:87], v[60:63], v[152:155]
    s_addk_i32 m0, 13504
    ds_read_b128 v[40:43], v5 offset:2048
    ds_read_b128 v[44:47], v5 offset:3072
    v_mfma_f32_16x16x32_bf16 v[152:155], v[80:83], v[56:59], v[152:155]
    v_mfma_f32_16x16x32_bf16 v[156:159], v[64:67], v[56:59], v[156:159]
    buffer_load_dwordx4 v1, s[24:27], s79 offen lds
    v_mfma_f32_16x16x32_bf16 v[156:159], v[68:71], v[60:63], v[156:159]
    s_addk_i32 m0, 960
    v_mul_f32 v224, s95, v224
    v_mul_f32 v225, s95, v225
    v_mfma_f32_16x16x32_bf16 v[140:143], v[68:71], v[52:55], v[140:143]
    v_cvt_pk_bf16_f32 v224, v224, v225
    v_mul_f32 v226, s95, v226
    v_mfma_f32_16x16x32_bf16 v[140:143], v[64:67], v[48:51], v[140:143]
    s_waitcnt lgkmcnt(0)
    ds_read_b128 v[48:51], v5 offset:8192
    v_mul_f32 v227, s95, v227
    v_mfma_f32_16x16x32_bf16 v[160:163], a[0:3], v[32:35], 0
    ds_read_b128 v[52:55], v5 offset:9216
    v_cvt_pk_bf16_f32 v225, v226, v227
    v_mfma_f32_16x16x32_bf16 v[160:163], a[16:19], v[36:39], v[160:163]
    buffer_load_dwordx4 v1, s[24:27], s79 offen offset:64 lds
    v_mfma_f32_16x16x32_bf16 v[160:163], a[32:35], v[40:43], v[160:163]
    ds_read_b128 v[56:59], v5 offset:10240
    v_mul_f32 v228, s95, v228
    v_mfma_f32_16x16x32_bf16 v[160:163], a[48:51], v[44:47], v[160:163]
    ds_read_b128 v[60:63], v5 offset:11264
    v_mul_f32 v229, s95, v229
    v_mfma_f32_16x16x32_bf16 v[164:167], a[52:55], v[44:47], 0
    v_cvt_pk_bf16_f32 v226, v228, v229
    v_mfma_f32_16x16x32_bf16 v[164:167], a[36:39], v[40:43], v[164:167]
    s_add_u32 s79, s79, s94
    s_addk_i32 m0, 1088
    v_mul_f32 v230, s95, v230
    v_mfma_f32_16x16x32_bf16 v[164:167], a[20:23], v[36:39], v[164:167]
    v_mul_f32 v66, 1.0, v26
    v_mul_f32 v67, 1.0, v27
    v_mfma_f32_16x16x32_bf16 v[164:167], a[4:7], v[32:35], v[164:167]
    v_mul_f32 v231, s95, v231
    v_mfma_f32_16x16x32_bf16 v[176:179], v[32:35], a[8:11], 0
    v_exp_f32 v66, v66
    v_mfma_f32_16x16x32_bf16 v[176:179], v[36:39], a[24:27], v[176:179]
    buffer_load_dwordx4 v1, s[24:27], s79 offen lds
    v_mfma_f32_16x16x32_bf16 v[176:179], v[40:43], a[40:43], v[176:179]
    v_cvt_pk_bf16_f32 v227, v230, v231
    v_fract_f32 v67, v67
    v_mfma_f32_16x16x32_bf16 v[176:179], v[44:47], a[56:59], v[176:179]
    s_add_u32 s80, s101, 65536
    v_cos_f32 v64, v67
    v_mfma_f32_16x16x32_bf16 v[184:187], v[44:47], a[60:63], 0
    buffer_store_dwordx4 v[224:227], v20, s[40:43], s80 offen offset:0 sc1
    v_mfma_f32_16x16x32_bf16 v[184:187], v[40:43], a[44:47], v[184:187]
    s_addk_i32 m0, 960
    v_sin_f32 v65, v67
    v_mfma_f32_16x16x32_bf16 v[184:187], v[36:39], a[28:31], v[184:187]
    v_mul_f32 v232, s95, v232
    v_mul_f32 v233, s95, v233
    v_mfma_f32_16x16x32_bf16 v[184:187], v[32:35], a[12:15], v[184:187]
    s_waitcnt lgkmcnt(0)
    ds_read_b128 v[32:35], v5 offset:4096
    v_mul_f32 v64, v64, v66
    v_mfma_f32_16x16x32_bf16 v[188:191], v[48:51], a[12:15], 0
    v_cvt_pk_bf16_f32 v232, v232, v233
    v_mul_f32 v65, v65, v66
    v_mfma_f32_16x16x32_bf16 v[188:191], v[52:55], a[28:31], v[188:191]
    buffer_load_dwordx4 v1, s[24:27], s79 offen offset:64 lds
    v_mfma_f32_16x16x32_bf16 v[188:191], v[56:59], a[44:47], v[188:191]
    v_mul_f32 v234, s95, v234
    v_fma_f32 v70, v64, v128, v129
    v_mfma_f32_16x16x32_bf16 v[188:191], v[60:63], a[60:63], v[188:191]
    v_mul_f32 v235, s95, v235
    v_fma_f32 v71, v64, v144, v145
    v_mfma_f32_16x16x32_bf16 v[180:183], v[60:63], a[56:59], 0
    v_cvt_pk_bf16_f32 v233, v234, v235
    v_fma_f32 v70, -v65, v144, v70
    v_mfma_f32_16x16x32_bf16 v[180:183], v[56:59], a[40:43], v[180:183]
    s_addk_i32 s98, 128
    ds_read_b128 v[36:39], v5 offset:5120
    v_fmac_f32 v71, v65, v128
    v_mfma_f32_16x16x32_bf16 v[180:183], v[52:55], a[24:27], v[180:183]
    s_and_b32 s98, s98, 1023
    ds_read_b128 v[40:43], v5 offset:6144
    ds_read_b128 v[44:47], v5 offset:7168
    v_mfma_f32_16x16x32_bf16 v[180:183], v[48:51], a[8:11], v[180:183]
    s_add_u32 s79, s77, s98
    s_addk_i32 m0, 13376
    v_mul_f32 v236, s95, v236
    v_mfma_f32_16x16x32_bf16 v[172:175], a[4:7], v[48:51], 0
    v_mul_f32 v237, s95, v237
    v_fma_f32 v68, v64, v70, v130
    v_mfma_f32_16x16x32_bf16 v[172:175], a[20:23], v[52:55], v[172:175]
    v_cvt_pk_bf16_f32 v234, v236, v237
    v_fma_f32 v69, v64, v71, v146
    v_mfma_f32_16x16x32_bf16 v[172:175], a[36:39], v[56:59], v[172:175]
    buffer_load_dwordx4 v1, s[24:27], s79 offen lds
    v_mfma_f32_16x16x32_bf16 v[172:175], a[52:55], v[60:63], v[172:175]
    v_fma_f32 v68, -v65, v71, v68
    v_mul_f32 v238, s95, v238
    v_mfma_f32_16x16x32_bf16 v[168:171], a[48:51], v[60:63], 0
    v_fmac_f32 v69, v65, v70
    v_mul_f32 v239, s95, v239
    v_mfma_f32_16x16x32_bf16 v[168:171], a[32:35], v[56:59], v[168:171]
    s_addk_i32 m0, 960
    v_fma_f32 v70, v64, v68, v131
    v_cvt_pk_bf16_f32 v235, v238, v239
    v_mfma_f32_16x16x32_bf16 v[168:171], a[16:19], v[52:55], v[168:171]
    v_fma_f32 v71, v64, v69, v147
    v_fma_f32 v70, -v65, v69, v70
    v_mfma_f32_16x16x32_bf16 v[168:171], a[0:3], v[48:51], v[168:171]
    s_waitcnt lgkmcnt(0)
    v_fmac_f32 v71, v65, v68
    v_fma_f32 v68, v64, v70, v132
    v_mfma_f32_16x16x32_bf16 v[160:163], a[64:67], v[32:35], v[160:163]
    buffer_store_dwordx4 v[232:235], v2, s[40:43], s80 offen offset:0 sc1
    v_mfma_f32_16x16x32_bf16 v[160:163], a[80:83], v[36:39], v[160:163]
    v_mul_f32 v240, s82, v240
    v_mul_f32 v241, s82, v241
    v_mfma_f32_16x16x32_bf16 v[160:163], a[96:99], v[40:43], v[160:163]
    buffer_load_dwordx4 v1, s[24:27], s79 offen offset:64 lds
    v_mfma_f32_16x16x32_bf16 v[160:163], a[112:115], v[44:47], v[160:163]
    v_fma_f32 v69, v64, v71, v148
    v_cvt_pk_bf16_f32 v240, v240, v241
    v_mfma_f32_16x16x32_bf16 v[164:167], a[116:119], v[44:47], v[164:167]
    v_fma_f32 v68, -v65, v71, v68
    v_mul_f32 v242, s82, v242
    v_mfma_f32_16x16x32_bf16 v[164:167], a[100:103], v[40:43], v[164:167]
    s_add_u32 s79, s79, s94
    v_fmac_f32 v69, v65, v70
    v_mul_f32 v243, s82, v243
    v_mfma_f32_16x16x32_bf16 v[164:167], a[84:87], v[36:39], v[164:167]
    s_addk_i32 m0, 1088
    ds_read_b128 v[48:51], v5 offset:12288
    v_fma_f32 v70, v64, v68, v133
    v_mfma_f32_16x16x32_bf16 v[164:167], a[68:71], v[32:35], v[164:167]
    ds_read_b128 v[52:55], v5 offset:13312
    ds_read_b128 v[56:59], v5 offset:14336
    v_mfma_f32_16x16x32_bf16 v[176:179], v[32:35], a[72:75], v[176:179]
    ds_read_b128 v[60:63], v5 offset:15360
    v_fma_f32 v71, v64, v69, v149
    v_mfma_f32_16x16x32_bf16 v[176:179], v[36:39], a[88:91], v[176:179]
    v_cvt_pk_bf16_f32 v241, v242, v243
    v_fma_f32 v70, -v65, v69, v70
    v_mfma_f32_16x16x32_bf16 v[176:179], v[40:43], a[104:107], v[176:179]
    v_mul_f32 v244, s82, v244
    v_mul_f32 v245, s82, v245
    v_mfma_f32_16x16x32_bf16 v[176:179], v[44:47], a[120:123], v[176:179]
    buffer_load_dwordx4 v1, s[24:27], s79 offen lds
    v_mfma_f32_16x16x32_bf16 v[184:187], v[44:47], a[124:127], v[184:187]
    v_fmac_f32 v71, v65, v68
    v_fma_f32 v68, v64, v70, v134
    v_mfma_f32_16x16x32_bf16 v[184:187], v[40:43], a[108:111], v[184:187]
    s_addk_i32 m0, 960
    v_cvt_pk_bf16_f32 v242, v244, v245
    v_fma_f32 v69, v64, v71, v150
    v_mfma_f32_16x16x32_bf16 v[184:187], v[36:39], a[92:95], v[184:187]
    v_mul_f32 v246, s82, v246
    v_fma_f32 v68, -v65, v71, v68
    v_mfma_f32_16x16x32_bf16 v[184:187], v[32:35], a[76:79], v[184:187]
    s_waitcnt lgkmcnt(0)
    v_mul_f32 v247, s82, v247
    v_fmac_f32 v69, v65, v70
    v_mfma_f32_16x16x32_bf16 v[188:191], v[48:51], a[76:79], v[188:191]
    v_cvt_pk_bf16_f32 v243, v246, v247
    v_fma_f32 v70, v64, v68, v135
    v_mfma_f32_16x16x32_bf16 v[188:191], v[52:55], a[92:95], v[188:191]
    buffer_store_dwordx4 v[240:243], v21, s[40:43], s80 offen offset:0 sc1
    v_mfma_f32_16x16x32_bf16 v[188:191], v[56:59], a[108:111], v[188:191]
    v_fma_f32 v71, v64, v69, v151
    v_fma_f32 v70, -v65, v69, v70
    v_mfma_f32_16x16x32_bf16 v[188:191], v[60:63], a[124:127], v[188:191]
    buffer_load_dwordx4 v1, s[24:27], s79 offen offset:64 lds
    v_mfma_f32_16x16x32_bf16 v[180:183], v[60:63], a[120:123], v[180:183]
    v_mul_f32 v248, s82, v248
    v_fmac_f32 v71, v65, v68
    v_mfma_f32_16x16x32_bf16 v[180:183], v[56:59], a[104:107], v[180:183]
    s_lshl_b32 s79, s98, 12
    v_mul_f32 v249, s82, v249
    v_fma_f32 v68, v64, v70, v136
    v_mfma_f32_16x16x32_bf16 v[180:183], v[52:55], a[88:91], v[180:183]
    s_add_u32 s79, s79, s73
    v_cvt_pk_bf16_f32 v248, v248, v249
    v_fma_f32 v69, v64, v71, v152
    v_mfma_f32_16x16x32_bf16 v[180:183], v[48:51], a[72:75], v[180:183]
    s_addk_i32 m0, 13376
    ds_read_b128 v[32:35], v5 offset:16384
    ds_read_b128 v[36:39], v5 offset:17408
    v_mfma_f32_16x16x32_bf16 v[172:175], a[68:71], v[48:51], v[172:175]
    ds_read_b128 v[40:43], v5 offset:18432
    ds_read_b128 v[44:47], v5 offset:19456
    v_mfma_f32_16x16x32_bf16 v[172:175], a[84:87], v[52:55], v[172:175]
    v_mul_f32 v250, s82, v250
    v_fma_f32 v68, -v65, v71, v68
    v_mfma_f32_16x16x32_bf16 v[172:175], a[100:103], v[56:59], v[172:175]
    v_fmac_f32 v69, v65, v70
    v_mul_f32 v251, s82, v251
    v_mfma_f32_16x16x32_bf16 v[172:175], a[116:119], v[60:63], v[172:175]
    v_fma_f32 v70, v64, v68, v137
    v_cvt_pk_bf16_f32 v249, v250, v251
    v_mfma_f32_16x16x32_bf16 v[168:171], a[112:115], v[60:63], v[168:171]
    buffer_load_dwordx4 v4, s[28:31], s79 offen lds
    v_mfma_f32_16x16x32_bf16 v[168:171], a[96:99], v[56:59], v[168:171]
    s_addk_i32 m0, 960
    v_mul_f32 v252, s82, v252
    v_fma_f32 v71, v64, v69, v153
    v_mfma_f32_16x16x32_bf16 v[168:171], a[80:83], v[52:55], v[168:171]
    v_mul_f32 v253, s82, v253
    v_fma_f32 v70, -v65, v69, v70
    v_mfma_f32_16x16x32_bf16 v[168:171], a[64:67], v[48:51], v[168:171]
    s_waitcnt lgkmcnt(0)
    v_fmac_f32 v71, v65, v68
    v_cvt_pk_bf16_f32 v250, v252, v253
    v_mfma_f32_16x16x32_bf16 v[160:163], a[128:131], v[32:35], v[160:163]
    v_fma_f32 v68, v64, v70, v138
    v_mul_f32 v254, s82, v254
    v_mfma_f32_16x16x32_bf16 v[160:163], a[144:147], v[36:39], v[160:163]
    v_fma_f32 v69, v64, v71, v154
    v_mul_f32 v255, s82, v255
    v_mfma_f32_16x16x32_bf16 v[160:163], a[160:163], v[40:43], v[160:163]
    v_fma_f32 v68, -v65, v71, v68
    v_cvt_pk_bf16_f32 v251, v254, v255
    v_mfma_f32_16x16x32_bf16 v[160:163], a[176:179], v[44:47], v[160:163]
    buffer_load_dwordx4 v4, s[28:31], s79 offen offset:64 lds
    v_mfma_f32_16x16x32_bf16 v[164:167], a[180:183], v[44:47], v[164:167]
    buffer_store_dwordx4 v[248:251], v21, s[40:43], s80 offen offset:1024 sc1
    v_mfma_f32_16x16x32_bf16 v[164:167], a[164:167], v[40:43], v[164:167]
    s_addk_i32 m0, 960
    v_fmac_f32 v69, v65, v70
    v_fma_f32 v70, v64, v68, v139
    v_mfma_f32_16x16x32_bf16 v[164:167], a[148:151], v[36:39], v[164:167]
    v_fma_f32 v71, v64, v69, v155
    v_fma_f32 v70, -v65, v69, v70
    v_mfma_f32_16x16x32_bf16 v[164:167], a[132:135], v[32:35], v[164:167]
    ds_read_b128 v[48:51], v5 offset:24576
    v_mul_f32 v96, s95, v96
    v_mfma_f32_16x16x32_bf16 v[176:179], v[32:35], a[136:139], v[176:179]
    ds_read_b128 v[52:55], v5 offset:25600
    ds_read_b128 v[56:59], v5 offset:26624
    v_mfma_f32_16x16x32_bf16 v[176:179], v[36:39], a[152:155], v[176:179]
    ds_read_b128 v[60:63], v5 offset:27648
    v_mul_f32 v97, s95, v97
    v_mfma_f32_16x16x32_bf16 v[176:179], v[40:43], a[168:171], v[176:179]
    v_fmac_f32 v71, v65, v68
    v_cvt_pk_bf16_f32 v96, v96, v97
    v_mfma_f32_16x16x32_bf16 v[176:179], v[44:47], a[184:187], v[176:179]
    v_fma_f32 v68, v64, v70, v140
    v_fma_f32 v69, v64, v71, v156
    v_mfma_f32_16x16x32_bf16 v[184:187], v[44:47], a[188:191], v[184:187]
    buffer_load_dwordx4 v4, s[28:31], s79 offen offset:128 lds
    v_mfma_f32_16x16x32_bf16 v[184:187], v[40:43], a[172:175], v[184:187]
    s_addk_i32 m0, 960
    v_mul_f32 v98, s95, v98
    v_fma_f32 v68, -v65, v71, v68
    v_mfma_f32_16x16x32_bf16 v[184:187], v[36:39], a[156:159], v[184:187]
    v_mul_f32 v99, s95, v99
    v_fmac_f32 v69, v65, v70
    v_mfma_f32_16x16x32_bf16 v[184:187], v[32:35], a[140:143], v[184:187]
    s_waitcnt lgkmcnt(0)
    v_cvt_pk_bf16_f32 v97, v98, v99
    v_fma_f32 v70, v64, v68, v141
    v_mfma_f32_16x16x32_bf16 v[188:191], v[48:51], a[140:143], v[188:191]
    v_mul_f32 v100, s95, v100
    v_fma_f32 v71, v64, v69, v157
    v_mfma_f32_16x16x32_bf16 v[188:191], v[52:55], a[156:159], v[188:191]
    v_mul_f32 v101, s95, v101
    v_fma_f32 v70, -v65, v69, v70
    v_mfma_f32_16x16x32_bf16 v[188:191], v[56:59], a[172:175], v[188:191]
    v_fmac_f32 v71, v65, v68
    v_cvt_pk_bf16_f32 v98, v100, v101
    v_mfma_f32_16x16x32_bf16 v[188:191], v[60:63], a[188:191], v[188:191]
    v_fma_f32 v68, v64, v70, v142
    v_mul_f32 v102, s95, v102
    v_mfma_f32_16x16x32_bf16 v[180:183], v[60:63], a[184:187], v[180:183]
    buffer_load_dwordx4 v4, s[28:31], s79 offen offset:192 lds
    v_mfma_f32_16x16x32_bf16 v[180:183], v[56:59], a[168:171], v[180:183]
    v_fma_f32 v69, v64, v71, v158
    v_mul_f32 v103, s95, v103
    v_mfma_f32_16x16x32_bf16 v[180:183], v[52:55], a[152:155], v[180:183]
    v_fma_f32 v68, -v65, v71, v68
    v_cvt_pk_bf16_f32 v99, v102, v103
    v_mfma_f32_16x16x32_bf16 v[180:183], v[48:51], a[136:139], v[180:183]
    s_add_u32 s80, s101, 81920
    v_fmac_f32 v69, v65, v70
    v_fma_f32 v70, v64, v68, v143
    v_mfma_f32_16x16x32_bf16 v[172:175], a[132:135], v[48:51], v[172:175]
    ds_read_b128 v[32:35], v5 offset:20480
    ds_read_b128 v[36:39], v5 offset:21504
    v_mfma_f32_16x16x32_bf16 v[172:175], a[148:151], v[52:55], v[172:175]
    ds_read_b128 v[40:43], v5 offset:22528
    ds_read_b128 v[44:47], v5 offset:23552
    v_mfma_f32_16x16x32_bf16 v[172:175], a[164:167], v[56:59], v[172:175]
    v_fma_f32 v71, v64, v69, v159
    v_fma_f32 v70, -v65, v69, v70
    v_mfma_f32_16x16x32_bf16 v[172:175], a[180:183], v[60:63], v[172:175]
    buffer_store_dwordx4 v[96:99], v20, s[40:43], s80 offen offset:0 sc1
    v_mfma_f32_16x16x32_bf16 v[168:171], a[176:179], v[60:63], v[168:171]
    v_fmac_f32 v71, v65, v68
    v_mul_f32 v104, s95, v104
    v_mfma_f32_16x16x32_bf16 v[168:171], a[160:163], v[56:59], v[168:171]
    v_and_b32 v30, 15, v0
    v_mul_f32 v105, s95, v105
    v_mfma_f32_16x16x32_bf16 v[168:171], a[144:147], v[52:55], v[168:171]
    s_and_b32 s67, s62, 1
    s_lshl_b32 s67, s67, 7
    v_cvt_pk_bf16_f32 v104, v104, v105
    v_mfma_f32_16x16x32_bf16 v[168:171], a[128:131], v[48:51], v[168:171]
    s_waitcnt lgkmcnt(0)
    s_add_u32 s67, s67, 32768
    v_mul_f32 v106, s95, v106
    v_mfma_f32_16x16x32_bf16 v[160:163], a[192:195], v[32:35], v[160:163]
    v_mul_f32 v107, s95, v107
    v_lshl_add_u32 v72, v30, 3, s67
    v_mfma_f32_16x16x32_bf16 v[160:163], a[208:211], v[36:39], v[160:163]
    v_lshl_add_u32 v31, v23, 8, v72
    v_cvt_pk_bf16_f32 v105, v106, v107
    v_mfma_f32_16x16x32_bf16 v[160:163], a[224:227], v[40:43], v[160:163]
    ds_write_b64 v31, v[70:71]
    v_mul_f32 v108, s95, v108
    v_mfma_f32_16x16x32_bf16 v[160:163], a[240:243], v[44:47], v[160:163]
    ds_read_b128 v[48:51], v5 offset:28672
    v_mul_f32 v109, s95, v109
    v_mfma_f32_16x16x32_bf16 v[164:167], a[244:247], v[44:47], v[164:167]
    ds_read_b128 v[52:55], v5 offset:29696
    ds_read_b128 v[56:59], v5 offset:30720
    v_mfma_f32_16x16x32_bf16 v[164:167], a[228:231], v[40:43], v[164:167]
    ds_read_b128 v[60:63], v5 offset:31744
    v_cvt_pk_bf16_f32 v106, v108, v109
    v_mfma_f32_16x16x32_bf16 v[164:167], a[212:215], v[36:39], v[164:167]
    v_mul_f32 v110, s95, v110
    v_mfma_f32_16x16x32_bf16 v[164:167], a[196:199], v[32:35], v[164:167]
    v_mul_f32 v111, s95, v111
    v_mfma_f32_16x16x32_bf16 v[176:179], v[32:35], a[200:203], v[176:179]
    v_cvt_pk_bf16_f32 v107, v110, v111
    v_mfma_f32_16x16x32_bf16 v[176:179], v[36:39], a[216:219], v[176:179]
    buffer_store_dwordx4 v[104:107], v2, s[40:43], s80 offen offset:0 sc1
    v_mfma_f32_16x16x32_bf16 v[176:179], v[40:43], a[232:235], v[176:179]
    v_mfma_f32_16x16x32_bf16 v[176:179], v[44:47], a[248:251], v[176:179]
    v_mfma_f32_16x16x32_bf16 v[184:187], v[44:47], a[252:255], v[184:187]
    v_mul_f32 v112, s82, v112
    v_mfma_f32_16x16x32_bf16 v[184:187], v[40:43], a[236:239], v[184:187]
POLL_Z:
    v_cmp_ne_u32 vcc, s83, v91
    s_nop 0
    s_cbranch_vccnz SPIN_Z
POLLOK_Z:
    s_waitcnt vmcnt(26) lgkmcnt(0)
    s_barrier
    v_mfma_f32_16x16x32_bf16 v[184:187], v[36:39], a[220:223], v[184:187]
    s_add_u32 s79, s78, s98
    s_add_u32 m0, s71, 0
    v_mul_f32 v113, s82, v113
    v_mfma_f32_16x16x32_bf16 v[184:187], v[32:35], a[204:207], v[184:187]
    ds_read_b128 v[32:35], v5 offset:49152
    v_cvt_pk_bf16_f32 v112, v112, v113
    v_mfma_f32_16x16x32_bf16 v[188:191], v[48:51], a[204:207], v[188:191]
    buffer_load_dwordx4 v1, s[24:27], s79 offen lds
    v_mfma_f32_16x16x32_bf16 v[188:191], v[52:55], a[220:223], v[188:191]
    ds_read_b128 v[36:39], v5 offset:50176
    v_mul_f32 v114, s82, v114
    v_mfma_f32_16x16x32_bf16 v[188:191], v[56:59], a[236:239], v[188:191]
    s_addk_i32 m0, 960
    ds_read_b128 v[40:43], v5 offset:51200
    v_mul_f32 v115, s82, v115
    v_mfma_f32_16x16x32_bf16 v[188:191], v[60:63], a[252:255], v[188:191]
    ds_read_b128 v[44:47], v5 offset:52224
    v_cvt_pk_bf16_f32 v113, v114, v115
    v_mfma_f32_16x16x32_bf16 v[180:183], v[60:63], a[248:251], v[180:183]
    v_mfma_f32_16x16x32_bf16 v[180:183], v[56:59], a[232:235], v[180:183]
    v_mul_f32 v116, s82, v116
    v_mfma_f32_16x16x32_bf16 v[180:183], v[52:55], a[216:219], v[180:183]
    buffer_load_dwordx4 v1, s[24:27], s79 offen offset:64 lds
    v_mfma_f32_16x16x32_bf16 v[180:183], v[48:51], a[200:203], v[180:183]
    v_mul_f32 v117, s82, v117
    v_cvt_pk_bf16_f32 v114, v116, v117
    v_mfma_f32_16x16x32_bf16 v[172:175], a[196:199], v[48:51], v[172:175]
    v_mfma_f32_16x16x32_bf16 v[172:175], a[212:215], v[52:55], v[172:175]
    v_mul_f32 v118, s82, v118
    v_mfma_f32_16x16x32_bf16 v[172:175], a[228:231], v[56:59], v[172:175]
    s_add_u32 s79, s79, s94
    s_addk_i32 m0, 1088
    v_mul_f32 v119, s82, v119
    v_mfma_f32_16x16x32_bf16 v[172:175], a[244:247], v[60:63], v[172:175]
    v_mfma_f32_16x16x32_bf16 v[168:171], a[240:243], v[60:63], v[168:171]
    v_cvt_pk_bf16_f32 v115, v118, v119
    v_mfma_f32_16x16x32_bf16 v[168:171], a[224:227], v[56:59], v[168:171]
    buffer_store_dwordx4 v[112:115], v21, s[40:43], s80 offen offset:0 sc1
    v_mfma_f32_16x16x32_bf16 v[168:171], a[208:211], v[52:55], v[168:171]
    buffer_load_dwordx4 v1, s[24:27], s79 offen lds
    v_mfma_f32_16x16x32_bf16 v[168:171], a[192:195], v[48:51], v[168:171]
    s_waitcnt lgkmcnt(0)
    ds_read_b128 v[48:51], v5 offset:57344
    ds_read_b128 v[52:55], v5 offset:58368
    v_mfma_f32_16x16x32_bf16 v[192:195], a[0:3], v[32:35], 0
    ds_read_b64 v[224:225], v72 offset:0
    ds_read_b64 v[226:227], v72 offset:256
    v_mfma_f32_16x16x32_bf16 v[192:195], a[16:19], v[36:39], v[192:195]
    ds_read_b64 v[228:229], v72 offset:512
    v_mul_f32 v120, s82, v120
    v_mfma_f32_16x16x32_bf16 v[192:195], a[32:35], v[40:43], v[192:195]
    s_addk_i32 m0, 960
    ds_read_b64 v[230:231], v72 offset:768
    ds_read_b64 v[232:233], v72 offset:1024
    v_mfma_f32_16x16x32_bf16 v[192:195], a[48:51], v[44:47], v[192:195]
    ds_read_b64 v[234:235], v72 offset:1280
    v_mul_f32 v121, s82, v121
    v_mfma_f32_16x16x32_bf16 v[196:199], a[52:55], v[44:47], 0
    ds_read_b64 v[236:237], v72 offset:1536
    v_cvt_pk_bf16_f32 v120, v120, v121
    v_mfma_f32_16x16x32_bf16 v[196:199], a[36:39], v[40:43], v[196:199]
PG_4:
    s_cbranch_execz PG_8
    ds_read_b64 v[238:239], v72 offset:1792
    v_mul_f32 v66, 0x41800000, v26
    v_mfma_f32_16x16x32_bf16 v[196:199], a[20:23], v[36:39], v[196:199]
    v_mul_f32 v122, s82, v122
    v_mul_f32 v67, 0x41800000, v27
    v_mfma_f32_16x16x32_bf16 v[196:199], a[4:7], v[32:35], v[196:199]
    buffer_load_dwordx4 v1, s[24:27], s79 offen offset:64 lds
    v_mfma_f32_16x16x32_bf16 v[208:211], v[32:35], a[8:11], 0
    ds_read_b128 v[56:59], v5 offset:59392
    ds_read_b128 v[60:63], v5 offset:60416
    v_mfma_f32_16x16x32_bf16 v[208:211], v[36:39], a[24:27], v[208:211]
    v_mul_f32 v123, s82, v123
    v_cvt_pk_bf16_f32 v121, v122, v123
    v_mfma_f32_16x16x32_bf16 v[208:211], v[40:43], a[40:43], v[208:211]
    s_addk_i32 s98, 128
    v_exp_f32 v66, v66
    v_mfma_f32_16x16x32_bf16 v[208:211], v[44:47], a[56:59], v[208:211]
    s_and_b32 s98, s98, 1023
    v_fract_f32 v67, v67
    v_mul_f32 v124, s82, v124
    v_mfma_f32_16x16x32_bf16 v[216:219], v[44:47], a[60:63], 0
    s_add_u32 s79, s77, s98
    v_cos_f32 v64, v67
    v_mfma_f32_16x16x32_bf16 v[216:219], v[40:43], a[44:47], v[216:219]
    s_addk_i32 m0, 13376
    v_sin_f32 v65, v67
    v_mfma_f32_16x16x32_bf16 v[216:219], v[36:39], a[28:31], v[216:219]
    v_mul_f32 v125, s82, v125
    v_mul_f32 v64, v64, v66
    v_mfma_f32_16x16x32_bf16 v[216:219], v[32:35], a[12:15], v[216:219]
    s_waitcnt lgkmcnt(0)
    v_cvt_pk_bf16_f32 v122, v124, v125
    v_mul_f32 v65, v65, v66
    v_mfma_f32_16x16x32_bf16 v[220:223], v[48:51], a[12:15], 0
    v_mov_b32 v24, 0
    v_mul_f32 v126, s82, v126
    v_mfma_f32_16x16x32_bf16 v[220:223], v[52:55], a[28:31], v[220:223]
    v_mov_b32 v25, 0
    v_and_b32 v30, 15, v0
    v_mfma_f32_16x16x32_bf16 v[220:223], v[56:59], a[44:47], v[220:223]
    buffer_load_dwordx4 v1, s[24:27], s79 offen lds
    s_and_b32 s67, s62, 1
    v_mfma_f32_16x16x32_bf16 v[220:223], v[60:63], a[60:63], v[220:223]
    s_lshl_b32 s67, s67, 7
    v_mul_f32 v127, s82, v127
    v_cvt_pk_bf16_f32 v123, v126, v127
    v_mfma_f32_16x16x32_bf16 v[212:215], v[60:63], a[56:59], 0
    s_lshl_b32 s69, s66, 8
    s_add_u32 s67, s67, s69
    v_lshl_add_u32 v11, v30, 3, s67
    v_mfma_f32_16x16x32_bf16 v[212:215], v[56:59], a[40:43], v[212:215]
    buffer_store_dwordx4 v[120:123], v21, s[40:43], s80 offen offset:1024 sc1
    v_mfma_f32_16x16x32_bf16 v[212:215], v[52:55], a[24:27], v[212:215]
    s_addk_i32 m0, 960
    v_lshl_add_u32 v30, v23, 16, v11
    s_lshl_b32 s67, s65, 12
    v_mfma_f32_16x16x32_bf16 v[212:215], v[48:51], a[8:11], v[212:215]
    v_cmp_eq_u32 vcc, 1, v23
    v_fma_f32 v70, v64, v224, v226
    v_mfma_f32_16x16x32_bf16 v[204:207], a[4:7], v[48:51], 0
    ds_read_b128 v[32:35], v5 offset:53248
    v_fma_f32 v71, v64, v225, v227
    v_mfma_f32_16x16x32_bf16 v[204:207], a[20:23], v[52:55], v[204:207]
    buffer_load_dwordx4 v1, s[24:27], s79 offen offset:64 lds
    v_mfma_f32_16x16x32_bf16 v[204:207], a[36:39], v[56:59], v[204:207]
    ds_read_b128 v[36:39], v5 offset:54272
    ds_read_b128 v[40:43], v5 offset:55296
    ds_read_b128 v[44:47], v5 offset:56320
    v_fma_f32 v70, -v65, v225, v70
    v_fmac_f32 v71, v65, v224
    v_mfma_f32_16x16x32_bf16 v[204:207], a[52:55], v[60:63], v[204:207]
    s_add_u32 s79, s79, s94
    v_cndmask_b32 v24, v24, v224, vcc
    v_cndmask_b32 v25, v25, v225, vcc
    v_mfma_f32_16x16x32_bf16 v[200:203], a[48:51], v[60:63], 0
    s_addk_i32 m0, 1088
    v_cmp_eq_u32 vcc, 2, v23
    v_fma_f32 v68, v64, v70, v228
    v_mfma_f32_16x16x32_bf16 v[200:203], a[32:35], v[56:59], v[200:203]
    v_fma_f32 v69, v64, v71, v229
    v_fma_f32 v68, -v65, v71, v68
    v_mfma_f32_16x16x32_bf16 v[200:203], a[16:19], v[52:55], v[200:203]
    v_fmac_f32 v69, v65, v70
    v_cndmask_b32 v24, v24, v70, vcc
    v_mfma_f32_16x16x32_bf16 v[200:203], a[0:3], v[48:51], v[200:203]
    s_waitcnt lgkmcnt(0)
    v_cndmask_b32 v25, v25, v71, vcc
    v_cmp_eq_u32 vcc, 3, v23
    v_mfma_f32_16x16x32_bf16 v[192:195], a[64:67], v[32:35], v[192:195]
    buffer_load_dwordx4 v1, s[24:27], s79 offen lds
    v_mfma_f32_16x16x32_bf16 v[192:195], a[80:83], v[36:39], v[192:195]
    v_fma_f32 v70, v64, v68, v230
    v_fma_f32 v71, v64, v69, v231
    v_mfma_f32_16x16x32_bf16 v[192:195], a[96:99], v[40:43], v[192:195]
    s_addk_i32 m0, 960
    v_fma_f32 v70, -v65, v69, v70
    v_fmac_f32 v71, v65, v68
    v_mfma_f32_16x16x32_bf16 v[192:195], a[112:115], v[44:47], v[192:195]
    v_cndmask_b32 v24, v24, v68, vcc
    v_cndmask_b32 v25, v25, v69, vcc
    v_mfma_f32_16x16x32_bf16 v[196:199], a[116:119], v[44:47], v[196:199]
    v_cmp_eq_u32 vcc, 4, v23
    v_fma_f32 v68, v64, v70, v232
    v_mfma_f32_16x16x32_bf16 v[196:199], a[100:103], v[40:43], v[196:199]
    v_fma_f32 v69, v64, v71, v233
    v_fma_f32 v68, -v65, v71, v68
    v_mfma_f32_16x16x32_bf16 v[196:199], a[84:87], v[36:39], v[196:199]
    buffer_load_dwordx4 v1, s[24:27], s79 offen offset:64 lds
    v_mfma_f32_16x16x32_bf16 v[196:199], a[68:71], v[32:35], v[196:199]
    ds_read_b128 v[48:51], v5 offset:61440
    ds_read_b128 v[52:55], v5 offset:62464
    v_mfma_f32_16x16x32_bf16 v[208:211], v[32:35], a[72:75], v[208:211]
    ds_read_b128 v[56:59], v5 offset:63488
    ds_read_b128 v[60:63], v5 offset:64512
    v_mfma_f32_16x16x32_bf16 v[208:211], v[36:39], a[88:91], v[208:211]
    v_fmac_f32 v69, v65, v70
    v_cndmask_b32 v24, v24, v70, vcc
    v_mfma_f32_16x16x32_bf16 v[208:211], v[40:43], a[104:107], v[208:211]
    v_cndmask_b32 v25, v25, v71, vcc
    v_cmp_eq_u32 vcc, 5, v23
    v_mfma_f32_16x16x32_bf16 v[208:211], v[44:47], a[120:123], v[208:211]
    v_fma_f32 v70, v64, v68, v234
    v_fma_f32 v71, v64, v69, v235
    v_mfma_f32_16x16x32_bf16 v[216:219], v[44:47], a[124:127], v[216:219]
    v_fma_f32 v70, -v65, v69, v70
    v_fmac_f32 v71, v65, v68
    v_mfma_f32_16x16x32_bf16 v[216:219], v[40:43], a[108:111], v[216:219]
    v_cndmask_b32 v24, v24, v68, vcc
    v_cndmask_b32 v25, v25, v69, vcc
    v_mfma_f32_16x16x32_bf16 v[216:219], v[36:39], a[92:95], v[216:219]
    v_cmp_eq_u32 vcc, 6, v23
    v_fma_f32 v68, v64, v70, v236
    v_mfma_f32_16x16x32_bf16 v[216:219], v[32:35], a[76:79], v[216:219]
    s_waitcnt lgkmcnt(0)
    v_fma_f32 v69, v64, v71, v237
    v_fma_f32 v68, -v65, v71, v68
    v_mfma_f32_16x16x32_bf16 v[220:223], v[48:51], a[76:79], v[220:223]
    v_fmac_f32 v69, v65, v70
    v_cndmask_b32 v24, v24, v70, vcc
    v_mfma_f32_16x16x32_bf16 v[220:223], v[52:55], a[92:95], v[220:223]
    v_cndmask_b32 v25, v25, v71, vcc
    v_cmp_eq_u32 vcc, 7, v23
    v_mfma_f32_16x16x32_bf16 v[220:223], v[56:59], a[108:111], v[220:223]
    v_mul_f32 v160, s95, v160
    v_mul_f32 v161, s95, v161
    v_mfma_f32_16x16x32_bf16 v[220:223], v[60:63], a[124:127], v[220:223]
    v_cvt_pk_bf16_f32 v160, v160, v161
    v_fma_f32 v70, v64, v68, v238
    v_mfma_f32_16x16x32_bf16 v[212:215], v[60:63], a[120:123], v[212:215]
    v_fma_f32 v71, v64, v69, v239
    v_mul_f32 v162, s95, v162
    v_mfma_f32_16x16x32_bf16 v[212:215], v[56:59], a[104:107], v[212:215]
    v_fma_f32 v70, -v65, v69, v70
    v_mul_f32 v163, s95, v163
    v_mfma_f32_16x16x32_bf16 v[212:215], v[52:55], a[88:91], v[212:215]
    v_fmac_f32 v71, v65, v68
    v_cndmask_b32 v24, v24, v68, vcc
    v_mfma_f32_16x16x32_bf16 v[212:215], v[48:51], a[72:75], v[212:215]
    ds_read_b128 v[32:35], v6 offset:0
    v_cndmask_b32 v25, v25, v69, vcc
    v_mfma_f32_16x16x32_bf16 v[204:207], a[68:71], v[48:51], v[204:207]
    buffer_store_dwordx2 v[70:71], v30, s[52:55], s67 offen sc1
    v_mfma_f32_16x16x32_bf16 v[204:207], a[84:87], v[52:55], v[204:207]
    ds_read_b128 v[36:39], v6 offset:1024
    ds_read_b128 v[40:43], v6 offset:2048
    v_mfma_f32_16x16x32_bf16 v[204:207], a[100:103], v[56:59], v[204:207]
    ds_read_b128 v[44:47], v6 offset:3072
    v_cvt_pk_bf16_f32 v161, v162, v163
    v_mfma_f32_16x16x32_bf16 v[204:207], a[116:119], v[60:63], v[204:207]
    v_mul_f32 v164, s95, v164
    v_mul_f32 v165, s95, v165
    v_mfma_f32_16x16x32_bf16 v[200:203], a[112:115], v[60:63], v[200:203]
    v_add_u32 v8, s71, v5
    v_cvt_pk_bf16_f32 v162, v164, v165
    v_mfma_f32_16x16x32_bf16 v[200:203], a[96:99], v[56:59], v[200:203]
    v_add_u32 v9, s71, v6
    v_add_u32 v10, s71, v7
    v_mfma_f32_16x16x32_bf16 v[200:203], a[80:83], v[52:55], v[200:203]
    s_lshl_b32 s68, s62, 10
    v_mul_f32 v166, s95, v166
    v_mul_f32 v167, s95, v167
    v_mfma_f32_16x16x32_bf16 v[200:203], a[64:67], v[48:51], v[200:203]
    s_waitcnt lgkmcnt(0)
    v_subrev_u32 v14, s68, v14
    v_cvt_pk_bf16_f32 v163, v166, v167
    v_mfma_f32_16x16x32_bf16 v[192:195], a[128:131], v[32:35], v[192:195]
    s_add_u32 s80, s101, 98304
    v_subrev_u32 v15, s68, v15
    v_subrev_u32 v16, s68, v16
    v_mfma_f32_16x16x32_bf16 v[192:195], a[144:147], v[36:39], v[192:195]
    buffer_store_dwordx4 v[160:163], v20, s[40:43], s80 offen offset:0 sc1
    v_mfma_f32_16x16x32_bf16 v[192:195], a[160:163], v[40:43], v[192:195]
    v_subrev_u32 v17, s68, v17
    v_subrev_u32 v18, s68, v18
    v_mfma_f32_16x16x32_bf16 v[192:195], a[176:179], v[44:47], v[192:195]
    v_subrev_u32 v19, s68, v19
    v_mul_f32 v168, s95, v168
    v_mfma_f32_16x16x32_bf16 v[196:199], a[180:183], v[44:47], v[196:199]
    v_mul_f32 v169, s95, v169
    v_cvt_pk_bf16_f32 v168, v168, v169
    v_mfma_f32_16x16x32_bf16 v[196:199], a[164:167], v[40:43], v[196:199]
    ds_read_b128 v[48:51], v6 offset:8192
    ds_read_b128 v[52:55], v6 offset:9216
    v_mfma_f32_16x16x32_bf16 v[196:199], a[148:151], v[36:39], v[196:199]
    ds_read_b128 v[56:59], v6 offset:10240
    ds_read_b128 v[60:63], v6 offset:11264
    v_mfma_f32_16x16x32_bf16 v[196:199], a[132:135], v[32:35], v[196:199]
    v_mul_f32 v170, s95, v170
    v_mul_f32 v171, s95, v171
    v_mfma_f32_16x16x32_bf16 v[208:211], v[32:35], a[136:139], v[208:211]
    v_cvt_pk_bf16_f32 v169, v170, v171
    v_mfma_f32_16x16x32_bf16 v[208:211], v[36:39], a[152:155], v[208:211]
    v_mul_f32 v172, s95, v172
    v_mfma_f32_16x16x32_bf16 v[208:211], v[40:43], a[168:171], v[208:211]
    v_mfma_f32_16x16x32_bf16 v[208:211], v[44:47], a[184:187], v[208:211]
    v_mul_f32 v173, s95, v173
    v_mfma_f32_16x16x32_bf16 v[216:219], v[44:47], a[188:191], v[216:219]
    v_cvt_pk_bf16_f32 v170, v172, v173
    v_mfma_f32_16x16x32_bf16 v[216:219], v[40:43], a[172:175], v[216:219]
    v_mul_f32 v174, s95, v174
    v_mfma_f32_16x16x32_bf16 v[216:219], v[36:39], a[156:159], v[216:219]
    v_mul_f32 v175, s95, v175
    v_mfma_f32_16x16x32_bf16 v[216:219], v[32:35], a[140:143], v[216:219]
    s_waitcnt lgkmcnt(0)
    ds_read_b128 v[32:35], v6 offset:4096
    v_cvt_pk_bf16_f32 v171, v174, v175
    v_mfma_f32_16x16x32_bf16 v[220:223], v[48:51], a[140:143], v[220:223]
    ds_read_b128 v[36:39], v6 offset:5120
    ds_read_b128 v[40:43], v6 offset:6144
    v_mfma_f32_16x16x32_bf16 v[220:223], v[52:55], a[156:159], v[220:223]
    buffer_store_dwordx4 v[168:171], v2, s[40:43], s80 offen offset:0 sc1
    v_mfma_f32_16x16x32_bf16 v[220:223], v[56:59], a[172:175], v[220:223]
    ds_read_b128 v[44:47], v6 offset:7168
    v_mfma_f32_16x16x32_bf16 v[220:223], v[60:63], a[188:191], v[220:223]
    v_mul_f32 v176, s82, v176
    v_mfma_f32_16x16x32_bf16 v[212:215], v[60:63], a[184:187], v[212:215]
    v_mul_f32 v177, s82, v177
    v_mfma_f32_16x16x32_bf16 v[212:215], v[56:59], a[168:171], v[212:215]
    v_mfma_f32_16x16x32_bf16 v[212:215], v[52:55], a[152:155], v[212:215]
    v_cvt_pk_bf16_f32 v176, v176, v177
    v_mfma_f32_16x16x32_bf16 v[212:215], v[48:51], a[136:139], v[212:215]
    v_mul_f32 v178, s82, v178
    v_mfma_f32_16x16x32_bf16 v[204:207], a[132:135], v[48:51], v[204:207]
    v_mul_f32 v179, s82, v179
    v_mfma_f32_16x16x32_bf16 v[204:207], a[148:151], v[52:55], v[204:207]
    v_cvt_pk_bf16_f32 v177, v178, v179
    v_mfma_f32_16x16x32_bf16 v[204:207], a[164:167], v[56:59], v[204:207]
    v_mul_f32 v180, s82, v180
    v_mfma_f32_16x16x32_bf16 v[204:207], a[180:183], v[60:63], v[204:207]
    v_mfma_f32_16x16x32_bf16 v[200:203], a[176:179], v[60:63], v[200:203]
    v_mul_f32 v181, s82, v181
    v_mfma_f32_16x16x32_bf16 v[200:203], a[160:163], v[56:59], v[200:203]
    v_cvt_pk_bf16_f32 v178, v180, v181
    v_mfma_f32_16x16x32_bf16 v[200:203], a[144:147], v[52:55], v[200:203]
    v_mul_f32 v182, s82, v182
    v_mfma_f32_16x16x32_bf16 v[200:203], a[128:131], v[48:51], v[200:203]
    s_waitcnt lgkmcnt(0)
    ds_read_b128 v[48:51], v6 offset:12288
    v_mul_f32 v183, s82, v183
    v_mfma_f32_16x16x32_bf16 v[192:195], a[192:195], v[32:35], v[192:195]
    ds_read_b128 v[52:55], v6 offset:13312
    ds_read_b128 v[56:59], v6 offset:14336
    v_mfma_f32_16x16x32_bf16 v[192:195], a[208:211], v[36:39], v[192:195]
    ds_read_b128 v[60:63], v6 offset:15360
    v_cvt_pk_bf16_f32 v179, v182, v183
    v_mfma_f32_16x16x32_bf16 v[192:195], a[224:227], v[40:43], v[192:195]
    buffer_store_dwordx4 v[176:179], v21, s[40:43], s80 offen offset:0 sc1
    v_mfma_f32_16x16x32_bf16 v[192:195], a[240:243], v[44:47], v[192:195]
    v_mfma_f32_16x16x32_bf16 v[196:199], a[244:247], v[44:47], v[196:199]
    v_mul_f32 v184, s82, v184
    v_mfma_f32_16x16x32_bf16 v[196:199], a[228:231], v[40:43], v[196:199]
    v_mfma_f32_16x16x32_bf16 v[196:199], a[212:215], v[36:39], v[196:199]
    v_mul_f32 v185, s82, v185
    v_mfma_f32_16x16x32_bf16 v[196:199], a[196:199], v[32:35], v[196:199]
    v_cvt_pk_bf16_f32 v184, v184, v185
    v_mfma_f32_16x16x32_bf16 v[208:211], v[32:35], a[200:203], v[208:211]
    v_mul_f32 v186, s82, v186
    v_mfma_f32_16x16x32_bf16 v[208:211], v[36:39], a[216:219], v[208:211]
    v_mul_f32 v187, s82, v187
    v_mfma_f32_16x16x32_bf16 v[208:211], v[40:43], a[232:235], v[208:211]
    v_cvt_pk_bf16_f32 v185, v186, v187
    v_mfma_f32_16x16x32_bf16 v[208:211], v[44:47], a[248:251], v[208:211]
    v_mfma_f32_16x16x32_bf16 v[216:219], v[44:47], a[252:255], v[216:219]
    v_mul_f32 v188, s82, v188
    v_mfma_f32_16x16x32_bf16 v[216:219], v[40:43], a[236:239], v[216:219]
    v_mul_f32 v189, s82, v189
    v_mfma_f32_16x16x32_bf16 v[216:219], v[36:39], a[220:223], v[216:219]
    v_cvt_pk_bf16_f32 v186, v188, v189
    v_mfma_f32_16x16x32_bf16 v[216:219], v[32:35], a[204:207], v[216:219]
    s_waitcnt lgkmcnt(0)
    v_mul_f32 v190, s82, v190
    v_mfma_f32_16x16x32_bf16 v[220:223], v[48:51], a[204:207], v[220:223]
    v_mfma_f32_16x16x32_bf16 v[220:223], v[52:55], a[220:223], v[220:223]
    s_waitcnt vmcnt(3) lgkmcnt(0)
    s_barrier
    v_mfma_f32_16x16x32_bf16 v[220:223], v[56:59], a[236:239], v[220:223]
    s_lshl_b32 s79, s98, 12
    s_add_u32 s79, s79, s73
    s_addk_i32 m0, 13376
    v_mfma_f32_16x16x32_bf16 v[220:223], v[60:63], a[252:255], v[220:223]
    s_lshl_b32 s61, s66, 5
    s_add_u32 s61, s61, s65
    s_lshl_b32 s61, s61, 2
    v_mfma_f32_16x16x32_bf16 v[212:215], v[60:63], a[248:251], v[212:215]
    buffer_load_dwordx4 v4, s[28:31], s79 offen lds
    v_mfma_f32_16x16x32_bf16 v[212:215], v[56:59], a[232:235], v[212:215]
    s_addk_i32 s61, 4096
    s_addk_i32 m0, 960
    v_mul_f32 v191, s82, v191
    v_mfma_f32_16x16x32_bf16 v[212:215], v[52:55], a[216:219], v[212:215]
    buffer_store_dword v89, v88, s[48:51], s61 offen sc1
    v_mfma_f32_16x16x32_bf16 v[212:215], v[48:51], a[200:203], v[212:215]
    v_cvt_pk_bf16_f32 v187, v190, v191
    buffer_store_dwordx4 v[184:187], v21, s[40:43], s80 offen offset:1024 sc1
    v_mfma_f32_16x16x32_bf16 v[204:207], a[196:199], v[48:51], v[204:207]
    buffer_load_dwordx4 v4, s[28:31], s79 offen offset:64 lds
    v_mfma_f32_16x16x32_bf16 v[204:207], a[212:215], v[52:55], v[204:207]
    s_addk_i32 m0, 960
    ds_read_b64_tr_b16 a[64:65], v15 offset:32768
    ds_read_b64_tr_b16 a[66:67], v15 offset:33024
    v_mfma_f32_16x16x32_bf16 v[204:207], a[228:231], v[56:59], v[204:207]
    ds_read_b128 a[0:3], v9 offset:16384
    ds_read_b64_tr_b16 a[68:69], v15 offset:40960
    ds_read_b64_tr_b16 a[70:71], v15 offset:41216
    ds_read_b128 a[4:7], v9 offset:17408
    ds_read_b128 a[12:15], v9 offset:19456
    ds_read_b128 a[8:11], v9 offset:18432
    ds_read_b128 a[16:19], v9 offset:49152
    ds_read_b128 a[20:23], v9 offset:50176
    ds_read_b128 a[28:31], v9 offset:52224
    ds_read_b128 a[24:27], v9 offset:51200
    v_mfma_f32_16x16x32_bf16 v[204:207], a[244:247], v[60:63], v[204:207]
    buffer_load_dwordx4 v4, s[28:31], s79 offen offset:128 lds
    v_mfma_f32_16x16x32_bf16 v[200:203], a[240:243], v[60:63], v[200:203]
    s_addk_i32 m0, 960
    ds_read_b64_tr_b16 a[72:73], v18 offset:32768
    ds_read_b64_tr_b16 a[74:75], v18 offset:33024
    v_mfma_f32_16x16x32_bf16 v[200:203], a[224:227], v[56:59], v[200:203]
    ds_read_b64_tr_b16 a[76:77], v18 offset:40960
    ds_read_b64_tr_b16 a[78:79], v18 offset:41216
    v_mfma_f32_16x16x32_bf16 v[200:203], a[208:211], v[52:55], v[200:203]
    ds_read_b64_tr_b16 a[80:81], v15 offset:33792
    ds_read_b64_tr_b16 a[82:83], v15 offset:34048
    v_mfma_f32_16x16x32_bf16 v[200:203], a[192:195], v[48:51], v[200:203]
    s_waitcnt lgkmcnt(6)
    ds_read_b64_tr_b16 a[84:85], v15 offset:41984
    ds_read_b64_tr_b16 a[86:87], v15 offset:42240
    v_mfma_f32_16x16x32_bf16 v[96:99], a[64:67], a[0:3], 0
    buffer_load_dwordx4 v4, s[28:31], s79 offen offset:192 lds
    v_mfma_f32_16x16x32_bf16 v[96:99], a[68:71], a[4:7], v[96:99]
    s_add_u32 s79, s78, s98
    s_addk_i32 m0, 13504
    ds_read_b64_tr_b16 a[88:89], v18 offset:33792
    v_mfma_f32_16x16x32_bf16 v[100:103], a[68:71], a[12:15], 0
    v_mul_f32 v192, s95, v192
    v_mul_f32 v193, s95, v193
    v_mfma_f32_16x16x32_bf16 v[100:103], a[64:67], a[8:11], v[100:103]
    v_cvt_pk_bf16_f32 v32, v192, v193
    v_mul_f32 v194, s95, v194
    v_mfma_f32_16x16x32_bf16 v[104:107], a[64:67], a[16:19], 0
    buffer_load_dwordx4 v1, s[24:27], s79 offen lds
    v_mfma_f32_16x16x32_bf16 v[104:107], a[68:71], a[20:23], v[104:107]
    s_addk_i32 m0, 960
    v_mul_f32 v195, s95, v195
    v_cvt_pk_bf16_f32 v33, v194, v195
    v_mfma_f32_16x16x32_bf16 v[108:111], a[68:71], a[28:31], 0
    v_mul_f32 v196, s95, v196
    v_mul_f32 v197, s95, v197
    v_mfma_f32_16x16x32_bf16 v[108:111], a[64:67], a[24:27], v[108:111]
    s_waitcnt lgkmcnt(5)
    v_cvt_pk_bf16_f32 v34, v196, v197
    v_mul_f32 v198, s95, v198
    v_mfma_f32_16x16x32_bf16 v[124:127], a[72:75], a[24:27], 0
    ds_read_b64_tr_b16 a[90:91], v18 offset:34048
    v_mul_f32 v199, s95, v199
    v_mfma_f32_16x16x32_bf16 v[124:127], a[76:79], a[28:31], v[124:127]
    buffer_load_dwordx4 v1, s[24:27], s79 offen offset:64 lds
    v_mfma_f32_16x16x32_bf16 v[120:123], a[76:79], a[20:23], 0
    s_add_u32 s79, s79, s94
    s_addk_i32 m0, 1088
    v_cvt_pk_bf16_f32 v35, v198, v199
    v_mfma_f32_16x16x32_bf16 v[120:123], a[72:75], a[16:19], v[120:123]
    v_mul_f32 v200, s95, v200
    v_mul_f32 v201, s95, v201
    v_mfma_f32_16x16x32_bf16 v[116:119], a[72:75], a[8:11], 0
    ds_read_b64_tr_b16 a[92:93], v18 offset:41984
    v_cvt_pk_bf16_f32 v36, v200, v201
    v_mfma_f32_16x16x32_bf16 v[116:119], a[76:79], a[12:15], v[116:119]
    ds_read_b64_tr_b16 a[94:95], v18 offset:42240
    v_mul_f32 v202, s95, v202
    v_mfma_f32_16x16x32_bf16 v[112:115], a[76:79], a[4:7], 0
    buffer_load_dwordx4 v1, s[24:27], s79 offen lds
    v_mfma_f32_16x16x32_bf16 v[112:115], a[72:75], a[0:3], v[112:115]
    s_waitcnt lgkmcnt(4)
    v_mul_f32 v203, s95, v203
    v_cvt_pk_bf16_f32 v37, v202, v203
    v_mfma_f32_16x16x32_bf16 v[160:163], a[80:83], a[0:3], 0
    s_addk_i32 m0, 960
    v_mul_f32 v204, s95, v204
    v_mul_f32 v205, s95, v205
    v_mfma_f32_16x16x32_bf16 v[160:163], a[84:87], a[4:7], v[160:163]
    ds_read_b64_tr_b16 a[96:97], v15 offset:34816
    v_cvt_pk_bf16_f32 v38, v204, v205
    v_mfma_f32_16x16x32_bf16 v[164:167], a[84:87], a[12:15], 0
    ds_read_b64_tr_b16 a[98:99], v15 offset:35072
    v_mul_f32 v206, s95, v206
    v_mfma_f32_16x16x32_bf16 v[164:167], a[80:83], a[8:11], v[164:167]
    buffer_load_dwordx4 v1, s[24:27], s79 offen offset:64 lds
    v_mfma_f32_16x16x32_bf16 v[168:171], a[80:83], a[16:19], 0
    s_addk_i32 s98, 128
    s_and_b32 s98, s98, 1023
    s_add_u32 s79, s77, s98
    v_mfma_f32_16x16x32_bf16 v[168:171], a[84:87], a[20:23], v[168:171]
    s_addk_i32 m0, 13376
    v_mul_f32 v207, s95, v207
    v_cvt_pk_bf16_f32 v39, v206, v207
    v_mfma_f32_16x16x32_bf16 v[172:175], a[84:87], a[28:31], 0
    ds_read_b64_tr_b16 a[100:101], v15 offset:43008
    ds_read_b64_tr_b16 a[102:103], v15 offset:43264
    v_mfma_f32_16x16x32_bf16 v[172:175], a[80:83], a[24:27], v[172:175]
    s_waitcnt lgkmcnt(4)
    v_mul_f32 v208, s82, v208
    v_mul_f32 v209, s82, v209
    v_mfma_f32_16x16x32_bf16 v[188:191], a[88:91], a[24:27], 0
    buffer_load_dwordx4 v1, s[24:27], s79 offen lds
    v_mfma_f32_16x16x32_bf16 v[188:191], a[92:95], a[28:31], v[188:191]
    s_addk_i32 m0, 960
    v_cvt_pk_bf16_f32 v40, v208, v209
    v_mul_f32 v210, s82, v210
    v_mfma_f32_16x16x32_bf16 v[184:187], a[92:95], a[20:23], 0
    v_mul_f32 v211, s82, v211
    v_and_b32 v90, 15, v0
    v_mfma_f32_16x16x32_bf16 v[184:187], a[88:91], a[16:19], v[184:187]
    v_cvt_pk_bf16_f32 v41, v210, v211
    v_mul_f32 v212, s82, v212
    v_mfma_f32_16x16x32_bf16 v[180:183], a[88:91], a[8:11], 0
    v_lshlrev_b32 v90, 2, v90
    v_mul_f32 v213, s82, v213
    v_mfma_f32_16x16x32_bf16 v[180:183], a[92:95], a[12:15], v[180:183]
    buffer_load_dwordx4 v1, s[24:27], s79 offen offset:64 lds
    v_mfma_f32_16x16x32_bf16 v[176:179], a[92:95], a[4:7], 0
    s_add_u32 s79, s79, s94
    v_cvt_pk_bf16_f32 v42, v212, v213
    v_mul_f32 v214, s82, v214
    v_mfma_f32_16x16x32_bf16 v[176:179], a[88:91], a[0:3], v[176:179]
    s_waitcnt lgkmcnt(0)
    v_lshrrev_b32 v57, 4, v0
    v_mul_f32 v86, 1.0, v26
    v_mfma_f32_16x16x32_bf16 v[224:227], a[96:99], a[0:3], 0
    s_addk_i32 m0, 1088
    ds_read_b64_tr_b16 a[104:105], v18 offset:34816
    ds_read_b64_tr_b16 a[106:107], v18 offset:35072
    v_mfma_f32_16x16x32_bf16 v[224:227], a[100:103], a[4:7], v[224:227]
    s_add_i32 s67, s65, -16
    ds_read_b64_tr_b16 a[108:109], v18 offset:43008
    ds_read_b64_tr_b16 a[110:111], v18 offset:43264
    v_mfma_f32_16x16x32_bf16 v[228:231], a[100:103], a[12:15], 0
    v_mul_f32 v215, s82, v215
    v_cvt_pk_bf16_f32 v43, v214, v215
    v_mfma_f32_16x16x32_bf16 v[228:231], a[96:99], a[8:11], v[228:231]
    v_mul_f32 v87, 1.0, v27
    v_mul_f32 v216, s82, v216
    v_mfma_f32_16x16x32_bf16 v[232:235], a[96:99], a[16:19], 0
    buffer_load_dwordx4 v1, s[24:27], s79 offen lds
    v_mfma_f32_16x16x32_bf16 v[232:235], a[100:103], a[20:23], v[232:235]
    v_mul_f32 v217, s82, v217
    v_lshl_add_u32 v56, v57, 2, s67
    v_exp_f32 v86, v86
    v_mfma_f32_16x16x32_bf16 v[236:239], a[100:103], a[28:31], 0
    s_addk_i32 m0, 960
    v_cvt_pk_bf16_f32 v44, v216, v217
    v_mul_f32 v218, s82, v218
    v_mfma_f32_16x16x32_bf16 v[236:239], a[96:99], a[24:27], v[236:239]
    s_waitcnt lgkmcnt(0)
    v_lshl_add_u32 v56, v56, 12, v11
    v_mul_f32 v219, s82, v219
    v_mfma_f32_16x16x32_bf16 v[252:255], a[104:107], a[24:27], 0
    v_cvt_pk_bf16_f32 v45, v218, v219
    v_mul_f32 v220, s82, v220
    v_mfma_f32_16x16x32_bf16 v[252:255], a[108:111], a[28:31], v[252:255]
    buffer_load_dwordx4 v1, s[24:27], s79 offen offset:64 lds
    v_fract_f32 v87, v87
    v_mfma_f32_16x16x32_bf16 v[248:251], a[108:111], a[20:23], 0
    ds_read_b64_tr_b16 a[64:65], v15 offset:35840
    ds_read_b64_tr_b16 a[66:67], v15 offset:36096
    ds_read_b64_tr_b16 a[68:69], v15 offset:44032
    ds_read_b64_tr_b16 a[70:71], v15 offset:44288
    v_mul_f32 v221, s82, v221
    v_sub_u32 v57, 3, v57
    v_mfma_f32_16x16x32_bf16 v[248:251], a[104:107], a[16:19], v[248:251]
    v_cvt_pk_bf16_f32 v46, v220, v221
    v_mul_f32 v222, s82, v222
    v_mul_f32 v223, s82, v223
    v_cvt_pk_bf16_f32 v47, v222, v223
    v_mfma_f32_16x16x32_bf16 v[244:247], a[104:107], a[8:11], 0
    ds_read_b64_tr_b16 a[72:73], v18 offset:35840
    ds_read_b64_tr_b16 a[74:75], v18 offset:36096
    ds_read_b64_tr_b16 a[76:77], v18 offset:44032
    ds_read_b64_tr_b16 a[78:79], v18 offset:44288
    v_cvt_f32_u32 v57, v57
    v_cos_f32 v78, v87
    v_mfma_f32_16x16x32_bf16 v[244:247], a[108:111], a[12:15], v[244:247]
    v_mul_f32 v57, 0x44000000, v57
    v_mul_f32 v58, v57, v26
    v_mfma_f32_16x16x32_bf16 v[240:243], a[108:111], a[4:7], 0
    s_add_u32 s80, s101, 114688
    v_sin_f32 v79, v87
    v_mfma_f32_16x16x32_bf16 v[240:243], a[104:107], a[0:3], v[240:243]
    s_waitcnt lgkmcnt(4)
    v_mul_f32 v59, v57, v27
    v_mul_f32 v78, v78, v86
    v_mfma_f32_16x16x32_bf16 v[192:195], a[64:67], a[0:3], 0
    v_exp_f32 v58, v58
    v_mfma_f32_16x16x32_bf16 v[192:195], a[68:71], a[4:7], v[192:195]
    s_waitcnt lgkmcnt(0)
    s_barrier
    v_mfma_f32_16x16x32_bf16 v[196:199], a[68:71], a[12:15], 0
    s_lshl_b32 s79, s98, 12
    s_add_u32 s79, s79, s73
    s_addk_i32 m0, 13376
    v_mfma_f32_16x16x32_bf16 v[196:199], a[64:67], a[8:11], v[196:199]
    ds_read_b64_tr_b16 a[80:81], v16 offset:16384
    v_mul_f32 v79, v79, v86
    v_mfma_f32_16x16x32_bf16 v[200:203], a[64:67], a[16:19], 0
    buffer_load_dwordx4 v4, s[28:31], s79 offen lds
    v_mfma_f32_16x16x32_bf16 v[200:203], a[68:71], a[20:23], v[200:203]
    s_addk_i32 m0, 960
    v_fract_f32 v59, v59
    v_add_f32 v86, -1.0, v78
    v_mfma_f32_16x16x32_bf16 v[204:207], a[68:71], a[28:31], 0
    buffer_store_dwordx4 v[32:35], v20, s[40:43], s80 offen offset:0 sc1
    v_mfma_f32_16x16x32_bf16 v[204:207], a[64:67], a[24:27], v[204:207]
    buffer_load_dwordx4 v4, s[28:31], s79 offen offset:64 lds
    v_mfma_f32_16x16x32_bf16 v[220:223], a[72:75], a[24:27], 0
    s_addk_i32 m0, 960
    ds_read_b64_tr_b16 a[82:83], v16 offset:16640
    ds_read_b128 a[32:35], v10 offset:0
    v_mfma_f32_16x16x32_bf16 v[220:223], a[76:79], a[28:31], v[220:223]
    ds_read_b64_tr_b16 a[84:85], v16 offset:24576
    ds_read_b64_tr_b16 a[86:87], v16 offset:24832
    v_mfma_f32_16x16x32_bf16 v[216:219], a[76:79], a[20:23], 0
    ds_read_b128 a[36:39], v10 offset:1024
    ds_read_b128 a[44:47], v10 offset:3072
    ds_read_b128 a[40:43], v10 offset:2048
    ds_read_b128 a[48:51], v8 offset:0
    ds_read_b128 a[52:55], v8 offset:1024
    ds_read_b128 a[60:63], v8 offset:3072
    ds_read_b128 a[56:59], v8 offset:2048
    v_mfma_f32_16x16x32_bf16 v[216:219], a[72:75], a[16:19], v[216:219]
    v_cos_f32 v74, v59
    v_mul_f32 v87, v28, v28
    v_mfma_f32_16x16x32_bf16 v[212:215], a[72:75], a[8:11], 0
    ds_read_b64_tr_b16 a[88:89], v19 offset:16384
    v_fmac_f32 v87, v29, v29
    v_mfma_f32_16x16x32_bf16 v[212:215], a[76:79], a[12:15], v[212:215]
    buffer_load_dwordx4 v4, s[28:31], s79 offen offset:128 lds
    v_mfma_f32_16x16x32_bf16 v[208:211], a[76:79], a[4:7], 0
    s_addk_i32 m0, 960
    v_sin_f32 v75, v59
    v_mfma_f32_16x16x32_bf16 v[208:211], a[72:75], a[0:3], v[208:211]
    s_waitcnt lgkmcnt(1)
    v_rcp_f32 v87, v87
    v_mfma_f32_16x16x32_bf16 v[96:99], a[80:83], a[32:35], v[96:99]
    ds_read_b64_tr_b16 a[90:91], v19 offset:16640
    ds_read_b64_tr_b16 a[92:93], v19 offset:24576
    v_mfma_f32_16x16x32_bf16 v[96:99], a[84:87], a[36:39], v[96:99]
    ds_read_b64_tr_b16 a[94:95], v19 offset:24832
    v_mul_f32 v74, v74, v58
    v_mfma_f32_16x16x32_bf16 v[100:103], a[84:87], a[44:47], v[100:103]
    buffer_load_dwordx4 v4, s[28:31], s79 offen offset:192 lds
    v_mfma_f32_16x16x32_bf16 v[100:103], a[80:83], a[40:43], v[100:103]
    s_add_u32 s79, s78, s98
    s_addk_i32 m0, 13504
    v_mul_f32 v84, v86, v28
    v_mfma_f32_16x16x32_bf16 v[104:107], a[80:83], a[48:51], v[104:107]
    buffer_store_dwordx4 v[36:39], v2, s[40:43], s80 offen offset:0 sc1
    v_mfma_f32_16x16x32_bf16 v[104:107], a[84:87], a[52:55], v[104:107]
    v_mul_f32 v75, v75, v58
    v_fmac_f32 v84, v79, v29
    v_mfma_f32_16x16x32_bf16 v[108:111], a[84:87], a[60:63], v[108:111]
    buffer_load_dwordx4 v1, s[24:27], s79 offen lds
    v_mfma_f32_16x16x32_bf16 v[108:111], a[80:83], a[56:59], v[108:111]
    s_waitcnt lgkmcnt(0)
    v_mul_f32 v58, 0x43000000, v26
    v_mul_f32 v85, v79, v28
    v_mfma_f32_16x16x32_bf16 v[124:127], a[88:91], a[56:59], v[124:127]
    s_addk_i32 m0, 960
    ds_read_b64_tr_b16 a[96:97], v16 offset:17408
    ds_read_b64_tr_b16 a[98:99], v16 offset:17664
    v_mfma_f32_16x16x32_bf16 v[124:127], a[92:95], a[60:63], v[124:127]
    ds_read_b64_tr_b16 a[100:101], v16 offset:25600
    ds_read_b64_tr_b16 a[102:103], v16 offset:25856
    v_mfma_f32_16x16x32_bf16 v[120:123], a[92:95], a[52:55], v[120:123]
    v_mul_f32 v59, 0x43000000, v27
    v_fma_f32 v85, -v86, v29, v85
    v_mfma_f32_16x16x32_bf16 v[120:123], a[88:91], a[48:51], v[120:123]
    v_exp_f32 v58, v58
    v_mfma_f32_16x16x32_bf16 v[116:119], a[88:91], a[40:43], v[116:119]
    buffer_load_dwordx4 v1, s[24:27], s79 offen offset:64 lds
    v_mfma_f32_16x16x32_bf16 v[116:119], a[92:95], a[44:47], v[116:119]
    s_add_u32 s79, s79, s94
    s_addk_i32 m0, 1088
    v_add_f32 v87, v87, v87
    v_mfma_f32_16x16x32_bf16 v[112:115], a[92:95], a[36:39], v[112:115]
    v_mul_f32 v84, v84, v87
    v_fract_f32 v59, v59
    v_mfma_f32_16x16x32_bf16 v[112:115], a[88:91], a[32:35], v[112:115]
    s_waitcnt lgkmcnt(0)
    ds_read_b64_tr_b16 a[104:105], v19 offset:17408
    v_mul_f32 v85, v85, v87
    v_mfma_f32_16x16x32_bf16 v[160:163], a[96:99], a[32:35], v[160:163]
    buffer_load_dwordx4 v1, s[24:27], s79 offen lds
    v_mfma_f32_16x16x32_bf16 v[160:163], a[100:103], a[36:39], v[160:163]
    s_addk_i32 m0, 960
    ds_read_b64_tr_b16 a[106:107], v19 offset:17664
    ds_read_b64_tr_b16 a[108:109], v19 offset:25600
    v_mfma_f32_16x16x32_bf16 v[164:167], a[100:103], a[44:47], v[164:167]
    ds_read_b64_tr_b16 a[110:111], v19 offset:25856
    v_mul_f32 v76, v84, v128
    v_mfma_f32_16x16x32_bf16 v[164:167], a[96:99], a[40:43], v[164:167]
PG_5:
    s_cbranch_execz PG_9
    v_cos_f32 v80, v59
    v_mfma_f32_16x16x32_bf16 v[168:171], a[96:99], a[48:51], v[168:171]
    buffer_store_dwordx4 v[40:43], v21, s[40:43], s80 offen offset:0 sc1
    v_mfma_f32_16x16x32_bf16 v[168:171], a[100:103], a[52:55], v[168:171]
    v_fma_f32 v76, -v85, v144, v76
    v_mul_f32 v144, v84, v144
    v_mfma_f32_16x16x32_bf16 v[172:175], a[100:103], a[60:63], v[172:175]
    buffer_load_dwordx4 v1, s[24:27], s79 offen offset:64 lds
    v_mfma_f32_16x16x32_bf16 v[172:175], a[96:99], a[56:59], v[172:175]
    s_waitcnt lgkmcnt(0)
    v_sin_f32 v81, v59
    v_mfma_f32_16x16x32_bf16 v[188:191], a[104:107], a[56:59], v[188:191]
    s_addk_i32 s98, 128
    s_and_b32 s98, s98, 1023
    s_add_u32 s79, s77, s98
    s_addk_i32 m0, 13376
    v_mfma_f32_16x16x32_bf16 v[188:191], a[108:111], a[60:63], v[188:191]
    ds_read_b64_tr_b16 a[64:65], v16 offset:18432
    ds_read_b64_tr_b16 a[66:67], v16 offset:18688
    v_mfma_f32_16x16x32_bf16 v[184:187], a[108:111], a[52:55], v[184:187]
    ds_read_b64_tr_b16 a[68:69], v16 offset:26624
    ds_read_b64_tr_b16 a[70:71], v16 offset:26880
    v_fmac_f32 v144, v85, v128
    v_mfma_f32_16x16x32_bf16 v[184:187], a[104:107], a[48:51], v[184:187]
    buffer_load_dwordx4 v1, s[24:27], s79 offen lds
    v_mul_f32 v80, v80, v58
    v_mfma_f32_16x16x32_bf16 v[180:183], a[104:107], a[40:43], v[180:183]
    s_addk_i32 m0, 960
    v_mul_f32 v128, v84, v129
    v_mul_f32 v81, v81, v58
    v_mfma_f32_16x16x32_bf16 v[180:183], a[108:111], a[44:47], v[180:183]
    v_fma_f32 v128, -v85, v145, v128
    v_cvt_f32_u32 v57, v23
    v_mfma_f32_16x16x32_bf16 v[176:179], a[108:111], a[36:39], v[176:179]
    buffer_load_dwordx4 v1, s[24:27], s79 offen offset:64 lds
    v_mfma_f32_16x16x32_bf16 v[176:179], a[104:107], a[32:35], v[176:179]
    s_waitcnt lgkmcnt(0)
    ds_read_b64_tr_b16 a[72:73], v19 offset:18432
    v_mul_f32 v145, v84, v145
    v_mfma_f32_16x16x32_bf16 v[224:227], a[64:67], a[32:35], v[224:227]
    buffer_store_dwordx4 v[44:47], v21, s[40:43], s80 offen offset:1024 sc1
    v_mfma_f32_16x16x32_bf16 v[224:227], a[68:71], a[36:39], v[224:227]
    s_add_u32 s79, s79, s94
    ds_read_b64_tr_b16 a[74:75], v19 offset:18688
    ds_read_b64_tr_b16 a[76:77], v19 offset:26624
    v_mfma_f32_16x16x32_bf16 v[228:231], a[68:71], a[44:47], v[228:231]
    s_addk_i32 m0, 1088
    ds_read_b64_tr_b16 a[78:79], v19 offset:26880
    v_mul_f32 v57, 0x41800000, v57
    v_mfma_f32_16x16x32_bf16 v[228:231], a[64:67], a[40:43], v[228:231]
    v_fmac_f32 v145, v85, v129
    v_mul_f32 v58, v57, v26
    v_mfma_f32_16x16x32_bf16 v[232:235], a[64:67], a[48:51], v[232:235]
    buffer_load_dwordx4 v1, s[24:27], s79 offen lds
    v_mfma_f32_16x16x32_bf16 v[232:235], a[68:71], a[52:55], v[232:235]
    s_addk_i32 m0, 960
    v_mul_f32 v129, v84, v130
    v_mul_f32 v59, v57, v27
    v_mfma_f32_16x16x32_bf16 v[236:239], a[68:71], a[60:63], v[236:239]
    v_fma_f32 v129, -v85, v146, v129
    v_mul_f32 v146, v84, v146
    v_mfma_f32_16x16x32_bf16 v[236:239], a[64:67], a[56:59], v[236:239]
    s_waitcnt lgkmcnt(0)
    v_exp_f32 v58, v58
    v_mfma_f32_16x16x32_bf16 v[252:255], a[72:75], a[56:59], v[252:255]
    buffer_load_dwordx4 v1, s[24:27], s79 offen offset:64 lds
    v_mfma_f32_16x16x32_bf16 v[252:255], a[76:79], a[60:63], v[252:255]
    ds_read_b64_tr_b16 a[80:81], v16 offset:19456
    ds_read_b64_tr_b16 a[82:83], v16 offset:19712
    v_mfma_f32_16x16x32_bf16 v[248:251], a[76:79], a[52:55], v[248:251]
    ds_read_b64_tr_b16 a[84:85], v16 offset:27648
    ds_read_b64_tr_b16 a[86:87], v16 offset:27904
    v_mfma_f32_16x16x32_bf16 v[248:251], a[72:75], a[48:51], v[248:251]
    ds_read_b64_tr_b16 a[88:89], v19 offset:19456
    ds_read_b64_tr_b16 a[90:91], v19 offset:19712
    v_mfma_f32_16x16x32_bf16 v[244:247], a[72:75], a[40:43], v[244:247]
    ds_read_b64_tr_b16 a[92:93], v19 offset:27648
    ds_read_b64_tr_b16 a[94:95], v19 offset:27904
    v_fmac_f32 v146, v85, v130
    v_mfma_f32_16x16x32_bf16 v[244:247], a[76:79], a[44:47], v[244:247]
    v_fract_f32 v59, v59
    v_mul_f32 v130, v84, v131
    v_mfma_f32_16x16x32_bf16 v[240:243], a[76:79], a[36:39], v[240:243]
    v_cos_f32 v82, v59
    v_mfma_f32_16x16x32_bf16 v[240:243], a[72:75], a[32:35], v[240:243]
    s_waitcnt lgkmcnt(4)
    v_fma_f32 v130, -v85, v147, v130
    v_mul_f32 v147, v84, v147
    v_mfma_f32_16x16x32_bf16 v[192:195], a[80:83], a[32:35], v[192:195]
    v_sin_f32 v83, v59
    v_mfma_f32_16x16x32_bf16 v[192:195], a[84:87], a[36:39], v[192:195]
    s_waitcnt vmcnt(20) lgkmcnt(0)
    s_barrier
    v_mfma_f32_16x16x32_bf16 v[196:199], a[84:87], a[44:47], v[196:199]
    s_lshl_b32 s79, s98, 12
    s_add_u32 s79, s79, s73
    s_addk_i32 m0, 13376
    v_mfma_f32_16x16x32_bf16 v[196:199], a[80:83], a[40:43], v[196:199]
    v_fmac_f32 v147, v85, v131
    v_mul_f32 v131, v84, v132
    v_mfma_f32_16x16x32_bf16 v[200:203], a[80:83], a[48:51], v[200:203]
    buffer_load_dwordx4 v4, s[28:31], s79 offen lds
    v_mfma_f32_16x16x32_bf16 v[200:203], a[84:87], a[52:55], v[200:203]
    s_addk_i32 m0, 960
    v_mul_f32 v82, v82, v58
    v_fma_f32 v131, -v85, v148, v131
    v_mfma_f32_16x16x32_bf16 v[204:207], a[84:87], a[60:63], v[204:207]
    ds_read_b64_tr_b16 a[96:97], v14 offset:32768
    ds_read_b64_tr_b16 a[98:99], v14 offset:33024
    v_mfma_f32_16x16x32_bf16 v[204:207], a[80:83], a[56:59], v[204:207]
    buffer_load_dwordx4 v4, s[28:31], s79 offen offset:64 lds
    v_mfma_f32_16x16x32_bf16 v[220:223], a[88:91], a[56:59], v[220:223]
    s_addk_i32 m0, 960
    ds_read_b128 a[0:3], v8 offset:16384
    ds_read_b64_tr_b16 a[100:101], v14 offset:40960
    v_mfma_f32_16x16x32_bf16 v[220:223], a[92:95], a[60:63], v[220:223]
    ds_read_b64_tr_b16 a[102:103], v14 offset:41216
    ds_read_b128 a[4:7], v8 offset:17408
    v_mfma_f32_16x16x32_bf16 v[216:219], a[92:95], a[52:55], v[216:219]
    ds_read_b128 a[12:15], v8 offset:19456
    ds_read_b128 a[8:11], v8 offset:18432
    ds_read_b128 a[16:19], v8 offset:49152
    ds_read_b128 a[20:23], v8 offset:50176
    ds_read_b128 a[28:31], v8 offset:52224
    ds_read_b128 a[24:27], v8 offset:51200
    v_mul_f32 v83, v83, v58
    v_mfma_f32_16x16x32_bf16 v[216:219], a[88:91], a[48:51], v[216:219]
    v_mul_f32 v148, v84, v148
    v_add_u32 v57, 4096, v56
    v_mfma_f32_16x16x32_bf16 v[212:215], a[88:91], a[40:43], v[212:215]
    v_fmac_f32 v148, v85, v132
    v_add_u32 v58, 8192, v56
    v_mfma_f32_16x16x32_bf16 v[212:215], a[92:95], a[44:47], v[212:215]
    buffer_load_dwordx4 v4, s[28:31], s79 offen offset:128 lds
    v_mfma_f32_16x16x32_bf16 v[208:211], a[92:95], a[36:39], v[208:211]
    s_addk_i32 m0, 960
    v_add_u32 v59, 12288, v56
    v_mul_f32 v132, v84, v133
    v_mfma_f32_16x16x32_bf16 v[208:211], a[88:91], a[32:35], v[208:211]
    s_waitcnt lgkmcnt(0)
    ds_read_b64_tr_b16 a[104:105], v17 offset:32768
    ds_read_b64_tr_b16 a[106:107], v17 offset:33024
    v_mfma_f32_16x16x32_bf16 v[96:99], a[96:99], a[0:3], v[96:99]
    ds_read_b64_tr_b16 a[108:109], v17 offset:40960
    ds_read_b64_tr_b16 a[110:111], v17 offset:41216
    v_mfma_f32_16x16x32_bf16 v[96:99], a[100:103], a[4:7], v[96:99]
    v_fma_f32 v132, -v85, v149, v132
    v_mul_f32 v149, v84, v149
    v_mfma_f32_16x16x32_bf16 v[100:103], a[100:103], a[12:15], v[100:103]
    buffer_load_dwordx4 v4, s[28:31], s79 offen offset:192 lds
    v_mfma_f32_16x16x32_bf16 v[100:103], a[96:99], a[8:11], v[100:103]
    s_add_u32 s79, s78, s98
    s_addk_i32 m0, 13504
    v_fmac_f32 v149, v85, v133
    v_mfma_f32_16x16x32_bf16 v[104:107], a[96:99], a[16:19], v[104:107]
    s_lshl_b32 s61, s66, 7
    s_addk_i32 s61, 4096
    v_mul_f32 v133, v84, v134
    v_mfma_f32_16x16x32_bf16 v[104:107], a[100:103], a[20:23], v[104:107]
    buffer_load_dwordx4 v1, s[24:27], s79 offen lds
    v_mfma_f32_16x16x32_bf16 v[108:111], a[100:103], a[28:31], v[108:111]
    buffer_load_dword v91, v90, s[48:51], s61 offen sc1
    v_mfma_f32_16x16x32_bf16 v[108:111], a[96:99], a[24:27], v[108:111]
    s_waitcnt lgkmcnt(0)
    ds_read_b64_tr_b16 a[64:65], v14 offset:33792
    ds_read_b64_tr_b16 a[66:67], v14 offset:34048
    v_mfma_f32_16x16x32_bf16 v[124:127], a[104:107], a[24:27], v[124:127]
    s_addk_i32 m0, 960
    ds_read_b64_tr_b16 a[68:69], v14 offset:41984
    ds_read_b64_tr_b16 a[70:71], v14 offset:42240
    v_mfma_f32_16x16x32_bf16 v[124:127], a[108:111], a[28:31], v[124:127]
    v_fma_f32 v133, -v85, v150, v133
    v_mul_f32 v150, v84, v150
    v_mfma_f32_16x16x32_bf16 v[120:123], a[108:111], a[20:23], v[120:123]
    buffer_load_dwordx4 v1, s[24:27], s79 offen offset:64 lds
    v_mfma_f32_16x16x32_bf16 v[120:123], a[104:107], a[16:19], v[120:123]
    s_add_u32 s79, s79, s94
    s_addk_i32 m0, 1088
    v_fmac_f32 v150, v85, v134
    v_mfma_f32_16x16x32_bf16 v[116:119], a[104:107], a[8:11], v[116:119]
    ds_read_b64_tr_b16 a[72:73], v17 offset:33792
    v_mul_f32 v134, v84, v135
    v_mfma_f32_16x16x32_bf16 v[116:119], a[108:111], a[12:15], v[116:119]
    ds_read_b64_tr_b16 a[74:75], v17 offset:34048
    ds_read_b64_tr_b16 a[76:77], v17 offset:41984
    v_mfma_f32_16x16x32_bf16 v[112:115], a[108:111], a[4:7], v[112:115]
    buffer_load_dwordx4 v1, s[24:27], s79 offen lds
    v_mfma_f32_16x16x32_bf16 v[112:115], a[104:107], a[0:3], v[112:115]
    s_waitcnt lgkmcnt(3)
    ds_read_b64_tr_b16 a[78:79], v17 offset:42240
    v_fma_f32 v134, -v85, v151, v134
    v_mfma_f32_16x16x32_bf16 v[160:163], a[64:67], a[0:3], v[160:163]
    s_addk_i32 m0, 960
    ds_read_b64_tr_b16 a[80:81], v14 offset:34816
    v_mul_f32 v151, v84, v151
    v_mfma_f32_16x16x32_bf16 v[160:163], a[68:71], a[4:7], v[160:163]
    ds_read_b64_tr_b16 a[82:83], v14 offset:35072
    ds_read_b64_tr_b16 a[84:85], v14 offset:43008
    v_mfma_f32_16x16x32_bf16 v[164:167], a[68:71], a[12:15], v[164:167]
    ds_read_b64_tr_b16 a[86:87], v14 offset:43264
    ds_read_b64_tr_b16 a[88:89], v17 offset:34816
    v_mfma_f32_16x16x32_bf16 v[164:167], a[64:67], a[8:11], v[164:167]
    buffer_load_dwordx4 v1, s[24:27], s79 offen offset:64 lds
    v_mfma_f32_16x16x32_bf16 v[168:171], a[64:67], a[16:19], v[168:171]
    s_addk_i32 s98, 128
    s_and_b32 s98, s98, 1023
    s_add_u32 s79, s77, s98
    v_mfma_f32_16x16x32_bf16 v[168:171], a[68:71], a[20:23], v[168:171]
    s_add_u32 m0, s71, 0
    v_fmac_f32 v151, v85, v135
    v_mul_f32 v135, v84, v136
    v_mfma_f32_16x16x32_bf16 v[172:175], a[68:71], a[28:31], v[172:175]
    ds_read_b64_tr_b16 a[90:91], v17 offset:35072
    ds_read_b64_tr_b16 a[92:93], v17 offset:43008
    v_mfma_f32_16x16x32_bf16 v[172:175], a[64:67], a[24:27], v[172:175]
    s_waitcnt lgkmcnt(7)
    ds_read_b64_tr_b16 a[94:95], v17 offset:43264
    v_fma_f32 v135, -v85, v152, v135
    v_mfma_f32_16x16x32_bf16 v[188:191], a[72:75], a[24:27], v[188:191]
    buffer_load_dwordx4 v1, s[24:27], s79 offen lds
    v_mfma_f32_16x16x32_bf16 v[188:191], a[76:79], a[28:31], v[188:191]
    s_addk_i32 m0, 960
    ds_read_b64_tr_b16 a[96:97], v14 offset:35840
    v_mul_f32 v152, v84, v152
    v_mfma_f32_16x16x32_bf16 v[184:187], a[76:79], a[20:23], v[184:187]
    ds_read_b64_tr_b16 a[98:99], v14 offset:36096
    ds_read_b64_tr_b16 a[100:101], v14 offset:44032
    v_mfma_f32_16x16x32_bf16 v[184:187], a[72:75], a[16:19], v[184:187]
    ds_read_b64_tr_b16 a[102:103], v14 offset:44288
    ds_read_b64_tr_b16 a[104:105], v17 offset:35840
    v_mfma_f32_16x16x32_bf16 v[180:183], a[72:75], a[8:11], v[180:183]
    buffer_load_dwordx4 v1, s[24:27], s79 offen offset:64 lds
    v_mfma_f32_16x16x32_bf16 v[180:183], a[76:79], a[12:15], v[180:183]
    s_add_u32 s79, s79, s94
    s_addk_i32 m0, 1088
    v_fmac_f32 v152, v85, v136
    v_mfma_f32_16x16x32_bf16 v[176:179], a[76:79], a[4:7], v[176:179]
    ds_read_b64_tr_b16 a[106:107], v17 offset:36096
    v_mul_f32 v136, v84, v137
    v_mfma_f32_16x16x32_bf16 v[176:179], a[72:75], a[0:3], v[176:179]
    s_waitcnt lgkmcnt(10)
    ds_read_b64_tr_b16 a[108:109], v17 offset:44032
    ds_read_b64_tr_b16 a[110:111], v17 offset:44288
    v_mfma_f32_16x16x32_bf16 v[224:227], a[80:83], a[0:3], v[224:227]
    v_fma_f32 v136, -v85, v153, v136
    v_mfma_f32_16x16x32_bf16 v[224:227], a[84:87], a[4:7], v[224:227]
    buffer_load_dwordx4 v1, s[24:27], s79 offen lds
    v_mfma_f32_16x16x32_bf16 v[228:231], a[84:87], a[12:15], v[228:231]
    s_addk_i32 m0, 960
    v_mul_f32 v153, v84, v153
    v_mfma_f32_16x16x32_bf16 v[228:231], a[80:83], a[8:11], v[228:231]
    v_mfma_f32_16x16x32_bf16 v[232:235], a[80:83], a[16:19], v[232:235]
    v_fmac_f32 v153, v85, v137
    v_mfma_f32_16x16x32_bf16 v[232:235], a[84:87], a[20:23], v[232:235]
    buffer_load_dwordx4 v1, s[24:27], s79 offen offset:64 lds
    v_mfma_f32_16x16x32_bf16 v[236:239], a[84:87], a[28:31], v[236:239]
    v_mfma_f32_16x16x32_bf16 v[236:239], a[80:83], a[24:27], v[236:239]
    s_waitcnt lgkmcnt(8)
    v_mul_f32 v137, v84, v138
    v_mfma_f32_16x16x32_bf16 v[252:255], a[88:91], a[24:27], v[252:255]
    v_mfma_f32_16x16x32_bf16 v[252:255], a[92:95], a[28:31], v[252:255]
    v_fma_f32 v137, -v85, v154, v137
    v_mfma_f32_16x16x32_bf16 v[248:251], a[92:95], a[20:23], v[248:251]
    v_mfma_f32_16x16x32_bf16 v[248:251], a[88:91], a[16:19], v[248:251]
    v_mul_f32 v154, v84, v154
    v_mfma_f32_16x16x32_bf16 v[244:247], a[88:91], a[8:11], v[244:247]
    v_mfma_f32_16x16x32_bf16 v[244:247], a[92:95], a[12:15], v[244:247]
    v_fmac_f32 v154, v85, v138
    v_mfma_f32_16x16x32_bf16 v[240:243], a[92:95], a[4:7], v[240:243]
    v_mfma_f32_16x16x32_bf16 v[240:243], a[88:91], a[0:3], v[240:243]
    s_waitcnt lgkmcnt(4)
    v_mul_f32 v138, v84, v139
    v_mfma_f32_16x16x32_bf16 v[192:195], a[96:99], a[0:3], v[192:195]
    v_mfma_f32_16x16x32_bf16 v[192:195], a[100:103], a[4:7], v[192:195]
    s_waitcnt vmcnt(15)
POLL_E:
    s_waitcnt vmcnt(7)
    v_cmp_ne_u32 vcc, s83, v91
    s_nop 0
    s_cbranch_vccnz SPIN_E
POLLOK_E:
    s_waitcnt lgkmcnt(0)
    s_barrier
    v_mfma_f32_16x16x32_bf16 v[196:199], a[100:103], a[12:15], v[196:199]
    s_lshl_b32 s79, s98, 12
    s_add_u32 s79, s79, s73
    s_add_u32 m0, s71, 16384
    v_mfma_f32_16x16x32_bf16 v[196:199], a[96:99], a[8:11], v[196:199]
    s_lshl_b32 s61, s63, 5
    s_add_u32 s61, s61, s64
    s_lshl_b32 s61, s61, 2
    v_mfma_f32_16x16x32_bf16 v[200:203], a[96:99], a[16:19], v[200:203]
    buffer_load_dwordx4 v4, s[28:31], s79 offen lds
    v_mfma_f32_16x16x32_bf16 v[200:203], a[100:103], a[20:23], v[200:203]
    buffer_store_dword v89, v88, s[48:51], s61 offen sc1
    v_mfma_f32_16x16x32_bf16 v[204:207], a[100:103], a[28:31], v[204:207]
    buffer_load_dwordx2 v[48:49], v56, s[52:55], 0 offen sc1
    v_mfma_f32_16x16x32_bf16 v[204:207], a[96:99], a[24:27], v[204:207]
    s_addk_i32 m0, 960
    v_fma_f32 v138, -v85, v155, v138
    v_mul_f32 v155, v84, v155
    v_mfma_f32_16x16x32_bf16 v[220:223], a[104:107], a[24:27], v[220:223]
    buffer_load_dwordx2 v[50:51], v57, s[52:55], 0 offen sc1
    v_mfma_f32_16x16x32_bf16 v[220:223], a[108:111], a[28:31], v[220:223]
    buffer_load_dwordx4 v4, s[28:31], s79 offen offset:64 lds
    v_mfma_f32_16x16x32_bf16 v[216:219], a[108:111], a[20:23], v[216:219]
    ds_read_b64_tr_b16 a[64:65], v15 offset:16384
    ds_read_b64_tr_b16 a[66:67], v15 offset:16640
    ds_read_b128 a[32:35], v9 offset:0
    ds_read_b64_tr_b16 a[68:69], v15 offset:24576
    ds_read_b64_tr_b16 a[70:71], v15 offset:24832
    ds_read_b128 a[36:39], v9 offset:1024
    ds_read_b128 a[44:47], v9 offset:3072
    ds_read_b128 a[40:43], v9 offset:2048
    ds_read_b128 a[48:51], v9 offset:32768
    ds_read_b128 a[52:55], v9 offset:33792
    ds_read_b128 a[60:63], v9 offset:35840
    ds_read_b128 a[56:59], v9 offset:34816
    v_mfma_f32_16x16x32_bf16 v[216:219], a[104:107], a[16:19], v[216:219]
    buffer_load_dwordx2 v[52:53], v58, s[52:55], 0 offen sc1
    v_fmac_f32 v155, v85, v139
    v_mfma_f32_16x16x32_bf16 v[212:215], a[104:107], a[8:11], v[212:215]
    s_addk_i32 m0, 960
    v_mul_f32 v139, v84, v140
    v_fma_f32 v139, -v85, v156, v139
    v_mfma_f32_16x16x32_bf16 v[212:215], a[108:111], a[12:15], v[212:215]
    buffer_load_dwordx2 v[54:55], v59, s[52:55], 0 offen sc1
    v_mfma_f32_16x16x32_bf16 v[208:211], a[108:111], a[4:7], v[208:211]
    buffer_load_dwordx4 v4, s[28:31], s79 offen offset:128 lds
    v_mfma_f32_16x16x32_bf16 v[208:211], a[104:107], a[0:3], v[208:211]
    s_waitcnt lgkmcnt(0)
    s_addk_i32 m0, 960
    ds_read_b64_tr_b16 a[72:73], v18 offset:16384
    v_mfma_f32_16x16x32_bf16 v[96:99], a[64:67], a[32:35], v[96:99]
    ds_read_b64_tr_b16 a[74:75], v18 offset:16640
    ds_read_b64_tr_b16 a[76:77], v18 offset:24576
    v_mfma_f32_16x16x32_bf16 v[96:99], a[68:71], a[36:39], v[96:99]
    ds_read_b64_tr_b16 a[78:79], v18 offset:24832
    v_mul_f32 v156, v84, v156
    v_mfma_f32_16x16x32_bf16 v[100:103], a[68:71], a[44:47], v[100:103]
    buffer_load_dwordx4 v4, s[28:31], s79 offen offset:192 lds
    v_mfma_f32_16x16x32_bf16 v[100:103], a[64:67], a[40:43], v[100:103]
    s_add_u32 s79, s78, s98
    s_addk_i32 m0, 13504
    v_fmac_f32 v156, v85, v140
    v_mfma_f32_16x16x32_bf16 v[104:107], a[64:67], a[48:51], v[104:107]
    v_mul_f32 v140, v84, v141
    v_fma_f32 v140, -v85, v157, v140
    v_mfma_f32_16x16x32_bf16 v[104:107], a[68:71], a[52:55], v[104:107]
    buffer_load_dwordx4 v1, s[24:27], s79 offen lds
    v_mfma_f32_16x16x32_bf16 v[108:111], a[68:71], a[60:63], v[108:111]
    s_addk_i32 m0, 960
    ds_read_b64_tr_b16 a[80:81], v15 offset:17408
    ds_read_b64_tr_b16 a[82:83], v15 offset:17664
    v_mfma_f32_16x16x32_bf16 v[108:111], a[64:67], a[56:59], v[108:111]
    s_waitcnt lgkmcnt(2)
    ds_read_b64_tr_b16 a[84:85], v15 offset:25600
    ds_read_b64_tr_b16 a[86:87], v15 offset:25856
    v_mfma_f32_16x16x32_bf16 v[124:127], a[72:75], a[56:59], v[124:127]
    v_mul_f32 v157, v84, v157
    v_fmac_f32 v157, v85, v141
    v_mfma_f32_16x16x32_bf16 v[124:127], a[76:79], a[60:63], v[124:127]
    buffer_load_dwordx4 v1, s[24:27], s79 offen offset:64 lds
    v_mfma_f32_16x16x32_bf16 v[120:123], a[76:79], a[52:55], v[120:123]
    s_add_u32 s79, s79, s94
    s_addk_i32 m0, 1088
    v_mul_f32 v141, v84, v142
    v_mfma_f32_16x16x32_bf16 v[120:123], a[72:75], a[48:51], v[120:123]
    ds_read_b64_tr_b16 a[88:89], v18 offset:17408
    ds_read_b64_tr_b16 a[90:91], v18 offset:17664
    v_mfma_f32_16x16x32_bf16 v[116:119], a[72:75], a[40:43], v[116:119]
    ds_read_b64_tr_b16 a[92:93], v18 offset:25600
    v_fma_f32 v141, -v85, v158, v141
    v_mfma_f32_16x16x32_bf16 v[116:119], a[76:79], a[44:47], v[116:119]
    ds_read_b64_tr_b16 a[94:95], v18 offset:25856
    ds_read_b64_tr_b16 a[96:97], v15 offset:18432
    v_mfma_f32_16x16x32_bf16 v[112:115], a[76:79], a[36:39], v[112:115]
    buffer_load_dwordx4 v1, s[24:27], s79 offen lds
    v_mfma_f32_16x16x32_bf16 v[112:115], a[72:75], a[32:35], v[112:115]
    s_waitcnt lgkmcnt(5)
    s_addk_i32 m0, 960
    v_mul_f32 v158, v84, v158
    v_mfma_f32_16x16x32_bf16 v[160:163], a[80:83], a[32:35], v[160:163]
    ds_read_b64_tr_b16 a[98:99], v15 offset:18688
    v_fmac_f32 v158, v85, v142
    v_mfma_f32_16x16x32_bf16 v[160:163], a[84:87], a[36:39], v[160:163]
    ds_read_b64_tr_b16 a[100:101], v15 offset:26624
    ds_read_b64_tr_b16 a[102:103], v15 offset:26880
    v_mfma_f32_16x16x32_bf16 v[164:167], a[84:87], a[44:47], v[164:167]
    ds_read_b64_tr_b16 a[104:105], v18 offset:18432
    ds_read_b64_tr_b16 a[106:107], v18 offset:18688
    v_mfma_f32_16x16x32_bf16 v[164:167], a[80:83], a[40:43], v[164:167]
    buffer_load_dwordx4 v1, s[24:27], s79 offen offset:64 lds
    v_mfma_f32_16x16x32_bf16 v[168:171], a[80:83], a[48:51], v[168:171]
    s_addk_i32 s98, 128
    s_and_b32 s98, s98, 1023
    s_add_u32 s79, s77, s98
    v_mfma_f32_16x16x32_bf16 v[168:171], a[84:87], a[52:55], v[168:171]
    s_addk_i32 m0, 13376
    v_mul_f32 v142, v84, v143
    v_fma_f32 v142, -v85, v159, v142
    v_mfma_f32_16x16x32_bf16 v[172:175], a[84:87], a[60:63], v[172:175]
    ds_read_b64_tr_b16 a[108:109], v18 offset:26624
    ds_read_b64_tr_b16 a[110:111], v18 offset:26880
    v_mfma_f32_16x16x32_bf16 v[172:175], a[80:83], a[56:59], v[172:175]
    s_waitcnt lgkmcnt(8)
    ds_read_b64_tr_b16 a[64:65], v15 offset:19456
    v_mul_f32 v159, v84, v159
    v_mfma_f32_16x16x32_bf16 v[188:191], a[88:91], a[56:59], v[188:191]
    buffer_load_dwordx4 v1, s[24:27], s79 offen lds
    v_mfma_f32_16x16x32_bf16 v[188:191], a[92:95], a[60:63], v[188:191]
    s_addk_i32 m0, 960
    ds_read_b64_tr_b16 a[66:67], v15 offset:19712
    v_fmac_f32 v159, v85, v143
    v_mfma_f32_16x16x32_bf16 v[184:187], a[92:95], a[52:55], v[184:187]
    ds_read_b64_tr_b16 a[68:69], v15 offset:27648
    ds_read_b64_tr_b16 a[70:71], v15 offset:27904
    v_mfma_f32_16x16x32_bf16 v[184:187], a[88:91], a[48:51], v[184:187]
    ds_read_b64_tr_b16 a[72:73], v18 offset:19456
    ds_read_b64_tr_b16 a[74:75], v18 offset:19712
    v_mfma_f32_16x16x32_bf16 v[180:183], a[88:91], a[40:43], v[180:183]
    buffer_load_dwordx4 v1, s[24:27], s79 offen offset:64 lds
    v_mfma_f32_16x16x32_bf16 v[180:183], a[92:95], a[44:47], v[180:183]
    s_add_u32 s79, s79, s94
    s_addk_i32 m0, 1088
    ds_read_b64_tr_b16 a[76:77], v18 offset:27648
    v_mfma_f32_16x16x32_bf16 v[176:179], a[92:95], a[36:39], v[176:179]
    ds_read_b64_tr_b16 a[78:79], v18 offset:27904
    v_mfma_f32_16x16x32_bf16 v[176:179], a[88:91], a[32:35], v[176:179]
    s_waitcnt lgkmcnt(12)
    v_mfma_f32_16x16x32_bf16 v[224:227], a[96:99], a[32:35], v[224:227]
    v_mfma_f32_16x16x32_bf16 v[224:227], a[100:103], a[36:39], v[224:227]
    buffer_load_dwordx4 v1, s[24:27], s79 offen lds
    v_mfma_f32_16x16x32_bf16 v[228:231], a[100:103], a[44:47], v[228:231]
    s_addk_i32 m0, 960
    v_mfma_f32_16x16x32_bf16 v[228:231], a[96:99], a[40:43], v[228:231]
    v_mfma_f32_16x16x32_bf16 v[232:235], a[96:99], a[48:51], v[232:235]
    v_mfma_f32_16x16x32_bf16 v[232:235], a[100:103], a[52:55], v[232:235]
    buffer_load_dwordx4 v1, s[24:27], s79 offen offset:64 lds
    v_mfma_f32_16x16x32_bf16 v[236:239], a[100:103], a[60:63], v[236:239]
    v_mfma_f32_16x16x32_bf16 v[236:239], a[96:99], a[56:59], v[236:239]
    s_waitcnt lgkmcnt(8)
    v_mfma_f32_16x16x32_bf16 v[252:255], a[104:107], a[56:59], v[252:255]
    s_waitcnt vmcnt(13)
    v_fma_f32 v60, v80, v48, v50
    v_fma_f32 v61, v80, v49, v51
    v_mfma_f32_16x16x32_bf16 v[252:255], a[108:111], a[60:63], v[252:255]
    v_fma_f32 v60, -v81, v49, v60
    v_fmac_f32 v61, v81, v48
    v_mfma_f32_16x16x32_bf16 v[248:251], a[108:111], a[52:55], v[248:251]
    s_waitcnt vmcnt(11)
    v_fma_f32 v62, v80, v60, v52
    v_mfma_f32_16x16x32_bf16 v[248:251], a[104:107], a[48:51], v[248:251]
    v_fma_f32 v63, v80, v61, v53
    v_mfma_f32_16x16x32_bf16 v[244:247], a[104:107], a[40:43], v[244:247]
    v_fma_f32 v62, -v81, v61, v62
    v_mfma_f32_16x16x32_bf16 v[244:247], a[108:111], a[44:47], v[244:247]
    v_fmac_f32 v63, v81, v60
    v_mfma_f32_16x16x32_bf16 v[240:243], a[108:111], a[36:39], v[240:243]
    s_waitcnt vmcnt(10)
    v_fma_f32 v60, v80, v62, v54
    v_mfma_f32_16x16x32_bf16 v[240:243], a[104:107], a[32:35], v[240:243]
    s_waitcnt lgkmcnt(4)
    v_fma_f32 v61, v80, v63, v55
    v_mfma_f32_16x16x32_bf16 v[192:195], a[64:67], a[32:35], v[192:195]
    v_fma_f32 v60, -v81, v63, v60
    v_mfma_f32_16x16x32_bf16 v[192:195], a[68:71], a[36:39], v[192:195]
    s_waitcnt lgkmcnt(0)
    s_barrier
    v_mfma_f32_16x16x32_bf16 v[196:199], a[68:71], a[44:47], v[196:199]
    s_lshl_b32 s79, s98, 12
    s_add_u32 s79, s79, s73
    s_addk_i32 m0, 13376
    v_mfma_f32_16x16x32_bf16 v[196:199], a[64:67], a[40:43], v[196:199]
    v_fmac_f32 v61, v81, v62
    v_mul_f32 v62, v74, v60
    v_mfma_f32_16x16x32_bf16 v[200:203], a[64:67], a[48:51], v[200:203]
    buffer_load_dwordx4 v4, s[28:31], s79 offen lds
    v_mfma_f32_16x16x32_bf16 v[200:203], a[68:71], a[52:55], v[200:203]
    s_addk_i32 m0, 960
    v_mul_f32 v63, v74, v61
    v_fma_f32 v62, -v75, v61, v62
    v_mfma_f32_16x16x32_bf16 v[204:207], a[68:71], a[60:63], v[204:207]
    ds_read_b64_tr_b16 a[80:81], v16 offset:0
    ds_read_b64_tr_b16 a[82:83], v16 offset:256
    v_mfma_f32_16x16x32_bf16 v[204:207], a[64:67], a[56:59], v[204:207]
    buffer_load_dwordx4 v4, s[28:31], s79 offen offset:64 lds
    v_mfma_f32_16x16x32_bf16 v[220:223], a[72:75], a[56:59], v[220:223]
    s_addk_i32 m0, 960
    ds_read_b128 a[0:3], v9 offset:49152
    ds_read_b64_tr_b16 a[84:85], v16 offset:8192
    v_mfma_f32_16x16x32_bf16 v[220:223], a[76:79], a[60:63], v[220:223]
    ds_read_b64_tr_b16 a[86:87], v16 offset:8448
    ds_read_b128 a[4:7], v9 offset:50176
    v_mfma_f32_16x16x32_bf16 v[216:219], a[76:79], a[52:55], v[216:219]
    ds_read_b128 a[12:15], v9 offset:52224
    ds_read_b128 a[8:11], v9 offset:51200
    ds_read_b128 a[16:19], v10 offset:16384
    ds_read_b128 a[20:23], v10 offset:17408
    ds_read_b128 a[28:31], v10 offset:19456
    ds_read_b128 a[24:27], v10 offset:18432
    v_fmac_f32 v63, v75, v60
    v_mfma_f32_16x16x32_bf16 v[216:219], a[72:75], a[48:51], v[216:219]
    v_mov_b32 v60, v62
    v_mov_b32 v61, v63
    v_mfma_f32_16x16x32_bf16 v[212:215], a[72:75], a[40:43], v[212:215]
    v_permlane16_swap_b32 v60, v62
    v_permlane16_swap_b32 v61, v63
    v_mfma_f32_16x16x32_bf16 v[212:215], a[76:79], a[44:47], v[212:215]
    buffer_load_dwordx4 v4, s[28:31], s79 offen offset:128 lds
    v_mfma_f32_16x16x32_bf16 v[208:211], a[76:79], a[36:39], v[208:211]
    s_addk_i32 m0, 960
    v_add_f32 v62, v62, v60
    v_add_f32 v63, v63, v61
    v_mfma_f32_16x16x32_bf16 v[208:211], a[72:75], a[32:35], v[208:211]
    s_waitcnt lgkmcnt(0)
    ds_read_b64_tr_b16 a[88:89], v19 offset:0
    v_mov_b32 v60, v62
    v_mfma_f32_16x16x32_bf16 v[96:99], a[80:83], a[0:3], v[96:99]
    ds_read_b64_tr_b16 a[90:91], v19 offset:256
    ds_read_b64_tr_b16 a[92:93], v19 offset:8192
    v_mfma_f32_16x16x32_bf16 v[96:99], a[84:87], a[4:7], v[96:99]
    ds_read_b64_tr_b16 a[94:95], v19 offset:8448
    v_mov_b32 v61, v63
    v_mfma_f32_16x16x32_bf16 v[100:103], a[84:87], a[12:15], v[100:103]
    v_permlane32_swap_b32 v60, v62
    v_permlane32_swap_b32 v61, v63
    v_mfma_f32_16x16x32_bf16 v[100:103], a[80:83], a[8:11], v[100:103]
    buffer_load_dwordx4 v4, s[28:31], s79 offen offset:192 lds
    v_mfma_f32_16x16x32_bf16 v[104:107], a[80:83], a[16:19], v[104:107]
    s_add_u32 s79, s78, s98
    s_addk_i32 m0, 13504
    v_add_f32 v62, v62, v60
    v_mfma_f32_16x16x32_bf16 v[104:107], a[84:87], a[20:23], v[104:107]
    v_add_f32 v63, v63, v61
    v_fma_f32 v60, v82, v62, v24
    v_mfma_f32_16x16x32_bf16 v[108:111], a[84:87], a[28:31], v[108:111]
    buffer_load_dwordx4 v1, s[24:27], s79 offen lds
    v_mfma_f32_16x16x32_bf16 v[108:111], a[80:83], a[24:27], v[108:111]
    s_waitcnt lgkmcnt(0)
    v_fma_f32 v61, v82, v63, v25
    v_fma_f32 v60, -v83, v63, v60
    v_mfma_f32_16x16x32_bf16 v[124:127], a[88:91], a[24:27], v[124:127]
    s_addk_i32 m0, 960
    ds_read_b64_tr_b16 a[96:97], v16 offset:1024
    ds_read_b64_tr_b16 a[98:99], v16 offset:1280
    v_mfma_f32_16x16x32_bf16 v[124:127], a[92:95], a[28:31], v[124:127]
    ds_read_b64_tr_b16 a[100:101], v16 offset:9216
    ds_read_b64_tr_b16 a[102:103], v16 offset:9472
    v_mfma_f32_16x16x32_bf16 v[120:123], a[92:95], a[20:23], v[120:123]
    v_fmac_f32 v61, v83, v62
    v_mul_f32 v62, v84, v60
    v_mfma_f32_16x16x32_bf16 v[120:123], a[88:91], a[16:19], v[120:123]
    v_mul_f32 v63, v84, v61
    v_fma_f32 v62, -v85, v61, v62
    v_mfma_f32_16x16x32_bf16 v[116:119], a[88:91], a[8:11], v[116:119]
    buffer_load_dwordx4 v1, s[24:27], s79 offen offset:64 lds
    v_mfma_f32_16x16x32_bf16 v[116:119], a[92:95], a[12:15], v[116:119]
    s_add_u32 s79, s79, s94
    s_addk_i32 m0, 1088
    v_fmac_f32 v63, v85, v60
    v_mfma_f32_16x16x32_bf16 v[112:115], a[92:95], a[4:7], v[112:115]
    v_fmac_f32 v76, v78, v62
    v_fmac_f32 v144, v78, v63
    v_mfma_f32_16x16x32_bf16 v[112:115], a[88:91], a[0:3], v[112:115]
    s_waitcnt lgkmcnt(0)
    ds_read_b64_tr_b16 a[104:105], v19 offset:1024
    v_fma_f32 v76, -v79, v63, v76
    v_mfma_f32_16x16x32_bf16 v[160:163], a[96:99], a[0:3], v[160:163]
    buffer_load_dwordx4 v1, s[24:27], s79 offen lds
    v_mfma_f32_16x16x32_bf16 v[160:163], a[100:103], a[4:7], v[160:163]
    s_addk_i32 m0, 960
    ds_read_b64_tr_b16 a[106:107], v19 offset:1280
    ds_read_b64_tr_b16 a[108:109], v19 offset:9216
    v_mfma_f32_16x16x32_bf16 v[164:167], a[100:103], a[12:15], v[164:167]
    ds_read_b64_tr_b16 a[110:111], v19 offset:9472
    v_fmac_f32 v144, v79, v62
    v_mfma_f32_16x16x32_bf16 v[164:167], a[96:99], a[8:11], v[164:167]
    v_fmac_f32 v128, v78, v76
    v_fmac_f32 v145, v78, v144
    v_mfma_f32_16x16x32_bf16 v[168:171], a[96:99], a[16:19], v[168:171]
    v_fma_f32 v128, -v79, v144, v128
    v_fmac_f32 v145, v79, v76
    v_mfma_f32_16x16x32_bf16 v[168:171], a[100:103], a[20:23], v[168:171]
    buffer_load_dwordx4 v1, s[24:27], s79 offen offset:64 lds
    v_mfma_f32_16x16x32_bf16 v[172:175], a[100:103], a[28:31], v[172:175]
    s_addk_i32 s98, 128
    s_and_b32 s98, s98, 1023
    v_cvt_pk_bf16_f32 v32, v76, v128
    v_mfma_f32_16x16x32_bf16 v[172:175], a[96:99], a[24:27], v[172:175]
    s_waitcnt lgkmcnt(0)
    s_add_u32 s79, s77, s98
    s_addk_i32 m0, 13376
    v_mfma_f32_16x16x32_bf16 v[188:191], a[104:107], a[24:27], v[188:191]
    v_cvt_pk_bf16_f32 v40, -v144, -v145
    v_fmac_f32 v129, v78, v128
    v_mfma_f32_16x16x32_bf16 v[188:191], a[108:111], a[28:31], v[188:191]
    ds_read_b64_tr_b16 a[64:65], v16 offset:2048
    ds_read_b64_tr_b16 a[66:67], v16 offset:2304
    v_mfma_f32_16x16x32_bf16 v[184:187], a[108:111], a[20:23], v[184:187]
    ds_read_b64_tr_b16 a[68:69], v16 offset:10240
    ds_read_b64_tr_b16 a[70:71], v16 offset:10496
    v_fmac_f32 v146, v78, v145
    v_mfma_f32_16x16x32_bf16 v[184:187], a[104:107], a[16:19], v[184:187]
    buffer_load_dwordx4 v1, s[24:27], s79 offen lds
    v_fma_f32 v129, -v79, v145, v129
    v_mfma_f32_16x16x32_bf16 v[180:183], a[104:107], a[8:11], v[180:183]
    s_addk_i32 m0, 960
    v_fmac_f32 v146, v79, v128
    v_fmac_f32 v130, v78, v129
    v_mfma_f32_16x16x32_bf16 v[180:183], a[108:111], a[12:15], v[180:183]
PG_6:
    s_cbranch_execz PG_10
    v_fmac_f32 v147, v78, v146
    v_fma_f32 v130, -v79, v146, v130
    v_mfma_f32_16x16x32_bf16 v[176:179], a[108:111], a[4:7], v[176:179]
    buffer_load_dwordx4 v1, s[24:27], s79 offen offset:64 lds
    v_mfma_f32_16x16x32_bf16 v[176:179], a[104:107], a[0:3], v[176:179]
    s_waitcnt lgkmcnt(0)
    v_fmac_f32 v147, v79, v129
    v_cvt_pk_bf16_f32 v33, v129, v130
    v_mfma_f32_16x16x32_bf16 v[224:227], a[64:67], a[0:3], v[224:227]
    s_add_u32 s79, s79, s94
    ds_read_b64_tr_b16 a[72:73], v19 offset:2048
    ds_read_b64_tr_b16 a[74:75], v19 offset:2304
    v_mfma_f32_16x16x32_bf16 v[224:227], a[68:71], a[4:7], v[224:227]
    s_addk_i32 m0, 1088
    ds_read_b64_tr_b16 a[76:77], v19 offset:10240
    ds_read_b64_tr_b16 a[78:79], v19 offset:10496
    v_mfma_f32_16x16x32_bf16 v[228:231], a[68:71], a[12:15], v[228:231]
    v_cvt_pk_bf16_f32 v41, -v146, -v147
    v_fmac_f32 v131, v78, v130
    v_mfma_f32_16x16x32_bf16 v[228:231], a[64:67], a[8:11], v[228:231]
    v_fmac_f32 v148, v78, v147
    v_fma_f32 v131, -v79, v147, v131
    v_mfma_f32_16x16x32_bf16 v[232:235], a[64:67], a[16:19], v[232:235]
    buffer_load_dwordx4 v1, s[24:27], s79 offen lds
    v_mfma_f32_16x16x32_bf16 v[232:235], a[68:71], a[20:23], v[232:235]
    s_addk_i32 m0, 960
    v_fmac_f32 v148, v79, v130
    v_fmac_f32 v132, v78, v131
    v_mfma_f32_16x16x32_bf16 v[236:239], a[68:71], a[28:31], v[236:239]
    v_fmac_f32 v149, v78, v148
    v_fma_f32 v132, -v79, v148, v132
    v_mfma_f32_16x16x32_bf16 v[236:239], a[64:67], a[24:27], v[236:239]
    s_waitcnt lgkmcnt(0)
    ds_read_b64_tr_b16 a[80:81], v16 offset:3072
    ds_read_b64_tr_b16 a[82:83], v16 offset:3328
    v_mfma_f32_16x16x32_bf16 v[252:255], a[72:75], a[24:27], v[252:255]
    buffer_load_dwordx4 v1, s[24:27], s79 offen offset:64 lds
    v_mfma_f32_16x16x32_bf16 v[252:255], a[76:79], a[28:31], v[252:255]
    ds_read_b64_tr_b16 a[84:85], v16 offset:11264
    ds_read_b64_tr_b16 a[86:87], v16 offset:11520
    v_mfma_f32_16x16x32_bf16 v[248:251], a[76:79], a[20:23], v[248:251]
    v_fmac_f32 v149, v79, v131
    v_cvt_pk_bf16_f32 v34, v131, v132
    v_mfma_f32_16x16x32_bf16 v[248:251], a[72:75], a[16:19], v[248:251]
    ds_read_b64_tr_b16 a[88:89], v19 offset:3072
    ds_read_b64_tr_b16 a[90:91], v19 offset:3328
    v_mfma_f32_16x16x32_bf16 v[244:247], a[72:75], a[8:11], v[244:247]
    ds_read_b64_tr_b16 a[92:93], v19 offset:11264
    ds_read_b64_tr_b16 a[94:95], v19 offset:11520
    v_cvt_pk_bf16_f32 v42, -v148, -v149
    v_mfma_f32_16x16x32_bf16 v[244:247], a[76:79], a[12:15], v[244:247]
    v_fmac_f32 v133, v78, v132
    v_fmac_f32 v150, v78, v149
    v_mfma_f32_16x16x32_bf16 v[240:243], a[76:79], a[4:7], v[240:243]
    v_fma_f32 v133, -v79, v149, v133
    v_fmac_f32 v150, v79, v132
    v_mfma_f32_16x16x32_bf16 v[240:243], a[72:75], a[0:3], v[240:243]
    s_waitcnt lgkmcnt(4)
    v_fmac_f32 v134, v78, v133
    v_fmac_f32 v151, v78, v150
    v_mfma_f32_16x16x32_bf16 v[192:195], a[80:83], a[0:3], v[192:195]
    v_fma_f32 v134, -v79, v150, v134
    v_fmac_f32 v151, v79, v133
    v_mfma_f32_16x16x32_bf16 v[192:195], a[84:87], a[4:7], v[192:195]
    s_waitcnt vmcnt(16) lgkmcnt(0)
    s_barrier
    v_mfma_f32_16x16x32_bf16 v[196:199], a[84:87], a[12:15], v[196:199]
    s_lshl_b32 s79, s98, 12
    s_add_u32 s79, s79, s73
    s_addk_i32 m0, 13376
    v_mfma_f32_16x16x32_bf16 v[196:199], a[80:83], a[8:11], v[196:199]
    v_cvt_pk_bf16_f32 v35, v133, v134
    v_cvt_pk_bf16_f32 v43, -v150, -v151
    v_mfma_f32_16x16x32_bf16 v[200:203], a[80:83], a[16:19], v[200:203]
    buffer_load_dwordx4 v4, s[28:31], s79 offen lds
    v_mfma_f32_16x16x32_bf16 v[200:203], a[84:87], a[20:23], v[200:203]
    s_addk_i32 m0, 960
    v_fmac_f32 v135, v78, v134
    v_fmac_f32 v152, v78, v151
    v_mfma_f32_16x16x32_bf16 v[204:207], a[84:87], a[28:31], v[204:207]
    ds_read_b64_tr_b16 a[96:97], v14 offset:16384
    v_fma_f32 v135, -v79, v151, v135
    v_mfma_f32_16x16x32_bf16 v[204:207], a[80:83], a[24:27], v[204:207]
    ds_read_b64_tr_b16 a[98:99], v14 offset:16640
    ds_read_b128 a[32:35], v8 offset:0
    v_mfma_f32_16x16x32_bf16 v[220:223], a[88:91], a[24:27], v[220:223]
    ds_read_b64_tr_b16 a[100:101], v14 offset:24576
    ds_read_b64_tr_b16 a[102:103], v14 offset:24832
    v_mfma_f32_16x16x32_bf16 v[220:223], a[92:95], a[28:31], v[220:223]
    ds_read_b128 a[36:39], v8 offset:1024
    ds_read_b128 a[44:47], v8 offset:3072
    v_mfma_f32_16x16x32_bf16 v[216:219], a[92:95], a[20:23], v[216:219]
    ds_read_b128 a[40:43], v8 offset:2048
    ds_read_b128 a[48:51], v8 offset:32768
    ds_read_b128 a[52:55], v8 offset:33792
    ds_read_b128 a[60:63], v8 offset:35840
    ds_read_b128 a[56:59], v8 offset:34816
    v_fmac_f32 v152, v79, v134
    v_mfma_f32_16x16x32_bf16 v[216:219], a[88:91], a[16:19], v[216:219]
    v_fmac_f32 v136, v78, v135
    v_fmac_f32 v153, v78, v152
    v_mfma_f32_16x16x32_bf16 v[212:215], a[88:91], a[8:11], v[212:215]
    buffer_load_dwordx4 v4, s[28:31], s79 offen offset:64 lds
    v_mfma_f32_16x16x32_bf16 v[212:215], a[92:95], a[12:15], v[212:215]
    s_addk_i32 m0, 960
    v_fma_f32 v136, -v79, v152, v136
    v_fmac_f32 v153, v79, v135
    v_mfma_f32_16x16x32_bf16 v[208:211], a[92:95], a[4:7], v[208:211]
    v_cvt_pk_bf16_f32 v36, v135, v136
    v_cvt_pk_bf16_f32 v44, -v152, -v153
    v_mfma_f32_16x16x32_bf16 v[208:211], a[88:91], a[0:3], v[208:211]
    s_waitcnt lgkmcnt(0)
    ds_read_b64_tr_b16 a[104:105], v17 offset:16384
    v_fmac_f32 v137, v78, v136
    v_mfma_f32_16x16x32_bf16 v[96:99], a[96:99], a[32:35], v[96:99]
    ds_read_b64_tr_b16 a[106:107], v17 offset:16640
    ds_read_b64_tr_b16 a[108:109], v17 offset:24576
    v_mfma_f32_16x16x32_bf16 v[96:99], a[100:103], a[36:39], v[96:99]
    ds_read_b64_tr_b16 a[110:111], v17 offset:24832
    v_fmac_f32 v154, v78, v153
    v_mfma_f32_16x16x32_bf16 v[100:103], a[100:103], a[44:47], v[100:103]
    v_fma_f32 v137, -v79, v153, v137
    v_fmac_f32 v154, v79, v136
    v_mfma_f32_16x16x32_bf16 v[100:103], a[96:99], a[40:43], v[100:103]
    buffer_load_dwordx4 v4, s[28:31], s79 offen offset:128 lds
    v_mfma_f32_16x16x32_bf16 v[104:107], a[96:99], a[48:51], v[104:107]
    s_addk_i32 m0, 960
    v_fmac_f32 v138, v78, v137
    v_fmac_f32 v155, v78, v154
    v_mfma_f32_16x16x32_bf16 v[104:107], a[100:103], a[52:55], v[104:107]
    v_fma_f32 v138, -v79, v154, v138
    v_fmac_f32 v155, v79, v137
    v_mfma_f32_16x16x32_bf16 v[108:111], a[100:103], a[60:63], v[108:111]
    ds_read_b64_tr_b16 a[64:65], v14 offset:17408
    v_cvt_pk_bf16_f32 v37, v137, v138
    v_mfma_f32_16x16x32_bf16 v[108:111], a[96:99], a[56:59], v[108:111]
    s_waitcnt lgkmcnt(1)
    ds_read_b64_tr_b16 a[66:67], v14 offset:17664
    ds_read_b64_tr_b16 a[68:69], v14 offset:25600
    v_mfma_f32_16x16x32_bf16 v[124:127], a[104:107], a[56:59], v[124:127]
    ds_read_b64_tr_b16 a[70:71], v14 offset:25856
    v_cvt_pk_bf16_f32 v45, -v154, -v155
    v_mfma_f32_16x16x32_bf16 v[124:127], a[108:111], a[60:63], v[124:127]
    buffer_load_dwordx4 v4, s[28:31], s79 offen offset:192 lds
    v_mfma_f32_16x16x32_bf16 v[120:123], a[108:111], a[52:55], v[120:123]
    s_add_u32 s79, s78, s98
    v_fmac_f32 v139, v78, v138
    v_fmac_f32 v156, v78, v155
    v_mfma_f32_16x16x32_bf16 v[120:123], a[104:107], a[48:51], v[120:123]
    s_addk_i32 m0, 13504
    v_fma_f32 v139, -v79, v155, v139
    v_fmac_f32 v156, v79, v138
    v_mfma_f32_16x16x32_bf16 v[116:119], a[104:107], a[40:43], v[116:119]
    v_fmac_f32 v140, v78, v139
    v_fmac_f32 v157, v78, v156
    v_mfma_f32_16x16x32_bf16 v[116:119], a[108:111], a[44:47], v[116:119]
    ds_read_b64_tr_b16 a[72:73], v17 offset:17408
    v_fma_f32 v140, -v79, v156, v140
    v_mfma_f32_16x16x32_bf16 v[112:115], a[108:111], a[36:39], v[112:115]
    buffer_load_dwordx4 v1, s[24:27], s79 offen lds
    v_mfma_f32_16x16x32_bf16 v[112:115], a[104:107], a[32:35], v[112:115]
    s_waitcnt lgkmcnt(1)
    ds_read_b64_tr_b16 a[74:75], v17 offset:17664
    ds_read_b64_tr_b16 a[76:77], v17 offset:25600
    v_mfma_f32_16x16x32_bf16 v[160:163], a[64:67], a[32:35], v[160:163]
    ds_read_b64_tr_b16 a[78:79], v17 offset:25856
    v_fmac_f32 v157, v79, v139
    v_mfma_f32_16x16x32_bf16 v[160:163], a[68:71], a[36:39], v[160:163]
    s_addk_i32 m0, 960
    v_cvt_pk_bf16_f32 v38, v139, v140
    v_cvt_pk_bf16_f32 v46, -v156, -v157
    v_mfma_f32_16x16x32_bf16 v[164:167], a[68:71], a[44:47], v[164:167]
    v_fmac_f32 v141, v78, v140
    v_fmac_f32 v158, v78, v157
    v_mfma_f32_16x16x32_bf16 v[164:167], a[64:67], a[40:43], v[164:167]
    v_fma_f32 v141, -v79, v157, v141
    v_fmac_f32 v158, v79, v140
    v_mfma_f32_16x16x32_bf16 v[168:171], a[64:67], a[48:51], v[168:171]
    ds_read_b64_tr_b16 a[80:81], v14 offset:18432
    v_fmac_f32 v142, v78, v141
    v_mfma_f32_16x16x32_bf16 v[168:171], a[68:71], a[52:55], v[168:171]
    buffer_load_dwordx4 v1, s[24:27], s79 offen offset:64 lds
    v_mfma_f32_16x16x32_bf16 v[172:175], a[68:71], a[60:63], v[172:175]
    ds_read_b64_tr_b16 a[82:83], v14 offset:18688
    ds_read_b64_tr_b16 a[84:85], v14 offset:26624
    v_mfma_f32_16x16x32_bf16 v[172:175], a[64:67], a[56:59], v[172:175]
    s_waitcnt lgkmcnt(3)
    ds_read_b64_tr_b16 a[86:87], v14 offset:26880
    v_fmac_f32 v159, v78, v158
    v_mfma_f32_16x16x32_bf16 v[188:191], a[72:75], a[56:59], v[188:191]
    s_add_u32 s79, s79, s94
    v_fma_f32 v142, -v79, v158, v142
    v_fmac_f32 v159, v79, v141
    v_mfma_f32_16x16x32_bf16 v[188:191], a[76:79], a[60:63], v[188:191]
    s_addk_i32 m0, 1088
    v_cvt_pk_bf16_f32 v39, v141, v142
    v_cvt_pk_bf16_f32 v47, -v158, -v159
    v_mfma_f32_16x16x32_bf16 v[184:187], a[76:79], a[52:55], v[184:187]
    ds_read_b64_tr_b16 a[88:89], v17 offset:18432
    v_mov_b32 v24, v88
    v_mfma_f32_16x16x32_bf16 v[184:187], a[72:75], a[48:51], v[184:187]
    ds_read_b64_tr_b16 a[90:91], v17 offset:18688
    v_mov_b32 v25, 1
    v_mfma_f32_16x16x32_bf16 v[180:183], a[72:75], a[40:43], v[180:183]
    buffer_load_dwordx4 v1, s[24:27], s79 offen lds
    v_mfma_f32_16x16x32_bf16 v[180:183], a[76:79], a[44:47], v[180:183]
    ds_read_b64_tr_b16 a[92:93], v17 offset:26624
    ds_read_b64_tr_b16 a[94:95], v17 offset:26880
    v_mfma_f32_16x16x32_bf16 v[176:179], a[76:79], a[36:39], v[176:179]
    s_lshl_b32 s68, s65, 18
    s_lshr_b32 s69, s62, 1
    ds_read_b64_tr_b16 a[96:97], v14 offset:19456
    v_mfma_f32_16x16x32_bf16 v[176:179], a[72:75], a[32:35], v[176:179]
    s_waitcnt lgkmcnt(5)
    s_addk_i32 m0, 960
    ds_read_b64_tr_b16 a[98:99], v14 offset:19712
    v_mfma_f32_16x16x32_bf16 v[224:227], a[80:83], a[32:35], v[224:227]
    ds_read_b64_tr_b16 a[100:101], v14 offset:27648
    ds_read_b64_tr_b16 a[102:103], v14 offset:27904
    v_mfma_f32_16x16x32_bf16 v[224:227], a[84:87], a[36:39], v[224:227]
    s_lshl_b32 s69, s69, 17
    ds_read_b64_tr_b16 a[104:105], v17 offset:19456
    ds_read_b64_tr_b16 a[106:107], v17 offset:19712
    v_mfma_f32_16x16x32_bf16 v[228:231], a[84:87], a[44:47], v[228:231]
    ds_read_b64_tr_b16 a[108:109], v17 offset:27648
    ds_read_b64_tr_b16 a[110:111], v17 offset:27904
    v_mfma_f32_16x16x32_bf16 v[228:231], a[80:83], a[40:43], v[228:231]
    buffer_load_dwordx4 v1, s[24:27], s79 offen offset:64 lds
    v_mfma_f32_16x16x32_bf16 v[232:235], a[80:83], a[48:51], v[232:235]
    s_add_u32 s68, s68, s69
    v_mfma_f32_16x16x32_bf16 v[232:235], a[84:87], a[52:55], v[232:235]
    v_mfma_f32_16x16x32_bf16 v[236:239], a[84:87], a[60:63], v[236:239]
    s_lshl_b32 s69, s66, 13
    v_mfma_f32_16x16x32_bf16 v[236:239], a[80:83], a[56:59], v[236:239]
    s_waitcnt lgkmcnt(8)
    v_mfma_f32_16x16x32_bf16 v[252:255], a[88:91], a[56:59], v[252:255]
    v_mfma_f32_16x16x32_bf16 v[252:255], a[92:95], a[60:63], v[252:255]
    s_add_u32 s68, s68, s69
    v_mfma_f32_16x16x32_bf16 v[248:251], a[92:95], a[52:55], v[248:251]
    v_mfma_f32_16x16x32_bf16 v[248:251], a[88:91], a[48:51], v[248:251]
    s_and_b32 s69, s62, 1
    v_mfma_f32_16x16x32_bf16 v[244:247], a[88:91], a[40:43], v[244:247]
    v_mfma_f32_16x16x32_bf16 v[244:247], a[92:95], a[44:47], v[244:247]
    v_mfma_f32_16x16x32_bf16 v[240:243], a[92:95], a[36:39], v[240:243]
    s_lshl_b32 s69, s69, 11
    v_mfma_f32_16x16x32_bf16 v[240:243], a[88:91], a[32:35], v[240:243]
    s_waitcnt lgkmcnt(4)
    v_mfma_f32_16x16x32_bf16 v[192:195], a[96:99], a[32:35], v[192:195]
    v_mfma_f32_16x16x32_bf16 v[192:195], a[100:103], a[36:39], v[192:195]
    s_add_u32 s68, s68, s69
    s_waitcnt vmcnt(12) lgkmcnt(0)
    s_barrier
    v_mfma_f32_16x16x32_bf16 v[196:199], a[100:103], a[44:47], v[196:199]
    ds_read_b64_tr_b16 a[64:65], v15 offset:0
    ds_read_b64_tr_b16 a[66:67], v15 offset:256
    v_mfma_f32_16x16x32_bf16 v[196:199], a[96:99], a[40:43], v[196:199]
    s_add_u32 s68, s68, 52428800
    ds_read_b128 a[0:3], v8 offset:49152
    ds_read_b64_tr_b16 a[68:69], v15 offset:8192
    v_mfma_f32_16x16x32_bf16 v[200:203], a[96:99], a[48:51], v[200:203]
    ds_read_b64_tr_b16 a[70:71], v15 offset:8448
    ds_read_b128 a[4:7], v8 offset:50176
    v_mfma_f32_16x16x32_bf16 v[200:203], a[100:103], a[52:55], v[200:203]
    ds_read_b128 a[12:15], v8 offset:52224
    ds_read_b128 a[8:11], v8 offset:51200
    v_mfma_f32_16x16x32_bf16 v[204:207], a[100:103], a[60:63], v[204:207]
    ds_read_b128 a[16:19], v9 offset:16384
    ds_read_b128 a[20:23], v9 offset:17408
    v_mfma_f32_16x16x32_bf16 v[204:207], a[96:99], a[56:59], v[204:207]
    ds_read_b128 a[28:31], v9 offset:19456
    ds_read_b128 a[24:27], v9 offset:18432
    v_mfma_f32_16x16x32_bf16 v[220:223], a[104:107], a[56:59], v[220:223]
    buffer_store_dwordx4 v[32:35], v22, s[40:43], s68 offen offset:0 sc1
    v_mfma_f32_16x16x32_bf16 v[220:223], a[108:111], a[60:63], v[220:223]
    ds_read_b64_tr_b16 a[72:73], v18 offset:0
    ds_read_b64_tr_b16 a[74:75], v18 offset:256
    v_mfma_f32_16x16x32_bf16 v[216:219], a[108:111], a[52:55], v[216:219]
    ds_read_b64_tr_b16 a[76:77], v18 offset:8192
    ds_read_b64_tr_b16 a[78:79], v18 offset:8448
    v_mfma_f32_16x16x32_bf16 v[216:219], a[104:107], a[48:51], v[216:219]
    buffer_store_dwordx4 v[36:39], v22, s[40:43], s68 offen offset:1024 sc1
    v_mfma_f32_16x16x32_bf16 v[212:215], a[104:107], a[40:43], v[212:215]
    ds_read_b64_tr_b16 a[80:81], v15 offset:1024
    ds_read_b64_tr_b16 a[82:83], v15 offset:1280
    v_mfma_f32_16x16x32_bf16 v[212:215], a[108:111], a[44:47], v[212:215]
    ds_read_b64_tr_b16 a[84:85], v15 offset:9216
    ds_read_b64_tr_b16 a[86:87], v15 offset:9472
    v_mfma_f32_16x16x32_bf16 v[208:211], a[108:111], a[36:39], v[208:211]
    ds_read_b64_tr_b16 a[88:89], v18 offset:1024
    ds_read_b64_tr_b16 a[90:91], v18 offset:1280
    v_mfma_f32_16x16x32_bf16 v[208:211], a[104:107], a[32:35], v[208:211]
    s_waitcnt lgkmcnt(10)
    ds_read_b64_tr_b16 a[92:93], v18 offset:9216
    ds_read_b64_tr_b16 a[94:95], v18 offset:9472
    v_mfma_f32_16x16x32_bf16 v[96:99], a[64:67], a[0:3], v[96:99]
    s_addk_i32 s68, 4096
    ds_read_b64_tr_b16 a[96:97], v15 offset:2048
    ds_read_b64_tr_b16 a[98:99], v15 offset:2304
    v_mfma_f32_16x16x32_bf16 v[96:99], a[68:71], a[4:7], v[96:99]
    ds_read_b64_tr_b16 a[100:101], v15 offset:10240
    ds_read_b64_tr_b16 a[102:103], v15 offset:10496
    v_mfma_f32_16x16x32_bf16 v[100:103], a[68:71], a[12:15], v[100:103]
    ds_read_b64_tr_b16 a[104:105], v18 offset:2048
    ds_read_b64_tr_b16 a[106:107], v18 offset:2304
    v_mfma_f32_16x16x32_bf16 v[100:103], a[64:67], a[8:11], v[100:103]
    buffer_store_dwordx4 v[40:43], v22, s[40:43], s68 offen offset:0 sc1
    v_mfma_f32_16x16x32_bf16 v[104:107], a[64:67], a[16:19], v[104:107]
    ds_read_b64_tr_b16 a[108:109], v18 offset:10240
    ds_read_b64_tr_b16 a[110:111], v18 offset:10496
    v_mfma_f32_16x16x32_bf16 v[104:107], a[68:71], a[20:23], v[104:107]
    v_mfma_f32_16x16x32_bf16 v[108:111], a[68:71], a[28:31], v[108:111]
    v_and_b32 v90, 7, v0
    v_lshlrev_b32 v90, 2, v90
    v_mfma_f32_16x16x32_bf16 v[108:111], a[64:67], a[24:27], v[108:111]
    s_waitcnt lgkmcnt(15)
    s_lshl_b32 s61, s63, 7
    ds_read_b64_tr_b16 a[64:65], v15 offset:3072
    v_mfma_f32_16x16x32_bf16 v[124:127], a[72:75], a[24:27], v[124:127]
    buffer_store_dwordx4 v[44:47], v22, s[40:43], s68 offen offset:1024 sc1
    v_mfma_f32_16x16x32_bf16 v[124:127], a[76:79], a[28:31], v[124:127]
    buffer_load_dword v91, v90, s[48:51], s61 offen sc1
    v_mfma_f32_16x16x32_bf16 v[120:123], a[76:79], a[20:23], v[120:123]
    ds_read_b64_tr_b16 a[66:67], v15 offset:3328
    ds_read_b64_tr_b16 a[68:69], v15 offset:11264
    v_mfma_f32_16x16x32_bf16 v[120:123], a[72:75], a[16:19], v[120:123]
    ds_read_b64_tr_b16 a[70:71], v15 offset:11520
    v_mfma_f32_16x16x32_bf16 v[116:119], a[72:75], a[8:11], v[116:119]
    v_mfma_f32_16x16x32_bf16 v[116:119], a[76:79], a[12:15], v[116:119]
    v_mfma_f32_16x16x32_bf16 v[112:115], a[76:79], a[4:7], v[112:115]
    v_mfma_f32_16x16x32_bf16 v[112:115], a[72:75], a[0:3], v[112:115]
    s_waitcnt lgkmcnt(15)
    ds_read_b64_tr_b16 a[72:73], v18 offset:3072
    ds_read_b64_tr_b16 a[74:75], v18 offset:3328
    v_mfma_f32_16x16x32_bf16 v[160:163], a[80:83], a[0:3], v[160:163]
    v_and_b32 v30, 3, v0
    s_mov_b32 s70, 0x3f803f80
    v_mfma_f32_16x16x32_bf16 v[160:163], a[84:87], a[4:7], v[160:163]
    ds_read_b64_tr_b16 a[76:77], v18 offset:11264
    ds_read_b64_tr_b16 a[78:79], v18 offset:11520
    v_mfma_f32_16x16x32_bf16 v[164:167], a[84:87], a[12:15], v[164:167]
    v_xor_b32 v31, 0, v30
    v_mfma_f32_16x16x32_bf16 v[164:167], a[80:83], a[8:11], v[164:167]
    v_mfma_f32_16x16x32_bf16 v[168:171], a[80:83], a[16:19], v[168:171]
    v_min_u32 v31, 1, v31
    v_mfma_f32_16x16x32_bf16 v[168:171], a[84:87], a[20:23], v[168:171]
    v_mfma_f32_16x16x32_bf16 v[172:175], a[84:87], a[28:31], v[172:175]
    v_xor_b32 v31, 1, v31
    v_mfma_f32_16x16x32_bf16 v[172:175], a[80:83], a[24:27], v[172:175]
    s_waitcnt lgkmcnt(15)
    v_mfma_f32_16x16x32_bf16 v[188:191], a[88:91], a[24:27], v[188:191]
    v_mul_lo_u32 v31, s70, v31
    v_mfma_f32_16x16x32_bf16 v[188:191], a[92:95], a[28:31], v[188:191]
    v_mfma_f32_16x16x32_bf16 v[184:187], a[92:95], a[20:23], v[184:187]
    v_mfma_f32_16x16x32_bf16 v[184:187], a[88:91], a[16:19], v[184:187]
    v_accvgpr_write_b32 a240, v31
    v_mfma_f32_16x16x32_bf16 v[180:183], a[88:91], a[8:11], v[180:183]
    v_mfma_f32_16x16x32_bf16 v[180:183], a[92:95], a[12:15], v[180:183]
    v_accvgpr_write_b32 a241, v31
    v_mfma_f32_16x16x32_bf16 v[176:179], a[92:95], a[4:7], v[176:179]
    v_mfma_f32_16x16x32_bf16 v[176:179], a[88:91], a[0:3], v[176:179]
    s_waitcnt lgkmcnt(12)
    v_accvgpr_write_b32 a242, v31
    v_mfma_f32_16x16x32_bf16 v[224:227], a[96:99], a[0:3], v[224:227]
    v_mfma_f32_16x16x32_bf16 v[224:227], a[100:103], a[4:7], v[224:227]
    v_accvgpr_write_b32 a243, v31
    v_mfma_f32_16x16x32_bf16 v[228:231], a[100:103], a[12:15], v[228:231]
    v_mfma_f32_16x16x32_bf16 v[228:231], a[96:99], a[8:11], v[228:231]
    v_xor_b32 v31, 1, v30
    v_mfma_f32_16x16x32_bf16 v[232:235], a[96:99], a[16:19], v[232:235]
    v_mfma_f32_16x16x32_bf16 v[232:235], a[100:103], a[20:23], v[232:235]
    v_min_u32 v31, 1, v31
    v_mfma_f32_16x16x32_bf16 v[236:239], a[100:103], a[28:31], v[236:239]
    v_mfma_f32_16x16x32_bf16 v[236:239], a[96:99], a[24:27], v[236:239]
    s_waitcnt lgkmcnt(8)
    v_mfma_f32_16x16x32_bf16 v[252:255], a[104:107], a[24:27], v[252:255]
    v_xor_b32 v31, 1, v31
    v_mfma_f32_16x16x32_bf16 v[252:255], a[108:111], a[28:31], v[252:255]
    v_mfma_f32_16x16x32_bf16 v[248:251], a[108:111], a[20:23], v[248:251]
    v_mul_lo_u32 v31, s70, v31
    v_mfma_f32_16x16x32_bf16 v[248:251], a[104:107], a[16:19], v[248:251]
    v_mfma_f32_16x16x32_bf16 v[244:247], a[104:107], a[8:11], v[244:247]
    v_accvgpr_write_b32 a244, v31
    v_mfma_f32_16x16x32_bf16 v[244:247], a[108:111], a[12:15], v[244:247]
    v_mfma_f32_16x16x32_bf16 v[240:243], a[108:111], a[4:7], v[240:243]
    v_accvgpr_write_b32 a245, v31
    v_mfma_f32_16x16x32_bf16 v[240:243], a[104:107], a[0:3], v[240:243]
    s_waitcnt lgkmcnt(4)
    v_mfma_f32_16x16x32_bf16 v[192:195], a[64:67], a[0:3], v[192:195]
    v_accvgpr_write_b32 a246, v31
    v_mfma_f32_16x16x32_bf16 v[192:195], a[68:71], a[4:7], v[192:195]
POLL_KV:
    s_waitcnt vmcnt(0)
    v_cmp_ne_u32 vcc, s83, v91
    s_nop 0
    s_cbranch_vccnz SPIN_KV
POLLOK_KV:
    s_waitcnt lgkmcnt(0)
    s_barrier
    s_lshl_b32 s72, s62, 13
    v_add_u32 v4, s72, v22
    v_mfma_f32_16x16x32_bf16 v[196:199], a[68:71], a[12:15], v[196:199]
    s_bitcmp1_b32 s62, 0
    s_cselect_b32 s79, 2097152, 0
    s_add_u32 m0, s72, 0
    v_mfma_f32_16x16x32_bf16 v[196:199], a[64:67], a[8:11], v[196:199]
    ds_read_b64_tr_b16 a[80:81], v15 offset:49152
    v_accvgpr_write_b32 a247, v31
    v_mfma_f32_16x16x32_bf16 v[200:203], a[64:67], a[16:19], v[200:203]
    buffer_load_dwordx4 v4, s[44:47], s79 offen offset:0 sc1 lds
    v_mfma_f32_16x16x32_bf16 v[200:203], a[68:71], a[20:23], v[200:203]
    ds_read_b64_tr_b16 a[82:83], v15 offset:49408
    ds_read_b128 a[32:35], v9 offset:32768
    v_mfma_f32_16x16x32_bf16 v[204:207], a[68:71], a[28:31], v[204:207]
    buffer_load_dwordx4 v4, s[44:47], s79 offen offset:1024 sc1 lds
    v_mfma_f32_16x16x32_bf16 v[204:207], a[64:67], a[24:27], v[204:207]
    ds_read_b64_tr_b16 a[84:85], v15 offset:57344
    ds_read_b64_tr_b16 a[86:87], v15 offset:57600
    v_mfma_f32_16x16x32_bf16 v[220:223], a[72:75], a[24:27], v[220:223]
    ds_read_b128 a[36:39], v9 offset:33792
    ds_read_b128 a[44:47], v9 offset:35840
    v_mfma_f32_16x16x32_bf16 v[220:223], a[76:79], a[28:31], v[220:223]
    ds_read_b128 a[40:43], v9 offset:34816
    ds_read_b128 a[48:51], v10 offset:0
    v_mfma_f32_16x16x32_bf16 v[216:219], a[76:79], a[20:23], v[216:219]
    ds_read_b128 a[52:55], v10 offset:1024
    ds_read_b128 a[60:63], v10 offset:3072
    ds_read_b128 a[56:59], v10 offset:2048
    v_xor_b32 v31, 2, v30
    v_mfma_f32_16x16x32_bf16 v[216:219], a[72:75], a[16:19], v[216:219]
    v_min_u32 v31, 1, v31
    v_xor_b32 v31, 1, v31
    v_mfma_f32_16x16x32_bf16 v[212:215], a[72:75], a[8:11], v[212:215]
    buffer_load_dwordx4 v4, s[44:47], s79 offen offset:2048 sc1 lds
    v_mfma_f32_16x16x32_bf16 v[212:215], a[76:79], a[12:15], v[212:215]
    ds_read_b64_tr_b16 a[88:89], v18 offset:49152
    v_mul_lo_u32 v31, s70, v31
    v_mfma_f32_16x16x32_bf16 v[208:211], a[76:79], a[4:7], v[208:211]
    buffer_load_dwordx4 v4, s[44:47], s79 offen offset:3072 sc1 lds
    v_mfma_f32_16x16x32_bf16 v[208:211], a[72:75], a[0:3], v[208:211]
    s_waitcnt lgkmcnt(1)
    ds_read_b64_tr_b16 a[90:91], v18 offset:49408
    ds_read_b64_tr_b16 a[92:93], v18 offset:57344
    v_mfma_f32_16x16x32_bf16 v[96:99], a[80:83], a[32:35], v[96:99]
    s_addk_i32 s79, 4096
    ds_read_b64_tr_b16 a[94:95], v18 offset:57600
    v_accvgpr_write_b32 a248, v31
    v_mfma_f32_16x16x32_bf16 v[96:99], a[84:87], a[36:39], v[96:99]
    s_addk_i32 m0, 4096
    ds_read_b64_tr_b16 a[96:97], v15 offset:50176
    v_accvgpr_write_b32 a249, v31
    v_mfma_f32_16x16x32_bf16 v[100:103], a[84:87], a[44:47], v[100:103]
    ds_read_b64_tr_b16 a[98:99], v15 offset:50432
    v_accvgpr_write_b32 a250, v31
    v_mfma_f32_16x16x32_bf16 v[100:103], a[80:83], a[40:43], v[100:103]
    buffer_load_dwordx4 v4, s[44:47], s79 offen offset:0 sc1 lds
    v_mfma_f32_16x16x32_bf16 v[104:107], a[80:83], a[48:51], v[104:107]
    ds_read_b64_tr_b16 a[100:101], v15 offset:58368
    v_accvgpr_write_b32 a251, v31
    v_mfma_f32_16x16x32_bf16 v[104:107], a[84:87], a[52:55], v[104:107]
    ds_read_b64_tr_b16 a[102:103], v15 offset:58624
    ds_read_b64_tr_b16 a[104:105], v18 offset:50176
    v_mfma_f32_16x16x32_bf16 v[108:111], a[84:87], a[60:63], v[108:111]
    buffer_load_dwordx4 v4, s[44:47], s79 offen offset:1024 sc1 lds
    v_mfma_f32_16x16x32_bf16 v[108:111], a[80:83], a[56:59], v[108:111]
    s_waitcnt lgkmcnt(5)
    ds_read_b64_tr_b16 a[106:107], v18 offset:50432
    v_xor_b32 v31, 3, v30
    v_mfma_f32_16x16x32_bf16 v[124:127], a[88:91], a[56:59], v[124:127]
    ds_read_b64_tr_b16 a[108:109], v18 offset:58368
    v_min_u32 v31, 1, v31
    v_mfma_f32_16x16x32_bf16 v[124:127], a[92:95], a[60:63], v[124:127]
    ds_read_b64_tr_b16 a[110:111], v18 offset:58624
    ds_read_b64_tr_b16 a[64:65], v15 offset:51200
    v_mfma_f32_16x16x32_bf16 v[120:123], a[92:95], a[52:55], v[120:123]
    buffer_load_dwordx4 v4, s[44:47], s79 offen offset:2048 sc1 lds
    v_mfma_f32_16x16x32_bf16 v[120:123], a[88:91], a[48:51], v[120:123]
    ds_read_b64_tr_b16 a[66:67], v15 offset:51456
    v_xor_b32 v31, 1, v31
    v_mfma_f32_16x16x32_bf16 v[116:119], a[88:91], a[40:43], v[116:119]
    ds_read_b64_tr_b16 a[68:69], v15 offset:59392
    ds_read_b64_tr_b16 a[70:71], v15 offset:59648
    v_mfma_f32_16x16x32_bf16 v[116:119], a[92:95], a[44:47], v[116:119]
    ds_read_b64_tr_b16 a[72:73], v18 offset:51200
    v_mul_lo_u32 v31, s70, v31
    v_mfma_f32_16x16x32_bf16 v[112:115], a[92:95], a[36:39], v[112:115]
    buffer_load_dwordx4 v4, s[44:47], s79 offen offset:3072 sc1 lds
    v_mfma_f32_16x16x32_bf16 v[112:115], a[88:91], a[32:35], v[112:115]
    s_waitcnt lgkmcnt(9)
    s_mov_b32 s79, 32768
    s_addk_i32 m0, 28672
    v_mfma_f32_16x16x32_bf16 v[160:163], a[96:99], a[32:35], v[160:163]
    ds_read_b64_tr_b16 a[74:75], v18 offset:51456
    v_accvgpr_write_b32 a252, v31
    v_mfma_f32_16x16x32_bf16 v[160:163], a[100:103], a[36:39], v[160:163]
    ds_read_b64_tr_b16 a[76:77], v18 offset:59392
    v_accvgpr_write_b32 a253, v31
    v_mfma_f32_16x16x32_bf16 v[164:167], a[100:103], a[44:47], v[164:167]
    buffer_load_dwordx4 v4, s[44:47], s79 offen offset:0 sc1 lds
    v_mfma_f32_16x16x32_bf16 v[164:167], a[96:99], a[40:43], v[164:167]
    ds_read_b64_tr_b16 a[78:79], v18 offset:59648
    v_accvgpr_write_b32 a254, v31
    v_mfma_f32_16x16x32_bf16 v[168:171], a[96:99], a[48:51], v[168:171]
    v_cvt_pk_bf16_f32 v32, v96, v97
    v_cvt_pk_bf16_f32 v33, v98, v99
    v_mfma_f32_16x16x32_bf16 v[168:171], a[100:103], a[52:55], v[168:171]
    v_accvgpr_write_b32 a255, v31
    v_cvt_pk_bf16_f32 v34, v112, v113
    v_mfma_f32_16x16x32_bf16 v[172:175], a[100:103], a[60:63], v[172:175]
    buffer_load_dwordx4 v4, s[44:47], s79 offen offset:1024 sc1 lds
    v_mfma_f32_16x16x32_bf16 v[172:175], a[96:99], a[56:59], v[172:175]
    s_waitcnt lgkmcnt(8)
    v_cvt_pk_bf16_f32 v35, v114, v115
    v_cvt_pk_bf16_f32 v36, v100, v101
    v_mfma_f32_16x16x32_bf16 v[188:191], a[104:107], a[56:59], v[188:191]
    v_cvt_pk_bf16_f32 v37, v102, v103
    v_cvt_pk_bf16_f32 v38, v116, v117
    v_mfma_f32_16x16x32_bf16 v[188:191], a[108:111], a[60:63], v[188:191]
    ds_read_b64_tr_b16 a[80:81], v15 offset:52224
    v_cvt_pk_bf16_f32 v39, v118, v119
    v_mfma_f32_16x16x32_bf16 v[184:187], a[108:111], a[52:55], v[184:187]
    buffer_load_dwordx4 v4, s[44:47], s79 offen offset:2048 sc1 lds
    v_mfma_f32_16x16x32_bf16 v[184:187], a[104:107], a[48:51], v[184:187]
    v_cvt_pk_bf16_f32 v64, v104, v105
    v_cvt_pk_bf16_f32 v65, v106, v107
    v_mfma_f32_16x16x32_bf16 v[180:183], a[104:107], a[40:43], v[180:183]
    ds_read_b64_tr_b16 a[82:83], v15 offset:52480
    v_cvt_pk_bf16_f32 v66, v120, v121
    v_mfma_f32_16x16x32_bf16 v[180:183], a[108:111], a[44:47], v[180:183]
    ds_read_b64_tr_b16 a[84:85], v15 offset:60416
    v_cvt_pk_bf16_f32 v67, v122, v123
    v_mfma_f32_16x16x32_bf16 v[176:179], a[108:111], a[36:39], v[176:179]
    buffer_load_dwordx4 v4, s[44:47], s79 offen offset:3072 sc1 lds
    v_mfma_f32_16x16x32_bf16 v[176:179], a[104:107], a[32:35], v[176:179]
    s_waitcnt lgkmcnt(7)
    s_mov_b32 s79, 36864
    s_addk_i32 m0, 4096
    v_mfma_f32_16x16x32_bf16 v[224:227], a[64:67], a[32:35], v[224:227]
    v_cvt_pk_bf16_f32 v68, v108, v109
    v_cvt_pk_bf16_f32 v69, v110, v111
    v_mfma_f32_16x16x32_bf16 v[224:227], a[68:71], a[36:39], v[224:227]
    v_cvt_pk_bf16_f32 v70, v124, v125
    v_cvt_pk_bf16_f32 v71, v126, v127
    v_mfma_f32_16x16x32_bf16 v[228:231], a[68:71], a[44:47], v[228:231]
    buffer_load_dwordx4 v4, s[44:47], s79 offen offset:0 sc1 lds
    v_mfma_f32_16x16x32_bf16 v[228:231], a[64:67], a[40:43], v[228:231]
    ds_read_b64_tr_b16 a[86:87], v15 offset:60672
    ds_read_b64_tr_b16 a[88:89], v18 offset:52224
    v_mfma_f32_16x16x32_bf16 v[232:235], a[64:67], a[48:51], v[232:235]
    v_cvt_pk_bf16_f32 v40, v160, v161
    v_cvt_pk_bf16_f32 v41, v162, v163
    v_mfma_f32_16x16x32_bf16 v[232:235], a[68:71], a[52:55], v[232:235]
    v_cvt_pk_bf16_f32 v42, v176, v177
    v_cvt_pk_bf16_f32 v43, v178, v179
    v_mfma_f32_16x16x32_bf16 v[236:239], a[68:71], a[60:63], v[236:239]
    buffer_load_dwordx4 v4, s[44:47], s79 offen offset:1024 sc1 lds
    v_mfma_f32_16x16x32_bf16 v[236:239], a[64:67], a[56:59], v[236:239]
    s_waitcnt lgkmcnt(5)
    v_cvt_pk_bf16_f32 v44, v164, v165
    v_cvt_pk_bf16_f32 v45, v166, v167
    v_mfma_f32_16x16x32_bf16 v[252:255], a[72:75], a[56:59], v[252:255]
    ds_read_b64_tr_b16 a[90:91], v18 offset:52480
    v_cvt_pk_bf16_f32 v46, v180, v181
    v_mfma_f32_16x16x32_bf16 v[252:255], a[76:79], a[60:63], v[252:255]
    ds_read_b64_tr_b16 a[92:93], v18 offset:60416
    v_cvt_pk_bf16_f32 v47, v182, v183
    v_mfma_f32_16x16x32_bf16 v[248:251], a[76:79], a[52:55], v[248:251]
    buffer_load_dwordx4 v4, s[44:47], s79 offen offset:2048 sc1 lds
    v_mfma_f32_16x16x32_bf16 v[248:251], a[72:75], a[48:51], v[248:251]
    v_cvt_pk_bf16_f32 v72, v168, v169
    v_cvt_pk_bf16_f32 v73, v170, v171
    v_mfma_f32_16x16x32_bf16 v[244:247], a[72:75], a[40:43], v[244:247]
    ds_read_b64_tr_b16 a[94:95], v18 offset:60672
    v_cvt_pk_bf16_f32 v74, v184, v185
    v_mfma_f32_16x16x32_bf16 v[244:247], a[76:79], a[44:47], v[244:247]
PG_7:
    s_cbranch_execz PG_11
    v_cvt_pk_bf16_f32 v75, v186, v187
    v_mfma_f32_16x16x32_bf16 v[240:243], a[76:79], a[36:39], v[240:243]
    buffer_load_dwordx4 v4, s[44:47], s79 offen offset:3072 sc1 lds
    v_mfma_f32_16x16x32_bf16 v[240:243], a[72:75], a[32:35], v[240:243]
    s_waitcnt lgkmcnt(4)
    v_cvt_pk_bf16_f32 v76, v172, v173
    v_cvt_pk_bf16_f32 v77, v174, v175
    v_mfma_f32_16x16x32_bf16 v[192:195], a[80:83], a[32:35], v[192:195]
    v_cvt_pk_bf16_f32 v78, v188, v189
    v_mfma_f32_16x16x32_bf16 v[192:195], a[84:87], a[36:39], v[192:195]
    v_cvt_pk_bf16_f32 v79, v190, v191
    v_mfma_f32_16x16x32_bf16 v[196:199], a[84:87], a[44:47], v[196:199]
    v_mfma_f32_16x16x32_bf16 v[196:199], a[80:83], a[40:43], v[196:199]
    v_mfma_f32_16x16x32_bf16 v[200:203], a[80:83], a[48:51], v[200:203]
    v_cvt_pk_bf16_f32 v48, v224, v225
    v_cvt_pk_bf16_f32 v49, v226, v227
    v_mfma_f32_16x16x32_bf16 v[200:203], a[84:87], a[52:55], v[200:203]
    v_cvt_pk_bf16_f32 v50, v240, v241
    v_cvt_pk_bf16_f32 v51, v242, v243
    v_mfma_f32_16x16x32_bf16 v[204:207], a[84:87], a[60:63], v[204:207]
    v_cvt_pk_bf16_f32 v52, v228, v229
    v_cvt_pk_bf16_f32 v53, v230, v231
    v_mfma_f32_16x16x32_bf16 v[204:207], a[80:83], a[56:59], v[204:207]
    s_waitcnt lgkmcnt(0)
    v_cvt_pk_bf16_f32 v54, v244, v245
    v_cvt_pk_bf16_f32 v55, v246, v247
    v_mfma_f32_16x16x32_bf16 v[220:223], a[88:91], a[56:59], v[220:223]
    v_cvt_pk_bf16_f32 v80, v232, v233
    v_cvt_pk_bf16_f32 v81, v234, v235
    v_mfma_f32_16x16x32_bf16 v[220:223], a[92:95], a[60:63], v[220:223]
    v_cvt_pk_bf16_f32 v82, v248, v249
    v_mfma_f32_16x16x32_bf16 v[216:219], a[92:95], a[52:55], v[216:219]
    v_cvt_pk_bf16_f32 v83, v250, v251
    v_mfma_f32_16x16x32_bf16 v[216:219], a[88:91], a[48:51], v[216:219]
    v_cvt_pk_bf16_f32 v84, v236, v237
    v_cvt_pk_bf16_f32 v85, v238, v239
    v_mfma_f32_16x16x32_bf16 v[212:215], a[88:91], a[40:43], v[212:215]
    v_cvt_pk_bf16_f32 v86, v252, v253
    v_mfma_f32_16x16x32_bf16 v[212:215], a[92:95], a[44:47], v[212:215]
    v_cvt_pk_bf16_f32 v87, v254, v255
    v_mfma_f32_16x16x32_bf16 v[208:211], a[92:95], a[36:39], v[208:211]
    v_mfma_f32_16x16x32_bf16 v[208:211], a[88:91], a[32:35], v[208:211]
    s_waitcnt vmcnt(8)
    s_barrier
    v_add_u32 v29, 0, v22
    ds_read_b128 a[128:131], v29 offset:0
    ds_read_b128 a[132:135], v29 offset:1024
    ds_read_b128 a[136:139], v29 offset:2048
    ds_read_b128 a[140:143], v29 offset:3072
    ds_read_b128 a[144:147], v29 offset:4096
    ds_read_b128 a[148:151], v29 offset:5120
    ds_read_b128 a[152:155], v29 offset:6144
    ds_read_b128 a[156:159], v29 offset:7168
    v_cvt_pk_bf16_f32 v56, v192, v193
    v_cvt_pk_bf16_f32 v57, v194, v195
    v_cvt_pk_bf16_f32 v58, v208, v209
    v_cvt_pk_bf16_f32 v59, v210, v211
    v_cvt_pk_bf16_f32 v60, v196, v197
    v_cvt_pk_bf16_f32 v61, v198, v199
    v_cvt_pk_bf16_f32 v62, v212, v213
    v_cvt_pk_bf16_f32 v63, v214, v215
    s_waitcnt lgkmcnt(7)
    v_mfma_f32_16x16x32_bf16 v[96:99], a[128:131], v[32:35], 0
    ds_read_b128 a[160:163], v29 offset:16384
    ds_read_b128 a[164:167], v29 offset:17408
    s_waitcnt lgkmcnt(8)
    v_mfma_f32_16x16x32_bf16 v[96:99], a[132:135], v[40:43], v[96:99]
    ds_read_b128 a[168:171], v29 offset:18432
    ds_read_b128 a[172:175], v29 offset:19456
    s_waitcnt lgkmcnt(9)
    v_mfma_f32_16x16x32_bf16 v[96:99], a[136:139], v[48:51], v[96:99]
    s_mov_b32 s79, 65536
    ds_read_b128 a[176:179], v29 offset:20480
    ds_read_b128 a[180:183], v29 offset:21504
    s_waitcnt lgkmcnt(10)
    v_mfma_f32_16x16x32_bf16 v[96:99], a[140:143], v[56:59], v[96:99]
    s_addk_i32 m0, 28672
    ds_read_b128 a[184:187], v29 offset:22528
    ds_read_b128 a[188:191], v29 offset:23552
    v_mfma_f32_16x16x32_bf16 v[104:107], a[140:143], v[60:63], 0
    v_cvt_pk_bf16_f32 v88, v200, v201
    v_cvt_pk_bf16_f32 v89, v202, v203
    v_mfma_f32_16x16x32_bf16 v[104:107], a[136:139], v[52:55], v[104:107]
    buffer_load_dwordx4 v4, s[44:47], s79 offen offset:0 sc1 lds
    v_mfma_f32_16x16x32_bf16 v[104:107], a[132:135], v[44:47], v[104:107]
    v_cvt_pk_bf16_f32 v90, v216, v217
    v_cvt_pk_bf16_f32 v91, v218, v219
    v_mfma_f32_16x16x32_bf16 v[104:107], a[128:131], v[36:39], v[104:107]
    v_cvt_pk_bf16_f32 v92, v204, v205
    v_cvt_pk_bf16_f32 v93, v206, v207
    s_waitcnt lgkmcnt(11)
    v_mfma_f32_16x16x32_bf16 v[108:111], a[144:147], v[36:39], 0
    v_cvt_pk_bf16_f32 v94, v220, v221
    v_cvt_pk_bf16_f32 v95, v222, v223
    s_waitcnt lgkmcnt(10)
    v_mfma_f32_16x16x32_bf16 v[108:111], a[148:151], v[44:47], v[108:111]
    buffer_load_dwordx4 v4, s[44:47], s79 offen offset:1024 sc1 lds
    s_waitcnt lgkmcnt(9)
    v_mfma_f32_16x16x32_bf16 v[108:111], a[152:155], v[52:55], v[108:111]
    buffer_load_dwordx4 v4, s[44:47], s79 offen offset:2048 sc1 lds
    s_waitcnt lgkmcnt(8)
    v_mfma_f32_16x16x32_bf16 v[108:111], a[156:159], v[60:63], v[108:111]
    v_mfma_f32_16x16x32_bf16 v[100:103], a[156:159], v[56:59], 0
    v_and_b32 v30, 15, v0
    v_lshrrev_b32 v31, 4, v0
    v_mfma_f32_16x16x32_bf16 v[100:103], a[152:155], v[48:51], v[100:103]
    v_lshlrev_b32 v31, 2, v31
    v_sub_u32 v30, v30, v31
    v_mfma_f32_16x16x32_bf16 v[100:103], a[148:151], v[40:43], v[100:103]
    buffer_load_dwordx4 v4, s[44:47], s79 offen offset:3072 sc1 lds
    v_mfma_f32_16x16x32_bf16 v[100:103], a[144:147], v[32:35], v[100:103]
    s_sub_u32 s67, 7, s62
    v_lshl_add_u32 v31, s67, 4, v30
    v_lshl_add_u32 v30, s62, 4, v30
    s_waitcnt lgkmcnt(7)
    v_mfma_f32_16x16x32_bf16 v[112:115], a[160:163], v[32:35], 0
    s_mov_b32 s79, 69632
    v_cvt_f32_i32 v30, v30
    s_waitcnt lgkmcnt(6)
    v_mfma_f32_16x16x32_bf16 v[112:115], a[164:167], v[40:43], v[112:115]
    v_cvt_f32_i32 v31, v31
    v_add_f32 v30, 0.5, v30
    s_waitcnt lgkmcnt(5)
    v_mfma_f32_16x16x32_bf16 v[112:115], a[168:171], v[48:51], v[112:115]
    s_addk_i32 m0, 4096
    v_add_f32 v31, 0.5, v31
    s_waitcnt lgkmcnt(4)
    v_mfma_f32_16x16x32_bf16 v[112:115], a[172:175], v[56:59], v[112:115]
    v_mul_f32 v238, 0x71800000, v30
    v_mfma_f32_16x16x32_bf16 v[120:123], a[172:175], v[60:63], 0
    buffer_load_dwordx4 v4, s[44:47], s79 offen offset:0 sc1 lds
    v_mfma_f32_16x16x32_bf16 v[120:123], a[168:171], v[52:55], v[120:123]
    v_mul_f32 v239, 0x71800000, v31
    v_mfma_f32_16x16x32_bf16 v[120:123], a[164:167], v[44:47], v[120:123]
    s_cmp_eq_u32 s64, 7
    s_cselect_b32 s67, 0, 0x75800000
    v_mfma_f32_16x16x32_bf16 v[120:123], a[160:163], v[36:39], v[120:123]
    buffer_load_dwordx4 v4, s[44:47], s79 offen offset:1024 sc1 lds
    s_waitcnt lgkmcnt(3)
    v_mfma_f32_16x16x32_bf16 v[124:127], a[176:179], v[36:39], 0
    v_add_f32 v247, s67, v238
    v_mov_b32 v248, 0
    s_waitcnt lgkmcnt(2)
    v_mfma_f32_16x16x32_bf16 v[124:127], a[180:183], v[44:47], v[124:127]
    v_mov_b32 v249, 0
    v_mov_b32 v250, 0
    s_waitcnt lgkmcnt(1)
    v_mfma_f32_16x16x32_bf16 v[124:127], a[184:187], v[52:55], v[124:127]
    buffer_load_dwordx4 v4, s[44:47], s79 offen offset:2048 sc1 lds
    s_waitcnt lgkmcnt(0)
    v_mfma_f32_16x16x32_bf16 v[124:127], a[188:191], v[60:63], v[124:127]
    v_mov_b32 v251, 0
    s_add_u32 s90, s72, 163840
    v_mfma_f32_16x16x32_bf16 v[116:119], a[188:191], v[56:59], 0
    s_mov_b32 s92, 32768
    v_mfma_f32_16x16x32_bf16 v[116:119], a[184:187], v[48:51], v[116:119]
    v_add_u32 v2, 4096, v4
    v_mfma_f32_16x16x32_bf16 v[116:119], a[180:183], v[40:43], v[116:119]
    s_mov_b32 s91, 98304
    v_mfma_f32_16x16x32_bf16 v[116:119], a[176:179], v[32:35], v[116:119]
    s_mov_b32 s94, 0x44800000
    v_mfma_f32_16x16x32_bf16 v[128:131], a[128:131], v[64:67], 0
    buffer_load_dwordx4 v4, s[44:47], s79 offen offset:3072 sc1 lds
    v_mfma_f32_16x16x32_bf16 v[128:131], a[132:135], v[72:75], v[128:131]
    s_mov_b32 s79, 98304
    v_mfma_f32_16x16x32_bf16 v[128:131], a[136:139], v[80:83], v[128:131]
    v_mfma_f32_16x16x32_bf16 v[128:131], a[140:143], v[88:91], v[128:131]
    s_addk_i32 m0, 28672
    s_cmp_lg_u32 s64, 0
    s_cbranch_scc1 ATT_NOMASK0
    v_min_f32 v96, v96, v238
    v_add_f32 v240, 0xf1800000, v238
    v_min_f32 v97, v97, v240
    v_add_f32 v240, 0xf2000000, v238
    v_min_f32 v98, v98, v240
    v_add_f32 v240, 0xf2400000, v238
    v_min_f32 v99, v99, v240
    v_add_f32 v240, 0xf3800000, v238
    v_min_f32 v100, v100, v240
    v_add_f32 v240, 0xf3880000, v238
    v_min_f32 v101, v101, v240
    v_add_f32 v240, 0xf3900000, v238
    v_min_f32 v102, v102, v240
    v_add_f32 v240, 0xf3980000, v238
    v_min_f32 v103, v103, v240
    v_add_f32 v240, 0xf4000000, v238
    v_min_f32 v112, v112, v240
    v_add_f32 v240, 0xf4040000, v238
    v_min_f32 v113, v113, v240
    v_add_f32 v240, 0xf4080000, v238
    v_min_f32 v114, v114, v240
    v_add_f32 v240, 0xf40c0000, v238
    v_min_f32 v115, v115, v240
    v_add_f32 v240, 0xf4400000, v238
    v_min_f32 v116, v116, v240
    v_add_f32 v240, 0xf4440000, v238
    v_min_f32 v117, v117, v240
    v_add_f32 v240, 0xf4480000, v238
    v_min_f32 v118, v118, v240
    v_add_f32 v240, 0xf44c0000, v238
    v_min_f32 v119, v119, v240
ATT_NOMASK0:
    v_mfma_f32_16x16x32_bf16 v[136:139], a[140:143], v[92:95], 0
    v_max3_f32 v241, v96, v97, v98
    v_max3_f32 v243, v104, v105, v106
    v_mfma_f32_16x16x32_bf16 v[136:139], a[136:139], v[84:87], v[136:139]
    v_max3_f32 v241, v241, v99, v100
    v_max3_f32 v243, v243, v107, v108
    v_mfma_f32_16x16x32_bf16 v[136:139], a[132:135], v[76:79], v[136:139]
    v_max3_f32 v241, v241, v101, v102
    v_max3_f32 v243, v243, v109, v110
    v_mfma_f32_16x16x32_bf16 v[136:139], a[128:131], v[68:71], v[136:139]
    v_max3_f32 v241, v241, v103, v112
    v_max3_f32 v243, v243, v111, v120
    v_mfma_f32_16x16x32_bf16 v[140:143], a[144:147], v[68:71], 0
    v_max3_f32 v241, v241, v113, v114
    v_max3_f32 v243, v243, v121, v122
    v_mfma_f32_16x16x32_bf16 v[140:143], a[148:151], v[76:79], v[140:143]
    v_max3_f32 v241, v241, v115, v116
    v_max3_f32 v243, v243, v123, v124
    v_mfma_f32_16x16x32_bf16 v[140:143], a[152:155], v[84:87], v[140:143]
    buffer_load_dwordx4 v4, s[44:47], s79 offen offset:0 sc1 lds
    v_max3_f32 v241, v241, v117, v118
    v_max3_f32 v243, v243, v125, v126
    v_mfma_f32_16x16x32_bf16 v[140:143], a[156:159], v[92:95], v[140:143]
    v_max_f32 v241, v241, v119
    v_max_f32 v243, v243, v127
    v_mov_b32 v242, v241
    v_mov_b32 v244, v243
    v_mfma_f32_16x16x32_bf16 v[132:135], a[156:159], v[88:91], 0
    v_permlane16_swap_b32 v241, v242
    v_permlane16_swap_b32 v243, v244
    v_max_f32 v241, v241, v242
    v_mfma_f32_16x16x32_bf16 v[132:135], a[152:155], v[80:83], v[132:135]
    buffer_load_dwordx4 v4, s[44:47], s79 offen offset:1024 sc1 lds
    v_max_f32 v243, v243, v244
    v_mov_b32 v242, v241
    v_mov_b32 v244, v243
    s_nop 0
    v_permlane32_swap_b32 v241, v242
    v_mfma_f32_16x16x32_bf16 v[132:135], a[148:151], v[72:75], v[132:135]
    v_permlane32_swap_b32 v243, v244
    v_max_f32 v241, v241, v242
    v_max_f32 v243, v243, v244
    v_mfma_f32_16x16x32_bf16 v[132:135], a[144:147], v[64:67], v[132:135]
    v_sub_f32 v192, 0xc2c80000, v241
    v_sub_f32 v196, 0xc2c80000, v243
    v_add_f32 v96, v96, v192
    v_add_f32 v97, v97, v192
    v_mfma_f32_16x16x32_bf16 v[144:147], a[160:163], v[64:67], 0
    buffer_load_dwordx4 v4, s[44:47], s79 offen offset:2048 sc1 lds
    v_add_f32 v98, v98, v192
    v_add_f32 v99, v99, v192
    v_add_f32 v100, v100, v192
    v_mfma_f32_16x16x32_bf16 v[144:147], a[164:167], v[72:75], v[144:147]
    v_add_f32 v101, v101, v192
    v_add_f32 v102, v102, v192
    v_add_f32 v103, v103, v192
    v_add_f32 v104, v104, v196
    v_mfma_f32_16x16x32_bf16 v[144:147], a[168:171], v[80:83], v[144:147]
    v_add_f32 v105, v105, v196
    v_add_f32 v106, v106, v196
    v_add_f32 v107, v107, v196
    v_mfma_f32_16x16x32_bf16 v[144:147], a[172:175], v[88:91], v[144:147]
    v_add_f32 v108, v108, v196
    v_add_f32 v109, v109, v196
    v_add_f32 v110, v110, v196
    v_add_f32 v111, v111, v196
    v_mfma_f32_16x16x32_bf16 v[152:155], a[172:175], v[92:95], 0
    buffer_load_dwordx4 v4, s[44:47], s79 offen offset:3072 sc1 lds
    s_waitcnt vmcnt(12)
    s_barrier
    v_exp_f32 v228, v96
    v_exp_f32 v229, v97
    v_mfma_f32_16x16x32_bf16 v[152:155], a[168:171], v[84:87], v[152:155]
    v_exp_f32 v230, v98
    v_exp_f32 v231, v99
    v_add_u32 v29, s92, v22
    v_mfma_f32_16x16x32_bf16 v[152:155], a[164:167], v[76:79], v[152:155]
    v_cvt_pk_bf16_f32 v160, v228, v229
    v_exp_f32 v232, v100
    v_mfma_f32_16x16x32_bf16 v[152:155], a[160:163], v[68:71], v[152:155]
    s_mov_b32 s79, 102400
    v_exp_f32 v233, v101
    v_cvt_pk_bf16_f32 v161, v230, v231
    v_mfma_f32_16x16x32_bf16 v[156:159], a[176:179], v[68:71], 0
    ds_read_b128 a[128:131], v29 offset:0
    v_exp_f32 v234, v102
    v_exp_f32 v235, v103
    v_mfma_f32_16x16x32_bf16 v[156:159], a[180:183], v[76:79], v[156:159]
    s_add_u32 m0, s72, 102400
    v_cvt_pk_bf16_f32 v162, v232, v233
    v_exp_f32 v228, v104
    v_mfma_f32_16x16x32_bf16 v[156:159], a[184:187], v[84:87], v[156:159]
    buffer_load_dwordx4 v4, s[44:47], s79 offen offset:0 sc1 lds
    ds_read_b128 a[132:135], v29 offset:1024
    v_exp_f32 v229, v105
    v_cvt_pk_bf16_f32 v163, v234, v235
    v_mfma_f32_16x16x32_bf16 v[156:159], a[188:191], v[92:95], v[156:159]
    v_exp_f32 v230, v106
    v_exp_f32 v231, v107
    v_mfma_f32_16x16x32_bf16 v[148:151], a[188:191], v[88:91], 0
    ds_read_b128 a[136:139], v29 offset:2048
    v_cvt_pk_bf16_f32 v164, v228, v229
    v_exp_f32 v232, v108
    v_mfma_f32_16x16x32_bf16 v[148:151], a[184:187], v[80:83], v[148:151]
    v_exp_f32 v233, v109
    v_cvt_pk_bf16_f32 v165, v230, v231
    v_exp_f32 v234, v110
    v_mfma_f32_16x16x32_bf16 v[148:151], a[180:183], v[72:75], v[148:151]
    buffer_load_dwordx4 v4, s[44:47], s79 offen offset:1024 sc1 lds
    ds_read_b128 a[140:143], v29 offset:3072
    v_exp_f32 v235, v111
    v_mfma_f32_16x16x32_bf16 v[148:151], a[176:179], v[64:67], v[148:151]
    v_cvt_pk_bf16_f32 v166, v232, v233
    v_cvt_pk_bf16_f32 v167, v234, v235
    v_add_f32 v112, v112, v192
    v_add_f32 v113, v113, v192
    v_mfma_f32_32x32x16_bf16 a[0:15], v[248:251], v[248:251], 0
    ds_read_b128 a[144:147], v29 offset:4096
    v_add_f32 v114, v114, v192
    v_add_f32 v115, v115, v192
    v_add_f32 v116, v116, v192
    v_add_f32 v117, v117, v192
    v_add_f32 v118, v118, v192
    v_mfma_f32_32x32x16_bf16 a[16:31], v[248:251], v[248:251], 0
    buffer_load_dwordx4 v4, s[44:47], s79 offen offset:2048 sc1 lds
    v_add_f32 v119, v119, v192
    v_add_f32 v120, v120, v196
    v_mfma_f32_32x32x16_bf16 a[32:47], v[248:251], v[248:251], 0
    ds_read_b128 a[148:151], v29 offset:5120
    v_add_f32 v121, v121, v196
    v_add_f32 v122, v122, v196
    v_add_f32 v123, v123, v196
    v_add_f32 v124, v124, v196
    v_add_f32 v125, v125, v196
    v_add_f32 v126, v126, v196
    v_add_f32 v127, v127, v196
    v_mov_b32 v193, v192
    v_mov_b32 v194, v192
    v_mov_b32 v195, v192
    v_mov_b32 v197, v196
    v_mov_b32 v198, v196
    v_mov_b32 v199, v196
    v_mfma_f32_32x32x16_bf16 a[48:63], v[248:251], v[248:251], 0
    buffer_load_dwordx4 v4, s[44:47], s79 offen offset:3072 sc1 lds
    v_mfma_f32_32x32x16_bf16 a[64:79], v[248:251], v[248:251], 0
    s_addk_i32 m0, 0
    ds_read_b128 a[152:155], v29 offset:6144
    v_max3_f32 v241, v128, v129, v130
    v_max3_f32 v243, v136, v137, v138
    v_max3_f32 v241, v241, v131, v132
    v_max3_f32 v243, v243, v139, v140
    v_max3_f32 v241, v241, v133, v134
    v_mfma_f32_32x32x16_bf16 a[80:95], v[248:251], v[248:251], 0
    ds_read_b128 a[156:159], v29 offset:7168
    v_max3_f32 v243, v243, v141, v142
    v_max3_f32 v241, v241, v135, v144
    v_max3_f32 v243, v243, v143, v152
    v_max3_f32 v241, v241, v145, v146
    v_max3_f32 v243, v243, v153, v154
    v_mfma_f32_32x32x16_bf16 a[96:111], v[248:251], v[248:251], 0
    v_max3_f32 v241, v241, v147, v148
    v_max3_f32 v243, v243, v155, v156
    v_max3_f32 v241, v241, v149, v150
    v_max3_f32 v243, v243, v157, v158
    v_max_f32 v241, v241, v151
    v_max_f32 v243, v243, v159
    v_mfma_f32_32x32x16_bf16 a[112:127], v[248:251], v[248:251], 0
    ds_read_b128 a[160:163], v29 offset:8192
    ds_read_b128 a[164:167], v29 offset:9216
    ds_read_b128 a[168:171], v29 offset:10240
    ds_read_b128 a[172:175], v29 offset:11264
    v_mov_b32 v242, v241
    v_mov_b32 v244, v243
    s_nop 0
    v_permlane16_swap_b32 v241, v242
    v_permlane16_swap_b32 v243, v244
    v_max_f32 v241, v241, v242
    v_max_f32 v243, v243, v244
    v_mov_b32 v242, v241
    v_mov_b32 v244, v243
    s_nop 0
    v_permlane32_swap_b32 v241, v242
    v_permlane32_swap_b32 v243, v244
    v_max_f32 v241, v241, v242
    v_max_f32 v243, v243, v244
    v_sub_f32 v208, 0xc2c80000, v241
    v_sub_f32 v212, 0xc2c80000, v243
    v_add_f32 v128, v128, v208
    v_add_f32 v129, v129, v208
    v_add_f32 v130, v130, v208
    v_add_f32 v131, v131, v208
    v_add_f32 v132, v132, v208
    v_add_f32 v133, v133, v208
    v_add_f32 v134, v134, v208
    v_add_f32 v135, v135, v208
    v_add_f32 v136, v136, v212
    v_add_f32 v137, v137, v212
    v_add_f32 v138, v138, v212
    v_add_f32 v139, v139, v212
    v_add_f32 v140, v140, v212
    v_add_f32 v141, v141, v212
    v_add_f32 v142, v142, v212
    v_add_f32 v143, v143, v212
    v_exp_f32 v228, v128
    v_exp_f32 v229, v129
    v_exp_f32 v230, v130
    v_exp_f32 v231, v131
    v_cvt_pk_bf16_f32 v176, v228, v229
    v_exp_f32 v232, v132
    v_exp_f32 v233, v133
    v_cvt_pk_bf16_f32 v177, v230, v231
    v_exp_f32 v234, v134
    v_exp_f32 v235, v135
    v_cvt_pk_bf16_f32 v178, v232, v233
    v_exp_f32 v228, v136
    v_exp_f32 v229, v137
    v_cvt_pk_bf16_f32 v179, v234, v235
    v_exp_f32 v230, v138
    v_exp_f32 v231, v139
    v_cvt_pk_bf16_f32 v180, v228, v229
    v_exp_f32 v232, v140
    v_exp_f32 v233, v141
    v_cvt_pk_bf16_f32 v181, v230, v231
    v_exp_f32 v234, v142
    v_exp_f32 v235, v143
    v_cvt_pk_bf16_f32 v182, v232, v233
    v_cvt_pk_bf16_f32 v183, v234, v235
    v_mfma_f32_16x16x32_bf16 v[216:219], a[240:243], v[160:163], 0
    v_mfma_f32_16x16x32_bf16 v[216:219], a[244:247], v[164:167], v[216:219]
    v_mfma_f32_16x16x32_bf16 v[216:219], a[248:251], v[176:179], v[216:219]
    v_mfma_f32_16x16x32_bf16 v[216:219], a[252:255], v[180:183], v[216:219]
    v_add_f32 v144, v144, v208
    v_add_f32 v145, v145, v208
    v_add_f32 v146, v146, v208
    v_add_f32 v147, v147, v208
    v_add_f32 v148, v148, v208
    v_add_f32 v149, v149, v208
    v_add_f32 v150, v150, v208
    v_add_f32 v151, v151, v208
    v_add_f32 v152, v152, v212
    v_add_f32 v153, v153, v212
    v_add_f32 v154, v154, v212
    v_add_f32 v155, v155, v212
    v_add_f32 v156, v156, v212
    v_add_f32 v157, v157, v212
    v_add_f32 v158, v158, v212
    v_add_f32 v159, v159, v212
    v_mov_b32 v209, v208
    v_mov_b32 v210, v208
    v_mov_b32 v211, v208
    v_mov_b32 v213, v212
    v_mov_b32 v214, v212
    v_mov_b32 v215, v212
    s_waitcnt lgkmcnt(8)
    s_cmp_eq_u32 s64, 0
    s_cbranch_scc1 ATT_D2
    s_lshl_b32 s93, s64, 1
    s_sub_u32 s93, s93, 2
.p2align 6
ATT_DL:
    v_mfma_f32_16x16x32_bf16 v[96:99], a[128:131], v[32:35], v[192:195]
    s_add_u32 s91, s91, 32768
    v_exp_f32 v228, v112
    v_mfma_f32_16x16x32_bf16 v[96:99], a[132:135], v[40:43], v[96:99]
    s_addk_i32 m0, 28672
    v_exp_f32 v229, v113
    v_mfma_f32_16x16x32_bf16 v[96:99], a[136:139], v[48:51], v[96:99]
    v_exp_f32 v230, v114
    v_mfma_f32_16x16x32_bf16 v[96:99], a[140:143], v[56:59], v[96:99]
    s_cmp_eq_u32 m0, s90
    s_cselect_b32 m0, s72, m0
    ds_read_b128 a[176:179], v29 offset:12288
    v_mfma_f32_16x16x32_bf16 v[104:107], a[140:143], v[60:63], v[196:199]
    v_exp_f32 v231, v115
    v_mfma_f32_16x16x32_bf16 v[104:107], a[136:139], v[52:55], v[104:107]
    v_cvt_pk_bf16_f32 v168, v228, v229
    v_mfma_f32_16x16x32_bf16 v[104:107], a[132:135], v[44:47], v[104:107]
    v_exp_f32 v232, v116
    v_mfma_f32_16x16x32_bf16 v[104:107], a[128:131], v[36:39], v[104:107]
    v_exp_f32 v233, v117
    v_mfma_f32_16x16x32_bf16 v[128:131], a[128:131], v[64:67], v[208:211]
    ds_read_b128 a[180:183], v29 offset:13312
    v_cvt_pk_bf16_f32 v169, v230, v231
    v_mfma_f32_16x16x32_bf16 v[128:131], a[132:135], v[72:75], v[128:131]
    v_exp_f32 v234, v118
    v_mfma_f32_16x16x32_bf16 v[128:131], a[136:139], v[80:83], v[128:131]
    v_exp_f32 v235, v119
    v_mfma_f32_16x16x32_bf16 v[128:131], a[140:143], v[88:91], v[128:131]
    v_cvt_pk_bf16_f32 v170, v232, v233
    v_mfma_f32_16x16x32_bf16 v[136:139], a[140:143], v[92:95], v[212:215]
    v_exp_f32 v228, v120
    v_mfma_f32_16x16x32_bf16 v[136:139], a[136:139], v[84:87], v[136:139]
    v_exp_f32 v229, v121
    v_mfma_f32_16x16x32_bf16 v[136:139], a[132:135], v[76:79], v[136:139]
    ds_read_b128 a[184:187], v29 offset:14336
    v_cvt_pk_bf16_f32 v171, v234, v235
    v_mfma_f32_16x16x32_bf16 v[136:139], a[128:131], v[68:71], v[136:139]
    s_waitcnt lgkmcnt(7)
    v_exp_f32 v230, v122
    v_mfma_f32_16x16x32_bf16 v[140:143], a[144:147], v[68:71], v[212:215]
    v_exp_f32 v231, v123
    v_mfma_f32_16x16x32_bf16 v[140:143], a[148:151], v[76:79], v[140:143]
    v_cvt_pk_bf16_f32 v172, v228, v229
    v_mfma_f32_16x16x32_bf16 v[140:143], a[152:155], v[84:87], v[140:143]
    v_exp_f32 v232, v124
    v_mfma_f32_16x16x32_bf16 v[140:143], a[156:159], v[92:95], v[140:143]
    v_exp_f32 v233, v125
    v_mfma_f32_16x16x32_bf16 v[132:135], a[156:159], v[88:91], v[208:211]
    ds_read_b128 a[188:191], v29 offset:15360
    v_cvt_pk_bf16_f32 v173, v230, v231
    v_mfma_f32_16x16x32_bf16 v[132:135], a[152:155], v[80:83], v[132:135]
    v_exp_f32 v234, v126
    v_mfma_f32_16x16x32_bf16 v[132:135], a[148:151], v[72:75], v[132:135]
    v_exp_f32 v235, v127
    v_mfma_f32_16x16x32_bf16 v[132:135], a[144:147], v[64:67], v[132:135]
    v_cvt_pk_bf16_f32 v174, v232, v233
    v_mfma_f32_16x16x32_bf16 v[108:111], a[144:147], v[36:39], v[196:199]
    v_exp_f32 v228, v144
    v_mfma_f32_16x16x32_bf16 v[108:111], a[148:151], v[44:47], v[108:111]
    v_exp_f32 v229, v145
    v_mfma_f32_16x16x32_bf16 v[108:111], a[152:155], v[52:55], v[108:111]
    ds_read_b128 a[128:131], v29 offset:16384
    v_cvt_pk_bf16_f32 v175, v234, v235
    v_mfma_f32_16x16x32_bf16 v[108:111], a[156:159], v[60:63], v[108:111]
    v_exp_f32 v230, v146
    v_mfma_f32_16x16x32_bf16 v[100:103], a[156:159], v[56:59], v[192:195]
    v_exp_f32 v231, v147
    v_mfma_f32_16x16x32_bf16 v[100:103], a[152:155], v[48:51], v[100:103]
    v_cvt_pk_bf16_f32 v184, v228, v229
    v_mfma_f32_16x16x32_bf16 v[100:103], a[148:151], v[40:43], v[100:103]
    v_exp_f32 v232, v148
    v_mfma_f32_16x16x32_bf16 v[100:103], a[144:147], v[32:35], v[100:103]
    s_waitcnt lgkmcnt(5)
    v_exp_f32 v233, v149
    v_mfma_f32_16x16x32_bf16 a[0:3], a[160:163], v[160:163], a[0:3]
    ds_read_b128 a[132:135], v29 offset:17408
    v_cvt_pk_bf16_f32 v185, v230, v231
    v_mfma_f32_16x16x32_bf16 a[4:7], a[160:163], v[164:167], a[4:7]
    v_exp_f32 v234, v150
    v_mfma_f32_16x16x32_bf16 a[64:67], a[160:163], v[176:179], a[64:67]
    v_exp_f32 v235, v151
    v_mfma_f32_16x16x32_bf16 a[68:71], a[160:163], v[180:183], a[68:71]
    v_cvt_pk_bf16_f32 v186, v232, v233
    v_mfma_f32_16x16x32_bf16 a[76:79], a[164:167], v[180:183], a[76:79]
    v_exp_f32 v228, v152
    v_mfma_f32_16x16x32_bf16 a[72:75], a[164:167], v[176:179], a[72:75]
    v_exp_f32 v229, v153
    v_mfma_f32_16x16x32_bf16 a[12:15], a[164:167], v[164:167], a[12:15]
    v_mfma_f32_16x16x32_bf16 a[8:11], a[164:167], v[160:163], a[8:11]
    ds_read_b128 a[136:139], v29 offset:18432
    v_cvt_pk_bf16_f32 v187, v234, v235
    v_mfma_f32_16x16x32_bf16 a[16:19], a[168:171], v[160:163], a[16:19]
    v_exp_f32 v230, v154
    v_mfma_f32_16x16x32_bf16 a[20:23], a[168:171], v[164:167], a[20:23]
    v_exp_f32 v231, v155
    v_mfma_f32_16x16x32_bf16 a[80:83], a[168:171], v[176:179], a[80:83]
    v_cvt_pk_bf16_f32 v188, v228, v229
    v_mfma_f32_16x16x32_bf16 a[84:87], a[168:171], v[180:183], a[84:87]
    v_exp_f32 v232, v156
    v_mfma_f32_16x16x32_bf16 a[92:95], a[172:175], v[180:183], a[92:95]
    v_exp_f32 v233, v157
    v_mfma_f32_16x16x32_bf16 a[88:91], a[172:175], v[176:179], a[88:91]
    ds_read_b128 a[140:143], v29 offset:19456
    v_mfma_f32_16x16x32_bf16 a[28:31], a[172:175], v[164:167], a[28:31]
    v_cvt_pk_bf16_f32 v189, v230, v231
    v_mfma_f32_16x16x32_bf16 a[24:27], a[172:175], v[160:163], a[24:27]
    s_waitcnt lgkmcnt(4)
    v_exp_f32 v234, v158
    v_mfma_f32_16x16x32_bf16 a[32:35], a[176:179], v[160:163], a[32:35]
    v_exp_f32 v235, v159
    v_mfma_f32_16x16x32_bf16 a[36:39], a[176:179], v[164:167], a[36:39]
    v_cvt_pk_bf16_f32 v190, v232, v233
    v_mfma_f32_16x16x32_bf16 a[96:99], a[176:179], v[176:179], a[96:99]
    v_cvt_pk_bf16_f32 v191, v234, v235
    v_mfma_f32_16x16x32_bf16 a[100:103], a[176:179], v[180:183], a[100:103]
    v_mfma_f32_16x16x32_bf16 a[108:111], a[180:183], v[180:183], a[108:111]
    buffer_load_dwordx4 v4, s[44:47], s91 offen offset:0 sc1 lds
    v_mfma_f32_16x16x32_bf16 v[220:223], a[240:243], v[168:171], v[216:219]
    ds_read_b128 a[144:147], v29 offset:20480
    ds_read_b128 a[148:151], v29 offset:21504
    v_mfma_f32_16x16x32_bf16 v[220:223], a[244:247], v[172:175], v[220:223]
    buffer_load_dwordx4 v4, s[44:47], s91 offen offset:1024 sc1 lds
    v_mfma_f32_16x16x32_bf16 v[220:223], a[248:251], v[184:187], v[220:223]
    ds_read_b128 a[152:155], v29 offset:22528
    ds_read_b128 a[156:159], v29 offset:23552
    v_mfma_f32_16x16x32_bf16 v[220:223], a[252:255], v[188:191], v[220:223]
    buffer_load_dwordx4 v4, s[44:47], s91 offen offset:2048 sc1 lds
    v_mfma_f32_16x16x32_bf16 a[104:107], a[180:183], v[176:179], a[104:107]
    ds_read_b128 a[160:163], v29 offset:24576
    ds_read_b128 a[164:167], v29 offset:25600
    v_mfma_f32_16x16x32_bf16 a[44:47], a[180:183], v[164:167], a[44:47]
    buffer_load_dwordx4 v4, s[44:47], s91 offen offset:3072 sc1 lds
    v_mfma_f32_16x16x32_bf16 a[40:43], a[180:183], v[160:163], a[40:43]
    ds_read_b128 a[168:171], v29 offset:26624
    ds_read_b128 a[172:175], v29 offset:27648
    v_mfma_f32_16x16x32_bf16 a[48:51], a[184:187], v[160:163], a[48:51]
    v_mfma_f32_16x16x32_bf16 a[52:55], a[184:187], v[164:167], a[52:55]
    v_mfma_f32_16x16x32_bf16 a[112:115], a[184:187], v[176:179], a[112:115]
    v_mfma_f32_16x16x32_bf16 a[116:119], a[184:187], v[180:183], a[116:119]
    v_mfma_f32_16x16x32_bf16 a[124:127], a[188:191], v[180:183], a[124:127]
    v_max3_f32 v241, v220, v221, v222
    v_max_f32 v241, v241, v223
    v_mfma_f32_16x16x32_bf16 a[120:123], a[188:191], v[176:179], a[120:123]
    v_cmp_nge_f32 vcc, s94, v241
    v_mfma_f32_16x16x32_bf16 a[60:63], a[188:191], v[164:167], a[60:63]
    s_waitcnt lgkmcnt(8)
    v_mfma_f32_16x16x32_bf16 a[56:59], a[188:191], v[160:163], a[56:59]
    s_cbranch_vccnz FIX_DL_0
FIX_DL_0_ret:
    v_exp_f32 v228, v96
    v_mfma_f32_16x16x32_bf16 v[112:115], a[128:131], v[32:35], v[192:195]
    s_addk_i32 m0, 4096
    v_exp_f32 v229, v97
    v_mfma_f32_16x16x32_bf16 v[112:115], a[132:135], v[40:43], v[112:115]
    s_add_u32 s92, s92, 32768
    v_exp_f32 v230, v98
    v_mfma_f32_16x16x32_bf16 v[112:115], a[136:139], v[48:51], v[112:115]
    v_exp_f32 v231, v99
    v_mfma_f32_16x16x32_bf16 v[112:115], a[140:143], v[56:59], v[112:115]
    ds_read_b128 a[176:179], v29 offset:28672
    v_cvt_pk_bf16_f32 v160, v228, v229
    v_mfma_f32_16x16x32_bf16 v[120:123], a[140:143], v[60:63], v[196:199]
    v_exp_f32 v232, v100
    v_mfma_f32_16x16x32_bf16 v[120:123], a[136:139], v[52:55], v[120:123]
    v_exp_f32 v233, v101
    v_mfma_f32_16x16x32_bf16 v[120:123], a[132:135], v[44:47], v[120:123]
    ds_read_b128 a[180:183], v29 offset:29696
    v_cvt_pk_bf16_f32 v161, v230, v231
    v_mfma_f32_16x16x32_bf16 v[120:123], a[128:131], v[36:39], v[120:123]
    v_exp_f32 v234, v102
    v_mfma_f32_16x16x32_bf16 v[144:147], a[128:131], v[64:67], v[208:211]
    v_exp_f32 v235, v103
    v_mfma_f32_16x16x32_bf16 v[144:147], a[132:135], v[72:75], v[144:147]
    s_cmp_eq_u32 s92, 163840
    s_cselect_b32 s92, 0, s92
    v_cvt_pk_bf16_f32 v162, v232, v233
    v_mfma_f32_16x16x32_bf16 v[144:147], a[136:139], v[80:83], v[144:147]
    v_exp_f32 v228, v104
    v_mfma_f32_16x16x32_bf16 v[144:147], a[140:143], v[88:91], v[144:147]
    v_exp_f32 v229, v105
    v_mfma_f32_16x16x32_bf16 v[152:155], a[140:143], v[92:95], v[212:215]
PG_8:
    s_cbranch_execz PG_12
    v_cvt_pk_bf16_f32 v163, v234, v235
    v_mfma_f32_16x16x32_bf16 v[152:155], a[136:139], v[84:87], v[152:155]
    v_exp_f32 v230, v106
    v_mfma_f32_16x16x32_bf16 v[152:155], a[132:135], v[76:79], v[152:155]
    ds_read_b128 a[184:187], v29 offset:30720
    v_mfma_f32_16x16x32_bf16 v[152:155], a[128:131], v[68:71], v[152:155]
    s_waitcnt lgkmcnt(7)
    v_exp_f32 v231, v107
    v_mfma_f32_16x16x32_bf16 v[156:159], a[144:147], v[68:71], v[212:215]
    v_cvt_pk_bf16_f32 v164, v228, v229
    v_mfma_f32_16x16x32_bf16 v[156:159], a[148:151], v[76:79], v[156:159]
    v_exp_f32 v232, v108
    v_mfma_f32_16x16x32_bf16 v[156:159], a[152:155], v[84:87], v[156:159]
    v_exp_f32 v233, v109
    v_mfma_f32_16x16x32_bf16 v[156:159], a[156:159], v[92:95], v[156:159]
    ds_read_b128 a[188:191], v29 offset:31744
    v_cvt_pk_bf16_f32 v165, v230, v231
    v_mfma_f32_16x16x32_bf16 v[148:151], a[156:159], v[88:91], v[208:211]
    v_exp_f32 v234, v110
    v_mfma_f32_16x16x32_bf16 v[148:151], a[152:155], v[80:83], v[148:151]
    v_exp_f32 v235, v111
    v_mfma_f32_16x16x32_bf16 v[148:151], a[148:151], v[72:75], v[148:151]
    v_cvt_pk_bf16_f32 v166, v232, v233
    v_mfma_f32_16x16x32_bf16 v[148:151], a[144:147], v[64:67], v[148:151]
    v_add_u32 v29, s92, v22
    v_mfma_f32_16x16x32_bf16 v[124:127], a[144:147], v[36:39], v[196:199]
    v_exp_f32 v228, v128
    v_mfma_f32_16x16x32_bf16 v[124:127], a[148:151], v[44:47], v[124:127]
    v_exp_f32 v229, v129
    v_mfma_f32_16x16x32_bf16 v[124:127], a[152:155], v[52:55], v[124:127]
    s_waitcnt vmcnt(12)
    s_barrier
    v_mfma_f32_16x16x32_bf16 v[124:127], a[156:159], v[60:63], v[124:127]
    ds_read_b128 a[128:131], v29 offset:0
    v_cvt_pk_bf16_f32 v167, v234, v235
    v_mfma_f32_16x16x32_bf16 v[116:119], a[156:159], v[56:59], v[192:195]
    v_exp_f32 v230, v130
    v_mfma_f32_16x16x32_bf16 v[116:119], a[152:155], v[48:51], v[116:119]
    v_exp_f32 v231, v131
    v_mfma_f32_16x16x32_bf16 v[116:119], a[148:151], v[40:43], v[116:119]
    v_cvt_pk_bf16_f32 v176, v228, v229
    v_mfma_f32_16x16x32_bf16 v[116:119], a[144:147], v[32:35], v[116:119]
    s_waitcnt lgkmcnt(5)
    v_exp_f32 v232, v132
    v_mfma_f32_16x16x32_bf16 a[0:3], a[160:163], v[168:171], a[0:3]
    v_exp_f32 v233, v133
    v_mfma_f32_16x16x32_bf16 a[4:7], a[160:163], v[172:175], a[4:7]
    ds_read_b128 a[132:135], v29 offset:1024
    v_cvt_pk_bf16_f32 v177, v230, v231
    v_mfma_f32_16x16x32_bf16 a[64:67], a[160:163], v[184:187], a[64:67]
    v_exp_f32 v234, v134
    v_mfma_f32_16x16x32_bf16 a[68:71], a[160:163], v[188:191], a[68:71]
    v_exp_f32 v235, v135
    v_mfma_f32_16x16x32_bf16 a[76:79], a[164:167], v[188:191], a[76:79]
    v_cvt_pk_bf16_f32 v178, v232, v233
    v_mfma_f32_16x16x32_bf16 a[72:75], a[164:167], v[184:187], a[72:75]
    v_exp_f32 v228, v136
    v_mfma_f32_16x16x32_bf16 a[12:15], a[164:167], v[172:175], a[12:15]
    v_exp_f32 v229, v137
    v_mfma_f32_16x16x32_bf16 a[8:11], a[164:167], v[168:171], a[8:11]
    ds_read_b128 a[136:139], v29 offset:2048
    v_cvt_pk_bf16_f32 v179, v234, v235
    v_mfma_f32_16x16x32_bf16 a[16:19], a[168:171], v[168:171], a[16:19]
    v_exp_f32 v230, v138
    v_mfma_f32_16x16x32_bf16 a[20:23], a[168:171], v[172:175], a[20:23]
    v_exp_f32 v231, v139
    v_mfma_f32_16x16x32_bf16 a[80:83], a[168:171], v[184:187], a[80:83]
    v_cvt_pk_bf16_f32 v180, v228, v229
    v_mfma_f32_16x16x32_bf16 a[84:87], a[168:171], v[188:191], a[84:87]
    v_exp_f32 v232, v140
    v_mfma_f32_16x16x32_bf16 a[92:95], a[172:175], v[188:191], a[92:95]
    v_exp_f32 v233, v141
    v_mfma_f32_16x16x32_bf16 a[88:91], a[172:175], v[184:187], a[88:91]
    ds_read_b128 a[140:143], v29 offset:3072
    v_mfma_f32_16x16x32_bf16 a[28:31], a[172:175], v[172:175], a[28:31]
    v_cvt_pk_bf16_f32 v181, v230, v231
    v_mfma_f32_16x16x32_bf16 a[24:27], a[172:175], v[168:171], a[24:27]
    s_waitcnt lgkmcnt(4)
    v_exp_f32 v234, v142
    v_mfma_f32_16x16x32_bf16 a[32:35], a[176:179], v[168:171], a[32:35]
    v_exp_f32 v235, v143
    v_mfma_f32_16x16x32_bf16 a[36:39], a[176:179], v[172:175], a[36:39]
    v_cvt_pk_bf16_f32 v182, v232, v233
    v_mfma_f32_16x16x32_bf16 a[96:99], a[176:179], v[184:187], a[96:99]
    v_cvt_pk_bf16_f32 v183, v234, v235
    v_mfma_f32_16x16x32_bf16 a[100:103], a[176:179], v[188:191], a[100:103]
    v_mfma_f32_16x16x32_bf16 a[108:111], a[180:183], v[188:191], a[108:111]
    buffer_load_dwordx4 v2, s[44:47], s91 offen offset:0 sc1 lds
    v_mfma_f32_16x16x32_bf16 v[216:219], a[240:243], v[160:163], v[220:223]
    ds_read_b128 a[144:147], v29 offset:4096
    ds_read_b128 a[148:151], v29 offset:5120
    v_mfma_f32_16x16x32_bf16 v[216:219], a[244:247], v[164:167], v[216:219]
    buffer_load_dwordx4 v2, s[44:47], s91 offen offset:1024 sc1 lds
    v_mfma_f32_16x16x32_bf16 v[216:219], a[248:251], v[176:179], v[216:219]
    ds_read_b128 a[152:155], v29 offset:6144
    ds_read_b128 a[156:159], v29 offset:7168
    v_mfma_f32_16x16x32_bf16 v[216:219], a[252:255], v[180:183], v[216:219]
    buffer_load_dwordx4 v2, s[44:47], s91 offen offset:2048 sc1 lds
    v_mfma_f32_16x16x32_bf16 a[104:107], a[180:183], v[184:187], a[104:107]
    ds_read_b128 a[160:163], v29 offset:8192
    ds_read_b128 a[164:167], v29 offset:9216
    v_mfma_f32_16x16x32_bf16 a[44:47], a[180:183], v[172:175], a[44:47]
    buffer_load_dwordx4 v2, s[44:47], s91 offen offset:3072 sc1 lds
    v_mfma_f32_16x16x32_bf16 a[40:43], a[180:183], v[168:171], a[40:43]
    ds_read_b128 a[168:171], v29 offset:10240
    ds_read_b128 a[172:175], v29 offset:11264
    v_mfma_f32_16x16x32_bf16 a[48:51], a[184:187], v[168:171], a[48:51]
    v_mfma_f32_16x16x32_bf16 a[52:55], a[184:187], v[172:175], a[52:55]
    v_mfma_f32_16x16x32_bf16 a[112:115], a[184:187], v[184:187], a[112:115]
    v_mfma_f32_16x16x32_bf16 a[116:119], a[184:187], v[188:191], a[116:119]
    v_mfma_f32_16x16x32_bf16 a[124:127], a[188:191], v[188:191], a[124:127]
    v_max3_f32 v241, v216, v217, v218
    v_max_f32 v241, v241, v219
    v_mfma_f32_16x16x32_bf16 a[120:123], a[188:191], v[184:187], a[120:123]
    v_cmp_nge_f32 vcc, s94, v241
    v_mfma_f32_16x16x32_bf16 a[60:63], a[188:191], v[172:175], a[60:63]
    s_waitcnt lgkmcnt(8)
    v_mfma_f32_16x16x32_bf16 a[56:59], a[188:191], v[168:171], a[56:59]
    s_cbranch_vccnz FIX_DL_1
FIX_DL_1_ret:
    s_sub_u32 s93, s93, 1
    s_cbranch_scc0 ATT_DL
    v_mfma_f32_16x16x32_bf16 v[96:99], a[128:131], v[32:35], v[192:195]
    s_add_u32 s91, s91, 32768
    v_exp_f32 v228, v112
    v_mfma_f32_16x16x32_bf16 v[96:99], a[132:135], v[40:43], v[96:99]
    s_addk_i32 m0, 28672
    v_min_u32 v226, 36, v0
    v_lshlrev_b32 v226, 7, v226
    v_mfma_f32_16x16x32_bf16 v[96:99], a[136:139], v[48:51], v[96:99]
    s_and_b32 s67, s2, 31
    v_exp_f32 v229, v113
    v_mfma_f32_16x16x32_bf16 v[96:99], a[140:143], v[56:59], v[96:99]
    s_lshl_b32 s67, s67, 2
    v_exp_f32 v230, v114
    v_mfma_f32_16x16x32_bf16 v[104:107], a[140:143], v[60:63], v[196:199]
    s_add_u32 s67, s67, s62
    ds_read_b128 a[176:179], v29 offset:12288
    s_mul_i32 s70, s67, 7
    v_mfma_f32_16x16x32_bf16 v[104:107], a[136:139], v[52:55], v[104:107]
    s_add_u32 s70, s70, s64
    v_exp_f32 v231, v115
    v_mfma_f32_16x16x32_bf16 v[104:107], a[132:135], v[44:47], v[104:107]
    s_sub_u32 s70, s70, 1
    s_mul_i32 s70, s70, 4736
    v_cvt_pk_bf16_f32 v168, v228, v229
    v_mfma_f32_16x16x32_bf16 v[104:107], a[128:131], v[36:39], v[104:107]
    v_exp_f32 v232, v116
    v_mfma_f32_16x16x32_bf16 v[128:131], a[128:131], v[64:67], v[208:211]
    v_exp_f32 v233, v117
    v_mfma_f32_16x16x32_bf16 v[128:131], a[132:135], v[72:75], v[128:131]
    v_cvt_pk_bf16_f32 v169, v230, v231
    v_add_u32 v226, s70, v226
    v_mfma_f32_16x16x32_bf16 v[128:131], a[136:139], v[80:83], v[128:131]
    buffer_load_dword v237, v226, s[32:35], 0 offen
    v_mfma_f32_16x16x32_bf16 v[128:131], a[140:143], v[88:91], v[128:131]
    v_exp_f32 v234, v118
    v_mfma_f32_16x16x32_bf16 v[136:139], a[140:143], v[92:95], v[212:215]
    ds_read_b128 a[180:183], v29 offset:13312
    v_min_u32 v226, 9, v0
    v_mfma_f32_16x16x32_bf16 v[136:139], a[136:139], v[84:87], v[136:139]
    v_exp_f32 v235, v119
    v_mfma_f32_16x16x32_bf16 v[136:139], a[132:135], v[76:79], v[136:139]
    v_lshlrev_b32 v226, 7, v226
    v_cvt_pk_bf16_f32 v170, v232, v233
    v_mfma_f32_16x16x32_bf16 v[136:139], a[128:131], v[68:71], v[136:139]
    s_waitcnt lgkmcnt(6)
    s_lshr_b32 s67, s67, 1
    s_mul_i32 s70, s67, 7
    v_mfma_f32_16x16x32_bf16 v[140:143], a[144:147], v[68:71], v[212:215]
    s_add_u32 s70, s70, s64
    v_exp_f32 v228, v120
    v_mfma_f32_16x16x32_bf16 v[140:143], a[148:151], v[76:79], v[140:143]
    s_sub_u32 s70, s70, 1
    v_exp_f32 v229, v121
    v_mfma_f32_16x16x32_bf16 v[140:143], a[152:155], v[84:87], v[140:143]
    s_mul_i32 s70, s70, 1280
    v_cvt_pk_bf16_f32 v171, v234, v235
    v_add_u32 v226, s70, v226
    v_mfma_f32_16x16x32_bf16 v[140:143], a[156:159], v[92:95], v[140:143]
    buffer_load_dword v224, v226, s[36:39], 0 offen
    v_exp_f32 v230, v122
    v_mfma_f32_16x16x32_bf16 v[132:135], a[156:159], v[88:91], v[208:211]
    ds_read_b128 a[184:187], v29 offset:14336
    v_exp_f32 v231, v123
    v_mfma_f32_16x16x32_bf16 v[132:135], a[152:155], v[80:83], v[132:135]
    ds_read_b128 a[188:191], v29 offset:15360
    v_cvt_pk_bf16_f32 v172, v228, v229
    v_mfma_f32_16x16x32_bf16 v[132:135], a[148:151], v[72:75], v[132:135]
    v_exp_f32 v232, v124
    v_mfma_f32_16x16x32_bf16 v[132:135], a[144:147], v[64:67], v[132:135]
    v_exp_f32 v233, v125
    v_mfma_f32_16x16x32_bf16 v[108:111], a[144:147], v[36:39], v[196:199]
    s_cmp_eq_u32 m0, s90
    s_cselect_b32 m0, s72, m0
    v_cvt_pk_bf16_f32 v173, v230, v231
    v_mfma_f32_16x16x32_bf16 v[108:111], a[148:151], v[44:47], v[108:111]
    v_exp_f32 v234, v126
    v_mfma_f32_16x16x32_bf16 v[108:111], a[152:155], v[52:55], v[108:111]
    v_exp_f32 v235, v127
    v_mfma_f32_16x16x32_bf16 v[108:111], a[156:159], v[60:63], v[108:111]
    ds_read_b128 a[128:131], v29 offset:16384
    v_cvt_pk_bf16_f32 v174, v232, v233
    v_mfma_f32_16x16x32_bf16 v[100:103], a[156:159], v[56:59], v[192:195]
    v_exp_f32 v228, v144
    v_mfma_f32_16x16x32_bf16 v[100:103], a[152:155], v[48:51], v[100:103]
    v_exp_f32 v229, v145
    v_mfma_f32_16x16x32_bf16 v[100:103], a[148:151], v[40:43], v[100:103]
    v_cvt_pk_bf16_f32 v175, v234, v235
    v_mfma_f32_16x16x32_bf16 v[100:103], a[144:147], v[32:35], v[100:103]
    s_waitcnt lgkmcnt(5)
    v_exp_f32 v230, v146
    v_mfma_f32_16x16x32_bf16 a[0:3], a[160:163], v[160:163], a[0:3]
    v_exp_f32 v231, v147
    v_mfma_f32_16x16x32_bf16 a[4:7], a[160:163], v[164:167], a[4:7]
    ds_read_b128 a[132:135], v29 offset:17408
    v_cvt_pk_bf16_f32 v184, v228, v229
    v_mfma_f32_16x16x32_bf16 a[64:67], a[160:163], v[176:179], a[64:67]
    v_exp_f32 v232, v148
    v_mfma_f32_16x16x32_bf16 a[68:71], a[160:163], v[180:183], a[68:71]
    v_exp_f32 v233, v149
    v_mfma_f32_16x16x32_bf16 a[76:79], a[164:167], v[180:183], a[76:79]
    v_cvt_pk_bf16_f32 v185, v230, v231
    v_mfma_f32_16x16x32_bf16 a[72:75], a[164:167], v[176:179], a[72:75]
    v_exp_f32 v234, v150
    v_mfma_f32_16x16x32_bf16 a[12:15], a[164:167], v[164:167], a[12:15]
    v_exp_f32 v235, v151
    v_mfma_f32_16x16x32_bf16 a[8:11], a[164:167], v[160:163], a[8:11]
    ds_read_b128 a[136:139], v29 offset:18432
    v_cvt_pk_bf16_f32 v186, v232, v233
    v_mfma_f32_16x16x32_bf16 a[16:19], a[168:171], v[160:163], a[16:19]
    v_exp_f32 v228, v152
    v_mfma_f32_16x16x32_bf16 a[20:23], a[168:171], v[164:167], a[20:23]
    v_exp_f32 v229, v153
    v_mfma_f32_16x16x32_bf16 a[80:83], a[168:171], v[176:179], a[80:83]
    v_cvt_pk_bf16_f32 v187, v234, v235
    v_mfma_f32_16x16x32_bf16 a[84:87], a[168:171], v[180:183], a[84:87]
    v_exp_f32 v230, v154
    v_mfma_f32_16x16x32_bf16 a[92:95], a[172:175], v[180:183], a[92:95]
    v_exp_f32 v231, v155
    v_mfma_f32_16x16x32_bf16 a[88:91], a[172:175], v[176:179], a[88:91]
    ds_read_b128 a[140:143], v29 offset:19456
    v_cvt_pk_bf16_f32 v188, v228, v229
    v_mfma_f32_16x16x32_bf16 a[28:31], a[172:175], v[164:167], a[28:31]
    v_exp_f32 v232, v156
    v_mfma_f32_16x16x32_bf16 a[24:27], a[172:175], v[160:163], a[24:27]
    s_waitcnt lgkmcnt(4)
    v_exp_f32 v233, v157
    v_mfma_f32_16x16x32_bf16 a[32:35], a[176:179], v[160:163], a[32:35]
    v_cvt_pk_bf16_f32 v189, v230, v231
    v_mfma_f32_16x16x32_bf16 a[36:39], a[176:179], v[164:167], a[36:39]
    v_exp_f32 v234, v158
    v_mfma_f32_16x16x32_bf16 a[96:99], a[176:179], v[176:179], a[96:99]
    v_exp_f32 v235, v159
    v_mfma_f32_16x16x32_bf16 a[100:103], a[176:179], v[180:183], a[100:103]
    v_cvt_pk_bf16_f32 v190, v232, v233
    v_cvt_pk_bf16_f32 v191, v234, v235
    v_mfma_f32_16x16x32_bf16 a[108:111], a[180:183], v[180:183], a[108:111]
    buffer_load_dwordx4 v4, s[44:47], s91 offen offset:0 sc1 lds
    v_mfma_f32_16x16x32_bf16 v[220:223], a[240:243], v[168:171], v[216:219]
    ds_read_b128 a[144:147], v29 offset:20480
    ds_read_b128 a[148:151], v29 offset:21504
    v_mfma_f32_16x16x32_bf16 v[220:223], a[244:247], v[172:175], v[220:223]
    buffer_load_dwordx4 v4, s[44:47], s91 offen offset:1024 sc1 lds
    v_mfma_f32_16x16x32_bf16 v[220:223], a[248:251], v[184:187], v[220:223]
    ds_read_b128 a[152:155], v29 offset:22528
    ds_read_b128 a[156:159], v29 offset:23552
    v_mfma_f32_16x16x32_bf16 v[220:223], a[252:255], v[188:191], v[220:223]
    buffer_load_dwordx4 v4, s[44:47], s91 offen offset:2048 sc1 lds
    v_mfma_f32_16x16x32_bf16 a[104:107], a[180:183], v[176:179], a[104:107]
    ds_read_b128 a[160:163], v29 offset:24576
    ds_read_b128 a[164:167], v29 offset:25600
    v_mfma_f32_16x16x32_bf16 a[44:47], a[180:183], v[164:167], a[44:47]
    buffer_load_dwordx4 v4, s[44:47], s91 offen offset:3072 sc1 lds
    v_mfma_f32_16x16x32_bf16 a[40:43], a[180:183], v[160:163], a[40:43]
    ds_read_b128 a[168:171], v29 offset:26624
    ds_read_b128 a[172:175], v29 offset:27648
    v_mfma_f32_16x16x32_bf16 a[48:51], a[184:187], v[160:163], a[48:51]
    v_mfma_f32_16x16x32_bf16 a[52:55], a[184:187], v[164:167], a[52:55]
    v_mfma_f32_16x16x32_bf16 a[112:115], a[184:187], v[176:179], a[112:115]
    v_mfma_f32_16x16x32_bf16 a[116:119], a[184:187], v[180:183], a[116:119]
    v_mfma_f32_16x16x32_bf16 a[124:127], a[188:191], v[180:183], a[124:127]
    v_max3_f32 v241, v220, v221, v222
    v_max_f32 v241, v241, v223
    v_mfma_f32_16x16x32_bf16 a[120:123], a[188:191], v[176:179], a[120:123]
    v_cmp_nge_f32 vcc, s94, v241
    v_mfma_f32_16x16x32_bf16 a[60:63], a[188:191], v[164:167], a[60:63]
    s_waitcnt lgkmcnt(8)
    v_mfma_f32_16x16x32_bf16 a[56:59], a[188:191], v[160:163], a[56:59]
    s_cbranch_vccnz FIX_D1_0
FIX_D1_0_ret:
    v_min_f32 v96, v96, v238
    v_mfma_f32_16x16x32_bf16 v[112:115], a[128:131], v[32:35], v[192:195]
    s_addk_i32 m0, 4096
    v_exp_f32 v228, v96
    v_mfma_f32_16x16x32_bf16 v[112:115], a[132:135], v[40:43], v[112:115]
    s_add_u32 s92, s92, 32768
    v_add_f32 v240, 0xf1800000, v238
    v_min_f32 v97, v97, v240
    v_mfma_f32_16x16x32_bf16 v[112:115], a[136:139], v[48:51], v[112:115]
    v_exp_f32 v229, v97
    v_mfma_f32_16x16x32_bf16 v[112:115], a[140:143], v[56:59], v[112:115]
    v_add_f32 v240, 0xf2000000, v238
    v_min_f32 v98, v98, v240
    v_mfma_f32_16x16x32_bf16 v[120:123], a[140:143], v[60:63], v[196:199]
    s_cmp_eq_u32 s92, 163840
    s_cselect_b32 s92, 0, s92
    ds_read_b128 a[176:179], v29 offset:28672
    v_mfma_f32_16x16x32_bf16 v[120:123], a[136:139], v[52:55], v[120:123]
    v_exp_f32 v230, v98
    v_mfma_f32_16x16x32_bf16 v[120:123], a[132:135], v[44:47], v[120:123]
    v_add_f32 v240, 0xf2400000, v238
    v_min_f32 v99, v99, v240
    v_mfma_f32_16x16x32_bf16 v[120:123], a[128:131], v[36:39], v[120:123]
    v_exp_f32 v231, v99
    v_mfma_f32_16x16x32_bf16 v[144:147], a[128:131], v[64:67], v[208:211]
    v_cvt_pk_bf16_f32 v160, v228, v229
    v_add_f32 v240, 0xf3800000, v238
    v_mfma_f32_16x16x32_bf16 v[144:147], a[132:135], v[72:75], v[144:147]
    ds_read_b128 a[180:183], v29 offset:29696
    v_min_f32 v100, v100, v240
    v_mfma_f32_16x16x32_bf16 v[144:147], a[136:139], v[80:83], v[144:147]
    v_exp_f32 v232, v100
    v_mfma_f32_16x16x32_bf16 v[144:147], a[140:143], v[88:91], v[144:147]
    v_add_f32 v240, 0xf3880000, v238
    v_min_f32 v101, v101, v240
    v_mfma_f32_16x16x32_bf16 v[152:155], a[140:143], v[92:95], v[212:215]
    v_exp_f32 v233, v101
    v_mfma_f32_16x16x32_bf16 v[152:155], a[136:139], v[84:87], v[152:155]
    v_cvt_pk_bf16_f32 v161, v230, v231
    v_add_f32 v240, 0xf3900000, v238
    v_mfma_f32_16x16x32_bf16 v[152:155], a[132:135], v[76:79], v[152:155]
    ds_read_b128 a[184:187], v29 offset:30720
    v_min_f32 v102, v102, v240
    v_mfma_f32_16x16x32_bf16 v[152:155], a[128:131], v[68:71], v[152:155]
    s_waitcnt lgkmcnt(7)
    v_exp_f32 v234, v102
    v_mfma_f32_16x16x32_bf16 v[156:159], a[144:147], v[68:71], v[212:215]
    v_add_f32 v240, 0xf3980000, v238
    v_min_f32 v103, v103, v240
    v_mfma_f32_16x16x32_bf16 v[156:159], a[148:151], v[76:79], v[156:159]
    v_exp_f32 v235, v103
    v_mfma_f32_16x16x32_bf16 v[156:159], a[152:155], v[84:87], v[156:159]
    v_cvt_pk_bf16_f32 v162, v232, v233
    v_mfma_f32_16x16x32_bf16 v[156:159], a[156:159], v[92:95], v[156:159]
    v_exp_f32 v228, v104
    v_mfma_f32_16x16x32_bf16 v[148:151], a[156:159], v[88:91], v[208:211]
    v_exp_f32 v229, v105
    v_mfma_f32_16x16x32_bf16 v[148:151], a[152:155], v[80:83], v[148:151]
    ds_read_b128 a[188:191], v29 offset:31744
    v_cvt_pk_bf16_f32 v163, v234, v235
    v_mfma_f32_16x16x32_bf16 v[148:151], a[148:151], v[72:75], v[148:151]
    v_exp_f32 v230, v106
    v_mfma_f32_16x16x32_bf16 v[148:151], a[144:147], v[64:67], v[148:151]
    v_add_u32 v29, s92, v22
    v_mfma_f32_16x16x32_bf16 v[124:127], a[144:147], v[36:39], v[196:199]
    v_exp_f32 v231, v107
    v_mfma_f32_16x16x32_bf16 v[124:127], a[148:151], v[44:47], v[124:127]
    v_cvt_pk_bf16_f32 v164, v228, v229
    v_mfma_f32_16x16x32_bf16 v[124:127], a[152:155], v[52:55], v[124:127]
    s_waitcnt vmcnt(12)
    s_barrier
    v_mfma_f32_16x16x32_bf16 v[124:127], a[156:159], v[60:63], v[124:127]
    v_exp_f32 v232, v108
    v_mfma_f32_16x16x32_bf16 v[116:119], a[156:159], v[56:59], v[192:195]
    v_exp_f32 v233, v109
    v_mfma_f32_16x16x32_bf16 v[116:119], a[152:155], v[48:51], v[116:119]
    ds_read_b128 a[128:131], v29 offset:0
    v_cvt_pk_bf16_f32 v165, v230, v231
    v_mfma_f32_16x16x32_bf16 v[116:119], a[148:151], v[40:43], v[116:119]
    v_exp_f32 v234, v110
    v_mfma_f32_16x16x32_bf16 v[116:119], a[144:147], v[32:35], v[116:119]
    s_waitcnt lgkmcnt(5)
    v_exp_f32 v235, v111
    v_mfma_f32_16x16x32_bf16 a[0:3], a[160:163], v[168:171], a[0:3]
    ds_read_b128 a[132:135], v29 offset:1024
    v_cvt_pk_bf16_f32 v166, v232, v233
    v_mfma_f32_16x16x32_bf16 a[4:7], a[160:163], v[172:175], a[4:7]
    v_exp_f32 v228, v128
    v_mfma_f32_16x16x32_bf16 a[64:67], a[160:163], v[184:187], a[64:67]
    v_exp_f32 v229, v129
    v_mfma_f32_16x16x32_bf16 a[68:71], a[160:163], v[188:191], a[68:71]
    v_cvt_pk_bf16_f32 v167, v234, v235
    v_mfma_f32_16x16x32_bf16 a[76:79], a[164:167], v[188:191], a[76:79]
    v_exp_f32 v230, v130
    v_mfma_f32_16x16x32_bf16 a[72:75], a[164:167], v[184:187], a[72:75]
    v_exp_f32 v231, v131
    v_mfma_f32_16x16x32_bf16 a[12:15], a[164:167], v[172:175], a[12:15]
    v_cvt_pk_bf16_f32 v176, v228, v229
    v_mfma_f32_16x16x32_bf16 a[8:11], a[164:167], v[168:171], a[8:11]
    v_exp_f32 v232, v132
    v_mfma_f32_16x16x32_bf16 a[16:19], a[168:171], v[168:171], a[16:19]
    v_exp_f32 v233, v133
    v_mfma_f32_16x16x32_bf16 a[20:23], a[168:171], v[172:175], a[20:23]
    ds_read_b128 a[136:139], v29 offset:2048
    v_cvt_pk_bf16_f32 v177, v230, v231
    v_mfma_f32_16x16x32_bf16 a[80:83], a[168:171], v[184:187], a[80:83]
    v_exp_f32 v234, v134
    v_mfma_f32_16x16x32_bf16 a[84:87], a[168:171], v[188:191], a[84:87]
    v_exp_f32 v235, v135
    v_mfma_f32_16x16x32_bf16 a[92:95], a[172:175], v[188:191], a[92:95]
    v_cvt_pk_bf16_f32 v178, v232, v233
    v_mfma_f32_16x16x32_bf16 a[88:91], a[172:175], v[184:187], a[88:91]
    v_exp_f32 v228, v136
    v_mfma_f32_16x16x32_bf16 a[28:31], a[172:175], v[172:175], a[28:31]
    v_exp_f32 v229, v137
    v_mfma_f32_16x16x32_bf16 a[24:27], a[172:175], v[168:171], a[24:27]
    s_waitcnt lgkmcnt(3)
    ds_read_b128 a[140:143], v29 offset:3072
    v_cvt_pk_bf16_f32 v179, v234, v235
    v_mfma_f32_16x16x32_bf16 a[32:35], a[176:179], v[168:171], a[32:35]
    v_exp_f32 v230, v138
    v_mfma_f32_16x16x32_bf16 a[36:39], a[176:179], v[172:175], a[36:39]
    v_exp_f32 v231, v139
    v_mfma_f32_16x16x32_bf16 a[96:99], a[176:179], v[184:187], a[96:99]
    v_cvt_pk_bf16_f32 v180, v228, v229
    v_mfma_f32_16x16x32_bf16 a[100:103], a[176:179], v[188:191], a[100:103]
    v_exp_f32 v232, v140
    v_mfma_f32_16x16x32_bf16 a[108:111], a[180:183], v[188:191], a[108:111]
    v_exp_f32 v233, v141
    v_mfma_f32_16x16x32_bf16 v[216:219], a[240:243], v[160:163], v[220:223]
    ds_read_b128 a[144:147], v29 offset:4096
    v_cvt_pk_bf16_f32 v181, v230, v231
    v_mfma_f32_16x16x32_bf16 v[216:219], a[244:247], v[164:167], v[216:219]
    v_exp_f32 v234, v142
    v_exp_f32 v235, v143
    v_cvt_pk_bf16_f32 v182, v232, v233
    v_cvt_pk_bf16_f32 v183, v234, v235
    v_mfma_f32_16x16x32_bf16 v[216:219], a[248:251], v[176:179], v[216:219]
    buffer_load_dwordx4 v2, s[44:47], s91 offen offset:0 sc1 lds
    v_mfma_f32_16x16x32_bf16 v[216:219], a[252:255], v[180:183], v[216:219]
    buffer_load_dwordx4 v2, s[44:47], s91 offen offset:1024 sc1 lds
    v_mfma_f32_16x16x32_bf16 a[104:107], a[180:183], v[184:187], a[104:107]
    buffer_load_dwordx4 v2, s[44:47], s91 offen offset:2048 sc1 lds
    v_mfma_f32_16x16x32_bf16 a[44:47], a[180:183], v[172:175], a[44:47]
    buffer_load_dwordx4 v2, s[44:47], s91 offen offset:3072 sc1 lds
    v_mfma_f32_16x16x32_bf16 a[40:43], a[180:183], v[168:171], a[40:43]
    ds_read_b128 a[148:151], v29 offset:5120
    ds_read_b128 a[152:155], v29 offset:6144
    v_mfma_f32_16x16x32_bf16 a[48:51], a[184:187], v[168:171], a[48:51]
    ds_read_b128 a[156:159], v29 offset:7168
    ds_read_b128 a[160:163], v29 offset:8192
    v_mfma_f32_16x16x32_bf16 a[52:55], a[184:187], v[172:175], a[52:55]
    ds_read_b128 a[164:167], v29 offset:9216
    ds_read_b128 a[168:171], v29 offset:10240
    v_mfma_f32_16x16x32_bf16 a[112:115], a[184:187], v[184:187], a[112:115]
    ds_read_b128 a[172:175], v29 offset:11264
    v_mfma_f32_16x16x32_bf16 a[116:119], a[184:187], v[188:191], a[116:119]
    v_mfma_f32_16x16x32_bf16 a[124:127], a[188:191], v[188:191], a[124:127]
    v_max3_f32 v241, v216, v217, v218
    v_max_f32 v241, v241, v219
    v_mfma_f32_16x16x32_bf16 a[120:123], a[188:191], v[184:187], a[120:123]
    v_cmp_nge_f32 vcc, s94, v241
    v_mfma_f32_16x16x32_bf16 a[60:63], a[188:191], v[172:175], a[60:63]
    s_waitcnt lgkmcnt(8)
    v_mfma_f32_16x16x32_bf16 a[56:59], a[188:191], v[168:171], a[56:59]
    s_cbranch_vccnz FIX_D1_1
FIX_D1_1_ret:
ATT_D2:
    v_mfma_f32_16x16x32_bf16 v[104:107], a[128:131], v[36:39], v[196:199]
    s_and_b32 s75, s63, 3
    v_add_f32 v240, 0xf4000000, v238
    v_min_f32 v112, v112, v240
    v_mfma_f32_16x16x32_bf16 v[104:107], a[132:135], v[44:47], v[104:107]
    s_lshr_b32 s73, s63, 2
    v_exp_f32 v228, v112
    v_mfma_f32_16x16x32_bf16 v[104:107], a[136:139], v[52:55], v[104:107]
    s_add_u32 s91, s91, 32768
    v_add_f32 v240, 0xf4040000, v238
    v_min_f32 v113, v113, v240
    v_mfma_f32_16x16x32_bf16 v[104:107], a[140:143], v[60:63], v[104:107]
    s_addk_i32 m0, 28672
    v_exp_f32 v229, v113
    v_mfma_f32_16x16x32_bf16 v[128:131], a[140:143], v[88:91], v[208:211]
    s_mul_i32 s99, s64, 1
    ds_read_b128 a[176:179], v29 offset:12288
    v_add_f32 v240, 0xf4080000, v238
    v_mfma_f32_16x16x32_bf16 v[128:131], a[136:139], v[80:83], v[128:131]
    ds_read_b128 a[180:183], v29 offset:13312
    v_min_f32 v114, v114, v240
    v_mfma_f32_16x16x32_bf16 v[128:131], a[132:135], v[72:75], v[128:131]
    v_exp_f32 v230, v114
    v_mfma_f32_16x16x32_bf16 v[128:131], a[128:131], v[64:67], v[128:131]
    s_mul_i32 s69, s75, 2
    v_add_f32 v240, 0xf40c0000, v238
    v_min_f32 v115, v115, v240
    v_mfma_f32_16x16x32_bf16 v[136:139], a[128:131], v[68:71], v[212:215]
    v_exp_f32 v231, v115
    v_mfma_f32_16x16x32_bf16 v[136:139], a[132:135], v[76:79], v[136:139]
    v_cvt_pk_bf16_f32 v168, v228, v229
    v_add_f32 v240, 0xf4400000, v238
    v_mfma_f32_16x16x32_bf16 v[136:139], a[136:139], v[84:87], v[136:139]
    s_add_u32 s99, s99, s69
    v_min_f32 v116, v116, v240
    v_mfma_f32_16x16x32_bf16 v[136:139], a[140:143], v[92:95], v[136:139]
    s_waitcnt lgkmcnt(6)
    v_exp_f32 v232, v116
    v_mfma_f32_16x16x32_bf16 v[140:143], a[156:159], v[92:95], v[212:215]
    v_add_f32 v240, 0xf4440000, v238
    v_min_f32 v117, v117, v240
    v_mfma_f32_16x16x32_bf16 v[140:143], a[152:155], v[84:87], v[140:143]
    s_and_b32 s99, s99, 7
    v_exp_f32 v233, v117
    v_mfma_f32_16x16x32_bf16 v[140:143], a[148:151], v[76:79], v[140:143]
    v_cvt_pk_bf16_f32 v169, v230, v231
    v_add_f32 v240, 0xf4480000, v238
    v_mfma_f32_16x16x32_bf16 v[140:143], a[144:147], v[68:71], v[140:143]
    ds_read_b128 a[184:187], v29 offset:14336
    v_min_f32 v118, v118, v240
    v_mfma_f32_16x16x32_bf16 v[132:135], a[144:147], v[64:67], v[208:211]
    s_lshl_b32 s101, s99, 14
    v_exp_f32 v234, v118
    v_mfma_f32_16x16x32_bf16 v[132:135], a[148:151], v[72:75], v[132:135]
    v_add_f32 v240, 0xf44c0000, v238
    v_min_f32 v119, v119, v240
    v_mfma_f32_16x16x32_bf16 v[132:135], a[152:155], v[80:83], v[132:135]
    v_exp_f32 v235, v119
    v_mfma_f32_16x16x32_bf16 v[132:135], a[156:159], v[88:91], v[132:135]
    s_lshl_b32 s99, s99, 16
    ds_read_b128 a[188:191], v29 offset:15360
    v_cvt_pk_bf16_f32 v170, v232, v233
    v_mfma_f32_16x16x32_bf16 v[108:111], a[156:159], v[60:63], v[196:199]
    v_exp_f32 v228, v120
    v_mfma_f32_16x16x32_bf16 v[108:111], a[152:155], v[52:55], v[108:111]
    v_exp_f32 v229, v121
    v_mfma_f32_16x16x32_bf16 v[108:111], a[148:151], v[44:47], v[108:111]
    v_cvt_pk_bf16_f32 v171, v234, v235
    v_exp_f32 v230, v122
    v_mfma_f32_16x16x32_bf16 v[108:111], a[144:147], v[36:39], v[108:111]
    s_waitcnt lgkmcnt(4)
    v_exp_f32 v231, v123
    v_mfma_f32_16x16x32_bf16 a[0:3], a[160:163], v[160:163], a[0:3]
    s_lshl_b32 s69, s73, 17
    ds_read_b128 a[128:131], v29 offset:16384
    v_cvt_pk_bf16_f32 v172, v228, v229
    v_mfma_f32_16x16x32_bf16 a[4:7], a[160:163], v[164:167], a[4:7]
    s_add_u32 s69, s69, s71
    v_exp_f32 v232, v124
    v_mfma_f32_16x16x32_bf16 a[64:67], a[160:163], v[176:179], a[64:67]
    v_exp_f32 v233, v125
    v_cvt_pk_bf16_f32 v173, v230, v231
    v_mfma_f32_16x16x32_bf16 a[68:71], a[160:163], v[180:183], a[68:71]
    v_exp_f32 v234, v126
    v_mfma_f32_16x16x32_bf16 a[76:79], a[164:167], v[180:183], a[76:79]
    s_add_u32 s69, s69, 35651584
    v_exp_f32 v235, v127
    v_mfma_f32_16x16x32_bf16 a[72:75], a[164:167], v[176:179], a[72:75]
    v_cvt_pk_bf16_f32 v174, v232, v233
    v_exp_f32 v228, v144
    v_mfma_f32_16x16x32_bf16 a[12:15], a[164:167], v[164:167], a[12:15]
    v_exp_f32 v229, v145
    v_mfma_f32_16x16x32_bf16 a[8:11], a[164:167], v[160:163], a[8:11]
    s_lshl_b32 s70, s64, 20
    ds_read_b128 a[132:135], v29 offset:17408
    v_cvt_pk_bf16_f32 v175, v234, v235
    v_mfma_f32_16x16x32_bf16 a[16:19], a[168:171], v[160:163], a[16:19]
    v_exp_f32 v230, v146
    v_mfma_f32_16x16x32_bf16 a[20:23], a[168:171], v[164:167], a[20:23]
    v_exp_f32 v231, v147
    v_mfma_f32_16x16x32_bf16 a[80:83], a[168:171], v[176:179], a[80:83]
    v_cvt_pk_bf16_f32 v184, v228, v229
    v_exp_f32 v232, v148
    v_mfma_f32_16x16x32_bf16 a[84:87], a[168:171], v[180:183], a[84:87]
    s_add_u32 s78, s69, s70
    v_exp_f32 v233, v149
    v_mfma_f32_16x16x32_bf16 a[92:95], a[172:175], v[180:183], a[92:95]
    ds_read_b128 a[136:139], v29 offset:18432
    v_cvt_pk_bf16_f32 v185, v230, v231
    v_mfma_f32_16x16x32_bf16 a[88:91], a[172:175], v[176:179], a[88:91]
    s_add_u32 s69, s69, 15728640
    v_exp_f32 v234, v150
    v_mfma_f32_16x16x32_bf16 a[28:31], a[172:175], v[164:167], a[28:31]
    v_exp_f32 v235, v151
    v_mfma_f32_16x16x32_bf16 a[24:27], a[172:175], v[160:163], a[24:27]
    s_waitcnt lgkmcnt(3)
    v_cvt_pk_bf16_f32 v186, v232, v233
    v_exp_f32 v228, v152
    v_mfma_f32_16x16x32_bf16 a[32:35], a[176:179], v[160:163], a[32:35]
    s_sub_u32 s74, s69, s70
    v_exp_f32 v229, v153
    v_mfma_f32_16x16x32_bf16 a[36:39], a[176:179], v[164:167], a[36:39]
    s_cmp_eq_u32 m0, s90
    s_cselect_b32 m0, s72, m0
    v_cvt_pk_bf16_f32 v187, v234, v235
    v_mfma_f32_16x16x32_bf16 a[96:99], a[176:179], v[176:179], a[96:99]
    v_exp_f32 v230, v154
    v_mfma_f32_16x16x32_bf16 a[100:103], a[176:179], v[180:183], a[100:103]
    ds_read_b128 a[140:143], v29 offset:19456
    v_exp_f32 v231, v155
    v_mfma_f32_16x16x32_bf16 a[108:111], a[180:183], v[180:183], a[108:111]
    v_cvt_pk_bf16_f32 v188, v228, v229
    v_exp_f32 v232, v156
    v_mfma_f32_16x16x32_bf16 v[220:223], a[240:243], v[168:171], v[216:219]
    s_lshl_b32 s96, s73, 19
    v_exp_f32 v233, v157
    v_mfma_f32_16x16x32_bf16 v[220:223], a[244:247], v[172:175], v[220:223]
    v_cvt_pk_bf16_f32 v189, v230, v231
    v_exp_f32 v234, v158
    v_exp_f32 v235, v159
    v_cvt_pk_bf16_f32 v190, v232, v233
    v_cvt_pk_bf16_f32 v191, v234, v235
    v_mfma_f32_16x16x32_bf16 v[220:223], a[248:251], v[184:187], v[220:223]
    s_lshl_b32 s69, s62, 14
    ds_read_b128 a[144:147], v29 offset:20480
    ds_read_b128 a[148:151], v29 offset:21504
    v_mfma_f32_16x16x32_bf16 v[220:223], a[252:255], v[188:191], v[220:223]
    buffer_load_dwordx4 v4, s[44:47], s91 offen offset:0 sc1 lds
    v_mfma_f32_16x16x32_bf16 a[104:107], a[180:183], v[176:179], a[104:107]
    s_add_u32 s96, s96, s69
    ds_read_b128 a[152:155], v29 offset:22528
    ds_read_b128 a[156:159], v29 offset:23552
    v_mfma_f32_16x16x32_bf16 a[44:47], a[180:183], v[164:167], a[44:47]
    buffer_load_dwordx4 v4, s[44:47], s91 offen offset:1024 sc1 lds
    v_mfma_f32_16x16x32_bf16 a[40:43], a[180:183], v[160:163], a[40:43]
    buffer_load_dwordx4 v4, s[44:47], s91 offen offset:2048 sc1 lds
    v_mfma_f32_16x16x32_bf16 a[48:51], a[184:187], v[160:163], a[48:51]
    s_lshl_b32 s69, s75, 8
    ds_read_b128 a[160:163], v29 offset:24576
    ds_read_b128 a[164:167], v29 offset:25600
    v_mfma_f32_16x16x32_bf16 a[52:55], a[184:187], v[164:167], a[52:55]
PG_9:
    s_cbranch_execz PG_13
    buffer_load_dwordx4 v4, s[44:47], s91 offen offset:3072 sc1 lds
    v_mfma_f32_16x16x32_bf16 a[112:115], a[184:187], v[176:179], a[112:115]
    ds_read_b128 a[168:171], v29 offset:26624
    ds_read_b128 a[172:175], v29 offset:27648
    v_mfma_f32_16x16x32_bf16 a[116:119], a[184:187], v[180:183], a[116:119]
    s_add_u32 s96, s96, s69
    v_mfma_f32_16x16x32_bf16 a[124:127], a[188:191], v[180:183], a[124:127]
    v_max3_f32 v241, v220, v221, v222
    v_max_f32 v241, v241, v223
    v_mfma_f32_16x16x32_bf16 a[120:123], a[188:191], v[176:179], a[120:123]
    v_cmp_nge_f32 vcc, s94, v241
    v_mfma_f32_16x16x32_bf16 a[60:63], a[188:191], v[164:167], a[60:63]
    s_waitcnt lgkmcnt(8)
    v_mfma_f32_16x16x32_bf16 a[56:59], a[188:191], v[160:163], a[56:59]
    s_cbranch_vccnz FIX_D2_0
FIX_D2_0_ret:
    v_add_f32 v240, 0xf4800000, v239
    v_min_f32 v104, v104, v240
    v_mfma_f32_16x16x32_bf16 v[120:123], a[128:131], v[36:39], v[196:199]
    s_lshl_b32 s69, s64, 1
    v_exp_f32 v228, v104
    v_mfma_f32_16x16x32_bf16 v[120:123], a[132:135], v[44:47], v[120:123]
    s_sub_u32 s69, 33, s69
    v_add_f32 v240, 0xf4820000, v239
    v_min_f32 v105, v105, v240
    v_mfma_f32_16x16x32_bf16 v[120:123], a[136:139], v[52:55], v[120:123]
    s_mul_i32 s70, s69, 52
    v_exp_f32 v229, v105
    v_mfma_f32_16x16x32_bf16 v[120:123], a[140:143], v[60:63], v[120:123]
    s_lshr_b32 s70, s70, 8
    ds_read_b128 a[176:179], v29 offset:28672
    v_add_f32 v240, 0xf4840000, v239
    v_mfma_f32_16x16x32_bf16 v[144:147], a[140:143], v[88:91], v[208:211]
    s_mul_i32 s70, s70, 5
    s_addk_i32 m0, 4096
    v_min_f32 v106, v106, v240
    v_mfma_f32_16x16x32_bf16 v[144:147], a[136:139], v[80:83], v[144:147]
    s_add_u32 s92, s92, 32768
    v_exp_f32 v230, v106
    v_mfma_f32_16x16x32_bf16 v[144:147], a[132:135], v[72:75], v[144:147]
    s_sub_u32 s69, s69, s70
    v_add_f32 v240, 0xf4860000, v239
    v_min_f32 v107, v107, v240
    v_mfma_f32_16x16x32_bf16 v[144:147], a[128:131], v[64:67], v[144:147]
    v_exp_f32 v231, v107
    v_mfma_f32_16x16x32_bf16 v[152:155], a[128:131], v[68:71], v[212:215]
    s_lshl_b32 s69, s69, 15
    ds_read_b128 a[180:183], v29 offset:29696
    v_cvt_pk_bf16_f32 v164, v228, v229
    v_mfma_f32_16x16x32_bf16 v[152:155], a[132:135], v[76:79], v[152:155]
    v_add_f32 v240, 0xf4a00000, v239
    v_min_f32 v108, v108, v240
    v_mfma_f32_16x16x32_bf16 v[152:155], a[136:139], v[84:87], v[152:155]
    s_add_u32 s24, s69, s71
    v_exp_f32 v232, v108
    v_mfma_f32_16x16x32_bf16 v[152:155], a[140:143], v[92:95], v[152:155]
    s_waitcnt lgkmcnt(6)
    v_add_f32 v240, 0xf4a20000, v239
    v_min_f32 v109, v109, v240
    v_mfma_f32_16x16x32_bf16 v[156:159], a[156:159], v[92:95], v[212:215]
    s_add_u32 s25, s24, 32768
    v_exp_f32 v233, v109
    v_mfma_f32_16x16x32_bf16 v[156:159], a[152:155], v[84:87], v[156:159]
    ds_read_b128 a[184:187], v29 offset:30720
    v_cvt_pk_bf16_f32 v165, v230, v231
    v_mfma_f32_16x16x32_bf16 v[156:159], a[148:151], v[76:79], v[156:159]
    s_cmp_eq_u32 s92, 163840
    s_cselect_b32 s92, 0, s92
    v_add_f32 v240, 0xf4a40000, v239
    v_mfma_f32_16x16x32_bf16 v[156:159], a[144:147], v[68:71], v[156:159]
    s_cmp_ge_u32 s25, 163840
    s_cselect_b32 s25, s71, s25
    v_min_f32 v110, v110, v240
    v_mfma_f32_16x16x32_bf16 v[148:151], a[144:147], v[64:67], v[208:211]
    v_exp_f32 v234, v110
    v_mfma_f32_16x16x32_bf16 v[148:151], a[148:151], v[72:75], v[148:151]
    s_add_u32 s26, s25, 32768
    ds_read_b128 a[188:191], v29 offset:31744
    v_add_f32 v240, 0xf4a60000, v239
    v_mfma_f32_16x16x32_bf16 v[148:151], a[152:155], v[80:83], v[148:151]
    s_cmp_ge_u32 s26, 163840
    s_cselect_b32 s26, s71, s26
    v_min_f32 v111, v111, v240
    v_mfma_f32_16x16x32_bf16 v[148:151], a[156:159], v[88:91], v[148:151]
    v_add_u32 v29, s92, v22
    v_mfma_f32_16x16x32_bf16 v[124:127], a[156:159], v[60:63], v[196:199]
    v_exp_f32 v235, v111
    v_mfma_f32_16x16x32_bf16 v[124:127], a[152:155], v[52:55], v[124:127]
    v_cvt_pk_bf16_f32 v166, v232, v233
    v_mfma_f32_16x16x32_bf16 v[124:127], a[148:151], v[44:47], v[124:127]
    s_add_u32 s27, s26, 32768
    s_waitcnt vmcnt(12)
    s_barrier
    v_mfma_f32_16x16x32_bf16 v[124:127], a[144:147], v[36:39], v[124:127]
    s_waitcnt lgkmcnt(4)
    v_exp_f32 v228, v128
    v_mfma_f32_16x16x32_bf16 a[0:3], a[160:163], v[168:171], a[0:3]
    v_exp_f32 v229, v129
    v_mfma_f32_16x16x32_bf16 a[4:7], a[160:163], v[172:175], a[4:7]
    ds_read_b128 a[128:131], v29 offset:0
    v_cvt_pk_bf16_f32 v167, v234, v235
    v_mfma_f32_16x16x32_bf16 a[64:67], a[160:163], v[184:187], a[64:67]
    v_exp_f32 v230, v130
    v_mfma_f32_16x16x32_bf16 a[68:71], a[160:163], v[188:191], a[68:71]
    v_exp_f32 v231, v131
    v_mfma_f32_16x16x32_bf16 a[76:79], a[164:167], v[188:191], a[76:79]
    s_cmp_ge_u32 s27, 163840
    s_cselect_b32 s27, s71, s27
    v_cvt_pk_bf16_f32 v176, v228, v229
    v_mfma_f32_16x16x32_bf16 a[72:75], a[164:167], v[184:187], a[72:75]
    s_add_u32 s28, s27, 32768
    v_exp_f32 v232, v132
    v_mfma_f32_16x16x32_bf16 a[12:15], a[164:167], v[172:175], a[12:15]
    v_exp_f32 v233, v133
    v_mfma_f32_16x16x32_bf16 a[8:11], a[164:167], v[168:171], a[8:11]
    ds_read_b128 a[132:135], v29 offset:1024
    v_cvt_pk_bf16_f32 v177, v230, v231
    v_mfma_f32_16x16x32_bf16 a[16:19], a[168:171], v[168:171], a[16:19]
    v_exp_f32 v234, v134
    v_mfma_f32_16x16x32_bf16 a[20:23], a[168:171], v[172:175], a[20:23]
    v_exp_f32 v235, v135
    v_mfma_f32_16x16x32_bf16 a[80:83], a[168:171], v[184:187], a[80:83]
    s_cmp_ge_u32 s28, 163840
    s_cselect_b32 s28, s71, s28
    v_cvt_pk_bf16_f32 v178, v232, v233
    v_mfma_f32_16x16x32_bf16 a[84:87], a[168:171], v[188:191], a[84:87]
    s_lshr_b32 s68, s63, 2
    v_exp_f32 v228, v136
    v_mfma_f32_16x16x32_bf16 a[92:95], a[172:175], v[188:191], a[92:95]
    s_sub_u32 s67, s62, s68
    v_exp_f32 v229, v137
    v_mfma_f32_16x16x32_bf16 a[88:91], a[172:175], v[184:187], a[88:91]
    s_add_u32 s68, s62, s68
    ds_read_b128 a[136:139], v29 offset:2048
    v_cvt_pk_bf16_f32 v179, v234, v235
    v_mfma_f32_16x16x32_bf16 a[28:31], a[172:175], v[172:175], a[28:31]
    s_sub_u32 s68, 3, s68
    v_exp_f32 v230, v138
    v_mfma_f32_16x16x32_bf16 a[24:27], a[172:175], v[168:171], a[24:27]
    s_waitcnt lgkmcnt(3)
    v_exp_f32 v231, v139
    v_mfma_f32_16x16x32_bf16 a[32:35], a[176:179], v[168:171], a[32:35]
    s_and_b32 s67, s67, 3
    ds_read_b128 a[140:143], v29 offset:3072
    v_cvt_pk_bf16_f32 v180, v228, v229
    v_mfma_f32_16x16x32_bf16 a[36:39], a[176:179], v[172:175], a[36:39]
    s_and_b32 s68, s68, 3
    v_exp_f32 v232, v140
    v_mfma_f32_16x16x32_bf16 a[96:99], a[176:179], v[184:187], a[96:99]
    v_exp_f32 v233, v141
    v_mfma_f32_16x16x32_bf16 a[100:103], a[176:179], v[188:191], a[100:103]
    s_add_u32 s68, s68, 4
    v_cvt_pk_bf16_f32 v181, v230, v231
    v_mfma_f32_16x16x32_bf16 a[108:111], a[180:183], v[188:191], a[108:111]
    s_lshl_b32 s80, s63, 5
    v_exp_f32 v234, v142
    v_mfma_f32_16x16x32_bf16 v[216:219], a[244:247], v[164:167], v[220:223]
    v_exp_f32 v235, v143
    v_cvt_pk_bf16_f32 v182, v232, v233
    v_cvt_pk_bf16_f32 v183, v234, v235
    v_mfma_f32_16x16x32_bf16 v[216:219], a[248:251], v[176:179], v[216:219]
    s_add_u32 s80, s80, 34816
    ds_read_b128 a[144:147], v29 offset:4096
    ds_read_b128 a[148:151], v29 offset:5120
    v_mfma_f32_16x16x32_bf16 v[216:219], a[252:255], v[180:183], v[216:219]
    buffer_load_dwordx4 v2, s[44:47], s91 offen offset:0 sc1 lds
    v_mfma_f32_16x16x32_bf16 a[104:107], a[180:183], v[184:187], a[104:107]
    s_add_u32 s67, s67, s80
    ds_read_b128 a[152:155], v29 offset:6144
    ds_read_b128 a[156:159], v29 offset:7168
    v_mfma_f32_16x16x32_bf16 a[44:47], a[180:183], v[172:175], a[44:47]
    buffer_load_dwordx4 v2, s[44:47], s91 offen offset:1024 sc1 lds
    v_mfma_f32_16x16x32_bf16 a[40:43], a[180:183], v[168:171], a[40:43]
    s_add_u32 s68, s68, s80
    ds_read_b128 a[160:163], v29 offset:8192
    ds_read_b128 a[164:167], v29 offset:9216
    v_mfma_f32_16x16x32_bf16 a[48:51], a[184:187], v[168:171], a[48:51]
    ds_read_b128 a[168:171], v29 offset:10240
    v_lshl_add_u32 v28, s67, 10, v22
    v_mfma_f32_16x16x32_bf16 a[52:55], a[184:187], v[172:175], a[52:55]
    buffer_load_dwordx4 v2, s[44:47], s91 offen offset:2048 sc1 lds
    v_mfma_f32_16x16x32_bf16 a[112:115], a[184:187], v[184:187], a[112:115]
    buffer_load_dwordx4 v2, s[44:47], s91 offen offset:3072 sc1 lds
    v_mfma_f32_16x16x32_bf16 a[116:119], a[184:187], v[188:191], a[116:119]
    ds_read_b128 a[172:175], v29 offset:11264
    v_lshl_add_u32 v236, s68, 10, v22
    v_mfma_f32_16x16x32_bf16 a[124:127], a[188:191], v[188:191], a[124:127]
    s_lshl_b32 s80, s64, 20
    v_max3_f32 v241, v217, v218, v219
    v_cmp_nge_f32 vcc, s94, v241
    v_mfma_f32_16x16x32_bf16 a[120:123], a[188:191], v[184:187], a[120:123]
    v_mfma_f32_16x16x32_bf16 a[60:63], a[188:191], v[172:175], a[60:63]
    s_waitcnt lgkmcnt(8)
    v_mfma_f32_16x16x32_bf16 a[56:59], a[188:191], v[168:171], a[56:59]
    s_cbranch_vccnz FIX_D2_1
FIX_D2_1_ret:
    v_mfma_f32_16x16x32_bf16 v[128:131], a[128:131], v[64:67], v[208:211]
    s_add_u32 s91, s91, 32768
    v_add_f32 v240, 0xf4c00000, v239
    v_min_f32 v120, v120, v240
    v_mfma_f32_16x16x32_bf16 v[128:131], a[132:135], v[72:75], v[128:131]
    s_addk_i32 m0, 28672
    v_exp_f32 v228, v120
    v_mfma_f32_16x16x32_bf16 v[128:131], a[136:139], v[80:83], v[128:131]
    ds_read_b128 a[176:179], v29 offset:12288
    v_add_f32 v240, 0xf4c20000, v239
    v_mfma_f32_16x16x32_bf16 v[128:131], a[140:143], v[88:91], v[128:131]
    ds_read_b128 a[180:183], v29 offset:13312
    v_min_f32 v121, v121, v240
    v_mfma_f32_16x16x32_bf16 v[136:139], a[140:143], v[92:95], v[212:215]
    v_exp_f32 v229, v121
    v_mfma_f32_16x16x32_bf16 v[136:139], a[136:139], v[84:87], v[136:139]
    v_add_f32 v240, 0xf4c40000, v239
    v_min_f32 v122, v122, v240
    v_mfma_f32_16x16x32_bf16 v[136:139], a[132:135], v[76:79], v[136:139]
    v_exp_f32 v230, v122
    v_mfma_f32_16x16x32_bf16 v[136:139], a[128:131], v[68:71], v[136:139]
    s_waitcnt lgkmcnt(6)
    v_add_f32 v240, 0xf4c60000, v239
    v_min_f32 v123, v123, v240
    v_mfma_f32_16x16x32_bf16 v[140:143], a[144:147], v[68:71], v[212:215]
    v_exp_f32 v231, v123
    v_mfma_f32_16x16x32_bf16 v[140:143], a[148:151], v[76:79], v[140:143]
    v_cvt_pk_bf16_f32 v172, v228, v229
    v_add_f32 v240, 0xf4e00000, v239
    v_mfma_f32_16x16x32_bf16 v[140:143], a[152:155], v[84:87], v[140:143]
    ds_read_b128 a[184:187], v29 offset:14336
    v_min_f32 v124, v124, v240
    v_mfma_f32_16x16x32_bf16 v[140:143], a[156:159], v[92:95], v[140:143]
    v_exp_f32 v232, v124
    v_mfma_f32_16x16x32_bf16 v[132:135], a[156:159], v[88:91], v[208:211]
    v_add_f32 v240, 0xf4e20000, v239
    v_min_f32 v125, v125, v240
    v_exp_f32 v233, v125
    v_mfma_f32_16x16x32_bf16 v[132:135], a[152:155], v[80:83], v[132:135]
    v_cvt_pk_bf16_f32 v173, v230, v231
    v_add_f32 v240, 0xf4e40000, v239
    v_mfma_f32_16x16x32_bf16 v[132:135], a[148:151], v[72:75], v[132:135]
    ds_read_b128 a[188:191], v29 offset:15360
    v_min_f32 v126, v126, v240
    v_mfma_f32_16x16x32_bf16 v[132:135], a[144:147], v[64:67], v[132:135]
    s_waitcnt lgkmcnt(4)
    v_exp_f32 v234, v126
    v_mfma_f32_16x16x32_bf16 a[4:7], a[160:163], v[164:167], a[4:7]
    v_add_f32 v240, 0xf4e60000, v239
    v_min_f32 v127, v127, v240
    v_exp_f32 v235, v127
    v_mfma_f32_16x16x32_bf16 a[64:67], a[160:163], v[176:179], a[64:67]
    ds_read_b128 a[128:131], v29 offset:16384
    v_cvt_pk_bf16_f32 v174, v232, v233
    v_mfma_f32_16x16x32_bf16 a[68:71], a[160:163], v[180:183], a[68:71]
    v_exp_f32 v228, v144
    v_mfma_f32_16x16x32_bf16 a[76:79], a[164:167], v[180:183], a[76:79]
    v_exp_f32 v229, v145
    v_cvt_pk_bf16_f32 v175, v234, v235
    v_mfma_f32_16x16x32_bf16 a[72:75], a[164:167], v[176:179], a[72:75]
    v_exp_f32 v230, v146
    v_mfma_f32_16x16x32_bf16 a[12:15], a[164:167], v[164:167], a[12:15]
    v_exp_f32 v231, v147
    v_mfma_f32_16x16x32_bf16 a[20:23], a[168:171], v[164:167], a[20:23]
    v_cvt_pk_bf16_f32 v184, v228, v229
    v_exp_f32 v232, v148
    v_mfma_f32_16x16x32_bf16 a[80:83], a[168:171], v[176:179], a[80:83]
    ds_read_b128 a[132:135], v29 offset:17408
    v_exp_f32 v233, v149
    v_mfma_f32_16x16x32_bf16 a[84:87], a[168:171], v[180:183], a[84:87]
    v_cvt_pk_bf16_f32 v185, v230, v231
    v_exp_f32 v234, v150
    v_mfma_f32_16x16x32_bf16 a[92:95], a[172:175], v[180:183], a[92:95]
    v_exp_f32 v235, v151
    v_mfma_f32_16x16x32_bf16 a[88:91], a[172:175], v[176:179], a[88:91]
    v_cvt_pk_bf16_f32 v186, v232, v233
    v_exp_f32 v228, v152
    v_mfma_f32_16x16x32_bf16 a[28:31], a[172:175], v[164:167], a[28:31]
    s_waitcnt lgkmcnt(2)
    ds_read_b128 a[136:139], v29 offset:18432
    v_exp_f32 v229, v153
    v_mfma_f32_16x16x32_bf16 a[36:39], a[176:179], v[164:167], a[36:39]
    s_cmp_eq_u32 m0, s90
    s_cselect_b32 m0, s72, m0
    v_cvt_pk_bf16_f32 v187, v234, v235
    v_mfma_f32_16x16x32_bf16 a[96:99], a[176:179], v[176:179], a[96:99]
    v_exp_f32 v230, v154
    v_exp_f32 v231, v155
    v_mfma_f32_16x16x32_bf16 a[100:103], a[176:179], v[180:183], a[100:103]
    ds_read_b128 a[140:143], v29 offset:19456
    v_cvt_pk_bf16_f32 v188, v228, v229
    v_mfma_f32_16x16x32_bf16 a[108:111], a[180:183], v[180:183], a[108:111]
    v_exp_f32 v232, v156
    v_mfma_f32_16x16x32_bf16 v[220:223], a[244:247], v[172:175], v[216:219]
    v_exp_f32 v233, v157
    v_cvt_pk_bf16_f32 v189, v230, v231
    v_exp_f32 v234, v158
    v_exp_f32 v235, v159
    v_cvt_pk_bf16_f32 v190, v232, v233
    v_cvt_pk_bf16_f32 v191, v234, v235
    v_mfma_f32_16x16x32_bf16 v[220:223], a[248:251], v[184:187], v[220:223]
    buffer_load_dwordx4 v4, s[44:47], s91 offen offset:0 sc1 lds
    v_mfma_f32_16x16x32_bf16 v[220:223], a[252:255], v[188:191], v[220:223]
    buffer_load_dwordx4 v4, s[44:47], s91 offen offset:1024 sc1 lds
    v_mfma_f32_16x16x32_bf16 a[104:107], a[180:183], v[176:179], a[104:107]
    buffer_load_dwordx4 v4, s[44:47], s91 offen offset:2048 sc1 lds
    v_mfma_f32_16x16x32_bf16 a[44:47], a[180:183], v[164:167], a[44:47]
    ds_read_b128 a[144:147], v29 offset:20480
    ds_read_b128 a[148:151], v29 offset:21504
    v_mfma_f32_16x16x32_bf16 a[52:55], a[184:187], v[164:167], a[52:55]
    buffer_load_dwordx4 v4, s[44:47], s91 offen offset:3072 sc1 lds
    v_mfma_f32_16x16x32_bf16 a[112:115], a[184:187], v[176:179], a[112:115]
    ds_read_b128 a[152:155], v29 offset:22528
    ds_read_b128 a[156:159], v29 offset:23552
    v_mfma_f32_16x16x32_bf16 a[116:119], a[184:187], v[180:183], a[116:119]
    v_max3_f32 v241, v221, v222, v223
    v_cmp_nge_f32 vcc, s94, v241
    v_mfma_f32_16x16x32_bf16 a[124:127], a[188:191], v[180:183], a[124:127]
    ds_read_b128 a[160:163], v29 offset:24576
    ds_read_b128 a[164:167], v29 offset:25600
    v_mfma_f32_16x16x32_bf16 a[120:123], a[188:191], v[176:179], a[120:123]
    s_waitcnt lgkmcnt(6)
    ds_read_b128 a[168:171], v29 offset:26624
    ds_read_b128 a[172:175], v29 offset:27648
    v_mfma_f32_16x16x32_bf16 a[60:63], a[188:191], v[164:167], a[60:63]
    s_cbranch_vccnz FIX_D3_0
FIX_D3_0_ret:
    v_min_f32 v128, v128, v247
    v_mfma_f32_16x16x32_bf16 v[144:147], a[128:131], v[64:67], v[208:211]
    s_lshr_b32 s69, s73, 2
    v_exp_f32 v228, v128
    v_mfma_f32_16x16x32_bf16 v[144:147], a[132:135], v[72:75], v[144:147]
    s_lshl_b32 s69, s69, 6
    ds_read_b128 a[176:179], v29 offset:28672
    v_add_f32 v240, 0xf1800000, v247
    v_mfma_f32_16x16x32_bf16 v[144:147], a[136:139], v[80:83], v[144:147]
    s_addk_i32 m0, 4096
    v_min_f32 v129, v129, v240
    v_add_u32 v21, 16, v0
    v_mfma_f32_16x16x32_bf16 v[144:147], a[140:143], v[88:91], v[144:147]
    s_add_u32 s92, s92, 32768
    v_exp_f32 v229, v129
    v_mfma_f32_16x16x32_bf16 v[152:155], a[140:143], v[92:95], v[212:215]
    v_add_f32 v240, 0xf2000000, v247
    v_min_f32 v130, v130, v240
    v_mfma_f32_16x16x32_bf16 v[152:155], a[136:139], v[84:87], v[152:155]
    ds_read_b128 a[180:183], v29 offset:29696
    v_and_b32 v21, 32, v21
    v_mfma_f32_16x16x32_bf16 v[152:155], a[132:135], v[76:79], v[152:155]
    v_exp_f32 v230, v130
    v_mfma_f32_16x16x32_bf16 v[152:155], a[128:131], v[68:71], v[152:155]
    s_waitcnt lgkmcnt(6)
    v_add_f32 v240, 0xf2400000, v247
    v_min_f32 v131, v131, v240
    v_mfma_f32_16x16x32_bf16 v[156:159], a[144:147], v[68:71], v[212:215]
    v_exp_f32 v231, v131
    v_mfma_f32_16x16x32_bf16 v[156:159], a[148:151], v[76:79], v[156:159]
    s_cmp_eq_u32 s92, 163840
    s_cselect_b32 s92, 0, s92
    ds_read_b128 a[184:187], v29 offset:30720
    v_mfma_f32_16x16x32_bf16 v[156:159], a[152:155], v[84:87], v[156:159]
    v_cvt_pk_bf16_f32 v176, v228, v229
    v_add_f32 v240, 0xf3800000, v247
    v_mfma_f32_16x16x32_bf16 v[156:159], a[156:159], v[92:95], v[156:159]
    v_xor_b32 v21, v21, v1
    v_min_f32 v132, v132, v240
    v_mfma_f32_16x16x32_bf16 v[148:151], a[156:159], v[88:91], v[208:211]
    v_exp_f32 v232, v132
    v_mfma_f32_16x16x32_bf16 v[148:151], a[152:155], v[80:83], v[148:151]
    ds_read_b128 a[188:191], v29 offset:31744
    v_add_u32 v21, s69, v21
    v_mfma_f32_16x16x32_bf16 v[148:151], a[148:151], v[72:75], v[148:151]
    v_add_u32 v29, s92, v22
    v_add_f32 v240, 0xf3880000, v247
    v_min_f32 v133, v133, v240
    v_mfma_f32_16x16x32_bf16 v[148:151], a[144:147], v[64:67], v[148:151]
    s_waitcnt vmcnt(12) lgkmcnt(4)
    s_barrier
    v_exp_f32 v233, v133
    v_xor_b32 v23, 64, v21
    v_mfma_f32_16x16x32_bf16 a[4:7], a[160:163], v[172:175], a[4:7]
    s_lshr_b32 s69, s62, 1
    v_cvt_pk_bf16_f32 v177, v230, v231
    v_add_f32 v240, 0xf3900000, v247
    v_mfma_f32_16x16x32_bf16 a[64:67], a[160:163], v[184:187], a[64:67]
    s_lshl_b32 s69, s69, 12
    ds_read_b128 a[128:131], v29 offset:0
    v_min_f32 v134, v134, v240
    v_mfma_f32_16x16x32_bf16 a[68:71], a[160:163], v[188:191], a[68:71]
    s_lshl_b32 s61, s65, 5
    v_exp_f32 v234, v134
    v_mfma_f32_16x16x32_bf16 a[76:79], a[164:167], v[188:191], a[76:79]
    s_add_u32 s61, s61, s66
    v_add_f32 v240, 0xf3980000, v247
    v_min_f32 v135, v135, v240
    v_mfma_f32_16x16x32_bf16 a[72:75], a[164:167], v[184:187], a[72:75]
    s_sub_u32 s69, s69, s71
    v_exp_f32 v235, v135
    v_mfma_f32_16x16x32_bf16 a[12:15], a[164:167], v[172:175], a[12:15]
    s_lshl_b32 s61, s61, 2
    ds_read_b128 a[132:135], v29 offset:1024
    v_cvt_pk_bf16_f32 v178, v232, v233
    v_mfma_f32_16x16x32_bf16 a[20:23], a[168:171], v[172:175], a[20:23]
    s_addk_i32 s61, 6144
    v_exp_f32 v228, v136
    v_mfma_f32_16x16x32_bf16 a[80:83], a[168:171], v[184:187], a[80:83]
    v_exp_f32 v229, v137
    v_mfma_f32_16x16x32_bf16 a[84:87], a[168:171], v[188:191], a[84:87]
    v_cvt_pk_bf16_f32 v179, v234, v235
    v_add_u32 v6, s69, v22
    v_mfma_f32_16x16x32_bf16 a[92:95], a[172:175], v[188:191], a[92:95]
    s_and_b32 s69, s62, 1
    v_exp_f32 v230, v138
    v_mfma_f32_16x16x32_bf16 a[88:91], a[172:175], v[184:187], a[88:91]
    buffer_store_dword v25, v24, s[48:51], s61 offen sc1
    v_exp_f32 v231, v139
    v_mfma_f32_16x16x32_bf16 a[28:31], a[172:175], v[172:175], a[28:31]
    s_waitcnt lgkmcnt(2)
    ds_read_b128 a[136:139], v29 offset:2048
    v_cvt_pk_bf16_f32 v180, v228, v229
    v_mfma_f32_16x16x32_bf16 a[36:39], a[176:179], v[172:175], a[36:39]
    s_lshl_b32 s69, s69, 11
    v_exp_f32 v232, v140
    v_mfma_f32_16x16x32_bf16 a[96:99], a[176:179], v[184:187], a[96:99]
    s_lshr_b32 s60, s63, 2
    v_exp_f32 v233, v141
    v_mfma_f32_16x16x32_bf16 a[100:103], a[176:179], v[188:191], a[100:103]
    s_sub_u32 s69, s69, s71
    ds_read_b128 a[140:143], v29 offset:3072
    v_cvt_pk_bf16_f32 v181, v230, v231
    v_mfma_f32_16x16x32_bf16 a[108:111], a[180:183], v[188:191], a[108:111]
    s_lshl_b32 s60, s60, 3
    v_exp_f32 v234, v142
    v_exp_f32 v235, v143
    v_cvt_pk_bf16_f32 v182, v232, v233
    v_cvt_pk_bf16_f32 v183, v234, v235
    v_mfma_f32_16x16x32_bf16 v[216:219], a[248:251], v[176:179], v[220:223]
    s_add_u32 s60, s60, s64
    s_lshl_b32 s60, s60, 7
    v_lshrrev_b32 v30, 2, v0
    v_mfma_f32_16x16x32_bf16 v[216:219], a[252:255], v[180:183], v[216:219]
    s_add_u32 s61, s60, 8192
    v_lshl_add_u32 v7, v30, 6, s69
    v_and_b32 v30, 3, v0
    v_mfma_f32_16x16x32_bf16 a[104:107], a[180:183], v[184:187], a[104:107]
    s_and_b32 s60, s63, 3
    s_lshl_b32 s60, s60, 2
    v_lshl_add_u32 v7, v30, 3, v7
    v_mfma_f32_16x16x32_bf16 a[44:47], a[180:183], v[172:175], a[44:47]
    buffer_load_dwordx4 v2, s[44:47], s91 offen offset:0 sc1 lds
    v_mfma_f32_16x16x32_bf16 a[52:55], a[184:187], v[172:175], a[52:55]
    buffer_load_dwordx4 v2, s[44:47], s91 offen offset:1024 sc1 lds
    v_mfma_f32_16x16x32_bf16 a[112:115], a[184:187], v[184:187], a[112:115]
    buffer_load_dwordx4 v2, s[44:47], s91 offen offset:2048 sc1 lds
    v_mfma_f32_16x16x32_bf16 a[116:119], a[184:187], v[188:191], a[116:119]
    s_add_u32 s60, s60, s61
    v_max_f32 v241, v218, v219
    v_cmp_nge_f32 vcc, s94, v241
    v_mfma_f32_16x16x32_bf16 a[124:127], a[188:191], v[188:191], a[124:127]
    buffer_load_dwordx4 v2, s[44:47], s91 offen offset:3072 sc1 lds
    v_mfma_f32_16x16x32_bf16 a[120:123], a[188:191], v[184:187], a[120:123]
    s_waitcnt lgkmcnt(0)
    ds_read_b128 a[144:147], v29 offset:4096
    ds_read_b128 a[148:151], v29 offset:5120
    ds_read_b128 a[152:155], v29 offset:6144
    ds_read_b128 a[156:159], v29 offset:7168
    ds_read_b128 a[160:163], v29 offset:8192
    ds_read_b128 a[164:167], v29 offset:9216
    ds_read_b128 a[168:171], v29 offset:10240
    ds_read_b128 a[172:175], v29 offset:11264
    v_bfe_u32 v30, v0, 4, 1
    v_mfma_f32_16x16x32_bf16 a[60:63], a[188:191], v[172:175], a[60:63]
    s_cbranch_vccnz FIX_D3_1
FIX_D3_1_ret:
    v_and_b32 v26, 3, v0
    v_lshlrev_b32 v26, 2, v26
    v_lshl_add_u32 v7, v30, 5, v7
    v_ldexp_f32 v240, v216, 52
    v_ldexp_f32 v241, v217, 52
    v_rcp_f32 v240, v240
    v_rcp_f32 v241, v241
    v_accvgpr_read_b32 v32, a0
    v_accvgpr_read_b32 v33, a1
    v_accvgpr_read_b32 v34, a2
    v_accvgpr_read_b32 v35, a3
    v_accvgpr_read_b32 v36, a8
    v_accvgpr_read_b32 v37, a9
    v_accvgpr_read_b32 v38, a10
    v_accvgpr_read_b32 v39, a11
    v_pk_mul_f32 v[32:33], v[32:33], v[240:241] op_sel:[0,0] op_sel_hi:[1,0]
    v_pk_mul_f32 v[34:35], v[34:35], v[240:241] op_sel:[0,0] op_sel_hi:[1,0]
    v_pk_mul_f32 v[36:37], v[36:37], v[240:241] op_sel:[0,0] op_sel_hi:[1,0]
    v_pk_mul_f32 v[38:39], v[38:39], v[240:241] op_sel:[0,0] op_sel_hi:[1,0]
    v_cvt_pk_bf16_f32 v40, v32, v33
    v_cvt_pk_bf16_f32 v41, v34, v35
    v_cvt_pk_bf16_f32 v42, v36, v37
    v_cvt_pk_bf16_f32 v43, v38, v39
    buffer_store_dwordx4 v[40:43], v28, s[40:43], s80 offen sc1
    v_accvgpr_read_b32 v44, a4
    v_accvgpr_read_b32 v45, a5
    v_accvgpr_read_b32 v46, a6
    v_accvgpr_read_b32 v47, a7
    v_accvgpr_read_b32 v48, a12
    v_accvgpr_read_b32 v49, a13
    v_accvgpr_read_b32 v50, a14
    v_accvgpr_read_b32 v51, a15
    v_pk_mul_f32 v[44:45], v[44:45], v[240:241] op_sel:[0,1] op_sel_hi:[1,1]
    v_pk_mul_f32 v[46:47], v[46:47], v[240:241] op_sel:[0,1] op_sel_hi:[1,1]
    v_pk_mul_f32 v[48:49], v[48:49], v[240:241] op_sel:[0,1] op_sel_hi:[1,1]
    v_pk_mul_f32 v[50:51], v[50:51], v[240:241] op_sel:[0,1] op_sel_hi:[1,1]
    v_cvt_pk_bf16_f32 v52, v44, v45
    v_cvt_pk_bf16_f32 v53, v46, v47
    v_cvt_pk_bf16_f32 v54, v48, v49
    v_cvt_pk_bf16_f32 v55, v50, v51
    buffer_store_dwordx4 v[52:55], v236, s[40:43], s80 offen sc1
    s_addk_i32 s80, 8192
    v_accvgpr_read_b32 v32, a16
    v_accvgpr_read_b32 v33, a17
    v_accvgpr_read_b32 v34, a18
    v_accvgpr_read_b32 v35, a19
    v_accvgpr_read_b32 v36, a24
    v_accvgpr_read_b32 v37, a25
    v_accvgpr_read_b32 v38, a26
    v_accvgpr_read_b32 v39, a27
    v_pk_mul_f32 v[32:33], v[32:33], v[240:241] op_sel:[0,0] op_sel_hi:[1,0]
    v_pk_mul_f32 v[34:35], v[34:35], v[240:241] op_sel:[0,0] op_sel_hi:[1,0]
    v_pk_mul_f32 v[36:37], v[36:37], v[240:241] op_sel:[0,0] op_sel_hi:[1,0]
    v_pk_mul_f32 v[38:39], v[38:39], v[240:241] op_sel:[0,0] op_sel_hi:[1,0]
    v_cvt_pk_bf16_f32 v40, v32, v33
    v_cvt_pk_bf16_f32 v41, v34, v35
    v_cvt_pk_bf16_f32 v42, v36, v37
    v_cvt_pk_bf16_f32 v43, v38, v39
    buffer_store_dwordx4 v[40:43], v28, s[40:43], s80 offen sc1
    v_accvgpr_read_b32 v44, a20
    v_accvgpr_read_b32 v45, a21
    v_accvgpr_read_b32 v46, a22
    v_accvgpr_read_b32 v47, a23
    v_accvgpr_read_b32 v48, a28
    v_accvgpr_read_b32 v49, a29
    v_accvgpr_read_b32 v50, a30
    v_accvgpr_read_b32 v51, a31
    v_pk_mul_f32 v[44:45], v[44:45], v[240:241] op_sel:[0,1] op_sel_hi:[1,1]
    v_pk_mul_f32 v[46:47], v[46:47], v[240:241] op_sel:[0,1] op_sel_hi:[1,1]
    v_pk_mul_f32 v[48:49], v[48:49], v[240:241] op_sel:[0,1] op_sel_hi:[1,1]
    v_pk_mul_f32 v[50:51], v[50:51], v[240:241] op_sel:[0,1] op_sel_hi:[1,1]
    v_cvt_pk_bf16_f32 v52, v44, v45
    v_cvt_pk_bf16_f32 v53, v46, v47
    v_cvt_pk_bf16_f32 v54, v48, v49
    v_cvt_pk_bf16_f32 v55, v50, v51
    buffer_store_dwordx4 v[52:55], v236, s[40:43], s80 offen sc1
    s_addk_i32 s80, 8192
    v_accvgpr_read_b32 v32, a32
    v_accvgpr_read_b32 v33, a33
    v_accvgpr_read_b32 v34, a34
    v_accvgpr_read_b32 v35, a35
    v_accvgpr_read_b32 v36, a40
    v_accvgpr_read_b32 v37, a41
    v_accvgpr_read_b32 v38, a42
    v_accvgpr_read_b32 v39, a43
    v_pk_mul_f32 v[32:33], v[32:33], v[240:241] op_sel:[0,0] op_sel_hi:[1,0]
    v_pk_mul_f32 v[34:35], v[34:35], v[240:241] op_sel:[0,0] op_sel_hi:[1,0]
    v_pk_mul_f32 v[36:37], v[36:37], v[240:241] op_sel:[0,0] op_sel_hi:[1,0]
    v_pk_mul_f32 v[38:39], v[38:39], v[240:241] op_sel:[0,0] op_sel_hi:[1,0]
    v_cvt_pk_bf16_f32 v40, v32, v33
    v_cvt_pk_bf16_f32 v41, v34, v35
    v_cvt_pk_bf16_f32 v42, v36, v37
    v_cvt_pk_bf16_f32 v43, v38, v39
    buffer_store_dwordx4 v[40:43], v28, s[40:43], s80 offen sc1
    v_accvgpr_read_b32 v44, a36
    v_accvgpr_read_b32 v45, a37
    v_accvgpr_read_b32 v46, a38
    v_accvgpr_read_b32 v47, a39
    v_accvgpr_read_b32 v48, a44
    v_accvgpr_read_b32 v49, a45
    v_accvgpr_read_b32 v50, a46
    v_accvgpr_read_b32 v51, a47
    v_pk_mul_f32 v[44:45], v[44:45], v[240:241] op_sel:[0,1] op_sel_hi:[1,1]
    v_pk_mul_f32 v[46:47], v[46:47], v[240:241] op_sel:[0,1] op_sel_hi:[1,1]
    v_pk_mul_f32 v[48:49], v[48:49], v[240:241] op_sel:[0,1] op_sel_hi:[1,1]
    v_pk_mul_f32 v[50:51], v[50:51], v[240:241] op_sel:[0,1] op_sel_hi:[1,1]
    v_cvt_pk_bf16_f32 v52, v44, v45
    v_cvt_pk_bf16_f32 v53, v46, v47
    v_cvt_pk_bf16_f32 v54, v48, v49
    v_cvt_pk_bf16_f32 v55, v50, v51
    buffer_store_dwordx4 v[52:55], v236, s[40:43], s80 offen sc1
    s_addk_i32 s80, 8192
    v_accvgpr_read_b32 v32, a48
    v_accvgpr_read_b32 v33, a49
    v_accvgpr_read_b32 v34, a50
    v_accvgpr_read_b32 v35, a51
    v_accvgpr_read_b32 v36, a56
    v_accvgpr_read_b32 v37, a57
    v_accvgpr_read_b32 v38, a58
    v_accvgpr_read_b32 v39, a59
    v_pk_mul_f32 v[32:33], v[32:33], v[240:241] op_sel:[0,0] op_sel_hi:[1,0]
    v_pk_mul_f32 v[34:35], v[34:35], v[240:241] op_sel:[0,0] op_sel_hi:[1,0]
    v_pk_mul_f32 v[36:37], v[36:37], v[240:241] op_sel:[0,0] op_sel_hi:[1,0]
    v_pk_mul_f32 v[38:39], v[38:39], v[240:241] op_sel:[0,0] op_sel_hi:[1,0]
    v_cvt_pk_bf16_f32 v40, v32, v33
    v_cvt_pk_bf16_f32 v41, v34, v35
    v_cvt_pk_bf16_f32 v42, v36, v37
    v_cvt_pk_bf16_f32 v43, v38, v39
    buffer_store_dwordx4 v[40:43], v28, s[40:43], s80 offen sc1
    v_accvgpr_read_b32 v44, a52
    v_accvgpr_read_b32 v45, a53
    v_accvgpr_read_b32 v46, a54
    v_accvgpr_read_b32 v47, a55
    v_accvgpr_read_b32 v48, a60
    v_accvgpr_read_b32 v49, a61
    v_accvgpr_read_b32 v50, a62
    v_accvgpr_read_b32 v51, a63
    v_pk_mul_f32 v[44:45], v[44:45], v[240:241] op_sel:[0,1] op_sel_hi:[1,1]
PG_10:
    s_cbranch_execz PG_14
    v_pk_mul_f32 v[46:47], v[46:47], v[240:241] op_sel:[0,1] op_sel_hi:[1,1]
    v_pk_mul_f32 v[48:49], v[48:49], v[240:241] op_sel:[0,1] op_sel_hi:[1,1]
    v_pk_mul_f32 v[50:51], v[50:51], v[240:241] op_sel:[0,1] op_sel_hi:[1,1]
    v_cvt_pk_bf16_f32 v52, v44, v45
    v_cvt_pk_bf16_f32 v53, v46, v47
    v_cvt_pk_bf16_f32 v54, v48, v49
    v_cvt_pk_bf16_f32 v55, v50, v51
    buffer_store_dwordx4 v[52:55], v236, s[40:43], s80 offen sc1
    s_cmp_eq_u32 s64, 7
    s_cbranch_scc1 ATT_I7
    s_lshl_b32 s93, s64, 2
    s_sub_u32 s93, 26, s93
    s_waitcnt lgkmcnt(0)
.p2align 6
ATT_SL:
    v_mfma_f32_16x16x32_bf16 v[128:131], a[128:131], v[64:67], v[208:211]
    s_add_u32 s91, s91, 32768
    v_exp_f32 v228, v144
    v_mfma_f32_16x16x32_bf16 v[128:131], a[132:135], v[72:75], v[128:131]
    s_addk_i32 m0, 28672
    v_exp_f32 v229, v145
    v_mfma_f32_16x16x32_bf16 v[128:131], a[136:139], v[80:83], v[128:131]
    s_cmp_eq_u32 m0, s90
    ds_read_b128 a[176:179], v29 offset:12288
    v_cvt_pk_bf16_f32 v184, v228, v229
    v_mfma_f32_16x16x32_bf16 v[128:131], a[140:143], v[88:91], v[128:131]
    s_cselect_b32 m0, s72, m0
    v_exp_f32 v230, v146
    v_mfma_f32_16x16x32_bf16 v[136:139], a[140:143], v[92:95], v[212:215]
    s_add_u32 s92, s92, 32768
    v_exp_f32 v231, v147
    v_mfma_f32_16x16x32_bf16 v[136:139], a[136:139], v[84:87], v[136:139]
    s_cmp_eq_u32 s92, 163840
    ds_read_b128 a[180:183], v29 offset:13312
    v_cvt_pk_bf16_f32 v185, v230, v231
    v_mfma_f32_16x16x32_bf16 v[136:139], a[132:135], v[76:79], v[136:139]
    s_cselect_b32 s92, 0, s92
    v_exp_f32 v232, v148
    v_mfma_f32_16x16x32_bf16 v[136:139], a[128:131], v[68:71], v[136:139]
    s_waitcnt lgkmcnt(6)
    v_exp_f32 v233, v149
    v_mfma_f32_16x16x32_bf16 v[140:143], a[144:147], v[68:71], v[212:215]
    ds_read_b128 a[184:187], v29 offset:14336
    v_cvt_pk_bf16_f32 v186, v232, v233
    v_mfma_f32_16x16x32_bf16 v[140:143], a[148:151], v[76:79], v[140:143]
    v_exp_f32 v234, v150
    v_mfma_f32_16x16x32_bf16 v[140:143], a[152:155], v[84:87], v[140:143]
    v_exp_f32 v235, v151
    v_mfma_f32_16x16x32_bf16 v[140:143], a[156:159], v[92:95], v[140:143]
    ds_read_b128 a[188:191], v29 offset:15360
    v_cvt_pk_bf16_f32 v187, v234, v235
    v_mfma_f32_16x16x32_bf16 v[132:135], a[156:159], v[88:91], v[208:211]
    v_exp_f32 v228, v152
    v_mfma_f32_16x16x32_bf16 v[132:135], a[152:155], v[80:83], v[132:135]
    v_exp_f32 v229, v153
    v_mfma_f32_16x16x32_bf16 v[132:135], a[148:151], v[72:75], v[132:135]
    ds_read_b128 a[128:131], v29 offset:16384
    v_cvt_pk_bf16_f32 v188, v228, v229
    v_mfma_f32_16x16x32_bf16 v[132:135], a[144:147], v[64:67], v[132:135]
    s_waitcnt lgkmcnt(5)
    v_exp_f32 v230, v154
    v_mfma_f32_16x16x32_bf16 a[64:67], a[160:163], v[176:179], a[64:67]
    v_exp_f32 v231, v155
    v_mfma_f32_16x16x32_bf16 a[68:71], a[160:163], v[180:183], a[68:71]
    ds_read_b128 a[132:135], v29 offset:17408
    v_cvt_pk_bf16_f32 v189, v230, v231
    v_mfma_f32_16x16x32_bf16 a[76:79], a[164:167], v[180:183], a[76:79]
    v_exp_f32 v232, v156
    v_mfma_f32_16x16x32_bf16 a[72:75], a[164:167], v[176:179], a[72:75]
    v_exp_f32 v233, v157
    v_mfma_f32_16x16x32_bf16 a[80:83], a[168:171], v[176:179], a[80:83]
    ds_read_b128 a[136:139], v29 offset:18432
    v_cvt_pk_bf16_f32 v190, v232, v233
    v_mfma_f32_16x16x32_bf16 a[84:87], a[168:171], v[180:183], a[84:87]
    v_exp_f32 v234, v158
    v_mfma_f32_16x16x32_bf16 a[92:95], a[172:175], v[180:183], a[92:95]
    v_exp_f32 v235, v159
    v_mfma_f32_16x16x32_bf16 a[88:91], a[172:175], v[176:179], a[88:91]
    s_waitcnt lgkmcnt(3)
    ds_read_b128 a[140:143], v29 offset:19456
    v_cvt_pk_bf16_f32 v191, v234, v235
    v_mfma_f32_16x16x32_bf16 v[220:223], a[248:251], v[184:187], v[216:219]
    buffer_load_dwordx4 v4, s[44:47], s91 offen offset:0 sc1 lds
    v_mfma_f32_16x16x32_bf16 v[220:223], a[252:255], v[188:191], v[220:223]
    ds_read_b128 a[144:147], v29 offset:20480
    ds_read_b128 a[148:151], v29 offset:21504
    v_mfma_f32_16x16x32_bf16 a[96:99], a[176:179], v[176:179], a[96:99]
    buffer_load_dwordx4 v4, s[44:47], s91 offen offset:1024 sc1 lds
    v_mfma_f32_16x16x32_bf16 a[100:103], a[176:179], v[180:183], a[100:103]
    ds_read_b128 a[152:155], v29 offset:22528
    ds_read_b128 a[156:159], v29 offset:23552
    v_mfma_f32_16x16x32_bf16 a[108:111], a[180:183], v[180:183], a[108:111]
    buffer_load_dwordx4 v4, s[44:47], s91 offen offset:2048 sc1 lds
    v_mfma_f32_16x16x32_bf16 a[104:107], a[180:183], v[176:179], a[104:107]
    ds_read_b128 a[160:163], v29 offset:24576
    ds_read_b128 a[164:167], v29 offset:25600
    v_mfma_f32_16x16x32_bf16 a[112:115], a[184:187], v[176:179], a[112:115]
    v_max_f32 v241, v222, v223
    v_cmp_nge_f32 vcc, s94, v241
    v_mfma_f32_16x16x32_bf16 a[116:119], a[184:187], v[180:183], a[116:119]
    buffer_load_dwordx4 v4, s[44:47], s91 offen offset:3072 sc1 lds
    v_mfma_f32_16x16x32_bf16 a[124:127], a[188:191], v[180:183], a[124:127]
    s_waitcnt lgkmcnt(6)
    ds_read_b128 a[168:171], v29 offset:26624
    ds_read_b128 a[172:175], v29 offset:27648
    v_mfma_f32_16x16x32_bf16 a[120:123], a[188:191], v[176:179], a[120:123]
    s_cbranch_vccnz FIX_SL_0
FIX_SL_0_ret:
    v_exp_f32 v228, v128
    v_mfma_f32_16x16x32_bf16 v[144:147], a[128:131], v[64:67], v[208:211]
    s_addk_i32 m0, 4096
    v_exp_f32 v229, v129
    v_mfma_f32_16x16x32_bf16 v[144:147], a[132:135], v[72:75], v[144:147]
    ds_read_b128 a[176:179], v29 offset:28672
    v_cvt_pk_bf16_f32 v176, v228, v229
    v_mfma_f32_16x16x32_bf16 v[144:147], a[136:139], v[80:83], v[144:147]
    v_exp_f32 v230, v130
    v_mfma_f32_16x16x32_bf16 v[144:147], a[140:143], v[88:91], v[144:147]
    v_exp_f32 v231, v131
    v_mfma_f32_16x16x32_bf16 v[152:155], a[140:143], v[92:95], v[212:215]
    ds_read_b128 a[180:183], v29 offset:29696
    v_cvt_pk_bf16_f32 v177, v230, v231
    v_mfma_f32_16x16x32_bf16 v[152:155], a[136:139], v[84:87], v[152:155]
    v_exp_f32 v232, v132
    v_mfma_f32_16x16x32_bf16 v[152:155], a[132:135], v[76:79], v[152:155]
    v_exp_f32 v233, v133
    v_mfma_f32_16x16x32_bf16 v[152:155], a[128:131], v[68:71], v[152:155]
    s_waitcnt lgkmcnt(6)
    ds_read_b128 a[184:187], v29 offset:30720
    v_cvt_pk_bf16_f32 v178, v232, v233
    v_mfma_f32_16x16x32_bf16 v[156:159], a[144:147], v[68:71], v[212:215]
    v_exp_f32 v234, v134
    v_mfma_f32_16x16x32_bf16 v[156:159], a[148:151], v[76:79], v[156:159]
    v_exp_f32 v235, v135
    v_mfma_f32_16x16x32_bf16 v[156:159], a[152:155], v[84:87], v[156:159]
    ds_read_b128 a[188:191], v29 offset:31744
    v_cvt_pk_bf16_f32 v179, v234, v235
    v_mfma_f32_16x16x32_bf16 v[156:159], a[156:159], v[92:95], v[156:159]
    s_waitcnt vmcnt(12)
    s_barrier
    v_add_u32 v29, s92, v22
    v_mfma_f32_16x16x32_bf16 v[148:151], a[156:159], v[88:91], v[208:211]
    v_exp_f32 v228, v136
    v_mfma_f32_16x16x32_bf16 v[148:151], a[152:155], v[80:83], v[148:151]
    v_exp_f32 v229, v137
    v_mfma_f32_16x16x32_bf16 v[148:151], a[148:151], v[72:75], v[148:151]
    ds_read_b128 a[128:131], v29 offset:0
    v_cvt_pk_bf16_f32 v180, v228, v229
    v_mfma_f32_16x16x32_bf16 v[148:151], a[144:147], v[64:67], v[148:151]
    s_waitcnt lgkmcnt(5)
    v_exp_f32 v230, v138
    v_mfma_f32_16x16x32_bf16 a[64:67], a[160:163], v[184:187], a[64:67]
    v_exp_f32 v231, v139
    v_mfma_f32_16x16x32_bf16 a[68:71], a[160:163], v[188:191], a[68:71]
    ds_read_b128 a[132:135], v29 offset:1024
    v_cvt_pk_bf16_f32 v181, v230, v231
    v_mfma_f32_16x16x32_bf16 a[76:79], a[164:167], v[188:191], a[76:79]
    v_exp_f32 v232, v140
    v_mfma_f32_16x16x32_bf16 a[72:75], a[164:167], v[184:187], a[72:75]
    v_exp_f32 v233, v141
    v_mfma_f32_16x16x32_bf16 a[80:83], a[168:171], v[184:187], a[80:83]
    ds_read_b128 a[136:139], v29 offset:2048
    v_cvt_pk_bf16_f32 v182, v232, v233
    v_mfma_f32_16x16x32_bf16 a[84:87], a[168:171], v[188:191], a[84:87]
    v_exp_f32 v234, v142
    v_mfma_f32_16x16x32_bf16 a[92:95], a[172:175], v[188:191], a[92:95]
    v_exp_f32 v235, v143
    v_mfma_f32_16x16x32_bf16 a[88:91], a[172:175], v[184:187], a[88:91]
    s_waitcnt lgkmcnt(3)
    ds_read_b128 a[140:143], v29 offset:3072
    v_cvt_pk_bf16_f32 v183, v234, v235
    v_mfma_f32_16x16x32_bf16 v[216:219], a[248:251], v[176:179], v[220:223]
    buffer_load_dwordx4 v2, s[44:47], s91 offen offset:0 sc1 lds
    v_mfma_f32_16x16x32_bf16 v[216:219], a[252:255], v[180:183], v[216:219]
    ds_read_b128 a[144:147], v29 offset:4096
    ds_read_b128 a[148:151], v29 offset:5120
    v_mfma_f32_16x16x32_bf16 a[96:99], a[176:179], v[184:187], a[96:99]
    buffer_load_dwordx4 v2, s[44:47], s91 offen offset:1024 sc1 lds
    v_mfma_f32_16x16x32_bf16 a[100:103], a[176:179], v[188:191], a[100:103]
    ds_read_b128 a[152:155], v29 offset:6144
    ds_read_b128 a[156:159], v29 offset:7168
    v_mfma_f32_16x16x32_bf16 a[108:111], a[180:183], v[188:191], a[108:111]
    buffer_load_dwordx4 v2, s[44:47], s91 offen offset:2048 sc1 lds
    v_mfma_f32_16x16x32_bf16 a[104:107], a[180:183], v[184:187], a[104:107]
    s_sub_u32 s93, s93, 1
    ds_read_b128 a[160:163], v29 offset:8192
    ds_read_b128 a[164:167], v29 offset:9216
    v_mfma_f32_16x16x32_bf16 a[112:115], a[184:187], v[184:187], a[112:115]
    v_max_f32 v241, v218, v219
    v_cmp_nge_f32 vcc, s94, v241
    v_mfma_f32_16x16x32_bf16 a[116:119], a[184:187], v[188:191], a[116:119]
    buffer_load_dwordx4 v2, s[44:47], s91 offen offset:3072 sc1 lds
    v_mfma_f32_16x16x32_bf16 a[124:127], a[188:191], v[188:191], a[124:127]
    s_waitcnt lgkmcnt(6)
    ds_read_b128 a[168:171], v29 offset:10240
    ds_read_b128 a[172:175], v29 offset:11264
    v_mfma_f32_16x16x32_bf16 a[120:123], a[188:191], v[184:187], a[120:123]
    s_cbranch_vccnz FIX_SL_1
FIX_SL_1_ret:
    s_cbranch_scc0 ATT_SL
    v_mfma_f32_16x16x32_bf16 v[128:131], a[128:131], v[64:67], v[208:211]
    s_add_u32 s92, s92, 32768
    ds_read_b128 a[176:179], v29 offset:12288
    v_mfma_f32_16x16x32_bf16 v[128:131], a[132:135], v[72:75], v[128:131]
    v_exp_f32 v228, v144
    v_mfma_f32_16x16x32_bf16 v[128:131], a[136:139], v[80:83], v[128:131]
    v_exp_f32 v229, v145
    v_mfma_f32_16x16x32_bf16 v[128:131], a[140:143], v[88:91], v[128:131]
    s_cmp_eq_u32 s92, 163840
    s_cselect_b32 s92, 0, s92
    ds_read_b128 a[180:183], v29 offset:13312
    v_mfma_f32_16x16x32_bf16 v[136:139], a[140:143], v[92:95], v[212:215]
    v_exp_f32 v230, v146
    v_mfma_f32_16x16x32_bf16 v[136:139], a[136:139], v[84:87], v[136:139]
    v_exp_f32 v231, v147
    v_mfma_f32_16x16x32_bf16 v[136:139], a[132:135], v[76:79], v[136:139]
    ds_read_b128 a[184:187], v29 offset:14336
    v_cvt_pk_bf16_f32 v184, v228, v229
    v_mfma_f32_16x16x32_bf16 v[136:139], a[128:131], v[68:71], v[136:139]
    s_waitcnt lgkmcnt(7)
    v_exp_f32 v232, v148
    v_mfma_f32_16x16x32_bf16 v[140:143], a[144:147], v[68:71], v[212:215]
    buffer_store_dword v25, v24, s[48:51], s60 offen offset:0 sc1
    v_mfma_f32_16x16x32_bf16 v[140:143], a[148:151], v[76:79], v[140:143]
    s_add_u32 s79, s99, s96
    v_exp_f32 v233, v149
    v_mfma_f32_16x16x32_bf16 v[140:143], a[152:155], v[84:87], v[140:143]
    s_add_u32 m0, s24, 0
    ds_read_b128 a[188:191], v29 offset:15360
    v_cvt_pk_bf16_f32 v185, v230, v231
    v_mfma_f32_16x16x32_bf16 v[140:143], a[156:159], v[92:95], v[140:143]
    v_exp_f32 v234, v150
    v_mfma_f32_16x16x32_bf16 v[132:135], a[156:159], v[88:91], v[208:211]
    v_exp_f32 v235, v151
    v_mfma_f32_16x16x32_bf16 v[132:135], a[152:155], v[80:83], v[132:135]
    ds_read_b128 a[128:131], v29 offset:16384
    v_cvt_pk_bf16_f32 v186, v232, v233
    v_mfma_f32_16x16x32_bf16 v[132:135], a[148:151], v[72:75], v[132:135]
    buffer_load_dwordx4 v21, s[32:35], s79 offen lds
    v_exp_f32 v228, v152
    v_mfma_f32_16x16x32_bf16 v[132:135], a[144:147], v[64:67], v[132:135]
    s_waitcnt lgkmcnt(5)
    v_exp_f32 v229, v153
    v_mfma_f32_16x16x32_bf16 a[64:67], a[160:163], v[176:179], a[64:67]
    s_addk_i32 m0, 1024
    ds_read_b128 a[132:135], v29 offset:17408
    v_cvt_pk_bf16_f32 v187, v234, v235
    v_mfma_f32_16x16x32_bf16 a[68:71], a[160:163], v[180:183], a[68:71]
    v_exp_f32 v230, v154
    v_mfma_f32_16x16x32_bf16 a[76:79], a[164:167], v[180:183], a[76:79]
    buffer_load_dwordx4 v23, s[32:35], s79 offen lds
    v_exp_f32 v231, v155
    v_mfma_f32_16x16x32_bf16 a[72:75], a[164:167], v[176:179], a[72:75]
    s_addk_i32 m0, 896
    ds_read_b128 a[136:139], v29 offset:18432
    v_cvt_pk_bf16_f32 v188, v228, v229
    v_mfma_f32_16x16x32_bf16 a[80:83], a[168:171], v[176:179], a[80:83]
    v_exp_f32 v232, v156
    v_mfma_f32_16x16x32_bf16 a[84:87], a[168:171], v[180:183], a[84:87]
    v_exp_f32 v233, v157
    v_mfma_f32_16x16x32_bf16 a[92:95], a[172:175], v[180:183], a[92:95]
    buffer_load_dwordx4 v21, s[32:35], s79 offen offset:128 lds
    ds_read_b128 a[140:143], v29 offset:19456
    v_cvt_pk_bf16_f32 v189, v230, v231
    v_mfma_f32_16x16x32_bf16 a[88:91], a[172:175], v[176:179], a[88:91]
    v_exp_f32 v234, v158
    v_exp_f32 v235, v159
    v_cvt_pk_bf16_f32 v190, v232, v233
    v_cvt_pk_bf16_f32 v191, v234, v235
    v_mfma_f32_16x16x32_bf16 v[220:223], a[248:251], v[184:187], v[216:219]
    s_addk_i32 m0, 1024
    ds_read_b128 a[144:147], v29 offset:20480
    ds_read_b128 a[148:151], v29 offset:21504
    v_mfma_f32_16x16x32_bf16 v[220:223], a[252:255], v[188:191], v[220:223]
    s_waitcnt lgkmcnt(6)
    ds_read_b128 a[152:155], v29 offset:22528
    ds_read_b128 a[156:159], v29 offset:23552
    v_mfma_f32_16x16x32_bf16 a[96:99], a[176:179], v[176:179], a[96:99]
    buffer_load_dwordx4 v23, s[32:35], s79 offen offset:128 lds
    v_mfma_f32_16x16x32_bf16 a[100:103], a[176:179], v[180:183], a[100:103]
    s_add_u32 s99, s99, 65536
    s_and_b32 s99, s99, 524287
    ds_read_b128 a[160:163], v29 offset:24576
    v_mfma_f32_16x16x32_bf16 a[108:111], a[180:183], v[180:183], a[108:111]
    s_add_u32 s79, s99, s96
    ds_read_b128 a[164:167], v29 offset:25600
    ds_read_b128 a[168:171], v29 offset:26624
    v_mfma_f32_16x16x32_bf16 a[104:107], a[180:183], v[176:179], a[104:107]
    s_addk_i32 m0, 13440
    ds_read_b128 a[172:175], v29 offset:27648
    v_mfma_f32_16x16x32_bf16 a[112:115], a[184:187], v[176:179], a[112:115]
    v_max_f32 v241, v222, v223
    v_cmp_nge_f32 vcc, s94, v241
    v_mfma_f32_16x16x32_bf16 a[116:119], a[184:187], v[180:183], a[116:119]
    buffer_load_dwordx4 v21, s[32:35], s79 offen lds
    v_mfma_f32_16x16x32_bf16 a[124:127], a[188:191], v[180:183], a[124:127]
    s_waitcnt lgkmcnt(8)
    s_addk_i32 m0, 1024
    v_mfma_f32_16x16x32_bf16 a[120:123], a[188:191], v[176:179], a[120:123]
    s_cbranch_vccnz FIX_S1_0
FIX_S1_0_ret:
    v_min_f32 v128, v128, v238
    v_mfma_f32_16x16x32_bf16 v[144:147], a[128:131], v[64:67], v[208:211]
    v_exp_f32 v228, v128
    v_mfma_f32_16x16x32_bf16 v[144:147], a[132:135], v[72:75], v[144:147]
    ds_read_b128 a[176:179], v29 offset:28672
    v_add_f32 v240, 0xf1800000, v238
    v_mfma_f32_16x16x32_bf16 v[144:147], a[136:139], v[80:83], v[144:147]
    ds_read_b128 a[180:183], v29 offset:29696
    v_min_f32 v129, v129, v240
    v_mfma_f32_16x16x32_bf16 v[144:147], a[140:143], v[88:91], v[144:147]
    v_exp_f32 v229, v129
    v_mfma_f32_16x16x32_bf16 v[152:155], a[140:143], v[92:95], v[212:215]
    buffer_load_dwordx4 v23, s[32:35], s79 offen lds
    v_mfma_f32_16x16x32_bf16 v[152:155], a[136:139], v[84:87], v[152:155]
    s_add_u32 m0, s24, 18304
    v_add_f32 v240, 0xf2000000, v238
    v_min_f32 v130, v130, v240
    v_mfma_f32_16x16x32_bf16 v[152:155], a[132:135], v[76:79], v[152:155]
    v_exp_f32 v230, v130
    v_mfma_f32_16x16x32_bf16 v[152:155], a[128:131], v[68:71], v[152:155]
    s_waitcnt lgkmcnt(6)
    v_add_f32 v240, 0xf2400000, v238
    v_min_f32 v131, v131, v240
    v_exp_f32 v231, v131
    v_mfma_f32_16x16x32_bf16 v[156:159], a[144:147], v[68:71], v[212:215]
    ds_read_b128 a[184:187], v29 offset:30720
    v_cvt_pk_bf16_f32 v176, v228, v229
    v_mfma_f32_16x16x32_bf16 v[156:159], a[148:151], v[76:79], v[156:159]
    buffer_load_dwordx4 v21, s[32:35], s79 offen offset:128 lds
    v_add_f32 v240, 0xf3800000, v238
    v_min_f32 v132, v132, v240
    v_mfma_f32_16x16x32_bf16 v[156:159], a[152:155], v[84:87], v[156:159]
    s_addk_i32 m0, 1024
    ds_read_b128 a[188:191], v29 offset:31744
    buffer_load_dwordx4 v23, s[32:35], s79 offen offset:128 lds
    v_add_u32 v29, s92, v22
    v_exp_f32 v232, v132
    v_mfma_f32_16x16x32_bf16 v[156:159], a[156:159], v[92:95], v[156:159]
    s_waitcnt vmcnt(16)
    s_barrier
    v_add_f32 v240, 0xf3880000, v238
    v_min_f32 v133, v133, v240
    v_mfma_f32_16x16x32_bf16 v[148:151], a[156:159], v[88:91], v[208:211]
    v_exp_f32 v233, v133
    v_cvt_pk_bf16_f32 v177, v230, v231
    v_mfma_f32_16x16x32_bf16 v[148:151], a[152:155], v[80:83], v[148:151]
    v_add_f32 v240, 0xf3900000, v238
    v_min_f32 v134, v134, v240
    v_mfma_f32_16x16x32_bf16 v[148:151], a[148:151], v[72:75], v[148:151]
    ds_read_b128 a[128:131], v29 offset:0
    v_exp_f32 v234, v134
    v_mfma_f32_16x16x32_bf16 v[148:151], a[144:147], v[64:67], v[148:151]
    s_waitcnt lgkmcnt(5)
    v_add_f32 v240, 0xf3980000, v238
    v_min_f32 v135, v135, v240
    v_mfma_f32_16x16x32_bf16 a[64:67], a[160:163], v[184:187], a[64:67]
    v_exp_f32 v235, v135
    v_mfma_f32_16x16x32_bf16 a[68:71], a[160:163], v[188:191], a[68:71]
    ds_read_b128 a[132:135], v29 offset:1024
    v_cvt_pk_bf16_f32 v178, v232, v233
    v_exp_f32 v228, v136
    v_mfma_f32_16x16x32_bf16 a[76:79], a[164:167], v[188:191], a[76:79]
    v_exp_f32 v229, v137
    v_mfma_f32_16x16x32_bf16 a[72:75], a[164:167], v[184:187], a[72:75]
    v_cvt_pk_bf16_f32 v179, v234, v235
    v_exp_f32 v230, v138
    v_mfma_f32_16x16x32_bf16 a[80:83], a[168:171], v[184:187], a[80:83]
    ds_read_b128 a[136:139], v29 offset:2048
    v_exp_f32 v231, v139
    v_mfma_f32_16x16x32_bf16 a[84:87], a[168:171], v[188:191], a[84:87]
    ds_read_b128 a[140:143], v29 offset:3072
    v_cvt_pk_bf16_f32 v180, v228, v229
    v_mfma_f32_16x16x32_bf16 a[92:95], a[172:175], v[188:191], a[92:95]
    v_exp_f32 v232, v140
    v_exp_f32 v233, v141
    v_mfma_f32_16x16x32_bf16 a[88:91], a[172:175], v[184:187], a[88:91]
    v_cvt_pk_bf16_f32 v181, v230, v231
    v_exp_f32 v234, v142
    v_exp_f32 v235, v143
    v_cvt_pk_bf16_f32 v182, v232, v233
    v_cvt_pk_bf16_f32 v183, v234, v235
    v_mfma_f32_16x16x32_bf16 v[216:219], a[248:251], v[176:179], v[220:223]
    ds_read_b128 a[144:147], v29 offset:4096
    ds_read_b128 a[148:151], v29 offset:5120
    v_mfma_f32_16x16x32_bf16 v[216:219], a[252:255], v[180:183], v[216:219]
    s_waitcnt lgkmcnt(6)
    ds_read_b128 a[152:155], v29 offset:6144
    ds_read_b128 a[156:159], v29 offset:7168
    v_mfma_f32_16x16x32_bf16 a[96:99], a[176:179], v[184:187], a[96:99]
    ds_read_b128 a[160:163], v29 offset:8192
    ds_read_b128 a[164:167], v29 offset:9216
    v_mfma_f32_16x16x32_bf16 a[100:103], a[176:179], v[188:191], a[100:103]
    ds_read_b128 a[168:171], v29 offset:10240
    ds_read_b128 a[172:175], v29 offset:11264
    v_mfma_f32_16x16x32_bf16 a[108:111], a[180:183], v[188:191], a[108:111]
    v_mfma_f32_16x16x32_bf16 a[104:107], a[180:183], v[184:187], a[104:107]
    v_mfma_f32_16x16x32_bf16 a[112:115], a[184:187], v[184:187], a[112:115]
    v_max_f32 v241, v218, v219
    v_cmp_nge_f32 vcc, s94, v241
    v_mfma_f32_16x16x32_bf16 a[116:119], a[184:187], v[188:191], a[116:119]
    v_mfma_f32_16x16x32_bf16 a[124:127], a[188:191], v[188:191], a[124:127]
    s_waitcnt lgkmcnt(8)
    v_mfma_f32_16x16x32_bf16 a[120:123], a[188:191], v[184:187], a[120:123]
    s_cbranch_vccnz FIX_S1_1
FIX_S1_1_ret:
ATT_S2:
    v_mfma_f32_16x16x32_bf16 v[136:139], a[128:131], v[68:71], v[212:215]
    s_add_u32 s92, s92, 32768
    ds_read_b128 a[176:179], v29 offset:12288
    v_add_f32 v240, 0xf4000000, v238
    v_mfma_f32_16x16x32_bf16 v[136:139], a[132:135], v[76:79], v[136:139]
    ds_read_b128 a[180:183], v29 offset:13312
    v_min_f32 v144, v144, v240
    v_mfma_f32_16x16x32_bf16 v[136:139], a[136:139], v[84:87], v[136:139]
    v_exp_f32 v228, v144
    v_mfma_f32_16x16x32_bf16 v[136:139], a[140:143], v[92:95], v[136:139]
    s_waitcnt lgkmcnt(6)
    v_add_f32 v240, 0xf4040000, v238
    v_min_f32 v145, v145, v240
    v_mfma_f32_16x16x32_bf16 v[140:143], a[156:159], v[92:95], v[212:215]
    v_exp_f32 v229, v145
    v_mfma_f32_16x16x32_bf16 v[140:143], a[152:155], v[84:87], v[140:143]
    s_cmp_eq_u32 s92, 163840
    s_cselect_b32 s92, 0, s92
    ds_read_b128 a[184:187], v29 offset:14336
    v_add_f32 v240, 0xf4080000, v238
    v_min_f32 v146, v146, v240
    v_exp_f32 v230, v146
    v_mfma_f32_16x16x32_bf16 v[140:143], a[148:151], v[76:79], v[140:143]
    s_add_u32 s99, s99, 65536
    v_add_f32 v240, 0xf40c0000, v238
    v_min_f32 v147, v147, v240
    v_mfma_f32_16x16x32_bf16 v[140:143], a[144:147], v[68:71], v[140:143]
    s_waitcnt lgkmcnt(3)
    ds_read_b128 a[188:191], v29 offset:15360
    v_exp_f32 v231, v147
    v_cvt_pk_bf16_f32 v184, v228, v229
    v_add_f32 v240, 0xf4400000, v238
    v_mfma_f32_16x16x32_bf16 a[64:67], a[160:163], v[176:179], a[64:67]
    s_and_b32 s99, s99, 524287
    v_min_f32 v148, v148, v240
    v_exp_f32 v232, v148
    v_mfma_f32_16x16x32_bf16 a[68:71], a[160:163], v[180:183], a[68:71]
    s_add_u32 s79, s99, s96
    ds_read_b128 a[128:131], v29 offset:16384
    v_add_f32 v240, 0xf4440000, v238
    v_min_f32 v149, v149, v240
    v_exp_f32 v233, v149
    v_mfma_f32_16x16x32_bf16 a[76:79], a[164:167], v[180:183], a[76:79]
    s_add_u32 m0, s25, 0
    v_cvt_pk_bf16_f32 v185, v230, v231
    v_add_f32 v240, 0xf4480000, v238
    v_min_f32 v150, v150, v240
    v_mfma_f32_16x16x32_bf16 a[72:75], a[164:167], v[176:179], a[72:75]
    buffer_load_dwordx4 v21, s[32:35], s79 offen lds
    ds_read_b128 a[132:135], v29 offset:17408
    v_exp_f32 v234, v150
    v_add_f32 v240, 0xf44c0000, v238
    v_min_f32 v151, v151, v240
    v_mfma_f32_16x16x32_bf16 a[80:83], a[168:171], v[176:179], a[80:83]
    v_exp_f32 v235, v151
    v_cvt_pk_bf16_f32 v186, v232, v233
    v_mfma_f32_16x16x32_bf16 a[84:87], a[168:171], v[180:183], a[84:87]
    s_addk_i32 m0, 1024
    ds_read_b128 a[136:139], v29 offset:18432
    v_exp_f32 v228, v152
    v_exp_f32 v229, v153
    v_mfma_f32_16x16x32_bf16 a[92:95], a[172:175], v[180:183], a[92:95]
    buffer_load_dwordx4 v23, s[32:35], s79 offen lds
    ds_read_b128 a[140:143], v29 offset:19456
    v_cvt_pk_bf16_f32 v187, v234, v235
    v_exp_f32 v230, v154
    v_mfma_f32_16x16x32_bf16 a[88:91], a[172:175], v[176:179], a[88:91]
    v_exp_f32 v231, v155
    v_cvt_pk_bf16_f32 v188, v228, v229
    v_exp_f32 v232, v156
    v_exp_f32 v233, v157
    v_cvt_pk_bf16_f32 v189, v230, v231
    v_exp_f32 v234, v158
    v_exp_f32 v235, v159
    v_cvt_pk_bf16_f32 v190, v232, v233
    v_cvt_pk_bf16_f32 v191, v234, v235
    v_mfma_f32_16x16x32_bf16 v[220:223], a[248:251], v[184:187], v[216:219]
    s_addk_i32 m0, 896
    ds_read_b128 a[144:147], v29 offset:20480
    ds_read_b128 a[148:151], v29 offset:21504
    v_mfma_f32_16x16x32_bf16 v[220:223], a[252:255], v[188:191], v[220:223]
    s_waitcnt lgkmcnt(6)
    buffer_load_dwordx4 v21, s[32:35], s79 offen offset:128 lds
    v_mfma_f32_16x16x32_bf16 a[96:99], a[176:179], v[176:179], a[96:99]
    s_addk_i32 m0, 1024
    ds_read_b128 a[152:155], v29 offset:22528
    ds_read_b128 a[156:159], v29 offset:23552
    v_mfma_f32_16x16x32_bf16 a[100:103], a[176:179], v[180:183], a[100:103]
    ds_read_b128 a[160:163], v29 offset:24576
    ds_read_b128 a[164:167], v29 offset:25600
    v_mfma_f32_16x16x32_bf16 a[108:111], a[180:183], v[180:183], a[108:111]
    buffer_load_dwordx4 v23, s[32:35], s79 offen offset:128 lds
    v_mfma_f32_16x16x32_bf16 a[104:107], a[180:183], v[176:179], a[104:107]
    buffer_load_dword v27, v26, s[48:51], s61 offen sc1
    v_mfma_f32_16x16x32_bf16 a[112:115], a[184:187], v[176:179], a[112:115]
    s_add_u32 s99, s99, 65536
    v_max_f32 v241, v222, v223
    v_cmp_nge_f32 vcc, s94, v241
    v_mfma_f32_16x16x32_bf16 a[116:119], a[184:187], v[180:183], a[116:119]
    s_and_b32 s99, s99, 524287
    ds_read_b128 a[168:171], v29 offset:26624
    ds_read_b128 a[172:175], v29 offset:27648
    v_mfma_f32_16x16x32_bf16 a[124:127], a[188:191], v[180:183], a[124:127]
    s_waitcnt lgkmcnt(8)
    s_add_u32 s79, s99, s96
    s_addk_i32 m0, 13440
    v_mfma_f32_16x16x32_bf16 a[120:123], a[188:191], v[176:179], a[120:123]
    s_cbranch_vccnz FIX_S2_0
FIX_S2_0_ret:
    v_add_f32 v240, 0xf4800000, v239
    v_min_f32 v136, v136, v240
    v_mfma_f32_16x16x32_bf16 v[152:155], a[128:131], v[68:71], v[212:215]
    buffer_load_dwordx4 v21, s[32:35], s79 offen lds
    v_mfma_f32_16x16x32_bf16 v[152:155], a[132:135], v[76:79], v[152:155]
    s_add_u32 m0, s25, 17408
    ds_read_b128 a[176:179], v29 offset:28672
    ds_read_b128 a[180:183], v29 offset:29696
    v_mfma_f32_16x16x32_bf16 v[152:155], a[136:139], v[84:87], v[152:155]
    v_exp_f32 v228, v136
    v_mfma_f32_16x16x32_bf16 v[152:155], a[140:143], v[92:95], v[152:155]
    s_waitcnt lgkmcnt(6)
    v_add_f32 v240, 0xf4820000, v239
    v_min_f32 v137, v137, v240
    v_mfma_f32_16x16x32_bf16 v[156:159], a[156:159], v[92:95], v[212:215]
    buffer_load_dwordx4 v23, s[32:35], s79 offen lds
    v_exp_f32 v229, v137
    v_mfma_f32_16x16x32_bf16 v[156:159], a[152:155], v[84:87], v[156:159]
    s_addk_i32 m0, 896
    ds_read_b128 a[184:187], v29 offset:30720
    v_add_f32 v240, 0xf4840000, v239
    v_mfma_f32_16x16x32_bf16 v[156:159], a[148:151], v[76:79], v[156:159]
    buffer_load_dwordx4 v21, s[32:35], s79 offen offset:128 lds
    ds_read_b128 a[188:191], v29 offset:31744
    s_addk_i32 m0, 1024
    s_nop 0
    buffer_load_dwordx4 v23, s[32:35], s79 offen offset:128 lds
    v_add_u32 v29, s92, v22
    v_min_f32 v138, v138, v240
    v_exp_f32 v230, v138
    v_mfma_f32_16x16x32_bf16 v[156:159], a[144:147], v[68:71], v[156:159]
    s_waitcnt lgkmcnt(4)
POLL_A:
    s_waitcnt vmcnt(4)
    v_cmp_ne_u32 vcc, s83, v27
    s_nop 0
    s_cbranch_vccnz SPIN_A
POLLOK_A:
    s_waitcnt vmcnt(9)
    s_barrier
    v_add_f32 v240, 0xf4860000, v239
    v_min_f32 v139, v139, v240
    v_mfma_f32_16x16x32_bf16 a[64:67], a[160:163], v[184:187], a[64:67]
    s_add_u32 s79, s78, s101
    v_exp_f32 v231, v139
    v_mfma_f32_16x16x32_bf16 a[68:71], a[160:163], v[188:191], a[68:71]
    ds_read_b128 a[128:131], v29 offset:8192
    v_cvt_pk_bf16_f32 v180, v228, v229
    v_add_f32 v240, 0xf4a00000, v239
    v_mfma_f32_16x16x32_bf16 a[76:79], a[164:167], v[188:191], a[76:79]
    v_min_f32 v140, v140, v240
    v_exp_f32 v232, v140
    v_mfma_f32_16x16x32_bf16 a[72:75], a[164:167], v[184:187], a[72:75]
    ds_read_b128 a[132:135], v29 offset:9216
    v_add_f32 v240, 0xf4a20000, v239
    v_min_f32 v141, v141, v240
    v_mfma_f32_16x16x32_bf16 a[80:83], a[168:171], v[184:187], a[80:83]
    s_add_u32 m0, s26, 0
    v_exp_f32 v233, v141
    v_mfma_f32_16x16x32_bf16 a[84:87], a[168:171], v[188:191], a[84:87]
    buffer_load_dwordx4 v22, s[40:43], s79 offen sc1 lds
    ds_read_b128 a[136:139], v29 offset:10240
    v_cvt_pk_bf16_f32 v181, v230, v231
    v_add_f32 v240, 0xf4a40000, v239
    v_mfma_f32_16x16x32_bf16 a[92:95], a[172:175], v[188:191], a[92:95]
    ds_read_b128 a[140:143], v29 offset:11264
    v_min_f32 v142, v142, v240
    v_exp_f32 v234, v142
    v_add_f32 v240, 0xf4a60000, v239
    v_min_f32 v143, v143, v240
    v_exp_f32 v235, v143
    v_cvt_pk_bf16_f32 v182, v232, v233
    v_cvt_pk_bf16_f32 v183, v234, v235
    v_mfma_f32_16x16x32_bf16 a[88:91], a[172:175], v[184:187], a[88:91]
    buffer_load_dwordx4 v22, s[40:43], s79 offen offset:1024 sc1 lds
    v_mfma_f32_16x16x32_bf16 v[216:219], a[252:255], v[180:183], v[220:223]
    s_waitcnt lgkmcnt(4)
    buffer_load_dwordx4 v22, s[40:43], s79 offen offset:2048 sc1 lds
    v_mfma_f32_16x16x32_bf16 a[96:99], a[176:179], v[184:187], a[96:99]
    buffer_load_dwordx4 v22, s[40:43], s79 offen offset:3072 sc1 lds
    v_mfma_f32_16x16x32_bf16 a[100:103], a[176:179], v[188:191], a[100:103]
    s_addk_i32 s101, 16384
    s_and_b32 s101, s101, 131071
    s_add_u32 s79, s78, s101
    v_mfma_f32_16x16x32_bf16 a[108:111], a[180:183], v[188:191], a[108:111]
    s_addk_i32 m0, 16384
    ds_read_b128 a[144:147], v29 offset:12288
    ds_read_b128 a[148:151], v29 offset:13312
    v_mfma_f32_16x16x32_bf16 a[104:107], a[180:183], v[184:187], a[104:107]
    ds_read_b128 a[152:155], v29 offset:14336
    ds_read_b128 a[156:159], v29 offset:15360
    v_mfma_f32_16x16x32_bf16 a[112:115], a[184:187], v[184:187], a[112:115]
    buffer_load_dwordx4 v22, s[40:43], s79 offen sc1 lds
    v_mfma_f32_16x16x32_bf16 a[116:119], a[184:187], v[188:191], a[116:119]
    ds_read_b128 a[160:163], v29 offset:24576
    v_cmp_nge_f32 vcc, s94, v219
    v_mfma_f32_16x16x32_bf16 a[124:127], a[188:191], v[188:191], a[124:127]
    s_waitcnt lgkmcnt(5)
    ds_read_b128 a[164:167], v29 offset:25600
    ds_read_b128 a[168:171], v29 offset:26624
    ds_read_b128 a[172:175], v29 offset:27648
    v_mfma_f32_16x16x32_bf16 a[120:123], a[188:191], v[184:187], a[120:123]
PG_11:
    s_cbranch_execz PG_done
    s_cbranch_vccnz FIX_S2_1
FIX_S2_1_ret:
    buffer_load_dwordx4 v22, s[40:43], s79 offen offset:1024 sc1 lds
    buffer_load_dwordx4 v22, s[40:43], s79 offen offset:2048 sc1 lds
    buffer_load_dwordx4 v22, s[40:43], s79 offen offset:3072 sc1 lds
    v_mfma_f32_16x16x32_bf16 a[68:71], a[128:131], v[180:183], a[68:71]
    ds_read_b128 a[176:179], v29 offset:28672
    v_add_f32 v240, 0xf4c00000, v239
    v_mfma_f32_16x16x32_bf16 a[76:79], a[132:135], v[180:183], a[76:79]
    ds_read_b128 a[180:183], v29 offset:29696
    v_min_f32 v152, v152, v240
    v_mfma_f32_16x16x32_bf16 a[84:87], a[136:139], v[180:183], a[84:87]
    v_exp_f32 v228, v152
    v_mfma_f32_16x16x32_bf16 a[92:95], a[140:143], v[180:183], a[92:95]
    s_waitcnt lgkmcnt(6)
    v_add_f32 v240, 0xf4c20000, v239
    v_min_f32 v153, v153, v240
    v_exp_f32 v229, v153
    v_add_f32 v240, 0xf4c40000, v239
    v_min_f32 v154, v154, v240
    v_exp_f32 v230, v154
    v_add_f32 v240, 0xf4c60000, v239
    v_min_f32 v155, v155, v240
    v_exp_f32 v231, v155
    v_cvt_pk_bf16_f32 v188, v228, v229
    v_add_f32 v240, 0xf4e00000, v239
    v_min_f32 v156, v156, v240
    v_exp_f32 v232, v156
    v_add_f32 v240, 0xf4e20000, v239
    v_min_f32 v157, v157, v240
    v_exp_f32 v233, v157
    v_cvt_pk_bf16_f32 v189, v230, v231
    v_add_f32 v240, 0xf4e40000, v239
    v_min_f32 v158, v158, v240
    v_exp_f32 v234, v158
    v_add_f32 v240, 0xf4e60000, v239
    v_min_f32 v159, v159, v240
    v_exp_f32 v235, v159
    v_cvt_pk_bf16_f32 v190, v232, v233
    v_cvt_pk_bf16_f32 v191, v234, v235
    v_mfma_f32_16x16x32_bf16 a[100:103], a[144:147], v[180:183], a[100:103]
    ds_read_b128 a[184:187], v29 offset:30720
    ds_read_b128 a[188:191], v29 offset:31744
    v_mfma_f32_16x16x32_bf16 v[220:223], a[252:255], v[188:191], v[216:219]
    v_mfma_f32_16x16x32_bf16 a[108:111], a[148:151], v[180:183], a[108:111]
    s_nop 6
    v_cmp_nge_f32 vcc, s94, v223
    v_mfma_f32_16x16x32_bf16 a[116:119], a[152:155], v[180:183], a[116:119]
    s_waitcnt lgkmcnt(4)
    v_mfma_f32_16x16x32_bf16 a[124:127], a[156:159], v[180:183], a[124:127]
    s_cbranch_vccnz FIX_S3_0
FIX_S3_0_ret:
    v_mfma_f32_16x16x32_bf16 a[68:71], a[160:163], v[188:191], a[68:71]
    v_add_u32 v192, s24, v6
    v_add_u32 v197, s24, v7
    v_mfma_f32_16x16x32_bf16 a[76:79], a[164:167], v[188:191], a[76:79]
    v_xor_b32 v202, 32, v197
    v_add_u32 v193, s25, v6
    v_mfma_f32_16x16x32_bf16 a[84:87], a[168:171], v[188:191], a[84:87]
    v_add_u32 v198, s25, v7
    v_xor_b32 v203, 32, v198
    v_mfma_f32_16x16x32_bf16 a[92:95], a[172:175], v[188:191], a[92:95]
    s_waitcnt lgkmcnt(0)
    v_add_u32 v194, s26, v6
    v_add_u32 v199, s26, v7
    v_mfma_f32_16x16x32_bf16 a[100:103], a[176:179], v[188:191], a[100:103]
    v_xor_b32 v204, 32, v199
    v_add_u32 v195, s27, v6
    v_mfma_f32_16x16x32_bf16 a[108:111], a[180:183], v[188:191], a[108:111]
    v_add_u32 v200, s27, v7
    v_xor_b32 v205, 32, v200
    v_mfma_f32_16x16x32_bf16 a[116:119], a[184:187], v[188:191], a[116:119]
    v_add_u32 v196, s28, v6
    v_add_u32 v201, s28, v7
    v_mfma_f32_16x16x32_bf16 a[124:127], a[188:191], v[188:191], a[124:127]
    v_xor_b32 v206, 32, v201
    s_barrier
    s_load_dwordx2 s[4:5], s[0:1], 120
    s_load_dwordx2 s[8:9], s[0:1], 64
    s_lshl_b32 s80, s64, 20
    s_sub_u32 s80, 15728640, s80
    v_ldexp_f32 v240, v222, 52
    v_ldexp_f32 v241, v223, 52
    v_rcp_f32 v240, v240
    v_rcp_f32 v241, v241
    v_accvgpr_read_b32 v96, a64
    v_accvgpr_read_b32 v97, a65
    v_accvgpr_read_b32 v98, a66
    v_accvgpr_read_b32 v99, a67
    v_accvgpr_read_b32 v100, a72
    v_accvgpr_read_b32 v101, a73
    v_accvgpr_read_b32 v102, a74
    v_accvgpr_read_b32 v103, a75
    v_pk_mul_f32 v[96:97], v[96:97], v[240:241] op_sel:[0,0] op_sel_hi:[1,0]
    v_pk_mul_f32 v[98:99], v[98:99], v[240:241] op_sel:[0,0] op_sel_hi:[1,0]
    v_pk_mul_f32 v[100:101], v[100:101], v[240:241] op_sel:[0,0] op_sel_hi:[1,0]
    v_pk_mul_f32 v[102:103], v[102:103], v[240:241] op_sel:[0,0] op_sel_hi:[1,0]
    v_cvt_pk_bf16_f32 v112, v96, v97
    v_cvt_pk_bf16_f32 v113, v98, v99
    v_cvt_pk_bf16_f32 v114, v100, v101
    v_cvt_pk_bf16_f32 v115, v102, v103
    buffer_store_dwordx4 v[112:115], v28, s[40:43], s80 offen sc1
    v_accvgpr_read_b32 v104, a68
    v_accvgpr_read_b32 v105, a69
    v_accvgpr_read_b32 v106, a70
    v_accvgpr_read_b32 v107, a71
    v_accvgpr_read_b32 v108, a76
    v_accvgpr_read_b32 v109, a77
    v_accvgpr_read_b32 v110, a78
    v_accvgpr_read_b32 v111, a79
    v_pk_mul_f32 v[104:105], v[104:105], v[240:241] op_sel:[0,1] op_sel_hi:[1,1]
    v_pk_mul_f32 v[106:107], v[106:107], v[240:241] op_sel:[0,1] op_sel_hi:[1,1]
    v_pk_mul_f32 v[108:109], v[108:109], v[240:241] op_sel:[0,1] op_sel_hi:[1,1]
    v_pk_mul_f32 v[110:111], v[110:111], v[240:241] op_sel:[0,1] op_sel_hi:[1,1]
    v_cvt_pk_bf16_f32 v116, v104, v105
    v_cvt_pk_bf16_f32 v117, v106, v107
    v_cvt_pk_bf16_f32 v118, v108, v109
    v_cvt_pk_bf16_f32 v119, v110, v111
    buffer_store_dwordx4 v[116:119], v236, s[40:43], s80 offen sc1
    s_addk_i32 s80, 8192
    v_accvgpr_read_b32 v96, a80
    v_accvgpr_read_b32 v97, a81
    v_accvgpr_read_b32 v98, a82
    v_accvgpr_read_b32 v99, a83
    v_accvgpr_read_b32 v100, a88
    v_accvgpr_read_b32 v101, a89
    v_accvgpr_read_b32 v102, a90
    v_accvgpr_read_b32 v103, a91
    v_pk_mul_f32 v[96:97], v[96:97], v[240:241] op_sel:[0,0] op_sel_hi:[1,0]
    v_pk_mul_f32 v[98:99], v[98:99], v[240:241] op_sel:[0,0] op_sel_hi:[1,0]
    v_pk_mul_f32 v[100:101], v[100:101], v[240:241] op_sel:[0,0] op_sel_hi:[1,0]
    v_pk_mul_f32 v[102:103], v[102:103], v[240:241] op_sel:[0,0] op_sel_hi:[1,0]
    v_cvt_pk_bf16_f32 v120, v96, v97
    v_cvt_pk_bf16_f32 v121, v98, v99
    v_cvt_pk_bf16_f32 v122, v100, v101
    v_cvt_pk_bf16_f32 v123, v102, v103
    buffer_store_dwordx4 v[120:123], v28, s[40:43], s80 offen sc1
    v_accvgpr_read_b32 v104, a84
    v_accvgpr_read_b32 v105, a85
    v_accvgpr_read_b32 v106, a86
    s_addk_i32 s101, 16384
    s_and_b32 s101, s101, 131071
    s_add_u32 s79, s78, s101
    s_add_u32 m0, s27, 0
    s_nop 0
    buffer_load_dwordx4 v22, s[40:43], s79 offen sc1 lds
    v_accvgpr_read_b32 v107, a87
    v_accvgpr_read_b32 v108, a92
    v_accvgpr_read_b32 v109, a93
    v_accvgpr_read_b32 v110, a94
    v_accvgpr_read_b32 v111, a95
    v_pk_mul_f32 v[104:105], v[104:105], v[240:241] op_sel:[0,1] op_sel_hi:[1,1]
    v_pk_mul_f32 v[106:107], v[106:107], v[240:241] op_sel:[0,1] op_sel_hi:[1,1]
    v_pk_mul_f32 v[108:109], v[108:109], v[240:241] op_sel:[0,1] op_sel_hi:[1,1]
    v_pk_mul_f32 v[110:111], v[110:111], v[240:241] op_sel:[0,1] op_sel_hi:[1,1]
    v_cvt_pk_bf16_f32 v124, v104, v105
    v_cvt_pk_bf16_f32 v125, v106, v107
    v_cvt_pk_bf16_f32 v126, v108, v109
    v_cvt_pk_bf16_f32 v127, v110, v111
    buffer_store_dwordx4 v[124:127], v236, s[40:43], s80 offen sc1
    s_addk_i32 s80, 8192
    v_accvgpr_read_b32 v96, a96
    v_accvgpr_read_b32 v97, a97
    v_accvgpr_read_b32 v98, a98
    v_accvgpr_read_b32 v99, a99
    v_accvgpr_read_b32 v100, a104
    v_accvgpr_read_b32 v101, a105
    buffer_load_dwordx4 v22, s[40:43], s79 offen offset:1024 sc1 lds
    v_accvgpr_read_b32 v102, a106
    v_accvgpr_read_b32 v103, a107
    v_pk_mul_f32 v[96:97], v[96:97], v[240:241] op_sel:[0,0] op_sel_hi:[1,0]
    v_pk_mul_f32 v[98:99], v[98:99], v[240:241] op_sel:[0,0] op_sel_hi:[1,0]
    v_pk_mul_f32 v[100:101], v[100:101], v[240:241] op_sel:[0,0] op_sel_hi:[1,0]
    v_pk_mul_f32 v[102:103], v[102:103], v[240:241] op_sel:[0,0] op_sel_hi:[1,0]
    v_cvt_pk_bf16_f32 v128, v96, v97
    v_cvt_pk_bf16_f32 v129, v98, v99
    v_cvt_pk_bf16_f32 v130, v100, v101
    v_cvt_pk_bf16_f32 v131, v102, v103
    buffer_store_dwordx4 v[128:131], v28, s[40:43], s80 offen sc1
    v_accvgpr_read_b32 v104, a100
    v_accvgpr_read_b32 v105, a101
    v_accvgpr_read_b32 v106, a102
    v_accvgpr_read_b32 v107, a103
    v_accvgpr_read_b32 v108, a108
    v_accvgpr_read_b32 v109, a109
    v_accvgpr_read_b32 v110, a110
    v_accvgpr_read_b32 v111, a111
    v_pk_mul_f32 v[104:105], v[104:105], v[240:241] op_sel:[0,1] op_sel_hi:[1,1]
    v_pk_mul_f32 v[106:107], v[106:107], v[240:241] op_sel:[0,1] op_sel_hi:[1,1]
    buffer_load_dwordx4 v22, s[40:43], s79 offen offset:2048 sc1 lds
    v_pk_mul_f32 v[108:109], v[108:109], v[240:241] op_sel:[0,1] op_sel_hi:[1,1]
    v_pk_mul_f32 v[110:111], v[110:111], v[240:241] op_sel:[0,1] op_sel_hi:[1,1]
    v_cvt_pk_bf16_f32 v132, v104, v105
    v_cvt_pk_bf16_f32 v133, v106, v107
    v_cvt_pk_bf16_f32 v134, v108, v109
    v_cvt_pk_bf16_f32 v135, v110, v111
    buffer_store_dwordx4 v[132:135], v236, s[40:43], s80 offen sc1
    s_addk_i32 s80, 8192
    v_accvgpr_read_b32 v96, a112
    v_accvgpr_read_b32 v97, a113
    v_accvgpr_read_b32 v98, a114
    v_accvgpr_read_b32 v99, a115
    v_accvgpr_read_b32 v100, a120
    v_accvgpr_read_b32 v101, a121
    v_accvgpr_read_b32 v102, a122
    v_accvgpr_read_b32 v103, a123
    v_pk_mul_f32 v[96:97], v[96:97], v[240:241] op_sel:[0,0] op_sel_hi:[1,0]
    v_pk_mul_f32 v[98:99], v[98:99], v[240:241] op_sel:[0,0] op_sel_hi:[1,0]
    v_pk_mul_f32 v[100:101], v[100:101], v[240:241] op_sel:[0,0] op_sel_hi:[1,0]
    v_pk_mul_f32 v[102:103], v[102:103], v[240:241] op_sel:[0,0] op_sel_hi:[1,0]
    v_cvt_pk_bf16_f32 v136, v96, v97
    buffer_load_dwordx4 v22, s[40:43], s79 offen offset:3072 sc1 lds
    v_cvt_pk_bf16_f32 v137, v98, v99
    v_cvt_pk_bf16_f32 v138, v100, v101
    v_cvt_pk_bf16_f32 v139, v102, v103
    buffer_store_dwordx4 v[136:139], v28, s[40:43], s80 offen sc1
    v_accvgpr_read_b32 v104, a116
    v_accvgpr_read_b32 v105, a117
    v_accvgpr_read_b32 v106, a118
    v_accvgpr_read_b32 v107, a119
    v_accvgpr_read_b32 v108, a124
    v_accvgpr_read_b32 v109, a125
    v_accvgpr_read_b32 v110, a126
    v_accvgpr_read_b32 v111, a127
    v_pk_mul_f32 v[104:105], v[104:105], v[240:241] op_sel:[0,1] op_sel_hi:[1,1]
    v_pk_mul_f32 v[106:107], v[106:107], v[240:241] op_sel:[0,1] op_sel_hi:[1,1]
    v_pk_mul_f32 v[108:109], v[108:109], v[240:241] op_sel:[0,1] op_sel_hi:[1,1]
    v_pk_mul_f32 v[110:111], v[110:111], v[240:241] op_sel:[0,1] op_sel_hi:[1,1]
    v_cvt_pk_bf16_f32 v140, v104, v105
    v_cvt_pk_bf16_f32 v141, v106, v107
    v_cvt_pk_bf16_f32 v142, v108, v109
    v_cvt_pk_bf16_f32 v143, v110, v111
    buffer_store_dwordx4 v[140:143], v236, s[40:43], s80 offen sc1
    s_waitcnt lgkmcnt(0)
    s_mov_b32 s6, 8388608
    s_mov_b32 s7, 0x20000
    s_mov_b32 s10, 1024
    s_mov_b32 s11, 0x20000
    s_waitcnt vmcnt(16)
    s_barrier
    ds_read_b128 v[160:163], v194 offset:1024
    ds_read_b64_tr_b16 a[192:193], v197 offset:0
    ds_read_b64_tr_b16 a[194:195], v197 offset:4096
    ds_read_b128 v[164:167], v194 offset:9216
    ds_read_b64_tr_b16 a[208:209], v197 offset:8192
    ds_read_b64_tr_b16 a[210:211], v197 offset:12288
    ds_read_b64_tr_b16 a[212:213], v202 offset:8192
    ds_read_b64_tr_b16 a[214:215], v202 offset:12288
    ds_read_b64_tr_b16 a[196:197], v202 offset:0
    ds_read_b64_tr_b16 a[198:199], v202 offset:4096
    ds_read_b64_tr_b16 a[200:201], v197 offset:1024
    ds_read_b64_tr_b16 a[202:203], v197 offset:5120
    ds_read_b64_tr_b16 a[216:217], v197 offset:9216
    ds_read_b64_tr_b16 a[218:219], v197 offset:13312
    s_waitcnt lgkmcnt(11)
    v_mfma_f32_16x16x32_bf16 v[48:51], a[192:195], v[160:163], 0
    ds_read_b64_tr_b16 a[220:221], v202 offset:9216
    ds_read_b64_tr_b16 a[222:223], v202 offset:13312
    ds_read_b64_tr_b16 a[204:205], v202 offset:1024
    ds_read_b64_tr_b16 a[206:207], v202 offset:5120
    s_waitcnt lgkmcnt(12)
    v_mfma_f32_16x16x32_bf16 v[48:51], a[208:211], v[164:167], v[48:51]
    s_and_b32 s67, s2, 7
    ds_read_b128 v[168:171], v194 offset:2048
    ds_read_b128 v[172:175], v194 offset:10240
    s_waitcnt lgkmcnt(12)
    v_mfma_f32_16x16x32_bf16 v[52:55], a[212:215], v[164:167], 0
    s_lshr_b32 s68, s2, 3
    ds_read_b128 v[176:179], v194 offset:3072
    ds_read_b128 v[180:183], v194 offset:11264
    s_waitcnt lgkmcnt(12)
    v_mfma_f32_16x16x32_bf16 v[52:55], a[196:199], v[160:163], v[52:55]
    s_waitcnt lgkmcnt(4)
    s_lshl_b32 s76, s67, 2
    ds_read_b128 v[184:187], v194 offset:0
    v_mfma_f32_16x16x32_bf16 v[56:59], a[200:203], v[160:163], 0
    ds_read_b128 v[188:191], v194 offset:8192
    v_mfma_f32_16x16x32_bf16 v[56:59], a[216:219], v[164:167], v[56:59]
    s_lshr_b32 s69, s68, 3
    v_mfma_f32_16x16x32_bf16 v[60:63], a[220:223], v[164:167], 0
    v_mfma_f32_16x16x32_bf16 v[60:63], a[204:207], v[160:163], v[60:63]
    s_waitcnt lgkmcnt(4)
    s_add_u32 s76, s76, s69
    v_mfma_f32_16x16x32_bf16 v[76:79], a[204:207], v[168:171], 0
    v_mfma_f32_16x16x32_bf16 v[76:79], a[220:223], v[172:175], v[76:79]
    s_addk_i32 s101, 16384
    s_and_b32 s101, s101, 131071
    s_add_u32 s79, s78, s101
    v_mfma_f32_16x16x32_bf16 v[72:75], a[216:219], v[172:175], 0
    s_addk_i32 m0, 16384
    s_and_b32 s77, s68, 7
    v_mfma_f32_16x16x32_bf16 v[72:75], a[200:203], v[168:171], v[72:75]
    v_mfma_f32_16x16x32_bf16 v[68:71], a[196:199], v[168:171], 0
    buffer_load_dwordx4 v22, s[40:43], s79 offen sc1 lds
    v_mfma_f32_16x16x32_bf16 v[68:71], a[212:215], v[172:175], v[68:71]
    buffer_load_dwordx4 v22, s[40:43], s79 offen offset:1024 sc1 lds
    v_mfma_f32_16x16x32_bf16 v[64:67], a[208:211], v[172:175], 0
    s_mul_i32 s100, s77, 4
    s_mul_i32 s69, s69, 4
    v_mfma_f32_16x16x32_bf16 v[64:67], a[192:195], v[168:171], v[64:67]
    s_waitcnt lgkmcnt(2)
    v_mfma_f32_16x16x32_bf16 v[80:83], a[192:195], v[176:179], 0
    s_add_u32 s100, s100, s69
    v_mfma_f32_16x16x32_bf16 v[80:83], a[208:211], v[180:183], v[80:83]
    s_waitcnt vmcnt(14) lgkmcnt(0)
    s_barrier
    v_mfma_f32_16x16x32_bf16 v[84:87], a[212:215], v[180:183], 0
    buffer_load_dwordx4 v22, s[40:43], s79 offen offset:2048 sc1 lds
    v_mfma_f32_16x16x32_bf16 v[84:87], a[196:199], v[176:179], v[84:87]
    s_and_b32 s100, s100, 7
    ds_read_b128 v[160:163], v194 offset:17408
    ds_read_b64_tr_b16 a[224:225], v197 offset:16384
    v_mfma_f32_16x16x32_bf16 v[88:91], a[200:203], v[176:179], 0
    ds_read_b64_tr_b16 a[226:227], v197 offset:20480
    ds_read_b128 v[164:167], v194 offset:25600
    v_mfma_f32_16x16x32_bf16 v[88:91], a[216:219], v[180:183], v[88:91]
    buffer_load_dwordx4 v22, s[40:43], s79 offen offset:3072 sc1 lds
    v_mfma_f32_16x16x32_bf16 v[92:95], a[220:223], v[180:183], 0
    s_add_u32 s99, s99, 65536
    ds_read_b64_tr_b16 a[240:241], v197 offset:24576
    ds_read_b64_tr_b16 a[242:243], v197 offset:28672
    v_mfma_f32_16x16x32_bf16 v[92:95], a[204:207], v[176:179], v[92:95]
    s_and_b32 s99, s99, 524287
    ds_read_b64_tr_b16 a[244:245], v202 offset:24576
    ds_read_b64_tr_b16 a[246:247], v202 offset:28672
    v_mfma_f32_16x16x32_bf16 v[44:47], a[204:207], v[184:187], 0
    s_add_u32 s79, s99, s96
    ds_read_b64_tr_b16 a[228:229], v202 offset:16384
    ds_read_b64_tr_b16 a[230:231], v202 offset:20480
    v_mfma_f32_16x16x32_bf16 v[44:47], a[220:223], v[188:191], v[44:47]
    s_add_u32 m0, s28, 0
    s_lshl_b32 s100, s100, 7
    s_lshl_b32 s97, s76, 17
    v_mfma_f32_16x16x32_bf16 v[40:43], a[216:219], v[188:191], 0
    s_add_u32 s97, s97, s71
    ds_read_b64_tr_b16 a[232:233], v197 offset:17408
    ds_read_b64_tr_b16 a[234:235], v197 offset:21504
    v_mfma_f32_16x16x32_bf16 v[40:43], a[200:203], v[184:187], v[40:43]
    buffer_load_dwordx4 v21, s[32:35], s79 offen lds
    v_mfma_f32_16x16x32_bf16 v[36:39], a[196:199], v[184:187], 0
    s_addk_i32 m0, 1024
    ds_read_b64_tr_b16 a[248:249], v197 offset:25600
    ds_read_b64_tr_b16 a[250:251], v197 offset:29696
    v_mfma_f32_16x16x32_bf16 v[36:39], a[212:215], v[188:191], v[36:39]
    s_add_u32 s97, s97, 52428800
    ds_read_b64_tr_b16 a[252:253], v202 offset:25600
    ds_read_b64_tr_b16 a[254:255], v202 offset:29696
    v_mfma_f32_16x16x32_bf16 v[32:35], a[208:211], v[188:191], 0
    s_lshl_b32 s98, s77, 16
    ds_read_b64_tr_b16 a[236:237], v202 offset:17408
    ds_read_b64_tr_b16 a[238:239], v202 offset:21504
    v_mfma_f32_16x16x32_bf16 v[32:35], a[192:195], v[184:187], v[32:35]
    s_waitcnt lgkmcnt(8)
    ds_read_b128 v[168:171], v194 offset:18432
    ds_read_b128 v[172:175], v194 offset:26624
    v_mfma_f32_16x16x32_bf16 v[48:51], a[224:227], v[160:163], v[48:51]
    buffer_load_dwordx4 v23, s[32:35], s79 offen lds
    v_mfma_f32_16x16x32_bf16 v[48:51], a[240:243], v[164:167], v[48:51]
    s_addk_i32 m0, 896
    s_lshr_b32 s69, s62, 1
    ds_read_b128 v[176:179], v194 offset:19456
    v_mfma_f32_16x16x32_bf16 v[52:55], a[244:247], v[164:167], v[52:55]
    s_lshl_b32 s70, s69, 11
    ds_read_b128 v[180:183], v194 offset:27648
    ds_read_b128 v[184:187], v194 offset:16384
    v_mfma_f32_16x16x32_bf16 v[52:55], a[228:231], v[160:163], v[52:55]
    s_waitcnt lgkmcnt(5)
    ds_read_b128 v[188:191], v194 offset:24576
    v_mfma_f32_16x16x32_bf16 v[56:59], a[232:235], v[160:163], v[56:59]
    buffer_load_dwordx4 v21, s[32:35], s79 offen offset:128 lds
    v_mfma_f32_16x16x32_bf16 v[56:59], a[248:251], v[164:167], v[56:59]
    s_addk_i32 m0, 1024
    s_add_u32 s98, s98, s70
    v_mfma_f32_16x16x32_bf16 v[60:63], a[252:255], v[164:167], v[60:63]
    v_lshrrev_b32 v20, 2, v0
    v_mfma_f32_16x16x32_bf16 v[60:63], a[236:239], v[160:163], v[60:63]
    s_waitcnt lgkmcnt(4)
    v_mfma_f32_16x16x32_bf16 v[76:79], a[236:239], v[168:171], v[76:79]
    buffer_load_dwordx4 v23, s[32:35], s79 offen offset:128 lds
    v_mfma_f32_16x16x32_bf16 v[76:79], a[252:255], v[172:175], v[76:79]
    s_addk_i32 s101, 16384
    s_and_b32 s101, s101, 131071
    s_add_u32 s79, s78, s101
    v_mfma_f32_16x16x32_bf16 v[72:75], a[248:251], v[172:175], v[72:75]
    s_addk_i32 m0, 13440
    v_mul_u32_u24 v20, 3072, v20
    v_mfma_f32_16x16x32_bf16 v[72:75], a[232:235], v[168:171], v[72:75]
    v_add_u32 v20, v20, v1
    v_mfma_f32_16x16x32_bf16 v[68:71], a[228:231], v[168:171], v[68:71]
    buffer_load_dwordx4 v22, s[40:43], s79 offen sc1 lds
    v_mfma_f32_16x16x32_bf16 v[68:71], a[244:247], v[172:175], v[68:71]
    buffer_load_dwordx4 v22, s[40:43], s79 offen offset:1024 sc1 lds
    v_mfma_f32_16x16x32_bf16 v[64:67], a[240:243], v[172:175], v[64:67]
    v_lshrrev_b32 v30, 5, v0
    v_mfma_f32_16x16x32_bf16 v[64:67], a[224:227], v[168:171], v[64:67]
    s_waitcnt lgkmcnt(2)
    s_lshl_b32 s68, s62, 8
    v_mfma_f32_16x16x32_bf16 v[80:83], a[224:227], v[176:179], v[80:83]
    v_mfma_f32_16x16x32_bf16 v[80:83], a[240:243], v[180:183], v[80:83]
    s_sub_u32 s68, s68, s71
    s_waitcnt vmcnt(10) lgkmcnt(0)
    s_barrier
    v_mfma_f32_16x16x32_bf16 v[84:87], a[244:247], v[180:183], v[84:87]
    buffer_store_dword v25, v24, s[48:51], s60 offen offset:64 sc1
    v_mfma_f32_16x16x32_bf16 v[84:87], a[228:231], v[176:179], v[84:87]
    buffer_load_dwordx4 v22, s[40:43], s79 offen offset:2048 sc1 lds
    v_mfma_f32_16x16x32_bf16 v[88:91], a[232:235], v[176:179], v[88:91]
    ds_read_b128 v[160:163], v195 offset:1024
    v_lshl_add_u32 v31, v30, 11, s68
    v_mfma_f32_16x16x32_bf16 v[88:91], a[248:251], v[180:183], v[88:91]
    buffer_load_dwordx4 v22, s[40:43], s79 offen offset:3072 sc1 lds
    v_mfma_f32_16x16x32_bf16 v[92:95], a[252:255], v[180:183], v[92:95]
    s_add_u32 s99, s99, 65536
    ds_read_b64_tr_b16 a[0:1], v198 offset:0
    ds_read_b64_tr_b16 a[2:3], v198 offset:4096
    v_mfma_f32_16x16x32_bf16 v[92:95], a[236:239], v[176:179], v[92:95]
    s_and_b32 s99, s99, 524287
    ds_read_b128 v[164:167], v195 offset:9216
    ds_read_b64_tr_b16 a[16:17], v198 offset:8192
    v_mfma_f32_16x16x32_bf16 v[44:47], a[236:239], v[184:187], v[44:47]
    s_add_u32 s79, s99, s96
    ds_read_b64_tr_b16 a[18:19], v198 offset:12288
    ds_read_b64_tr_b16 a[20:21], v203 offset:8192
    v_mfma_f32_16x16x32_bf16 v[44:47], a[252:255], v[188:191], v[44:47]
    s_add_u32 m0, s24, 0
    ds_read_b64_tr_b16 a[22:23], v203 offset:12288
    ds_read_b64_tr_b16 a[4:5], v203 offset:0
    v_mfma_f32_16x16x32_bf16 v[40:43], a[248:251], v[188:191], v[40:43]
    ds_read_b64_tr_b16 a[6:7], v203 offset:4096
    v_bfe_u32 v30, v0, 1, 1
    v_mfma_f32_16x16x32_bf16 v[40:43], a[232:235], v[184:187], v[40:43]
    buffer_load_dwordx4 v21, s[32:35], s79 offen lds
    v_mfma_f32_16x16x32_bf16 v[36:39], a[228:231], v[184:187], v[36:39]
    s_addk_i32 m0, 1024
    ds_read_b64_tr_b16 a[8:9], v198 offset:1024
    v_lshl_add_u32 v31, v30, 10, v31
    v_mfma_f32_16x16x32_bf16 v[36:39], a[244:247], v[188:191], v[36:39]
    ds_read_b64_tr_b16 a[10:11], v198 offset:5120
    ds_read_b64_tr_b16 a[24:25], v198 offset:9216
    v_mfma_f32_16x16x32_bf16 v[32:35], a[240:243], v[188:191], v[32:35]
    ds_read_b64_tr_b16 a[26:27], v198 offset:13312
    ds_read_b64_tr_b16 a[28:29], v203 offset:9216
    ds_read_b64_tr_b16 a[30:31], v203 offset:13312
    ds_read_b64_tr_b16 a[12:13], v203 offset:1024
    ds_read_b64_tr_b16 a[14:15], v203 offset:5120
    v_mfma_f32_16x16x32_bf16 v[32:35], a[224:227], v[184:187], v[32:35]
    s_waitcnt lgkmcnt(8)
    v_bfe_u32 v30, v0, 4, 1
    v_lshl_add_u32 v31, v30, 7, v31
    v_mfma_f32_16x16x32_bf16 v[48:51], a[0:3], v[160:163], v[48:51]
    buffer_load_dwordx4 v23, s[32:35], s79 offen lds
    v_mfma_f32_16x16x32_bf16 v[48:51], a[16:19], v[164:167], v[48:51]
    s_addk_i32 m0, 896
    ds_read_b128 v[168:171], v195 offset:2048
    ds_read_b128 v[172:175], v195 offset:10240
    v_mfma_f32_16x16x32_bf16 v[52:55], a[20:23], v[164:167], v[52:55]
    v_bfe_u32 v30, v0, 2, 2
    v_lshl_add_u32 v31, v30, 4, v31
    v_mfma_f32_16x16x32_bf16 v[52:55], a[4:7], v[160:163], v[52:55]
    s_waitcnt lgkmcnt(2)
    ds_read_b128 v[176:179], v195 offset:3072
    v_and_b32 v30, 1, v0
    v_mfma_f32_16x16x32_bf16 v[56:59], a[8:11], v[160:163], v[56:59]
    buffer_load_dwordx4 v21, s[32:35], s79 offen offset:128 lds
    v_mfma_f32_16x16x32_bf16 v[56:59], a[24:27], v[164:167], v[56:59]
    s_addk_i32 m0, 1024
    ds_read_b128 v[180:183], v195 offset:11264
    v_lshl_add_u32 v31, v30, 3, v31
    v_mfma_f32_16x16x32_bf16 v[60:63], a[28:31], v[164:167], v[60:63]
    ds_read_b128 v[184:187], v195 offset:0
    ds_read_b128 v[188:191], v195 offset:8192
    v_mfma_f32_16x16x32_bf16 v[60:63], a[12:15], v[160:163], v[60:63]
    s_waitcnt lgkmcnt(4)
    v_subrev_u32 v5, s71, v5
    v_mfma_f32_16x16x32_bf16 v[76:79], a[12:15], v[168:171], v[76:79]
    buffer_load_dwordx4 v23, s[32:35], s79 offen offset:128 lds
    v_mfma_f32_16x16x32_bf16 v[76:79], a[28:31], v[172:175], v[76:79]
    s_addk_i32 s101, 16384
    s_and_b32 s101, s101, 131071
    s_add_u32 s79, s78, s101
    v_mfma_f32_16x16x32_bf16 v[72:75], a[24:27], v[172:175], v[72:75]
    s_add_u32 m0, s26, 0
    v_add_u32 v13, s24, v31
    v_mfma_f32_16x16x32_bf16 v[72:75], a[8:11], v[168:171], v[72:75]
    v_mfma_f32_16x16x32_bf16 v[68:71], a[4:7], v[168:171], v[68:71]
    buffer_load_dwordx4 v22, s[40:43], s79 offen sc1 lds
    v_mfma_f32_16x16x32_bf16 v[68:71], a[20:23], v[172:175], v[68:71]
    buffer_load_dwordx4 v22, s[40:43], s79 offen offset:1024 sc1 lds
    v_mfma_f32_16x16x32_bf16 v[64:67], a[16:19], v[172:175], v[64:67]
    v_add_u32 v8, s24, v5
    v_add_u32 v14, s25, v31
    v_mfma_f32_16x16x32_bf16 v[64:67], a[0:3], v[168:171], v[64:67]
    s_waitcnt lgkmcnt(2)
    v_mfma_f32_16x16x32_bf16 v[80:83], a[0:3], v[176:179], v[80:83]
    v_add_u32 v9, s25, v5
    v_mfma_f32_16x16x32_bf16 v[80:83], a[16:19], v[180:183], v[80:83]
    s_waitcnt vmcnt(15) lgkmcnt(0)
    s_barrier
    v_mfma_f32_16x16x32_bf16 v[84:87], a[20:23], v[180:183], v[84:87]
    buffer_load_dwordx4 v22, s[40:43], s79 offen offset:2048 sc1 lds
    v_mfma_f32_16x16x32_bf16 v[84:87], a[4:7], v[176:179], v[84:87]
    ds_read_b128 v[160:163], v195 offset:17408
    v_add_u32 v15, s26, v31
    v_mfma_f32_16x16x32_bf16 v[88:91], a[8:11], v[176:179], v[88:91]
    ds_read_b64_tr_b16 a[32:33], v198 offset:16384
    v_add_u32 v10, s26, v5
    v_mfma_f32_16x16x32_bf16 v[88:91], a[24:27], v[180:183], v[88:91]
    buffer_load_dwordx4 v22, s[40:43], s79 offen offset:3072 sc1 lds
    v_mfma_f32_16x16x32_bf16 v[92:95], a[28:31], v[180:183], v[92:95]
    s_add_u32 s99, s99, 65536
    ds_read_b64_tr_b16 a[34:35], v198 offset:20480
    ds_read_b128 v[164:167], v195 offset:25600
    v_mfma_f32_16x16x32_bf16 v[92:95], a[12:15], v[176:179], v[92:95]
    s_and_b32 s99, s99, 524287
    ds_read_b64_tr_b16 a[48:49], v198 offset:24576
    ds_read_b64_tr_b16 a[50:51], v198 offset:28672
    v_mfma_f32_16x16x32_bf16 v[44:47], a[12:15], v[184:187], v[44:47]
    s_add_u32 s79, s99, s96
    ds_read_b64_tr_b16 a[52:53], v203 offset:24576
    ds_read_b64_tr_b16 a[54:55], v203 offset:28672
    v_mfma_f32_16x16x32_bf16 v[44:47], a[28:31], v[188:191], v[44:47]
    s_add_u32 m0, s24, 16384
    ds_read_b64_tr_b16 a[36:37], v203 offset:16384
    ds_read_b64_tr_b16 a[38:39], v203 offset:20480
    v_mfma_f32_16x16x32_bf16 v[40:43], a[24:27], v[188:191], v[40:43]
    ds_read_b64_tr_b16 a[40:41], v198 offset:17408
    v_add_u32 v16, s27, v31
    v_mfma_f32_16x16x32_bf16 v[40:43], a[8:11], v[184:187], v[40:43]
    buffer_load_dwordx4 v21, s[32:35], s79 offen lds
    v_mfma_f32_16x16x32_bf16 v[36:39], a[4:7], v[184:187], v[36:39]
    s_addk_i32 m0, 1024
    ds_read_b64_tr_b16 a[42:43], v198 offset:21504
    ds_read_b64_tr_b16 a[56:57], v198 offset:25600
    v_mfma_f32_16x16x32_bf16 v[36:39], a[20:23], v[188:191], v[36:39]
    ds_read_b64_tr_b16 a[58:59], v198 offset:29696
    ds_read_b64_tr_b16 a[60:61], v203 offset:25600
    v_mfma_f32_16x16x32_bf16 v[32:35], a[16:19], v[188:191], v[32:35]
    ds_read_b64_tr_b16 a[62:63], v203 offset:29696
    ds_read_b64_tr_b16 a[44:45], v203 offset:17408
    ds_read_b64_tr_b16 a[46:47], v203 offset:21504
    v_add_u32 v11, s27, v5
    v_mfma_f32_16x16x32_bf16 v[32:35], a[0:3], v[184:187], v[32:35]
    s_waitcnt lgkmcnt(8)
    v_add_u32 v17, s28, v31
    v_add_u32 v12, s28, v5
    v_mfma_f32_16x16x32_bf16 v[48:51], a[32:35], v[160:163], v[48:51]
    buffer_load_dwordx4 v23, s[32:35], s79 offen lds
    v_mfma_f32_16x16x32_bf16 v[48:51], a[48:51], v[164:167], v[48:51]
    s_addk_i32 m0, 896
    ds_read_b128 v[168:171], v195 offset:18432
    ds_read_b128 v[172:175], v195 offset:26624
    v_mfma_f32_16x16x32_bf16 v[52:55], a[52:55], v[164:167], v[52:55]
    s_add_u32 s67, s61, 64
    s_lshr_b32 s68, s76, 1
    s_lshl_b32 s68, s68, 7
    v_mfma_f32_16x16x32_bf16 v[52:55], a[36:39], v[160:163], v[52:55]
    s_waitcnt lgkmcnt(2)
    s_addk_i32 s68, 6144
    v_add_u32 v30, s67, v26
    v_mfma_f32_16x16x32_bf16 v[56:59], a[40:43], v[160:163], v[56:59]
    buffer_load_dwordx4 v21, s[32:35], s79 offen offset:128 lds
    v_mfma_f32_16x16x32_bf16 v[56:59], a[56:59], v[164:167], v[56:59]
    s_addk_i32 m0, 1024
    ds_read_b128 v[176:179], v195 offset:19456
    v_and_b32 v31, 15, v0
    v_mfma_f32_16x16x32_bf16 v[60:63], a[60:63], v[164:167], v[60:63]
    ds_read_b128 v[180:183], v195 offset:27648
    v_lshl_add_u32 v31, v31, 2, s68
    v_mfma_f32_16x16x32_bf16 v[60:63], a[44:47], v[160:163], v[60:63]
    s_waitcnt lgkmcnt(2)
    v_cmp_gt_u32 vcc, 32, v0
    s_nop 1
    v_cndmask_b32 v26, v31, v30, vcc
    v_mfma_f32_16x16x32_bf16 v[76:79], a[44:47], v[168:171], v[76:79]
    buffer_load_dwordx4 v23, s[32:35], s79 offen offset:128 lds
    v_mfma_f32_16x16x32_bf16 v[76:79], a[60:63], v[172:175], v[76:79]
    s_addk_i32 s101, 16384
    s_and_b32 s101, s101, 131071
    s_add_u32 s79, s78, s101
    v_mfma_f32_16x16x32_bf16 v[72:75], a[56:59], v[172:175], v[72:75]
    s_add_u32 m0, s26, 16384
    ds_read_b128 v[184:187], v195 offset:16384
    ds_read_b128 v[188:191], v195 offset:24576
    v_mfma_f32_16x16x32_bf16 v[72:75], a[40:43], v[168:171], v[72:75]
    buffer_load_dword v27, v26, s[48:51], 0 offen sc1
    v_mfma_f32_16x16x32_bf16 v[68:71], a[36:39], v[168:171], v[68:71]
PG_12:
    s_cbranch_execz PG_done
    buffer_load_dwordx4 v22, s[40:43], s79 offen sc1 lds
    v_mfma_f32_16x16x32_bf16 v[68:71], a[52:55], v[172:175], v[68:71]
    buffer_load_dwordx4 v22, s[40:43], s79 offen offset:1024 sc1 lds
    v_mfma_f32_16x16x32_bf16 v[64:67], a[48:51], v[172:175], v[64:67]
    v_mfma_f32_16x16x32_bf16 v[64:67], a[32:35], v[168:171], v[64:67]
    s_waitcnt lgkmcnt(2)
    v_mfma_f32_16x16x32_bf16 v[80:83], a[32:35], v[176:179], v[80:83]
    v_mfma_f32_16x16x32_bf16 v[80:83], a[48:51], v[180:183], v[80:83]
    s_waitcnt vmcnt(15) lgkmcnt(0)
    s_barrier
    v_mfma_f32_16x16x32_bf16 v[84:87], a[52:55], v[180:183], v[84:87]
    buffer_load_dwordx4 v22, s[40:43], s79 offen offset:2048 sc1 lds
    v_mfma_f32_16x16x32_bf16 v[84:87], a[36:39], v[176:179], v[84:87]
    ds_read_b128 v[160:163], v196 offset:17408
    ds_read_b64_tr_b16 a[128:129], v201 offset:0
    v_mfma_f32_16x16x32_bf16 v[88:91], a[40:43], v[176:179], v[88:91]
    ds_read_b64_tr_b16 a[130:131], v201 offset:4096
    ds_read_b128 v[164:167], v196 offset:25600
    v_mfma_f32_16x16x32_bf16 v[88:91], a[56:59], v[180:183], v[88:91]
    buffer_load_dwordx4 v22, s[40:43], s79 offen offset:3072 sc1 lds
    v_mfma_f32_16x16x32_bf16 v[92:95], a[60:63], v[180:183], v[92:95]
    s_add_u32 s99, s99, 65536
    ds_read_b64_tr_b16 a[144:145], v201 offset:8192
    ds_read_b64_tr_b16 a[146:147], v201 offset:12288
    v_mfma_f32_16x16x32_bf16 v[92:95], a[44:47], v[176:179], v[92:95]
    s_and_b32 s99, s99, 524287
    ds_read_b64_tr_b16 a[148:149], v206 offset:8192
    ds_read_b64_tr_b16 a[150:151], v206 offset:12288
    v_mfma_f32_16x16x32_bf16 v[44:47], a[44:47], v[184:187], v[44:47]
    s_add_u32 s79, s99, s96
    ds_read_b64_tr_b16 a[132:133], v206 offset:0
    ds_read_b64_tr_b16 a[134:135], v206 offset:4096
    v_mfma_f32_16x16x32_bf16 v[44:47], a[60:63], v[188:191], v[44:47]
    s_add_u32 m0, s25, 0
    ds_read_b64_tr_b16 a[136:137], v201 offset:1024
    ds_read_b64_tr_b16 a[138:139], v201 offset:5120
    v_mfma_f32_16x16x32_bf16 v[40:43], a[56:59], v[188:191], v[40:43]
    ds_read_b64_tr_b16 a[152:153], v201 offset:9216
    ds_read_b64_tr_b16 a[154:155], v201 offset:13312
    v_mfma_f32_16x16x32_bf16 v[40:43], a[40:43], v[184:187], v[40:43]
    buffer_load_dwordx4 v21, s[32:35], s79 offen lds
    v_mfma_f32_16x16x32_bf16 v[36:39], a[36:39], v[184:187], v[36:39]
    s_addk_i32 m0, 1024
    ds_read_b64_tr_b16 a[156:157], v206 offset:9216
    ds_read_b64_tr_b16 a[158:159], v206 offset:13312
    v_mfma_f32_16x16x32_bf16 v[36:39], a[52:55], v[188:191], v[36:39]
    ds_read_b64_tr_b16 a[140:141], v206 offset:1024
    ds_read_b64_tr_b16 a[142:143], v206 offset:5120
    v_mfma_f32_16x16x32_bf16 v[32:35], a[48:51], v[188:191], v[32:35]
    buffer_load_dwordx4 v23, s[32:35], s79 offen lds
    v_mfma_f32_16x16x32_bf16 v[32:35], a[32:35], v[184:187], v[32:35]
    s_waitcnt lgkmcnt(8)
    ds_read_b128 v[168:171], v196 offset:18432
    ds_read_b128 v[172:175], v196 offset:26624
    v_mfma_f32_16x16x32_bf16 v[48:51], a[128:131], v[160:163], v[48:51]
    s_addk_i32 m0, 896
    ds_read_b128 v[176:179], v196 offset:19456
    ds_read_b128 v[180:183], v196 offset:27648
    v_mfma_f32_16x16x32_bf16 v[48:51], a[144:147], v[164:167], v[48:51]
    ds_read_b128 v[184:187], v196 offset:16384
    ds_read_b128 v[188:191], v196 offset:24576
    v_mfma_f32_16x16x32_bf16 v[52:55], a[148:151], v[164:167], v[52:55]
    buffer_load_dwordx4 v21, s[32:35], s79 offen offset:128 lds
    v_mfma_f32_16x16x32_bf16 v[52:55], a[132:135], v[160:163], v[52:55]
    s_waitcnt lgkmcnt(6)
    s_addk_i32 m0, 1024
    v_mfma_f32_16x16x32_bf16 v[56:59], a[136:139], v[160:163], v[56:59]
    v_mfma_f32_16x16x32_bf16 v[56:59], a[152:155], v[164:167], v[56:59]
    buffer_load_dwordx4 v23, s[32:35], s79 offen offset:128 lds
    v_mfma_f32_16x16x32_bf16 v[60:63], a[156:159], v[164:167], v[60:63]
    s_addk_i32 s101, 16384
    s_and_b32 s101, s101, 131071
    s_add_u32 s79, s78, s101
    v_mfma_f32_16x16x32_bf16 v[60:63], a[140:143], v[160:163], v[60:63]
    s_waitcnt lgkmcnt(4)
    s_add_u32 m0, s27, 0
    v_mfma_f32_16x16x32_bf16 v[76:79], a[140:143], v[168:171], v[76:79]
    v_mfma_f32_16x16x32_bf16 v[76:79], a[156:159], v[172:175], v[76:79]
    buffer_load_dwordx4 v22, s[40:43], s79 offen sc1 lds
    v_mfma_f32_16x16x32_bf16 v[72:75], a[152:155], v[172:175], v[72:75]
    v_mfma_f32_16x16x32_bf16 v[72:75], a[136:139], v[168:171], v[72:75]
    v_mfma_f32_16x16x32_bf16 v[68:71], a[132:135], v[168:171], v[68:71]
    v_mfma_f32_16x16x32_bf16 v[68:71], a[148:151], v[172:175], v[68:71]
    buffer_load_dwordx4 v22, s[40:43], s79 offen offset:1024 sc1 lds
    v_mfma_f32_16x16x32_bf16 v[64:67], a[144:147], v[172:175], v[64:67]
    v_mfma_f32_16x16x32_bf16 v[64:67], a[128:131], v[168:171], v[64:67]
    s_waitcnt lgkmcnt(2)
    v_mfma_f32_16x16x32_bf16 v[80:83], a[128:131], v[176:179], v[80:83]
    v_mfma_f32_16x16x32_bf16 v[80:83], a[144:147], v[180:183], v[80:83]
POLL_B:
    s_waitcnt vmcnt(10)
    v_cmp_ne_u32 vcc, s83, v27
    s_nop 0
    s_cbranch_vccnz SPIN_B
POLLOK_B:
    s_waitcnt lgkmcnt(0)
    s_barrier
    v_mfma_f32_16x16x32_bf16 v[84:87], a[148:151], v[180:183], v[84:87]
    buffer_load_dwordx4 v22, s[40:43], s79 offen offset:2048 sc1 lds
    v_mfma_f32_16x16x32_bf16 v[84:87], a[132:135], v[176:179], v[84:87]
    ds_read_b128 v[160:163], v194 offset:1024
    ds_read_b64_tr_b16 a[160:161], v197 offset:0
    v_mfma_f32_16x16x32_bf16 v[88:91], a[136:139], v[176:179], v[88:91]
    ds_read_b64_tr_b16 a[162:163], v197 offset:4096
    ds_read_b128 v[164:167], v194 offset:9216
    v_mfma_f32_16x16x32_bf16 v[88:91], a[152:155], v[180:183], v[88:91]
    buffer_load_dwordx4 v22, s[40:43], s79 offen offset:3072 sc1 lds
    v_mfma_f32_16x16x32_bf16 v[92:95], a[156:159], v[180:183], v[92:95]
    s_addk_i32 s101, 16384
    ds_read_b64_tr_b16 a[176:177], v197 offset:8192
    ds_read_b64_tr_b16 a[178:179], v197 offset:12288
    v_mfma_f32_16x16x32_bf16 v[92:95], a[140:143], v[176:179], v[92:95]
    s_and_b32 s101, s101, 131071
    ds_read_b64_tr_b16 a[180:181], v202 offset:8192
    ds_read_b64_tr_b16 a[182:183], v202 offset:12288
    v_mfma_f32_16x16x32_bf16 v[44:47], a[140:143], v[184:187], v[44:47]
    s_add_u32 s79, s74, s101
    ds_read_b64_tr_b16 a[164:165], v202 offset:0
    ds_read_b64_tr_b16 a[166:167], v202 offset:4096
    v_mfma_f32_16x16x32_bf16 v[44:47], a[156:159], v[188:191], v[44:47]
    s_add_u32 m0, s25, 16384
    ds_read_b64_tr_b16 a[168:169], v197 offset:1024
    ds_read_b64_tr_b16 a[170:171], v197 offset:5120
    v_mfma_f32_16x16x32_bf16 v[40:43], a[152:155], v[188:191], v[40:43]
    ds_read_b64_tr_b16 a[184:185], v197 offset:9216
    ds_read_b64_tr_b16 a[186:187], v197 offset:13312
    v_mfma_f32_16x16x32_bf16 v[40:43], a[136:139], v[184:187], v[40:43]
    buffer_load_dwordx4 v22, s[40:43], s79 offen sc1 lds
    v_mfma_f32_16x16x32_bf16 v[36:39], a[132:135], v[184:187], v[36:39]
    ds_read_b64_tr_b16 a[188:189], v202 offset:9216
    ds_read_b64_tr_b16 a[190:191], v202 offset:13312
    v_mfma_f32_16x16x32_bf16 v[36:39], a[148:151], v[188:191], v[36:39]
    ds_read_b64_tr_b16 a[172:173], v202 offset:1024
    ds_read_b64_tr_b16 a[174:175], v202 offset:5120
    v_mfma_f32_16x16x32_bf16 v[32:35], a[144:147], v[188:191], v[32:35]
    buffer_load_dwordx4 v22, s[40:43], s79 offen offset:1024 sc1 lds
    v_mfma_f32_16x16x32_bf16 v[32:35], a[128:131], v[184:187], v[32:35]
    s_waitcnt lgkmcnt(8)
    ds_read_b128 v[168:171], v194 offset:2048
    ds_read_b128 v[172:175], v194 offset:10240
    v_mfma_f32_16x16x32_bf16 v[48:51], a[160:163], v[160:163], v[48:51]
    s_lshl_b32 s67, s64, 2
    s_add_u32 s67, s67, s75
    ds_read_b128 v[176:179], v194 offset:3072
    v_mfma_f32_16x16x32_bf16 v[48:51], a[176:179], v[164:167], v[48:51]
    buffer_load_dwordx4 v22, s[40:43], s79 offen offset:2048 sc1 lds
    v_mfma_f32_16x16x32_bf16 v[52:55], a[180:183], v[164:167], v[52:55]
    ds_read_b128 v[180:183], v194 offset:11264
    ds_read_b128 v[184:187], v194 offset:0
    v_mfma_f32_16x16x32_bf16 v[52:55], a[164:167], v[160:163], v[52:55]
    s_waitcnt lgkmcnt(5)
    s_lshl_b32 s61, s67, 8
    ds_read_b128 v[188:191], v194 offset:8192
    v_mfma_f32_16x16x32_bf16 v[56:59], a[168:171], v[160:163], v[56:59]
    v_mfma_f32_16x16x32_bf16 v[56:59], a[184:187], v[164:167], v[56:59]
    buffer_load_dwordx4 v22, s[40:43], s79 offen offset:3072 sc1 lds
    v_mfma_f32_16x16x32_bf16 v[60:63], a[188:191], v[164:167], v[60:63]
    s_addk_i32 s101, 16384
    s_and_b32 s101, s101, 131071
    s_add_u32 s79, s74, s101
    v_mfma_f32_16x16x32_bf16 v[60:63], a[172:175], v[160:163], v[60:63]
    s_waitcnt lgkmcnt(4)
    s_add_u32 m0, s27, 16384
    s_addk_i32 s61, 16384
    v_mfma_f32_16x16x32_bf16 v[76:79], a[172:175], v[168:171], v[76:79]
    s_lshl_b32 s60, s73, 2
    v_mfma_f32_16x16x32_bf16 v[76:79], a[188:191], v[172:175], v[76:79]
    buffer_load_dwordx4 v22, s[40:43], s79 offen sc1 lds
    v_mfma_f32_16x16x32_bf16 v[72:75], a[184:187], v[172:175], v[72:75]
    v_mfma_f32_16x16x32_bf16 v[72:75], a[168:171], v[168:171], v[72:75]
    s_add_u32 s60, s60, s61
    v_mfma_f32_16x16x32_bf16 v[68:71], a[164:167], v[168:171], v[68:71]
    v_mfma_f32_16x16x32_bf16 v[68:71], a[180:183], v[172:175], v[68:71]
    buffer_load_dwordx4 v22, s[40:43], s79 offen offset:1024 sc1 lds
    v_mfma_f32_16x16x32_bf16 v[64:67], a[176:179], v[172:175], v[64:67]
    s_mul_i32 s92, s67, 458752
    v_mfma_f32_16x16x32_bf16 v[64:67], a[160:163], v[168:171], v[64:67]
    s_waitcnt lgkmcnt(2)
    v_mfma_f32_16x16x32_bf16 v[80:83], a[160:163], v[176:179], v[80:83]
    s_lshl_b32 s67, s62, 10
    v_mfma_f32_16x16x32_bf16 v[80:83], a[176:179], v[180:183], v[80:83]
    s_waitcnt vmcnt(14) lgkmcnt(0)
    s_barrier
    v_mfma_f32_16x16x32_bf16 v[84:87], a[180:183], v[180:183], v[84:87]
    buffer_load_dwordx4 v22, s[40:43], s79 offen offset:2048 sc1 lds
    v_mfma_f32_16x16x32_bf16 v[84:87], a[164:167], v[176:179], v[84:87]
    s_add_u32 s92, s92, s67
    ds_read_b128 v[160:163], v194 offset:17408
    ds_read_b64_tr_b16 a[64:65], v197 offset:16384
    v_mfma_f32_16x16x32_bf16 v[88:91], a[168:171], v[176:179], v[88:91]
    ds_read_b64_tr_b16 a[66:67], v197 offset:20480
    ds_read_b128 v[164:167], v194 offset:25600
    v_mfma_f32_16x16x32_bf16 v[88:91], a[184:187], v[180:183], v[88:91]
    buffer_load_dwordx4 v22, s[40:43], s79 offen offset:3072 sc1 lds
    v_mfma_f32_16x16x32_bf16 v[92:95], a[188:191], v[180:183], v[92:95]
    s_addk_i32 s101, 16384
    ds_read_b64_tr_b16 a[80:81], v197 offset:24576
    ds_read_b64_tr_b16 a[82:83], v197 offset:28672
    v_mfma_f32_16x16x32_bf16 v[92:95], a[172:175], v[176:179], v[92:95]
    s_and_b32 s101, s101, 131071
    ds_read_b64_tr_b16 a[84:85], v202 offset:24576
    ds_read_b64_tr_b16 a[86:87], v202 offset:28672
    v_mfma_f32_16x16x32_bf16 v[44:47], a[172:175], v[184:187], v[44:47]
    s_add_u32 s79, s74, s101
    ds_read_b64_tr_b16 a[68:69], v202 offset:16384
    ds_read_b64_tr_b16 a[70:71], v202 offset:20480
    v_mfma_f32_16x16x32_bf16 v[44:47], a[188:191], v[188:191], v[44:47]
    s_add_u32 m0, s28, 0
    s_add_u32 s92, s92, 56623104
    s_mul_i32 s93, s73, 28672
    v_mfma_f32_16x16x32_bf16 v[40:43], a[184:187], v[188:191], v[40:43]
    s_add_u32 s93, s93, s92
    ds_read_b64_tr_b16 a[72:73], v197 offset:17408
    ds_read_b64_tr_b16 a[74:75], v197 offset:21504
    v_mfma_f32_16x16x32_bf16 v[40:43], a[168:171], v[184:187], v[40:43]
    buffer_load_dwordx4 v22, s[40:43], s79 offen sc1 lds
    v_mfma_f32_16x16x32_bf16 v[36:39], a[164:167], v[184:187], v[36:39]
    ds_read_b64_tr_b16 a[88:89], v197 offset:25600
    ds_read_b64_tr_b16 a[90:91], v197 offset:29696
    v_mfma_f32_16x16x32_bf16 v[36:39], a[180:183], v[188:191], v[36:39]
    ds_read_b64_tr_b16 a[92:93], v202 offset:25600
    ds_read_b64_tr_b16 a[94:95], v202 offset:29696
    v_mfma_f32_16x16x32_bf16 v[32:35], a[176:179], v[188:191], v[32:35]
    ds_read_b64_tr_b16 a[76:77], v202 offset:17408
    ds_read_b64_tr_b16 a[78:79], v202 offset:21504
    v_mfma_f32_16x16x32_bf16 v[32:35], a[160:163], v[184:187], v[32:35]
    s_waitcnt lgkmcnt(8)
    ds_read_b128 v[168:171], v194 offset:18432
    ds_read_b128 v[172:175], v194 offset:26624
    v_mfma_f32_16x16x32_bf16 v[48:51], a[64:67], v[160:163], v[48:51]
    buffer_load_dwordx4 v22, s[40:43], s79 offen offset:1024 sc1 lds
    v_mfma_f32_16x16x32_bf16 v[48:51], a[80:83], v[164:167], v[48:51]
    v_and_b32 v26, 7, v0
    v_max_u32 v26, 1, v26
    v_mfma_f32_16x16x32_bf16 v[52:55], a[84:87], v[164:167], v[52:55]
    buffer_load_dwordx4 v22, s[40:43], s79 offen offset:2048 sc1 lds
    v_mfma_f32_16x16x32_bf16 v[52:55], a[68:71], v[160:163], v[52:55]
    s_waitcnt lgkmcnt(2)
    ds_read_b128 v[176:179], v194 offset:19456
    v_xor_b32 v26, s73, v26
    v_mfma_f32_16x16x32_bf16 v[56:59], a[72:75], v[160:163], v[56:59]
    ds_read_b128 v[180:183], v194 offset:27648
    ds_read_b128 v[184:187], v194 offset:16384
    v_mfma_f32_16x16x32_bf16 v[56:59], a[88:91], v[164:167], v[56:59]
    buffer_load_dwordx4 v22, s[40:43], s79 offen offset:3072 sc1 lds
    v_mfma_f32_16x16x32_bf16 v[60:63], a[92:95], v[164:167], v[60:63]
    s_addk_i32 s101, 16384
    s_and_b32 s101, s101, 131071
    s_add_u32 s79, s74, s101
    v_mfma_f32_16x16x32_bf16 v[60:63], a[76:79], v[160:163], v[60:63]
    s_waitcnt lgkmcnt(3)
    s_addk_i32 m0, 16384
    v_lshlrev_b32 v26, 2, v26
    v_mfma_f32_16x16x32_bf16 v[76:79], a[76:79], v[168:171], v[76:79]
    ds_read_b128 v[188:191], v194 offset:24576
    v_lshrrev_b32 v30, 4, v0
    v_mfma_f32_16x16x32_bf16 v[76:79], a[92:95], v[172:175], v[76:79]
    buffer_load_dwordx4 v22, s[40:43], s79 offen sc1 lds
    v_mfma_f32_16x16x32_bf16 v[72:75], a[88:91], v[172:175], v[72:75]
    v_and_b32 v31, 15, v0
    v_mfma_f32_16x16x32_bf16 v[72:75], a[72:75], v[168:171], v[72:75]
    v_mfma_f32_16x16x32_bf16 v[68:71], a[68:71], v[168:171], v[68:71]
    v_mfma_f32_16x16x32_bf16 v[68:71], a[84:87], v[172:175], v[68:71]
    buffer_load_dwordx4 v22, s[40:43], s79 offen offset:1024 sc1 lds
    v_mfma_f32_16x16x32_bf16 v[64:67], a[80:83], v[172:175], v[64:67]
    v_lshlrev_b32 v250, 12, v30
    v_mfma_f32_16x16x32_bf16 v[64:67], a[64:67], v[168:171], v[64:67]
    s_waitcnt lgkmcnt(2)
    v_lshl_add_u32 v250, v31, 3, v250
    v_mfma_f32_16x16x32_bf16 v[80:83], a[64:67], v[176:179], v[80:83]
    v_mfma_f32_16x16x32_bf16 v[80:83], a[80:83], v[180:183], v[80:83]
    s_waitcnt vmcnt(14) lgkmcnt(0)
    s_barrier
    v_mfma_f32_16x16x32_bf16 v[84:87], a[84:87], v[180:183], v[84:87]
    buffer_load_dwordx4 v22, s[40:43], s79 offen offset:2048 sc1 lds
    v_mfma_f32_16x16x32_bf16 v[84:87], a[68:71], v[176:179], v[84:87]
    s_lshl_b32 s90, s76, 2
    ds_read_b128 v[160:163], v195 offset:1024
    ds_read_b64_tr_b16 a[96:97], v198 offset:0
    v_mfma_f32_16x16x32_bf16 v[88:91], a[72:75], v[176:179], v[88:91]
    s_add_u32 s90, s90, s62
    ds_read_b64_tr_b16 a[98:99], v198 offset:4096
    ds_read_b128 v[164:167], v195 offset:9216
    v_mfma_f32_16x16x32_bf16 v[88:91], a[88:91], v[180:183], v[88:91]
    buffer_load_dwordx4 v22, s[40:43], s79 offen offset:3072 sc1 lds
    v_mfma_f32_16x16x32_bf16 v[92:95], a[92:95], v[180:183], v[92:95]
    s_addk_i32 s101, 16384
    ds_read_b64_tr_b16 a[112:113], v198 offset:8192
    ds_read_b64_tr_b16 a[114:115], v198 offset:12288
    v_mfma_f32_16x16x32_bf16 v[92:95], a[76:79], v[176:179], v[92:95]
    s_and_b32 s101, s101, 131071
    ds_read_b64_tr_b16 a[116:117], v203 offset:8192
    ds_read_b64_tr_b16 a[118:119], v203 offset:12288
    v_mfma_f32_16x16x32_bf16 v[44:47], a[76:79], v[184:187], v[44:47]
    s_add_u32 s79, s74, s101
    ds_read_b64_tr_b16 a[100:101], v203 offset:0
    ds_read_b64_tr_b16 a[102:103], v203 offset:4096
    v_mfma_f32_16x16x32_bf16 v[44:47], a[92:95], v[188:191], v[44:47]
    s_add_u32 m0, s24, 0
    s_lshl_b32 s67, s90, 14
    ds_read_b64_tr_b16 a[104:105], v198 offset:1024
    v_mfma_f32_16x16x32_bf16 v[40:43], a[88:91], v[188:191], v[40:43]
    s_lshl_b32 s68, s77, 7
    ds_read_b64_tr_b16 a[106:107], v198 offset:5120
    ds_read_b64_tr_b16 a[120:121], v198 offset:9216
    v_mfma_f32_16x16x32_bf16 v[40:43], a[72:75], v[184:187], v[40:43]
    buffer_load_dwordx4 v22, s[40:43], s79 offen sc1 lds
    v_mfma_f32_16x16x32_bf16 v[36:39], a[68:71], v[184:187], v[36:39]
    s_add_u32 s67, s67, s68
    ds_read_b64_tr_b16 a[122:123], v198 offset:13312
    ds_read_b64_tr_b16 a[124:125], v203 offset:9216
    v_mfma_f32_16x16x32_bf16 v[36:39], a[84:87], v[188:191], v[36:39]
    ds_read_b64_tr_b16 a[126:127], v203 offset:13312
    ds_read_b64_tr_b16 a[108:109], v203 offset:1024
    v_mfma_f32_16x16x32_bf16 v[32:35], a[80:83], v[188:191], v[32:35]
    ds_read_b64_tr_b16 a[110:111], v203 offset:5120
    ds_read_b128 v[168:171], v195 offset:2048
    v_mfma_f32_16x16x32_bf16 v[32:35], a[64:67], v[184:187], v[32:35]
    s_waitcnt lgkmcnt(9)
    ds_read_b128 v[172:175], v195 offset:10240
    ds_read_b128 v[176:179], v195 offset:3072
    v_mfma_f32_16x16x32_bf16 v[48:51], a[96:99], v[160:163], v[48:51]
    buffer_load_dwordx4 v22, s[40:43], s79 offen offset:1024 sc1 lds
    v_mfma_f32_16x16x32_bf16 v[48:51], a[112:115], v[164:167], v[48:51]
    buffer_load_dwordx2 v[240:241], v250, s[16:19], s67 offen offset:0
    v_mfma_f32_16x16x32_bf16 v[52:55], a[116:119], v[164:167], v[52:55]
    buffer_load_dwordx4 v22, s[40:43], s79 offen offset:2048 sc1 lds
    v_mfma_f32_16x16x32_bf16 v[52:55], a[100:103], v[160:163], v[52:55]
    s_waitcnt lgkmcnt(3)
    ds_read_b128 v[180:183], v195 offset:11264
    ds_read_b128 v[184:187], v195 offset:0
    v_mfma_f32_16x16x32_bf16 v[56:59], a[104:107], v[160:163], v[56:59]
    buffer_load_dwordx2 v[242:243], v250, s[16:19], s67 offen offset:1024
    v_mfma_f32_16x16x32_bf16 v[56:59], a[120:123], v[164:167], v[56:59]
    buffer_load_dwordx4 v22, s[40:43], s79 offen offset:3072 sc1 lds
    v_mfma_f32_16x16x32_bf16 v[60:63], a[124:127], v[164:167], v[60:63]
    s_addk_i32 s101, 16384
    s_and_b32 s101, s101, 131071
    s_add_u32 s79, s74, s101
    v_mfma_f32_16x16x32_bf16 v[60:63], a[108:111], v[160:163], v[60:63]
    s_waitcnt lgkmcnt(3)
    s_add_u32 m0, s26, 0
    ds_read_b128 v[188:191], v195 offset:8192
    v_mfma_f32_16x16x32_bf16 v[76:79], a[108:111], v[168:171], v[76:79]
    v_mfma_f32_16x16x32_bf16 v[76:79], a[124:127], v[172:175], v[76:79]
    buffer_load_dwordx4 v22, s[40:43], s79 offen sc1 lds
    v_mfma_f32_16x16x32_bf16 v[72:75], a[120:123], v[172:175], v[72:75]
    buffer_load_dwordx2 v[244:245], v250, s[16:19], s67 offen offset:2048
    v_mfma_f32_16x16x32_bf16 v[72:75], a[104:107], v[168:171], v[72:75]
    v_mfma_f32_16x16x32_bf16 v[68:71], a[100:103], v[168:171], v[68:71]
    v_mfma_f32_16x16x32_bf16 v[68:71], a[116:119], v[172:175], v[68:71]
    buffer_load_dwordx4 v22, s[40:43], s79 offen offset:1024 sc1 lds
    v_mfma_f32_16x16x32_bf16 v[64:67], a[112:115], v[172:175], v[64:67]
    buffer_load_dwordx2 v[246:247], v250, s[16:19], s67 offen offset:3072
    v_mfma_f32_16x16x32_bf16 v[64:67], a[96:99], v[168:171], v[64:67]
    s_waitcnt lgkmcnt(2)
    v_mfma_f32_16x16x32_bf16 v[80:83], a[96:99], v[176:179], v[80:83]
    v_mfma_f32_16x16x32_bf16 v[80:83], a[112:115], v[180:183], v[80:83]
    s_waitcnt vmcnt(18) lgkmcnt(0)
    s_barrier
    v_mfma_f32_16x16x32_bf16 v[84:87], a[116:119], v[180:183], v[84:87]
    buffer_load_dwordx4 v22, s[40:43], s79 offen offset:2048 sc1 lds
    v_mfma_f32_16x16x32_bf16 v[84:87], a[100:103], v[176:179], v[84:87]
    ds_read_b128 v[160:163], v193 offset:17408
    ds_read_b128 v[164:167], v193 offset:25600
    v_mfma_f32_16x16x32_bf16 v[88:91], a[104:107], v[176:179], v[88:91]
    ds_read_b128 v[168:171], v195 offset:17408
    v_lshlrev_b32 v250, 3, v31
    v_mfma_f32_16x16x32_bf16 v[88:91], a[120:123], v[180:183], v[88:91]
    buffer_load_dwordx4 v22, s[40:43], s79 offen offset:3072 sc1 lds
    v_mfma_f32_16x16x32_bf16 v[92:95], a[124:127], v[180:183], v[92:95]
    s_addk_i32 s101, 16384
    ds_read_b128 v[172:175], v195 offset:25600
    s_and_b32 s101, s101, 131071
    v_mfma_f32_16x16x32_bf16 v[92:95], a[108:111], v[176:179], v[92:95]
    s_add_u32 s79, s74, s101
    s_add_u32 m0, s24, 16384
    ds_read_b128 v[176:179], v193 offset:18432
    v_mfma_f32_16x16x32_bf16 v[44:47], a[108:111], v[184:187], v[44:47]
    buffer_load_dwordx2 v[248:249], v250, s[8:11], s68 offen
    v_mfma_f32_16x16x32_bf16 v[44:47], a[124:127], v[188:191], v[44:47]
    buffer_load_dwordx4 v22, s[40:43], s79 offen sc1 lds
    v_mfma_f32_16x16x32_bf16 v[40:43], a[120:123], v[188:191], v[40:43]
    ds_read_b128 v[180:183], v193 offset:26624
    v_mfma_f32_16x16x32_bf16 v[40:43], a[104:107], v[184:187], v[40:43]
    v_mfma_f32_16x16x32_bf16 v[36:39], a[100:103], v[184:187], v[36:39]
    v_mfma_f32_16x16x32_bf16 v[36:39], a[116:119], v[188:191], v[36:39]
    buffer_load_dwordx4 v22, s[40:43], s79 offen offset:1024 sc1 lds
    v_mfma_f32_16x16x32_bf16 v[32:35], a[112:115], v[188:191], v[32:35]
    v_mfma_f32_16x16x32_bf16 v[32:35], a[96:99], v[184:187], v[32:35]
    s_waitcnt lgkmcnt(2)
    ds_read_b128 v[184:187], v195 offset:18432
    ds_read_b128 v[188:191], v195 offset:26624
    v_mfma_f32_16x16x32_bf16 v[112:115], a[192:195], v[160:163], 0
    v_mfma_f32_16x16x32_bf16 v[112:115], a[208:211], v[164:167], v[112:115]
    s_add_u32 s69, s73, 1
    s_and_b32 s69, s69, 3
    s_and_b32 s70, s73, 4
    v_mfma_f32_16x16x32_bf16 v[112:115], a[224:227], v[168:171], v[112:115]
    buffer_load_dwordx4 v22, s[40:43], s79 offen offset:2048 sc1 lds
    v_mfma_f32_16x16x32_bf16 v[112:115], a[240:243], v[172:175], v[112:115]
    s_or_b32 s69, s69, s70
    v_mfma_f32_16x16x32_bf16 v[116:119], a[244:247], v[172:175], 0
    s_mul_i32 s70, s69, 28672
    v_mfma_f32_16x16x32_bf16 v[116:119], a[228:231], v[168:171], v[116:119]
    buffer_load_dwordx4 v22, s[40:43], s79 offen offset:3072 sc1 lds
    v_mfma_f32_16x16x32_bf16 v[116:119], a[212:215], v[164:167], v[116:119]
    s_addk_i32 s101, 16384
    s_and_b32 s101, s101, 131071
    s_add_u32 s79, s74, s101
    v_mfma_f32_16x16x32_bf16 v[116:119], a[196:199], v[160:163], v[116:119]
    s_add_u32 m0, s26, 16384
    s_add_u32 s70, s70, s92
    s_addk_i32 s70, 4096
    v_mfma_f32_16x16x32_bf16 v[120:123], a[200:203], v[160:163], 0
    v_mfma_f32_16x16x32_bf16 v[120:123], a[216:219], v[164:167], v[120:123]
    buffer_load_dwordx4 v22, s[40:43], s79 offen sc1 lds
    v_mfma_f32_16x16x32_bf16 v[120:123], a[232:235], v[168:171], v[120:123]
    v_cvt_pk_bf16_f32 v48, v48, v49
    v_cvt_pk_bf16_f32 v49, v50, v51
    v_mfma_f32_16x16x32_bf16 v[120:123], a[248:251], v[172:175], v[120:123]
    v_cvt_pk_bf16_f32 v50, v52, v53
    v_mfma_f32_16x16x32_bf16 v[124:127], a[252:255], v[172:175], 0
    v_mfma_f32_16x16x32_bf16 v[124:127], a[236:239], v[168:171], v[124:127]
    buffer_load_dwordx4 v22, s[40:43], s79 offen offset:1024 sc1 lds
    v_mfma_f32_16x16x32_bf16 v[124:127], a[220:223], v[164:167], v[124:127]
    v_cvt_pk_bf16_f32 v51, v54, v55
    v_mfma_f32_16x16x32_bf16 v[124:127], a[204:207], v[160:163], v[124:127]
    s_waitcnt lgkmcnt(0)
    ds_read_b128 v[160:163], v193 offset:19456
    ds_read_b128 v[164:167], v193 offset:27648
    v_mfma_f32_16x16x32_bf16 v[140:143], a[204:207], v[176:179], 0
    buffer_store_dwordx4 v[48:51], v22, s[40:43], s70 offen sc1
    v_mfma_f32_16x16x32_bf16 v[140:143], a[220:223], v[180:183], v[140:143]
    buffer_load_dwordx4 v22, s[40:43], s79 offen offset:2048 sc1 lds
    v_mfma_f32_16x16x32_bf16 v[140:143], a[236:239], v[184:187], v[140:143]
    s_xor_b32 s69, s69, 4
    ds_read_b128 v[168:171], v195 offset:19456
    ds_read_b128 v[172:175], v195 offset:27648
    v_mfma_f32_16x16x32_bf16 v[140:143], a[252:255], v[188:191], v[140:143]
    s_mul_i32 s70, s69, 28672
    v_mfma_f32_16x16x32_bf16 v[136:139], a[248:251], v[188:191], 0
    s_add_u32 s70, s70, s92
    v_mfma_f32_16x16x32_bf16 v[136:139], a[232:235], v[184:187], v[136:139]
    buffer_load_dwordx4 v22, s[40:43], s79 offen offset:3072 sc1 lds
    v_mfma_f32_16x16x32_bf16 v[136:139], a[216:219], v[180:183], v[136:139]
    s_lshl_b32 s79, s100, 7
    s_add_u32 s79, s79, s97
    s_add_u32 m0, s25, 0
    v_mfma_f32_16x16x32_bf16 v[136:139], a[200:203], v[176:179], v[136:139]
    s_addk_i32 s70, 8192
    v_cvt_pk_bf16_f32 v56, v56, v57
    v_mfma_f32_16x16x32_bf16 v[132:135], a[196:199], v[176:179], 0
    v_cvt_pk_bf16_f32 v57, v58, v59
    v_mfma_f32_16x16x32_bf16 v[132:135], a[212:215], v[180:183], v[132:135]
    buffer_load_dwordx4 v22, s[40:43], s79 offen sc1 lds
    v_mfma_f32_16x16x32_bf16 v[132:135], a[228:231], v[184:187], v[132:135]
    v_cvt_pk_bf16_f32 v58, v60, v61
    v_mfma_f32_16x16x32_bf16 v[132:135], a[244:247], v[188:191], v[132:135]
    v_cvt_pk_bf16_f32 v59, v62, v63
    v_mfma_f32_16x16x32_bf16 v[128:131], a[240:243], v[188:191], 0
    v_mfma_f32_16x16x32_bf16 v[128:131], a[224:227], v[184:187], v[128:131]
    buffer_load_dwordx4 v22, s[40:43], s79 offen offset:1024 sc1 lds
    v_mfma_f32_16x16x32_bf16 v[128:131], a[208:211], v[180:183], v[128:131]
    buffer_store_dwordx4 v[56:59], v22, s[40:43], s70 offen sc1
    v_mfma_f32_16x16x32_bf16 v[128:131], a[192:195], v[176:179], v[128:131]
    s_waitcnt lgkmcnt(0)
    s_add_u32 s69, s73, 2
    ds_read_b128 v[176:179], v193 offset:16384
    v_mfma_f32_16x16x32_bf16 v[144:147], a[192:195], v[160:163], 0
    ds_read_b128 v[180:183], v193 offset:24576
    ds_read_b128 v[184:187], v195 offset:16384
    v_mfma_f32_16x16x32_bf16 v[144:147], a[208:211], v[164:167], v[144:147]
    buffer_load_dwordx4 v22, s[40:43], s79 offen offset:2048 sc1 lds
    v_mfma_f32_16x16x32_bf16 v[144:147], a[224:227], v[168:171], v[144:147]
    s_and_b32 s69, s69, 3
    s_and_b32 s70, s73, 4
    ds_read_b128 v[188:191], v195 offset:24576
    v_mfma_f32_16x16x32_bf16 v[144:147], a[240:243], v[172:175], v[144:147]
    v_mfma_f32_16x16x32_bf16 v[148:151], a[244:247], v[172:175], 0
    s_or_b32 s69, s69, s70
    v_mfma_f32_16x16x32_bf16 v[148:151], a[228:231], v[168:171], v[148:151]
    buffer_load_dwordx4 v22, s[40:43], s79 offen offset:3072 sc1 lds
    v_mfma_f32_16x16x32_bf16 v[148:151], a[212:215], v[164:167], v[148:151]
    s_add_u32 s79, s98, s100
    s_add_u32 m0, s27, 0
    s_mul_i32 s70, s69, 28672
    v_mfma_f32_16x16x32_bf16 v[148:151], a[196:199], v[160:163], v[148:151]
    s_add_u32 s70, s70, s92
    v_mfma_f32_16x16x32_bf16 v[152:155], a[200:203], v[160:163], 0
    s_addk_i32 s70, 12288
    v_mfma_f32_16x16x32_bf16 v[152:155], a[216:219], v[164:167], v[152:155]
    buffer_load_dwordx4 v20, s[36:39], s79 offen lds
    v_mfma_f32_16x16x32_bf16 v[152:155], a[232:235], v[168:171], v[152:155]
    s_addk_i32 m0, 960
    v_cvt_pk_bf16_f32 v64, v64, v65
    v_mfma_f32_16x16x32_bf16 v[152:155], a[248:251], v[172:175], v[152:155]
    v_cvt_pk_bf16_f32 v65, v66, v67
    v_mfma_f32_16x16x32_bf16 v[156:159], a[252:255], v[172:175], 0
    v_cvt_pk_bf16_f32 v66, v68, v69
    v_mfma_f32_16x16x32_bf16 v[156:159], a[236:239], v[168:171], v[156:159]
    buffer_load_dwordx4 v20, s[36:39], s79 offen offset:64 lds
    v_mfma_f32_16x16x32_bf16 v[156:159], a[220:223], v[164:167], v[156:159]
    s_addk_i32 m0, 64
    v_cvt_pk_bf16_f32 v67, v70, v71
    v_mfma_f32_16x16x32_bf16 v[156:159], a[204:207], v[160:163], v[156:159]
    s_waitcnt lgkmcnt(0)
    v_mfma_f32_16x16x32_bf16 v[108:111], a[204:207], v[176:179], 0
    buffer_store_dwordx4 v[64:67], v22, s[40:43], s70 offen sc1
    v_mfma_f32_16x16x32_bf16 v[108:111], a[220:223], v[180:183], v[108:111]
    s_waitcnt vmcnt(30) lgkmcnt(0)
    s_barrier
    v_mfma_f32_16x16x32_bf16 v[108:111], a[236:239], v[184:187], v[108:111]
    buffer_load_dwordx4 v20, s[36:39], s79 offen offset:1024 lds
    v_mfma_f32_16x16x32_bf16 v[108:111], a[252:255], v[188:191], v[108:111]
    s_addk_i32 m0, 960
    s_xor_b32 s69, s69, 4
    ds_read_b128 v[160:163], v196 offset:1024
    v_mfma_f32_16x16x32_bf16 v[104:107], a[248:251], v[188:191], 0
    s_mul_i32 s70, s69, 28672
    ds_read_b128 v[164:167], v196 offset:9216
    ds_read_b128 v[168:171], v196 offset:17408
    v_mfma_f32_16x16x32_bf16 v[104:107], a[232:235], v[184:187], v[104:107]
    buffer_load_dwordx4 v20, s[36:39], s79 offen offset:1088 lds
    v_mfma_f32_16x16x32_bf16 v[104:107], a[216:219], v[180:183], v[104:107]
    s_addk_i32 s100, 128
    ds_read_b128 v[172:175], v196 offset:25600
    s_and_b32 s100, s100, 1023
    v_mfma_f32_16x16x32_bf16 v[104:107], a[200:203], v[176:179], v[104:107]
    s_lshl_b32 s79, s100, 7
    s_add_u32 s79, s79, s97
    s_add_u32 m0, s25, 16384
    v_mfma_f32_16x16x32_bf16 v[100:103], a[196:199], v[176:179], 0
    s_add_u32 s70, s70, s92
    s_addk_i32 s70, 16384
    v_cvt_pk_bf16_f32 v72, v72, v73
    v_mfma_f32_16x16x32_bf16 v[100:103], a[212:215], v[180:183], v[100:103]
    buffer_load_dwordx4 v22, s[40:43], s79 offen sc1 lds
    v_mfma_f32_16x16x32_bf16 v[100:103], a[228:231], v[184:187], v[100:103]
    v_cvt_pk_bf16_f32 v73, v74, v75
    v_mfma_f32_16x16x32_bf16 v[100:103], a[244:247], v[188:191], v[100:103]
    v_cvt_pk_bf16_f32 v74, v76, v77
    v_mfma_f32_16x16x32_bf16 v[96:99], a[240:243], v[188:191], 0
    v_cvt_pk_bf16_f32 v75, v78, v79
    v_mfma_f32_16x16x32_bf16 v[96:99], a[224:227], v[184:187], v[96:99]
    v_mfma_f32_16x16x32_bf16 v[96:99], a[208:211], v[180:183], v[96:99]
    buffer_store_dwordx4 v[72:75], v22, s[40:43], s70 offen sc1
    v_mfma_f32_16x16x32_bf16 v[96:99], a[192:195], v[176:179], v[96:99]
    s_waitcnt lgkmcnt(0)
    ds_read_b128 v[176:179], v196 offset:2048
    ds_read_b128 v[180:183], v196 offset:10240
    v_mfma_f32_16x16x32_bf16 v[112:115], a[0:3], v[160:163], v[112:115]
    buffer_load_dwordx4 v22, s[40:43], s79 offen offset:1024 sc1 lds
    v_mfma_f32_16x16x32_bf16 v[112:115], a[16:19], v[164:167], v[112:115]
    s_add_u32 s69, s73, 3
    v_lshlrev_b32 v23, 14, v30
    v_lshl_add_u32 v23, v31, 4, v23
    v_mfma_f32_16x16x32_bf16 v[112:115], a[32:35], v[168:171], v[112:115]
    s_lshl_b32 s90, s90, 16
    s_lshl_b32 s68, s77, 8
    s_and_b32 s69, s69, 3
    v_mfma_f32_16x16x32_bf16 v[112:115], a[48:51], v[172:175], v[112:115]
    s_add_u32 s90, s90, s68
    s_and_b32 s70, s73, 4
    v_mul_u32_u24 v29, 144, v31
    v_mfma_f32_16x16x32_bf16 v[116:119], a[52:55], v[172:175], v[116:119]
    ds_read_b128 v[184:187], v196 offset:18432
    v_lshl_add_u32 v29, v30, 4, v29
    v_mfma_f32_16x16x32_bf16 v[116:119], a[36:39], v[168:171], v[116:119]
    buffer_load_dwordx4 v22, s[40:43], s79 offen offset:2048 sc1 lds
    v_mfma_f32_16x16x32_bf16 v[116:119], a[20:23], v[164:167], v[116:119]
    s_or_b32 s69, s69, s70
    ds_read_b128 v[188:191], v196 offset:26624
    v_lshrrev_b32 v30, 3, v0
    v_mfma_f32_16x16x32_bf16 v[116:119], a[4:7], v[160:163], v[116:119]
    s_mul_i32 s70, s69, 28672
    v_and_b32 v31, 7, v0
    v_mul_u32_u24 v28, 144, v30
    v_mfma_f32_16x16x32_bf16 v[120:123], a[8:11], v[160:163], v[120:123]
PG_13:
    s_cbranch_execz PG_done
    s_add_u32 s70, s70, s92
    v_lshl_add_u32 v28, v31, 4, v28
    v_mfma_f32_16x16x32_bf16 v[120:123], a[24:27], v[164:167], v[120:123]
    s_addk_i32 s70, 20480
    s_add_u32 s67, s24, 0
    v_mfma_f32_16x16x32_bf16 v[120:123], a[40:43], v[168:171], v[120:123]
    v_cvt_pk_bf16_f32 v80, v80, v81
    v_add_u32 v28, s67, v28
    v_mfma_f32_16x16x32_bf16 v[120:123], a[56:59], v[172:175], v[120:123]
    buffer_load_dwordx4 v22, s[40:43], s79 offen offset:3072 sc1 lds
    v_mfma_f32_16x16x32_bf16 v[124:127], a[60:63], v[172:175], v[124:127]
    v_add_u32 v29, s67, v29
    v_cvt_pk_bf16_f32 v81, v82, v83
    v_mfma_f32_16x16x32_bf16 v[124:127], a[44:47], v[168:171], v[124:127]
    v_lshlrev_b32 v21, 12, v30
    v_cvt_pk_bf16_f32 v82, v84, v85
    v_mfma_f32_16x16x32_bf16 v[124:127], a[28:31], v[164:167], v[124:127]
    s_add_u32 s79, s98, s100
    s_add_u32 m0, s27, 16384
    v_lshl_add_u32 v21, v31, 4, v21
    v_mfma_f32_16x16x32_bf16 v[124:127], a[12:15], v[160:163], v[124:127]
    s_waitcnt lgkmcnt(0)
    s_lshr_b32 s68, s62, 1
    v_cvt_pk_bf16_f32 v83, v86, v87
    v_mfma_f32_16x16x32_bf16 v[140:143], a[12:15], v[176:179], v[140:143]
    s_lshl_b32 s68, s68, 2
    s_and_b32 s67, s73, 3
    ds_read_b128 v[160:163], v196 offset:3072
    v_mfma_f32_16x16x32_bf16 v[140:143], a[28:31], v[180:183], v[140:143]
    buffer_store_dwordx4 v[80:83], v22, s[40:43], s70 offen sc1
    v_mfma_f32_16x16x32_bf16 v[140:143], a[44:47], v[184:187], v[140:143]
    buffer_load_dwordx4 v20, s[36:39], s79 offen lds
    v_mfma_f32_16x16x32_bf16 v[140:143], a[60:63], v[188:191], v[140:143]
    s_add_u32 s68, s68, s67
    s_lshl_b32 s91, s68, 16
    s_xor_b32 s69, s69, 4
    v_mfma_f32_16x16x32_bf16 v[136:139], a[56:59], v[188:191], v[136:139]
    s_lshl_b32 s68, s75, 1
    s_addk_i32 m0, 960
    s_and_b32 s67, s62, 1
    v_mfma_f32_16x16x32_bf16 v[136:139], a[40:43], v[184:187], v[136:139]
    s_mul_i32 s70, s69, 28672
    ds_read_b128 v[164:167], v196 offset:11264
    ds_read_b128 v[168:171], v196 offset:19456
    v_mfma_f32_16x16x32_bf16 v[136:139], a[24:27], v[180:183], v[136:139]
    s_add_u32 s68, s68, s67
    ds_read_b128 v[172:175], v196 offset:27648
    s_add_u32 s70, s70, s92
    v_mfma_f32_16x16x32_bf16 v[136:139], a[8:11], v[176:179], v[136:139]
    s_lshl_b32 s68, s68, 1
    s_addk_i32 s70, 24576
    s_lshr_b32 s67, s73, 2
    v_mfma_f32_16x16x32_bf16 v[132:135], a[4:7], v[176:179], v[132:135]
    buffer_load_dwordx4 v20, s[36:39], s79 offen offset:64 lds
    v_mfma_f32_16x16x32_bf16 v[132:135], a[20:23], v[180:183], v[132:135]
    s_add_u32 s68, s68, s67
    s_lshl_b32 s68, s68, 7
    v_cvt_pk_bf16_f32 v88, v88, v89
    v_mfma_f32_16x16x32_bf16 v[132:135], a[36:39], v[184:187], v[132:135]
    s_addk_i32 m0, 64
    s_add_u32 s91, s91, s68
    v_cvt_pk_bf16_f32 v89, v90, v91
    v_mfma_f32_16x16x32_bf16 v[132:135], a[52:55], v[188:191], v[132:135]
    s_waitcnt vmcnt(27)
    v_lshlrev_b32 v6, 16, v248
    v_mfma_f32_16x16x32_bf16 v[128:131], a[48:51], v[188:191], v[128:131]
    v_cvt_pk_bf16_f32 v90, v92, v93
    v_and_b32 v7, 0xffff0000, v248
    v_mfma_f32_16x16x32_bf16 v[128:131], a[32:35], v[184:187], v[128:131]
    v_cvt_pk_bf16_f32 v91, v94, v95
    v_lshlrev_b32 v18, 16, v249
    v_mfma_f32_16x16x32_bf16 v[128:131], a[16:19], v[180:183], v[128:131]
    buffer_load_dwordx4 v20, s[36:39], s79 offen offset:1024 lds
    v_mfma_f32_16x16x32_bf16 v[128:131], a[0:3], v[176:179], v[128:131]
    s_waitcnt lgkmcnt(0)
    v_and_b32 v19, 0xffff0000, v249
    v_lshlrev_b32 v224, 16, v240
    v_mfma_f32_16x16x32_bf16 v[144:147], a[0:3], v[160:163], v[144:147]
    buffer_store_dwordx4 v[88:91], v22, s[40:43], s70 offen sc1
    v_mfma_f32_16x16x32_bf16 v[144:147], a[16:19], v[164:167], v[144:147]
    s_addk_i32 m0, 960
    s_add_u32 s69, s73, 0
    v_and_b32 v225, 0xffff0000, v240
    v_mfma_f32_16x16x32_bf16 v[144:147], a[32:35], v[168:171], v[144:147]
    v_lshlrev_b32 v226, 16, v241
    v_and_b32 v227, 0xffff0000, v241
    v_mfma_f32_16x16x32_bf16 v[144:147], a[48:51], v[172:175], v[144:147]
    s_and_b32 s69, s69, 3
    ds_read_b128 v[176:179], v196 offset:0
    v_mul_f32 v224, v224, v6
    v_mfma_f32_16x16x32_bf16 v[148:151], a[52:55], v[172:175], v[148:151]
    s_and_b32 s70, s73, 4
    ds_read_b128 v[180:183], v196 offset:8192
    v_mul_f32 v225, v225, v7
    v_mfma_f32_16x16x32_bf16 v[148:151], a[36:39], v[168:171], v[148:151]
    buffer_load_dwordx4 v20, s[36:39], s79 offen offset:1088 lds
    v_mfma_f32_16x16x32_bf16 v[148:151], a[20:23], v[164:167], v[148:151]
    s_or_b32 s69, s69, s70
    ds_read_b128 v[184:187], v196 offset:16384
    ds_read_b128 v[188:191], v196 offset:24576
    v_mfma_f32_16x16x32_bf16 v[148:151], a[4:7], v[160:163], v[148:151]
    s_xor_b32 s69, s69, 4
    v_mul_f32 v226, v226, v18
    v_mul_f32 v227, v227, v19
    v_mfma_f32_16x16x32_bf16 v[152:155], a[8:11], v[160:163], v[152:155]
    v_cvt_pk_bf16_f32 v240, v224, v225
    v_cvt_pk_bf16_f32 v241, v226, v227
    v_mfma_f32_16x16x32_bf16 v[152:155], a[24:27], v[164:167], v[152:155]
    s_mul_i32 s70, s69, 28672
    v_lshlrev_b32 v224, 16, v240
    v_mfma_f32_16x16x32_bf16 v[152:155], a[40:43], v[168:171], v[152:155]
    s_add_u32 s70, s70, s92
    v_and_b32 v225, 0xffff0000, v240
    v_mfma_f32_16x16x32_bf16 v[152:155], a[56:59], v[172:175], v[152:155]
    s_add_u32 s70, s70, 0
    v_lshlrev_b32 v226, 16, v241
    v_mfma_f32_16x16x32_bf16 v[156:159], a[60:63], v[172:175], v[156:159]
    v_and_b32 v227, 0xffff0000, v241
    v_mfma_f32_16x16x32_bf16 v[156:159], a[44:47], v[168:171], v[156:159]
    v_cvt_pk_bf16_f32 v40, v40, v41
    v_lshlrev_b32 v228, 16, v242
    v_mfma_f32_16x16x32_bf16 v[156:159], a[28:31], v[164:167], v[156:159]
    v_cvt_pk_bf16_f32 v41, v42, v43
    v_and_b32 v229, 0xffff0000, v242
    v_mfma_f32_16x16x32_bf16 v[156:159], a[12:15], v[160:163], v[156:159]
    s_waitcnt lgkmcnt(0)
    v_lshlrev_b32 v230, 16, v243
    v_mfma_f32_16x16x32_bf16 v[108:111], a[12:15], v[176:179], v[108:111]
    v_cvt_pk_bf16_f32 v42, v44, v45
    v_and_b32 v231, 0xffff0000, v243
    v_mfma_f32_16x16x32_bf16 v[108:111], a[28:31], v[180:183], v[108:111]
    s_waitcnt lgkmcnt(0)
    s_barrier
    v_mfma_f32_16x16x32_bf16 v[108:111], a[44:47], v[184:187], v[108:111]
    s_addk_i32 s100, 128
    s_and_b32 s100, s100, 1023
    s_lshl_b32 s79, s100, 7
    v_mfma_f32_16x16x32_bf16 v[108:111], a[60:63], v[188:191], v[108:111]
    s_add_u32 s79, s79, s97
    s_add_u32 m0, s28, 0
    v_cvt_pk_bf16_f32 v43, v46, v47
    v_mfma_f32_16x16x32_bf16 v[104:107], a[56:59], v[188:191], v[104:107]
    v_mul_f32 v228, v228, v6
    v_mul_f32 v229, v229, v7
    v_mfma_f32_16x16x32_bf16 v[104:107], a[40:43], v[184:187], v[104:107]
    buffer_load_dwordx4 v22, s[40:43], s79 offen sc1 lds
    v_mfma_f32_16x16x32_bf16 v[104:107], a[24:27], v[180:183], v[104:107]
    buffer_store_dwordx4 v[40:43], v22, s[40:43], s70 offen sc1
    v_mfma_f32_16x16x32_bf16 v[104:107], a[8:11], v[176:179], v[104:107]
    v_mul_f32 v230, v230, v18
    v_mul_f32 v231, v231, v19
    v_mfma_f32_16x16x32_bf16 v[100:103], a[4:7], v[176:179], v[100:103]
    ds_read_b128 v[160:163], v192 offset:1024
    ds_read_b128 v[164:167], v192 offset:9216
    v_mfma_f32_16x16x32_bf16 v[100:103], a[20:23], v[180:183], v[100:103]
    ds_read_b128 v[168:171], v194 offset:1024
    ds_read_b128 v[172:175], v194 offset:9216
    v_mfma_f32_16x16x32_bf16 v[100:103], a[36:39], v[184:187], v[100:103]
    v_cvt_pk_bf16_f32 v242, v228, v229
    v_cvt_pk_bf16_f32 v243, v230, v231
    v_mfma_f32_16x16x32_bf16 v[100:103], a[52:55], v[188:191], v[100:103]
    v_lshlrev_b32 v228, 16, v242
    v_and_b32 v229, 0xffff0000, v242
    v_mfma_f32_16x16x32_bf16 v[96:99], a[48:51], v[188:191], v[96:99]
    buffer_load_dwordx4 v22, s[40:43], s79 offen offset:1024 sc1 lds
    v_mfma_f32_16x16x32_bf16 v[96:99], a[32:35], v[184:187], v[96:99]
    v_lshlrev_b32 v230, 16, v243
    v_and_b32 v231, 0xffff0000, v243
    v_mfma_f32_16x16x32_bf16 v[96:99], a[16:19], v[180:183], v[96:99]
    v_lshlrev_b32 v232, 16, v244
    v_and_b32 v233, 0xffff0000, v244
    v_mfma_f32_16x16x32_bf16 v[96:99], a[0:3], v[176:179], v[96:99]
    s_waitcnt lgkmcnt(0)
    v_lshlrev_b32 v234, 16, v245
    v_and_b32 v235, 0xffff0000, v245
    v_mfma_f32_16x16x32_bf16 v[112:115], a[128:131], v[160:163], v[112:115]
    buffer_load_dwordx4 v22, s[40:43], s79 offen offset:2048 sc1 lds
    v_mfma_f32_16x16x32_bf16 v[112:115], a[144:147], v[164:167], v[112:115]
    v_mul_f32 v232, v232, v6
    v_mul_f32 v233, v233, v7
    v_mfma_f32_16x16x32_bf16 v[112:115], a[160:163], v[168:171], v[112:115]
    v_mul_f32 v234, v234, v18
    v_mul_f32 v235, v235, v19
    v_mfma_f32_16x16x32_bf16 v[112:115], a[176:179], v[172:175], v[112:115]
    ds_read_b128 v[176:179], v192 offset:2048
    v_cvt_pk_bf16_f32 v244, v232, v233
    v_mfma_f32_16x16x32_bf16 v[116:119], a[180:183], v[172:175], v[116:119]
    ds_read_b128 v[180:183], v192 offset:10240
    v_cvt_pk_bf16_f32 v245, v234, v235
    v_mfma_f32_16x16x32_bf16 v[116:119], a[164:167], v[168:171], v[116:119]
    ds_read_b128 v[184:187], v194 offset:2048
    ds_read_b128 v[188:191], v194 offset:10240
    v_mfma_f32_16x16x32_bf16 v[116:119], a[148:151], v[164:167], v[116:119]
    v_lshlrev_b32 v232, 16, v244
    v_and_b32 v233, 0xffff0000, v244
    v_mfma_f32_16x16x32_bf16 v[116:119], a[132:135], v[160:163], v[116:119]
    buffer_load_dwordx4 v22, s[40:43], s79 offen offset:3072 sc1 lds
    v_mfma_f32_16x16x32_bf16 v[120:123], a[136:139], v[160:163], v[120:123]
    v_lshlrev_b32 v234, 16, v245
    v_and_b32 v235, 0xffff0000, v245
    v_mfma_f32_16x16x32_bf16 v[120:123], a[152:155], v[164:167], v[120:123]
    v_lshlrev_b32 v236, 16, v246
    v_mfma_f32_16x16x32_bf16 v[120:123], a[168:171], v[168:171], v[120:123]
    s_add_u32 s79, s98, s100
    s_addk_i32 m0, 16384
    v_and_b32 v237, 0xffff0000, v246
    v_mfma_f32_16x16x32_bf16 v[120:123], a[184:187], v[172:175], v[120:123]
    v_lshlrev_b32 v238, 16, v247
    v_mfma_f32_16x16x32_bf16 v[124:127], a[188:191], v[172:175], v[124:127]
    v_and_b32 v239, 0xffff0000, v247
    v_mfma_f32_16x16x32_bf16 v[124:127], a[172:175], v[168:171], v[124:127]
    v_mul_f32 v236, v236, v6
    v_mfma_f32_16x16x32_bf16 v[124:127], a[156:159], v[164:167], v[124:127]
    buffer_load_dwordx4 v20, s[36:39], s79 offen lds
    v_mfma_f32_16x16x32_bf16 v[124:127], a[140:143], v[160:163], v[124:127]
    s_waitcnt lgkmcnt(0)
    v_mul_f32 v237, v237, v7
    v_mul_f32 v238, v238, v18
    v_mfma_f32_16x16x32_bf16 v[140:143], a[140:143], v[176:179], v[140:143]
    ds_read_b128 v[160:163], v192 offset:3072
    v_mul_f32 v239, v239, v19
    v_mfma_f32_16x16x32_bf16 v[140:143], a[156:159], v[180:183], v[140:143]
    s_addk_i32 m0, 960
    ds_read_b128 v[164:167], v192 offset:11264
    v_cvt_pk_bf16_f32 v246, v236, v237
    v_mfma_f32_16x16x32_bf16 v[140:143], a[172:175], v[184:187], v[140:143]
    ds_read_b128 v[168:171], v194 offset:3072
    v_cvt_pk_bf16_f32 v247, v238, v239
    v_mfma_f32_16x16x32_bf16 v[140:143], a[188:191], v[188:191], v[140:143]
    ds_read_b128 v[172:175], v194 offset:11264
    v_lshlrev_b32 v236, 16, v246
    v_mfma_f32_16x16x32_bf16 v[136:139], a[184:187], v[188:191], v[136:139]
    v_and_b32 v237, 0xffff0000, v246
    v_mfma_f32_16x16x32_bf16 v[136:139], a[168:171], v[184:187], v[136:139]
    buffer_load_dwordx4 v20, s[36:39], s79 offen offset:64 lds
    v_mfma_f32_16x16x32_bf16 v[136:139], a[152:155], v[180:183], v[136:139]
    v_lshlrev_b32 v238, 16, v247
    v_and_b32 v239, 0xffff0000, v247
    v_mfma_f32_16x16x32_bf16 v[136:139], a[136:139], v[176:179], v[136:139]
    v_mfma_f32_16x16x32_bf16 v[132:135], a[132:135], v[176:179], v[132:135]
    s_addk_i32 m0, 64
    v_mfma_f32_16x16x32_bf16 v[132:135], a[148:151], v[180:183], v[132:135]
    v_mfma_f32_16x16x32_bf16 v[132:135], a[164:167], v[184:187], v[132:135]
    v_mfma_f32_16x16x32_bf16 v[132:135], a[180:183], v[188:191], v[132:135]
    v_mfma_f32_16x16x32_bf16 v[128:131], a[176:179], v[188:191], v[128:131]
    buffer_load_dwordx4 v20, s[36:39], s79 offen offset:1024 lds
    v_mfma_f32_16x16x32_bf16 v[128:131], a[160:163], v[184:187], v[128:131]
    v_mfma_f32_16x16x32_bf16 v[128:131], a[144:147], v[180:183], v[128:131]
    v_mfma_f32_16x16x32_bf16 v[128:131], a[128:131], v[176:179], v[128:131]
    s_waitcnt lgkmcnt(0)
    s_addk_i32 m0, 960
    ds_read_b128 v[176:179], v192 offset:0
    v_mfma_f32_16x16x32_bf16 v[144:147], a[128:131], v[160:163], v[144:147]
    ds_read_b128 v[180:183], v192 offset:8192
    ds_read_b128 v[184:187], v194 offset:0
    v_mfma_f32_16x16x32_bf16 v[144:147], a[144:147], v[164:167], v[144:147]
    ds_read_b128 v[188:191], v194 offset:8192
    v_mfma_f32_16x16x32_bf16 v[144:147], a[160:163], v[168:171], v[144:147]
    v_mfma_f32_16x16x32_bf16 v[144:147], a[176:179], v[172:175], v[144:147]
    buffer_load_dwordx4 v20, s[36:39], s79 offen offset:1088 lds
    v_mfma_f32_16x16x32_bf16 v[148:151], a[180:183], v[172:175], v[148:151]
    v_mfma_f32_16x16x32_bf16 v[148:151], a[164:167], v[168:171], v[148:151]
    v_mfma_f32_16x16x32_bf16 v[148:151], a[148:151], v[164:167], v[148:151]
    v_mfma_f32_16x16x32_bf16 v[148:151], a[132:135], v[160:163], v[148:151]
    v_mfma_f32_16x16x32_bf16 v[152:155], a[136:139], v[160:163], v[152:155]
    v_mfma_f32_16x16x32_bf16 v[152:155], a[152:155], v[164:167], v[152:155]
    v_mfma_f32_16x16x32_bf16 v[152:155], a[168:171], v[168:171], v[152:155]
    v_bfe_u32 v68, v0, 2, 2
    v_mfma_f32_16x16x32_bf16 v[152:155], a[184:187], v[172:175], v[152:155]
    v_lshrrev_b32 v69, 4, v0
    v_mfma_f32_16x16x32_bf16 v[156:159], a[188:191], v[172:175], v[156:159]
    v_mfma_f32_16x16x32_bf16 v[156:159], a[172:175], v[168:171], v[156:159]
    v_mfma_f32_16x16x32_bf16 v[156:159], a[156:159], v[164:167], v[156:159]
    v_xor_b32 v68, v68, v69
    v_mfma_f32_16x16x32_bf16 v[156:159], a[140:143], v[160:163], v[156:159]
    s_waitcnt lgkmcnt(0)
    v_mfma_f32_16x16x32_bf16 v[108:111], a[140:143], v[176:179], v[108:111]
    v_mfma_f32_16x16x32_bf16 v[108:111], a[156:159], v[180:183], v[108:111]
    s_waitcnt vmcnt(7) lgkmcnt(0)
    s_barrier
    v_mfma_f32_16x16x32_bf16 v[108:111], a[172:175], v[184:187], v[108:111]
    buffer_store_dword v25, v24, s[48:51], s60 offen offset:0 sc1
    v_mfma_f32_16x16x32_bf16 v[108:111], a[188:191], v[188:191], v[108:111]
    s_addk_i32 s100, 128
    s_and_b32 s100, s100, 1023
    s_lshl_b32 s79, s100, 7
    s_add_u32 s79, s79, s97
    s_add_u32 m0, s24, 0
    v_mfma_f32_16x16x32_bf16 v[104:107], a[184:187], v[188:191], v[104:107]
    ds_read_b128 v[160:163], v192 offset:17408
    v_min_u32 v68, 1, v68
    v_mfma_f32_16x16x32_bf16 v[104:107], a[168:171], v[184:187], v[104:107]
    buffer_load_dwordx4 v22, s[40:43], s79 offen sc1 lds
    v_mfma_f32_16x16x32_bf16 v[104:107], a[152:155], v[180:183], v[104:107]
    ds_read_b128 v[164:167], v192 offset:25600
    ds_read_b128 v[168:171], v194 offset:17408
    v_mfma_f32_16x16x32_bf16 v[104:107], a[136:139], v[176:179], v[104:107]
    ds_read_b128 v[172:175], v194 offset:25600
    v_xor_b32 v68, 1, v68
    v_mfma_f32_16x16x32_bf16 v[100:103], a[132:135], v[176:179], v[100:103]
    v_mul_u32_u24 v68, 0x3f80, v68
    v_mfma_f32_16x16x32_bf16 v[100:103], a[148:151], v[180:183], v[100:103]
    buffer_load_dwordx4 v22, s[40:43], s79 offen offset:1024 sc1 lds
    v_mfma_f32_16x16x32_bf16 v[100:103], a[164:167], v[184:187], v[100:103]
    v_mfma_f32_16x16x32_bf16 v[100:103], a[180:183], v[188:191], v[100:103]
    v_mfma_f32_16x16x32_bf16 v[96:99], a[176:179], v[188:191], v[96:99]
    v_lshlrev_b32 v69, 4, v0
    v_mfma_f32_16x16x32_bf16 v[96:99], a[160:163], v[184:187], v[96:99]
    v_mfma_f32_16x16x32_bf16 v[96:99], a[144:147], v[180:183], v[96:99]
    v_mfma_f32_16x16x32_bf16 v[96:99], a[128:131], v[176:179], v[96:99]
    s_waitcnt lgkmcnt(0)
    ds_read_b128 v[176:179], v192 offset:18432
    v_lshlrev_b32 v68, v69, v68
    v_mfma_f32_16x16x32_bf16 v[112:115], a[64:67], v[160:163], v[112:115]
    buffer_load_dwordx4 v22, s[40:43], s79 offen offset:2048 sc1 lds
    v_mfma_f32_16x16x32_bf16 v[112:115], a[80:83], v[164:167], v[112:115]
    ds_read_b128 v[180:183], v192 offset:26624
    ds_read_b128 v[184:187], v194 offset:18432
    v_mfma_f32_16x16x32_bf16 v[112:115], a[96:99], v[168:171], v[112:115]
    ds_read_b128 v[188:191], v194 offset:26624
    v_bfe_i32 v69, v0, 1, 1
    v_mfma_f32_16x16x32_bf16 v[112:115], a[112:115], v[172:175], v[112:115]
    v_mfma_f32_16x16x32_bf16 v[116:119], a[116:119], v[172:175], v[116:119]
    v_mfma_f32_16x16x32_bf16 v[116:119], a[100:103], v[168:171], v[116:119]
    v_mfma_f32_16x16x32_bf16 v[116:119], a[84:87], v[164:167], v[116:119]
    v_and_b32 v71, v69, v68
    v_mfma_f32_16x16x32_bf16 v[116:119], a[68:71], v[160:163], v[116:119]
    buffer_load_dwordx4 v22, s[40:43], s79 offen offset:3072 sc1 lds
    v_mfma_f32_16x16x32_bf16 v[120:123], a[72:75], v[160:163], v[120:123]
    v_mfma_f32_16x16x32_bf16 v[120:123], a[88:91], v[164:167], v[120:123]
    v_xor_b32 v70, v71, v68
    v_mfma_f32_16x16x32_bf16 v[120:123], a[104:107], v[168:171], v[120:123]
    s_add_u32 s79, s98, s100
    s_add_u32 m0, s26, 0
    v_mfma_f32_16x16x32_bf16 v[120:123], a[120:123], v[172:175], v[120:123]
    v_mfma_f32_16x16x32_bf16 v[124:127], a[124:127], v[172:175], v[124:127]
    v_mov_b32 v68, 0
    v_mfma_f32_16x16x32_bf16 v[124:127], a[108:111], v[168:171], v[124:127]
    v_mfma_f32_16x16x32_bf16 v[124:127], a[92:95], v[164:167], v[124:127]
    buffer_load_dwordx4 v20, s[36:39], s79 offen lds
    v_mfma_f32_16x16x32_bf16 v[124:127], a[76:79], v[160:163], v[124:127]
    s_waitcnt lgkmcnt(0)
    ds_read_b128 v[160:163], v192 offset:19456
    ds_read_b128 v[164:167], v192 offset:27648
    v_mfma_f32_16x16x32_bf16 v[140:143], a[76:79], v[176:179], v[140:143]
    ds_read_b128 v[168:171], v194 offset:19456
    v_mov_b32 v69, 0
    v_mfma_f32_16x16x32_bf16 v[140:143], a[92:95], v[180:183], v[140:143]
    s_addk_i32 m0, 960
    ds_read_b128 v[172:175], v194 offset:27648
    v_mfma_f32_16x16x32_bf16 v[140:143], a[108:111], v[184:187], v[140:143]
    v_mfma_f32_16x16x32_bf16 v[140:143], a[124:127], v[188:191], v[140:143]
    v_mov_b32 v72, 0
    v_mfma_f32_16x16x32_bf16 v[136:139], a[120:123], v[188:191], v[136:139]
    s_add_u32 s69, s73, 1
    s_and_b32 s69, s69, 3
    s_and_b32 s70, s73, 4
    v_mfma_f32_16x16x32_bf16 v[136:139], a[104:107], v[184:187], v[136:139]
    s_or_b32 s69, s69, s70
    s_mul_i32 s70, s69, 28672
    s_add_u32 s70, s70, s92
    v_mfma_f32_16x16x32_bf16 v[136:139], a[88:91], v[180:183], v[136:139]
    buffer_load_dwordx4 v20, s[36:39], s79 offen offset:64 lds
    v_mfma_f32_16x16x32_bf16 v[136:139], a[72:75], v[176:179], v[136:139]
    s_add_u32 s70, s70, 233472
    v_mov_b32 v73, 0
    v_cvt_pk_bf16_f32 v112, v112, v113
    v_mfma_f32_16x16x32_bf16 v[132:135], a[68:71], v[176:179], v[132:135]
    s_addk_i32 m0, 64
    v_cvt_pk_bf16_f32 v113, v114, v115
    v_cvt_pk_bf16_f32 v114, v116, v117
    v_mfma_f32_16x16x32_bf16 v[132:135], a[84:87], v[180:183], v[132:135]
    v_cvt_pk_bf16_f32 v115, v118, v119
    v_mfma_f32_16x16x32_bf16 v[132:135], a[100:103], v[184:187], v[132:135]
    buffer_store_dwordx4 v[112:115], v22, s[40:43], s70 offen sc1
    v_mfma_f32_16x16x32_bf16 v[132:135], a[116:119], v[188:191], v[132:135]
    s_xor_b32 s69, s69, 4
    s_mul_i32 s70, s69, 28672
    s_add_u32 s70, s70, s92
    v_mfma_f32_16x16x32_bf16 v[128:131], a[112:115], v[188:191], v[128:131]
    buffer_load_dwordx4 v20, s[36:39], s79 offen offset:1024 lds
    v_mfma_f32_16x16x32_bf16 v[128:131], a[96:99], v[184:187], v[128:131]
    s_add_u32 s70, s70, 237568
    v_cvt_pk_bf16_f32 v120, v120, v121
    v_cvt_pk_bf16_f32 v121, v122, v123
    v_mfma_f32_16x16x32_bf16 v[128:131], a[80:83], v[180:183], v[128:131]
    v_cvt_pk_bf16_f32 v122, v124, v125
    v_cvt_pk_bf16_f32 v123, v126, v127
    v_mfma_f32_16x16x32_bf16 v[128:131], a[64:67], v[176:179], v[128:131]
    s_waitcnt lgkmcnt(0)
    s_addk_i32 m0, 960
    ds_read_b128 v[176:179], v192 offset:16384
    v_mfma_f32_16x16x32_bf16 v[144:147], a[64:67], v[160:163], v[144:147]
    buffer_store_dwordx4 v[120:123], v22, s[40:43], s70 offen sc1
    v_mfma_f32_16x16x32_bf16 v[144:147], a[80:83], v[164:167], v[144:147]
    s_add_u32 s69, s73, 2
    s_and_b32 s69, s69, 3
    s_and_b32 s70, s73, 4
    v_mfma_f32_16x16x32_bf16 v[144:147], a[96:99], v[168:171], v[144:147]
    s_or_b32 s69, s69, s70
    s_mul_i32 s70, s69, 28672
    ds_read_b128 v[180:183], v192 offset:24576
    v_mfma_f32_16x16x32_bf16 v[144:147], a[112:115], v[172:175], v[144:147]
    buffer_load_dwordx4 v20, s[36:39], s79 offen offset:1088 lds
    v_mfma_f32_16x16x32_bf16 v[148:151], a[116:119], v[172:175], v[148:151]
    s_add_u32 s70, s70, s92
    s_add_u32 s70, s70, 241664
    v_cvt_pk_bf16_f32 v128, v128, v129
    v_mfma_f32_16x16x32_bf16 v[148:151], a[100:103], v[168:171], v[148:151]
    ds_read_b128 v[184:187], v194 offset:16384
    ds_read_b128 v[188:191], v194 offset:24576
    v_mfma_f32_16x16x32_bf16 v[148:151], a[84:87], v[164:167], v[148:151]
    v_cvt_pk_bf16_f32 v129, v130, v131
    v_cvt_pk_bf16_f32 v130, v132, v133
    v_mfma_f32_16x16x32_bf16 v[148:151], a[68:71], v[160:163], v[148:151]
    v_cvt_pk_bf16_f32 v131, v134, v135
    v_mfma_f32_16x16x32_bf16 v[152:155], a[72:75], v[160:163], v[152:155]
    buffer_store_dwordx4 v[128:131], v22, s[40:43], s70 offen sc1
    v_mfma_f32_16x16x32_bf16 v[152:155], a[88:91], v[164:167], v[152:155]
    s_xor_b32 s69, s69, 4
    s_mul_i32 s70, s69, 28672
    s_add_u32 s70, s70, s92
    v_mfma_f32_16x16x32_bf16 v[152:155], a[104:107], v[168:171], v[152:155]
    s_add_u32 s70, s70, 245760
    v_mfma_f32_16x16x32_bf16 v[152:155], a[120:123], v[172:175], v[152:155]
    v_cvt_pk_bf16_f32 v136, v136, v137
    v_cvt_pk_bf16_f32 v137, v138, v139
    v_mfma_f32_16x16x32_bf16 v[156:159], a[124:127], v[172:175], v[156:159]
    v_cvt_pk_bf16_f32 v138, v140, v141
    v_cvt_pk_bf16_f32 v139, v142, v143
    v_mfma_f32_16x16x32_bf16 v[156:159], a[108:111], v[168:171], v[156:159]
    buffer_store_dwordx4 v[136:139], v22, s[40:43], s70 offen sc1
    v_mfma_f32_16x16x32_bf16 v[156:159], a[92:95], v[164:167], v[156:159]
    s_add_u32 s69, s73, 3
    v_mfma_f32_16x16x32_bf16 v[156:159], a[76:79], v[160:163], v[156:159]
    s_waitcnt lgkmcnt(0)
    s_and_b32 s69, s69, 3
    v_mfma_f32_16x16x32_bf16 v[108:111], a[76:79], v[176:179], v[108:111]
    s_and_b32 s70, s73, 4
    s_or_b32 s69, s69, s70
    v_mfma_f32_16x16x32_bf16 v[108:111], a[92:95], v[180:183], v[108:111]
    s_mul_i32 s70, s69, 28672
    s_waitcnt lgkmcnt(0)
    s_barrier
    v_mfma_f32_16x16x32_bf16 v[108:111], a[108:111], v[184:187], v[108:111]
    s_addk_i32 s100, 128
    s_and_b32 s100, s100, 1023
    s_lshl_b32 s79, s100, 7
    v_mfma_f32_16x16x32_bf16 v[108:111], a[124:127], v[188:191], v[108:111]
    s_add_u32 s79, s79, s97
    s_add_u32 m0, s24, 16384
    s_add_u32 s70, s70, s92
    v_mfma_f32_16x16x32_bf16 v[104:107], a[120:123], v[188:191], v[104:107]
    s_add_u32 s70, s70, 249856
    v_cvt_pk_bf16_f32 v144, v144, v145
    v_cvt_pk_bf16_f32 v145, v146, v147
    v_mfma_f32_16x16x32_bf16 v[104:107], a[104:107], v[184:187], v[104:107]
    buffer_load_dwordx4 v22, s[40:43], s79 offen sc1 lds
    v_mfma_f32_16x16x32_bf16 v[104:107], a[88:91], v[180:183], v[104:107]
    buffer_load_dwordx4 v22, s[40:43], s79 offen offset:1024 sc1 lds
    v_mfma_f32_16x16x32_bf16 v[104:107], a[72:75], v[176:179], v[104:107]
    ds_read_b128 a[0:3], v11 offset:0
    v_cvt_pk_bf16_f32 v146, v148, v149
    v_mfma_f32_16x16x32_bf16 v[100:103], a[68:71], v[176:179], v[100:103]
    buffer_load_dwordx4 v22, s[40:43], s79 offen offset:2048 sc1 lds
    v_mfma_f32_16x16x32_bf16 v[100:103], a[84:87], v[180:183], v[100:103]
    ds_read_b64_tr_b16 a[128:129], v14 offset:0
    ds_read_b64_tr_b16 a[130:131], v14 offset:64
    v_mfma_f32_16x16x32_bf16 v[100:103], a[100:103], v[184:187], v[100:103]
    ds_read_b128 a[4:7], v11 offset:4096
    ds_read_b64_tr_b16 a[132:133], v14 offset:4096
    ds_read_b64_tr_b16 a[134:135], v14 offset:4160
    ds_read_b128 a[8:11], v11 offset:1024
    ds_read_b64_tr_b16 a[136:137], v14 offset:8192
    ds_read_b64_tr_b16 a[138:139], v14 offset:8256
    ds_read_b128 a[12:15], v11 offset:5120
    ds_read_b64_tr_b16 a[140:141], v14 offset:12288
    ds_read_b64_tr_b16 a[142:143], v14 offset:12352
    v_cvt_pk_bf16_f32 v147, v150, v151
    buffer_store_dwordx4 v[144:147], v22, s[40:43], s70 offen sc1
    v_mfma_f32_16x16x32_bf16 v[100:103], a[116:119], v[188:191], v[100:103]
    buffer_load_dwordx4 v22, s[40:43], s79 offen offset:3072 sc1 lds
    s_add_u32 s79, s98, s100
    s_add_u32 m0, s26, 16384
    s_xor_b32 s69, s69, 4
    v_mfma_f32_16x16x32_bf16 v[96:99], a[112:115], v[188:191], v[96:99]
    s_mul_i32 s70, s69, 28672
    s_add_u32 s70, s70, s92
    s_add_u32 s70, s70, 253952
    v_mfma_f32_16x16x32_bf16 v[96:99], a[96:99], v[184:187], v[96:99]
    buffer_load_dwordx4 v20, s[36:39], s79 offen lds
    s_addk_i32 m0, 960
    v_mfma_f32_16x16x32_bf16 v[96:99], a[80:83], v[180:183], v[96:99]
    ds_read_b128 a[28:31], v11 offset:7168
    ds_read_b128 a[24:27], v11 offset:3072
    ds_read_b128 a[20:23], v11 offset:6144
    ds_read_b128 a[16:19], v11 offset:2048
    v_cvt_pk_bf16_f32 v152, v152, v153
    v_mfma_f32_16x16x32_bf16 v[96:99], a[64:67], v[176:179], v[96:99]
    s_waitcnt lgkmcnt(4)
    buffer_load_dwordx4 v20, s[36:39], s79 offen offset:64 lds
    s_addk_i32 m0, 64
    v_cvt_pk_bf16_f32 v153, v154, v155
    v_cvt_pk_bf16_f32 v154, v156, v157
    v_mfma_f32_16x16x32_bf16 v[208:211], a[128:131], a[0:3], 0
    v_cvt_pk_bf16_f32 v155, v158, v159
    buffer_store_dwordx4 v[152:155], v22, s[40:43], s70 offen sc1
    v_mfma_f32_16x16x32_bf16 v[208:211], a[132:135], a[4:7], v[208:211]
    buffer_load_dwordx4 v20, s[36:39], s79 offen offset:1024 lds
    s_addk_i32 m0, 960
    v_mfma_f32_16x16x32_bf16 v[208:211], a[136:139], a[8:11], v[208:211]
    s_add_u32 s69, s73, 0
    ds_read_b128 a[32:35], v11 offset:8192
    ds_read_b128 a[36:39], v11 offset:12288
    ds_read_b128 a[40:43], v11 offset:9216
    ds_read_b128 a[44:47], v11 offset:13312
    ds_read_b128 a[60:63], v11 offset:15360
    ds_read_b128 a[56:59], v11 offset:11264
    ds_read_b128 a[52:55], v11 offset:14336
    ds_read_b128 a[48:51], v11 offset:10240
    s_and_b32 s69, s69, 3
    v_mfma_f32_16x16x32_bf16 v[208:211], a[140:143], a[12:15], v[208:211]
    s_waitcnt lgkmcnt(8)
    s_and_b32 s70, s73, 4
    s_or_b32 s69, s69, s70
    v_mfma_f32_16x16x32_bf16 v[212:215], a[140:143], a[28:31], 0
    buffer_load_dwordx4 v20, s[36:39], s79 offen offset:1088 lds
    s_xor_b32 s69, s69, 4
    v_mfma_f32_16x16x32_bf16 v[212:215], a[136:139], a[24:27], v[212:215]
    s_mul_i32 s70, s69, 28672
    s_add_u32 s70, s70, s92
    s_add_u32 s70, s70, 229376
    v_mfma_f32_16x16x32_bf16 v[212:215], a[132:135], a[20:23], v[212:215]
    v_cvt_pk_bf16_f32 v104, v104, v105
    v_cvt_pk_bf16_f32 v105, v106, v107
    v_mfma_f32_16x16x32_bf16 v[212:215], a[128:131], a[16:19], v[212:215]
    v_cvt_pk_bf16_f32 v106, v108, v109
    v_cvt_pk_bf16_f32 v107, v110, v111
    buffer_store_dwordx4 v[104:107], v22, s[40:43], s70 offen sc1
    s_waitcnt lgkmcnt(0)
    s_barrier
    v_mfma_f32_16x16x32_bf16 v[216:219], a[128:131], a[32:35], 0
    s_addk_i32 s100, 128
    s_and_b32 s100, s100, 1023
    s_lshl_b32 s79, s100, 7
    v_mfma_f32_16x16x32_bf16 v[216:219], a[132:135], a[36:39], v[216:219]
    s_add_u32 s79, s79, s97
    s_add_u32 m0, s25, 0
    ds_read_b128 a[160:163], v11 offset:26624
    v_mfma_f32_16x16x32_bf16 v[216:219], a[136:139], a[40:43], v[216:219]
    ds_read_b64_tr_b16 a[144:145], v14 offset:16384
    ds_read_b64_tr_b16 a[146:147], v14 offset:16448
    ds_read_b128 a[164:167], v11 offset:30720
    ds_read_b64_tr_b16 a[148:149], v14 offset:20480
    ds_read_b64_tr_b16 a[150:151], v14 offset:20544
    ds_read_b128 a[168:171], v11 offset:27648
    ds_read_b64_tr_b16 a[152:153], v14 offset:24576
    ds_read_b64_tr_b16 a[154:155], v14 offset:24640
    ds_read_b128 a[172:175], v11 offset:31744
    ds_read_b64_tr_b16 a[156:157], v14 offset:28672
    ds_read_b64_tr_b16 a[158:159], v14 offset:28736
    v_mfma_f32_16x16x32_bf16 v[216:219], a[140:143], a[44:47], v[216:219]
    buffer_load_dwordx4 v22, s[40:43], s79 offen sc1 lds
    v_mfma_f32_16x16x32_bf16 v[220:223], a[140:143], a[60:63], 0
    buffer_load_dwordx4 v22, s[40:43], s79 offen offset:1024 sc1 lds
    v_mfma_f32_16x16x32_bf16 v[220:223], a[136:139], a[56:59], v[220:223]
    ds_read_b128 a[188:191], v11 offset:29696
    ds_read_b128 a[184:187], v11 offset:25600
    v_mfma_f32_16x16x32_bf16 v[220:223], a[132:135], a[52:55], v[220:223]
    ds_read_b128 a[180:183], v11 offset:28672
    ds_read_b128 a[176:179], v11 offset:24576
    v_mfma_f32_16x16x32_bf16 v[220:223], a[128:131], a[48:51], v[220:223]
    s_waitcnt lgkmcnt(4)
    buffer_load_dwordx4 v22, s[40:43], s79 offen offset:2048 sc1 lds
    buffer_load_dwordx4 v22, s[40:43], s79 offen offset:3072 sc1 lds
    s_add_u32 s79, s98, s100
    s_add_u32 m0, s27, 0
    v_mfma_f32_16x16x32_bf16 v[220:223], a[144:147], a[160:163], v[220:223]
    buffer_load_dwordx4 v20, s[36:39], s79 offen lds
    s_addk_i32 m0, 960
    v_mfma_f32_16x16x32_bf16 v[220:223], a[148:151], a[164:167], v[220:223]
    ds_read_b128 a[0:3], v11 offset:18432
    ds_read_b128 a[4:7], v11 offset:22528
    v_mfma_f32_16x16x32_bf16 v[220:223], a[152:155], a[168:171], v[220:223]
    buffer_load_dwordx4 v20, s[36:39], s79 offen offset:64 lds
    ds_read_b128 a[8:11], v11 offset:19456
    ds_read_b128 a[12:15], v11 offset:23552
    ds_read_b128 a[28:31], v11 offset:21504
    ds_read_b128 a[24:27], v11 offset:17408
    ds_read_b128 a[20:23], v11 offset:20480
    ds_read_b128 a[16:19], v11 offset:16384
    s_addk_i32 m0, 64
    v_mfma_f32_16x16x32_bf16 v[220:223], a[156:159], a[172:175], v[220:223]
PG_14:
    s_cbranch_execz PG_done
    s_waitcnt lgkmcnt(8)
    buffer_load_dwordx4 v20, s[36:39], s79 offen offset:1024 lds
    s_addk_i32 m0, 960
    v_mfma_f32_16x16x32_bf16 v[216:219], a[156:159], a[188:191], v[216:219]
    v_mfma_f32_16x16x32_bf16 v[216:219], a[152:155], a[184:187], v[216:219]
    buffer_load_dwordx4 v20, s[36:39], s79 offen offset:1088 lds
    v_mfma_f32_16x16x32_bf16 v[216:219], a[148:151], a[180:183], v[216:219]
    v_mfma_f32_16x16x32_bf16 v[216:219], a[144:147], a[176:179], v[216:219]
    s_waitcnt vmcnt(8) lgkmcnt(0)
    s_barrier
    v_mfma_f32_16x16x32_bf16 v[212:215], a[144:147], a[0:3], v[212:215]
    buffer_store_dword v25, v24, s[48:51], s60 offen offset:128 sc1
    v_mfma_f32_16x16x32_bf16 v[212:215], a[148:151], a[4:7], v[212:215]
    s_addk_i32 s100, 128
    s_and_b32 s100, s100, 1023
    s_lshl_b32 s79, s100, 7
    s_add_u32 s79, s79, s97
    s_add_u32 m0, s25, 16384
    v_mfma_f32_16x16x32_bf16 v[212:215], a[152:155], a[8:11], v[212:215]
    ds_read_b128 a[32:35], v12 offset:16384
    ds_read_b64_tr_b16 a[128:129], v17 offset:0
    ds_read_b64_tr_b16 a[130:131], v17 offset:64
    ds_read_b128 a[36:39], v12 offset:20480
    ds_read_b64_tr_b16 a[132:133], v17 offset:4096
    ds_read_b64_tr_b16 a[134:135], v17 offset:4160
    ds_read_b128 a[40:43], v12 offset:17408
    ds_read_b64_tr_b16 a[136:137], v17 offset:8192
    ds_read_b64_tr_b16 a[138:139], v17 offset:8256
    ds_read_b128 a[44:47], v12 offset:21504
    ds_read_b64_tr_b16 a[140:141], v17 offset:12288
    ds_read_b64_tr_b16 a[142:143], v17 offset:12352
    v_mfma_f32_16x16x32_bf16 v[212:215], a[156:159], a[12:15], v[212:215]
    buffer_load_dwordx4 v22, s[40:43], s79 offen sc1 lds
    v_mfma_f32_16x16x32_bf16 v[208:211], a[156:159], a[28:31], v[208:211]
    buffer_load_dwordx4 v22, s[40:43], s79 offen offset:1024 sc1 lds
    v_mfma_f32_16x16x32_bf16 v[208:211], a[152:155], a[24:27], v[208:211]
    ds_read_b128 a[60:63], v12 offset:23552
    ds_read_b128 a[56:59], v12 offset:19456
    v_mfma_f32_16x16x32_bf16 v[208:211], a[148:151], a[20:23], v[208:211]
    ds_read_b128 a[52:55], v12 offset:22528
    ds_read_b128 a[48:51], v12 offset:18432
    v_mfma_f32_16x16x32_bf16 v[208:211], a[144:147], a[16:19], v[208:211]
    s_waitcnt lgkmcnt(4)
    buffer_load_dwordx4 v22, s[40:43], s79 offen offset:2048 sc1 lds
    buffer_load_dwordx4 v22, s[40:43], s79 offen offset:3072 sc1 lds
    s_add_u32 s79, s98, s100
    s_add_u32 m0, s27, 16384
    v_mfma_f32_16x16x32_bf16 v[208:211], a[128:131], a[32:35], v[208:211]
    buffer_load_dwordx4 v20, s[36:39], s79 offen lds
    s_addk_i32 m0, 960
    v_mfma_f32_16x16x32_bf16 v[208:211], a[132:135], a[36:39], v[208:211]
    ds_read_b128 a[160:163], v12 offset:24576
    ds_read_b128 a[164:167], v12 offset:28672
    v_mfma_f32_16x16x32_bf16 v[208:211], a[136:139], a[40:43], v[208:211]
    buffer_load_dwordx4 v20, s[36:39], s79 offen offset:64 lds
    ds_read_b128 a[168:171], v12 offset:25600
    ds_read_b128 a[172:175], v12 offset:29696
    ds_read_b128 a[188:191], v12 offset:31744
    ds_read_b128 a[184:187], v12 offset:27648
    ds_read_b128 a[180:183], v12 offset:30720
    ds_read_b128 a[176:179], v12 offset:26624
    s_addk_i32 m0, 64
    v_mfma_f32_16x16x32_bf16 v[208:211], a[140:143], a[44:47], v[208:211]
    s_waitcnt lgkmcnt(8)
    buffer_load_dwordx4 v20, s[36:39], s79 offen offset:1024 lds
    s_addk_i32 m0, 960
    v_mfma_f32_16x16x32_bf16 v[212:215], a[140:143], a[60:63], v[212:215]
    buffer_load_dword v27, v26, s[48:51], s61 offen sc1
    v_mfma_f32_16x16x32_bf16 v[212:215], a[136:139], a[56:59], v[212:215]
    buffer_load_dwordx4 v20, s[36:39], s79 offen offset:1088 lds
    v_mfma_f32_16x16x32_bf16 v[212:215], a[132:135], a[52:55], v[212:215]
    v_mfma_f32_16x16x32_bf16 v[212:215], a[128:131], a[48:51], v[212:215]
    s_waitcnt lgkmcnt(0)
    s_barrier
    v_mfma_f32_16x16x32_bf16 v[216:219], a[128:131], a[160:163], v[216:219]
    s_addk_i32 s100, 128
    s_and_b32 s100, s100, 1023
    s_lshl_b32 s79, s100, 7
    v_mfma_f32_16x16x32_bf16 v[216:219], a[132:135], a[164:167], v[216:219]
    s_add_u32 s79, s79, s97
    s_add_u32 m0, s28, 0
    ds_read_b128 a[0:3], v10 offset:10240
    v_mfma_f32_16x16x32_bf16 v[216:219], a[136:139], a[168:171], v[216:219]
    ds_read_b64_tr_b16 a[144:145], v13 offset:0
    ds_read_b64_tr_b16 a[146:147], v13 offset:64
    ds_read_b128 a[4:7], v10 offset:14336
    ds_read_b64_tr_b16 a[148:149], v13 offset:4096
    ds_read_b64_tr_b16 a[150:151], v13 offset:4160
    ds_read_b128 a[8:11], v10 offset:11264
    ds_read_b64_tr_b16 a[152:153], v13 offset:8192
    ds_read_b64_tr_b16 a[154:155], v13 offset:8256
    ds_read_b128 a[12:15], v10 offset:15360
    ds_read_b64_tr_b16 a[156:157], v13 offset:12288
    ds_read_b64_tr_b16 a[158:159], v13 offset:12352
    v_mfma_f32_16x16x32_bf16 v[216:219], a[140:143], a[172:175], v[216:219]
    buffer_load_dwordx4 v22, s[40:43], s79 offen sc1 lds
    v_mfma_f32_16x16x32_bf16 v[220:223], a[140:143], a[188:191], v[220:223]
    buffer_load_dwordx4 v22, s[40:43], s79 offen offset:1024 sc1 lds
    v_mfma_f32_16x16x32_bf16 v[220:223], a[136:139], a[184:187], v[220:223]
    ds_read_b128 a[28:31], v10 offset:13312
    ds_read_b128 a[24:27], v10 offset:9216
    v_mfma_f32_16x16x32_bf16 v[220:223], a[132:135], a[180:183], v[220:223]
    ds_read_b128 a[20:23], v10 offset:12288
    ds_read_b128 a[16:19], v10 offset:8192
    v_mfma_f32_16x16x32_bf16 v[220:223], a[128:131], a[176:179], v[220:223]
    s_waitcnt lgkmcnt(4)
    buffer_load_dwordx4 v22, s[40:43], s79 offen offset:2048 sc1 lds
    buffer_load_dwordx4 v22, s[40:43], s79 offen offset:3072 sc1 lds
    s_add_u32 s79, s98, s100
    s_addk_i32 m0, 16384
    v_mfma_f32_16x16x32_bf16 v[220:223], a[144:147], a[0:3], v[220:223]
    buffer_load_dwordx4 v20, s[36:39], s79 offen lds
    s_addk_i32 m0, 960
    v_mfma_f32_16x16x32_bf16 v[220:223], a[148:151], a[4:7], v[220:223]
    ds_read_b128 a[32:35], v10 offset:2048
    ds_read_b128 a[36:39], v10 offset:6144
    v_mfma_f32_16x16x32_bf16 v[220:223], a[152:155], a[8:11], v[220:223]
    buffer_load_dwordx4 v20, s[36:39], s79 offen offset:64 lds
    ds_read_b128 a[40:43], v10 offset:3072
    ds_read_b128 a[44:47], v10 offset:7168
    ds_read_b128 a[60:63], v10 offset:5120
    ds_read_b128 a[56:59], v10 offset:1024
    ds_read_b128 a[52:55], v10 offset:4096
    ds_read_b128 a[48:51], v10 offset:0
    s_addk_i32 m0, 64
    v_mfma_f32_16x16x32_bf16 v[220:223], a[156:159], a[12:15], v[220:223]
    s_waitcnt lgkmcnt(8)
    buffer_load_dwordx4 v20, s[36:39], s79 offen offset:1024 lds
    s_addk_i32 m0, 960
    v_mfma_f32_16x16x32_bf16 v[216:219], a[156:159], a[28:31], v[216:219]
    v_mfma_f32_16x16x32_bf16 v[216:219], a[152:155], a[24:27], v[216:219]
    buffer_load_dwordx4 v20, s[36:39], s79 offen offset:1088 lds
    v_mfma_f32_16x16x32_bf16 v[216:219], a[148:151], a[20:23], v[216:219]
    v_mfma_f32_16x16x32_bf16 v[216:219], a[144:147], a[16:19], v[216:219]
    s_waitcnt lgkmcnt(0)
    s_barrier
    v_mfma_f32_16x16x32_bf16 v[212:215], a[144:147], a[32:35], v[212:215]
    ds_read_b128 a[160:163], v10 offset:16384
    ds_read_b64_tr_b16 a[128:129], v13 offset:16384
    v_mfma_f32_16x16x32_bf16 v[212:215], a[148:151], a[36:39], v[212:215]
    ds_read_b64_tr_b16 a[130:131], v13 offset:16448
    ds_read_b128 a[164:167], v10 offset:20480
    v_mfma_f32_16x16x32_bf16 v[212:215], a[152:155], a[40:43], v[212:215]
    ds_read_b64_tr_b16 a[132:133], v13 offset:20480
    ds_read_b64_tr_b16 a[134:135], v13 offset:20544
    ds_read_b128 a[168:171], v10 offset:17408
    ds_read_b64_tr_b16 a[136:137], v13 offset:24576
    ds_read_b64_tr_b16 a[138:139], v13 offset:24640
    ds_read_b128 a[172:175], v10 offset:21504
    ds_read_b64_tr_b16 a[140:141], v13 offset:28672
    ds_read_b64_tr_b16 a[142:143], v13 offset:28736
    v_mfma_f32_16x16x32_bf16 v[212:215], a[156:159], a[44:47], v[212:215]
    ds_read_b128 a[188:191], v10 offset:23552
    ds_read_b128 a[184:187], v10 offset:19456
    v_mfma_f32_16x16x32_bf16 v[208:211], a[156:159], a[60:63], v[208:211]
    ds_read_b128 a[180:183], v10 offset:22528
    ds_read_b128 a[176:179], v10 offset:18432
    v_mfma_f32_16x16x32_bf16 v[208:211], a[152:155], a[56:59], v[208:211]
    ds_read_b128 a[0:3], v10 offset:24576
    ds_read_b128 a[4:7], v10 offset:28672
    v_mfma_f32_16x16x32_bf16 v[208:211], a[148:151], a[52:55], v[208:211]
    ds_read_b128 a[8:11], v10 offset:25600
    ds_read_b128 a[12:15], v10 offset:29696
    v_mfma_f32_16x16x32_bf16 v[208:211], a[144:147], a[48:51], v[208:211]
    s_waitcnt lgkmcnt(8)
    ds_read_b128 a[28:31], v10 offset:31744
    ds_read_b128 a[24:27], v10 offset:27648
    v_mfma_f32_16x16x32_bf16 v[208:211], a[128:131], a[160:163], v[208:211]
    ds_read_b128 a[20:23], v10 offset:30720
    ds_read_b128 a[16:19], v10 offset:26624
    v_mfma_f32_16x16x32_bf16 v[208:211], a[132:135], a[164:167], v[208:211]
    v_mfma_f32_16x16x32_bf16 v[208:211], a[136:139], a[168:171], v[208:211]
    v_mfma_f32_16x16x32_bf16 v[208:211], a[140:143], a[172:175], v[208:211]
    s_waitcnt lgkmcnt(8)
    v_mfma_f32_16x16x32_bf16 v[212:215], a[140:143], a[188:191], v[212:215]
    v_mfma_f32_16x16x32_bf16 v[212:215], a[136:139], a[184:187], v[212:215]
    v_mfma_f32_16x16x32_bf16 v[212:215], a[132:135], a[180:183], v[212:215]
    v_mfma_f32_16x16x32_bf16 v[212:215], a[128:131], a[176:179], v[212:215]
POLL_PL:
    s_waitcnt vmcnt(9)
    v_cmp_ne_u32 vcc, s83, v27
    s_nop 0
    s_cbranch_vccnz SPIN_PL
POLLOK_PL:
    s_waitcnt lgkmcnt(0)
    s_barrier
    v_mfma_f32_16x16x32_bf16 v[216:219], a[128:131], a[0:3], v[216:219]
    buffer_load_dwordx4 v[40:43], v22, s[40:43], s93 offen sc1
    v_mfma_f32_16x16x32_bf16 v[216:219], a[132:135], a[4:7], v[216:219]
    s_addk_i32 s93, 4096
    ds_read_b128 a[32:35], v11 offset:10240
    ds_read_b64_tr_b16 a[144:145], v14 offset:0
    v_mfma_f32_16x16x32_bf16 v[216:219], a[136:139], a[8:11], v[216:219]
    ds_read_b64_tr_b16 a[146:147], v14 offset:64
    ds_read_b128 a[36:39], v11 offset:14336
    ds_read_b64_tr_b16 a[148:149], v14 offset:4096
    ds_read_b64_tr_b16 a[150:151], v14 offset:4160
    ds_read_b128 a[40:43], v11 offset:11264
    ds_read_b64_tr_b16 a[152:153], v14 offset:8192
    ds_read_b64_tr_b16 a[154:155], v14 offset:8256
    ds_read_b128 a[44:47], v11 offset:15360
    ds_read_b64_tr_b16 a[156:157], v14 offset:12288
    ds_read_b64_tr_b16 a[158:159], v14 offset:12352
    v_mfma_f32_16x16x32_bf16 v[216:219], a[140:143], a[12:15], v[216:219]
    buffer_load_dwordx4 v[44:47], v22, s[40:43], s93 offen sc1
    v_mfma_f32_16x16x32_bf16 v[220:223], a[140:143], a[28:31], v[220:223]
    s_addk_i32 s93, 4096
    ds_read_b128 a[60:63], v11 offset:13312
    ds_read_b128 a[56:59], v11 offset:9216
    v_mfma_f32_16x16x32_bf16 v[220:223], a[136:139], a[24:27], v[220:223]
    buffer_load_dwordx4 v[48:51], v22, s[40:43], s93 offen sc1
    v_mfma_f32_16x16x32_bf16 v[220:223], a[132:135], a[20:23], v[220:223]
    s_addk_i32 s93, 4096
    ds_read_b128 a[52:55], v11 offset:12288
    ds_read_b128 a[48:51], v11 offset:8192
    v_mfma_f32_16x16x32_bf16 v[220:223], a[128:131], a[16:19], v[220:223]
    s_waitcnt lgkmcnt(4)
    buffer_load_dwordx4 v[52:55], v22, s[40:43], s93 offen sc1
    v_mfma_f32_16x16x32_bf16 v[220:223], a[144:147], a[32:35], v[220:223]
    s_addk_i32 s93, 4096
    ds_read_b128 a[160:163], v11 offset:2048
    ds_read_b128 a[164:167], v11 offset:6144
    v_mfma_f32_16x16x32_bf16 v[220:223], a[148:151], a[36:39], v[220:223]
    buffer_load_dwordx4 v[56:59], v22, s[40:43], s93 offen sc1
    v_mfma_f32_16x16x32_bf16 v[220:223], a[152:155], a[40:43], v[220:223]
    s_addk_i32 s93, 4096
    ds_read_b128 a[168:171], v11 offset:3072
    ds_read_b128 a[172:175], v11 offset:7168
    ds_read_b128 a[188:191], v11 offset:5120
    ds_read_b128 a[184:187], v11 offset:1024
    ds_read_b128 a[180:183], v11 offset:4096
    ds_read_b128 a[176:179], v11 offset:0
    v_mfma_f32_16x16x32_bf16 v[220:223], a[156:159], a[44:47], v[220:223]
    s_waitcnt lgkmcnt(8)
    buffer_load_dwordx4 v[60:63], v22, s[40:43], s93 offen sc1
    v_mfma_f32_16x16x32_bf16 v[216:219], a[156:159], a[60:63], v[216:219]
    s_addk_i32 s93, 4096
    v_mfma_f32_16x16x32_bf16 v[216:219], a[152:155], a[56:59], v[216:219]
    buffer_load_dwordx4 v[64:67], v22, s[40:43], s93 offen sc1
    v_mfma_f32_16x16x32_bf16 v[216:219], a[148:151], a[52:55], v[216:219]
    s_add_u32 s93, s93, 204800
    s_addk_i32 s61, 128
    v_mfma_f32_16x16x32_bf16 v[216:219], a[144:147], a[48:51], v[216:219]
    s_waitcnt vmcnt(15) lgkmcnt(0)
    s_barrier
    v_mfma_f32_16x16x32_bf16 v[212:215], a[144:147], a[160:163], v[212:215]
    ds_read_b128 a[0:3], v11 offset:16384
    ds_read_b64_tr_b16 a[128:129], v14 offset:16384
    v_mfma_f32_16x16x32_bf16 v[212:215], a[148:151], a[164:167], v[212:215]
    ds_read_b64_tr_b16 a[130:131], v14 offset:16448
    ds_read_b128 a[4:7], v11 offset:20480
    v_mfma_f32_16x16x32_bf16 v[212:215], a[152:155], a[168:171], v[212:215]
    ds_read_b64_tr_b16 a[132:133], v14 offset:20480
    ds_read_b64_tr_b16 a[134:135], v14 offset:20544
    ds_read_b128 a[8:11], v11 offset:17408
    ds_read_b64_tr_b16 a[136:137], v14 offset:24576
    ds_read_b64_tr_b16 a[138:139], v14 offset:24640
    ds_read_b128 a[12:15], v11 offset:21504
    ds_read_b64_tr_b16 a[140:141], v14 offset:28672
    ds_read_b64_tr_b16 a[142:143], v14 offset:28736
    v_mfma_f32_16x16x32_bf16 v[212:215], a[156:159], a[172:175], v[212:215]
    s_add_u32 s61, s61, 71368704
    s_mov_b32 s83, 1
    s_mov_b32 s94, 0
    v_mfma_f32_16x16x32_bf16 v[208:211], a[156:159], a[188:191], v[208:211]
    buffer_load_dword v27, v26, s[40:43], s61 offen sc1
    v_mfma_f32_16x16x32_bf16 v[208:211], a[152:155], a[184:187], v[208:211]
    ds_read_b128 a[28:31], v11 offset:23552
    ds_read_b128 a[24:27], v11 offset:19456
    v_mfma_f32_16x16x32_bf16 v[208:211], a[148:151], a[180:183], v[208:211]
    ds_read_b128 a[20:23], v11 offset:22528
    ds_read_b128 a[16:19], v11 offset:18432
    v_mfma_f32_16x16x32_bf16 v[208:211], a[144:147], a[176:179], v[208:211]
    s_waitcnt lgkmcnt(4)
    ds_read_b128 a[32:35], v11 offset:24576
    ds_read_b128 a[36:39], v11 offset:28672
    v_mfma_f32_16x16x32_bf16 v[208:211], a[128:131], a[0:3], v[208:211]
    ds_read_b128 a[40:43], v11 offset:25600
    ds_read_b128 a[44:47], v11 offset:29696
    v_mfma_f32_16x16x32_bf16 v[208:211], a[132:135], a[4:7], v[208:211]
    ds_read_b128 a[60:63], v11 offset:31744
    ds_read_b128 a[56:59], v11 offset:27648
    v_mfma_f32_16x16x32_bf16 v[208:211], a[136:139], a[8:11], v[208:211]
    ds_read_b128 a[52:55], v11 offset:30720
    ds_read_b128 a[48:51], v11 offset:26624
    v_mfma_f32_16x16x32_bf16 v[208:211], a[140:143], a[12:15], v[208:211]
    s_waitcnt lgkmcnt(8)
    v_mfma_f32_16x16x32_bf16 v[212:215], a[140:143], a[28:31], v[212:215]
    s_waitcnt vmcnt(7)
    v_mfma_f32_16x16x32_bf16 v[32:35], v[70:73], v[40:43], v[32:35]
    v_mfma_f32_16x16x32_bf16 v[212:215], a[136:139], a[24:27], v[212:215]
    v_mfma_f32_16x16x32_bf16 v[36:39], v[68:71], v[40:43], v[36:39]
    v_mfma_f32_16x16x32_bf16 v[212:215], a[132:135], a[20:23], v[212:215]
    s_waitcnt vmcnt(6)
    v_mfma_f32_16x16x32_bf16 v[32:35], v[70:73], v[44:47], v[32:35]
    v_mfma_f32_16x16x32_bf16 v[212:215], a[128:131], a[16:19], v[212:215]
    s_waitcnt lgkmcnt(0)
    s_barrier
    v_mfma_f32_16x16x32_bf16 v[216:219], a[128:131], a[32:35], v[216:219]
    ds_read_b128 a[160:163], v12 offset:26624
    ds_read_b64_tr_b16 a[144:145], v17 offset:0
    v_mfma_f32_16x16x32_bf16 v[216:219], a[132:135], a[36:39], v[216:219]
    ds_read_b64_tr_b16 a[146:147], v17 offset:64
    ds_read_b128 a[164:167], v12 offset:30720
    v_mfma_f32_16x16x32_bf16 v[216:219], a[136:139], a[40:43], v[216:219]
    ds_read_b64_tr_b16 a[148:149], v17 offset:4096
    ds_read_b64_tr_b16 a[150:151], v17 offset:4160
    ds_read_b128 a[168:171], v12 offset:27648
    ds_read_b64_tr_b16 a[152:153], v17 offset:8192
    ds_read_b64_tr_b16 a[154:155], v17 offset:8256
    ds_read_b128 a[172:175], v12 offset:31744
    ds_read_b64_tr_b16 a[156:157], v17 offset:12288
    ds_read_b64_tr_b16 a[158:159], v17 offset:12352
    v_mfma_f32_16x16x32_bf16 v[216:219], a[140:143], a[44:47], v[216:219]
    v_mfma_f32_16x16x32_bf16 v[36:39], v[68:71], v[44:47], v[36:39]
    v_mfma_f32_16x16x32_bf16 v[220:223], a[140:143], a[60:63], v[220:223]
    ds_read_b128 a[188:191], v12 offset:29696
    ds_read_b128 a[184:187], v12 offset:25600
    v_mfma_f32_16x16x32_bf16 v[220:223], a[136:139], a[56:59], v[220:223]
    ds_read_b128 a[180:183], v12 offset:28672
    ds_read_b128 a[176:179], v12 offset:24576
    v_mfma_f32_16x16x32_bf16 v[220:223], a[132:135], a[52:55], v[220:223]
    s_waitcnt vmcnt(5)
    v_mfma_f32_16x16x32_bf16 v[32:35], v[70:73], v[48:51], v[32:35]
    v_mfma_f32_16x16x32_bf16 v[220:223], a[128:131], a[48:51], v[220:223]
    s_waitcnt lgkmcnt(4)
    v_mfma_f32_16x16x32_bf16 v[36:39], v[68:71], v[48:51], v[36:39]
    v_mfma_f32_16x16x32_bf16 v[220:223], a[144:147], a[160:163], v[220:223]
    ds_read_b128 a[0:3], v12 offset:18432
    ds_read_b128 a[4:7], v12 offset:22528
    v_mfma_f32_16x16x32_bf16 v[220:223], a[148:151], a[164:167], v[220:223]
    ds_read_b128 a[8:11], v12 offset:19456
    ds_read_b128 a[12:15], v12 offset:23552
    v_mfma_f32_16x16x32_bf16 v[220:223], a[152:155], a[168:171], v[220:223]
    s_waitcnt vmcnt(4)
    v_mfma_f32_16x16x32_bf16 v[32:35], v[70:73], v[52:55], v[32:35]
    s_waitcnt vmcnt(0)
    v_cmp_ne_u32 vcc, 1, v27
    s_nop 0
    s_cbranch_vccnz PH_later
    s_mov_b32 s94, 1
    buffer_load_dwordx4 v[104:107], v22, s[40:43], s93 offen sc1
    s_addk_i32 s93, 4096
    buffer_load_dwordx4 v[108:111], v22, s[40:43], s93 offen sc1
    s_addk_i32 s93, 4096
    buffer_load_dwordx4 v[112:115], v22, s[40:43], s93 offen sc1
    s_addk_i32 s93, 4096
    buffer_load_dwordx4 v[116:119], v22, s[40:43], s93 offen sc1
    s_addk_i32 s93, 4096
    buffer_load_dwordx4 v[120:123], v22, s[40:43], s93 offen sc1
    s_addk_i32 s93, 4096
    buffer_load_dwordx4 v[124:127], v22, s[40:43], s93 offen sc1
    s_addk_i32 s93, 4096
    buffer_load_dwordx4 v[128:131], v22, s[40:43], s93 offen sc1
    s_add_u32 s93, s93, 204800
PH_later:
    v_mfma_f32_16x16x32_bf16 v[220:223], a[156:159], a[172:175], v[220:223]
    s_waitcnt lgkmcnt(4)
    v_mfma_f32_16x16x32_bf16 v[36:39], v[68:71], v[52:55], v[36:39]
    v_mfma_f32_16x16x32_bf16 v[216:219], a[156:159], a[188:191], v[216:219]
    v_mfma_f32_16x16x32_bf16 v[32:35], v[70:73], v[56:59], v[32:35]
    v_mfma_f32_16x16x32_bf16 v[216:219], a[152:155], a[184:187], v[216:219]
    ds_read_b128 a[28:31], v12 offset:21504
    ds_read_b128 a[24:27], v12 offset:17408
    v_mfma_f32_16x16x32_bf16 v[216:219], a[148:151], a[180:183], v[216:219]
    ds_read_b128 a[20:23], v12 offset:20480
    ds_read_b128 a[16:19], v12 offset:16384
    v_mfma_f32_16x16x32_bf16 v[216:219], a[144:147], a[176:179], v[216:219]
    s_waitcnt lgkmcnt(4)
    v_mfma_f32_16x16x32_bf16 v[36:39], v[68:71], v[56:59], v[36:39]
    v_mfma_f32_16x16x32_bf16 v[212:215], a[144:147], a[0:3], v[212:215]
    v_mfma_f32_16x16x32_bf16 v[32:35], v[70:73], v[60:63], v[32:35]
    v_mfma_f32_16x16x32_bf16 v[212:215], a[148:151], a[4:7], v[212:215]
    v_mfma_f32_16x16x32_bf16 v[36:39], v[68:71], v[60:63], v[36:39]
    v_mfma_f32_16x16x32_bf16 v[212:215], a[152:155], a[8:11], v[212:215]
    v_mfma_f32_16x16x32_bf16 v[32:35], v[70:73], v[64:67], v[32:35]
    v_mfma_f32_16x16x32_bf16 v[212:215], a[156:159], a[12:15], v[212:215]
    s_waitcnt lgkmcnt(0)
    v_mfma_f32_16x16x32_bf16 v[36:39], v[68:71], v[64:67], v[36:39]
    v_mfma_f32_16x16x32_bf16 v[208:211], a[156:159], a[28:31], v[208:211]
    v_mfma_f32_16x16x32_bf16 v[208:211], a[152:155], a[24:27], v[208:211]
    v_mfma_f32_16x16x32_bf16 v[208:211], a[148:151], a[20:23], v[208:211]
    v_mfma_f32_16x16x32_bf16 v[208:211], a[144:147], a[16:19], v[208:211]
    s_cmp_eq_u32 s94, 0
    s_cbranch_scc1 PH_slow
    s_waitcnt vmcnt(6)
    v_mfma_f32_16x16x32_bf16 v[96:99], v[70:73], v[104:107], v[96:99]
    s_lshl_b32 s67, s64, 19
    s_sub_u32 s69, 7864320, s67
    v_mfma_f32_16x16x32_bf16 v[100:103], v[68:71], v[104:107], v[100:103]
    s_waitcnt vmcnt(5)
    v_mfma_f32_16x16x32_bf16 v[96:99], v[70:73], v[108:111], v[96:99]
    s_add_u32 s67, s67, s91
    v_add_f32 v224, v224, v208
    v_add_f32 v225, v225, v212
    v_mfma_f32_16x16x32_bf16 v[100:103], v[68:71], v[108:111], v[100:103]
    v_add_f32 v226, v226, v216
    v_add_f32 v227, v227, v220
    s_waitcnt vmcnt(4)
    v_mfma_f32_16x16x32_bf16 v[96:99], v[70:73], v[112:115], v[96:99]
    buffer_store_dwordx4 v[224:227], v23, s[4:7], s90 offen sc1
    v_mfma_f32_16x16x32_bf16 v[100:103], v[68:71], v[112:115], v[100:103]
    s_addk_i32 s90, 4096
    v_add_f32 v228, v228, v209
    v_add_f32 v229, v229, v213
    s_waitcnt vmcnt(4)
    v_mfma_f32_16x16x32_bf16 v[96:99], v[70:73], v[116:119], v[96:99]
    s_add_u32 s68, s67, 32768
    v_add_f32 v230, v230, v217
    v_add_f32 v231, v231, v221
    v_mfma_f32_16x16x32_bf16 v[100:103], v[68:71], v[116:119], v[100:103]
    buffer_store_dwordx4 v[228:231], v23, s[4:7], s90 offen sc1
    s_waitcnt vmcnt(4)
    v_mfma_f32_16x16x32_bf16 v[96:99], v[70:73], v[120:123], v[96:99]
    s_addk_i32 s90, 4096
    v_add_f32 v232, v232, v210
    v_add_f32 v233, v233, v214
    v_mfma_f32_16x16x32_bf16 v[100:103], v[68:71], v[120:123], v[100:103]
    s_add_u32 s69, s69, s91
    v_add_f32 v234, v234, v218
    v_add_f32 v235, v235, v222
    s_waitcnt vmcnt(3)
    v_mfma_f32_16x16x32_bf16 v[96:99], v[70:73], v[124:127], v[96:99]
    buffer_store_dwordx4 v[232:235], v23, s[4:7], s90 offen sc1
    v_mfma_f32_16x16x32_bf16 v[100:103], v[68:71], v[124:127], v[100:103]
    s_addk_i32 s90, 4096
    v_add_f32 v236, v236, v211
    v_add_f32 v237, v237, v215
    s_waitcnt vmcnt(3)
    v_mfma_f32_16x16x32_bf16 v[96:99], v[70:73], v[128:131], v[96:99]
    s_add_u32 s70, s69, 32768
    v_add_f32 v238, v238, v219
    v_add_f32 v239, v239, v223
    v_mfma_f32_16x16x32_bf16 v[100:103], v[68:71], v[128:131], v[100:103]
    buffer_store_dwordx4 v[236:239], v23, s[4:7], s90 offen sc1
    ds_write_b128 v29, v[32:35] offset:0
    ds_write_b128 v29, v[36:39] offset:64
    s_nop 0
    ds_write_b128 v29, v[96:99] offset:16384
    s_nop 2
    ds_write_b128 v29, v[100:103] offset:16448
    s_waitcnt lgkmcnt(0)
    ds_read_b128 v[80:83], v28 offset:0
    ds_read_b128 v[84:87], v28 offset:1152
    ds_read_b128 v[144:147], v28 offset:16384
    ds_read_b128 v[148:151], v28 offset:17536
    s_waitcnt lgkmcnt(3)
    buffer_store_dwordx4 v[80:83], v21, s[4:7], s67 offen offset:2048 sc1
    s_waitcnt lgkmcnt(2)
    buffer_store_dwordx4 v[84:87], v21, s[4:7], s68 offen offset:2048 sc1
    s_waitcnt lgkmcnt(1)
    buffer_store_dwordx4 v[144:147], v21, s[4:7], s69 offen offset:2048 sc1
    s_waitcnt lgkmcnt(0)
    buffer_store_dwordx4 v[148:151], v21, s[4:7], s70 offen offset:2048 sc1
    s_branch PH_fin
PH_slow:
    ds_write_b128 v29, v[32:35] offset:0
    s_nop 0
    ds_write_b128 v29, v[36:39] offset:64
    s_lshl_b32 s67, s64, 19
    s_add_u32 s67, s67, s91
    s_add_u32 s68, s67, 32768
    s_waitcnt lgkmcnt(0)
    ds_read_b128 v[80:83], v28 offset:0
    ds_read_b128 v[84:87], v28 offset:1152
    v_add_f32 v224, v224, v208
    v_add_f32 v225, v225, v212
    v_add_f32 v226, v226, v216
    v_add_f32 v227, v227, v220
    v_add_f32 v228, v228, v209
    v_add_f32 v229, v229, v213
    v_add_f32 v230, v230, v217
    v_add_f32 v231, v231, v221
    v_add_f32 v232, v232, v210
    v_add_f32 v233, v233, v214
    v_add_f32 v234, v234, v218
    v_add_f32 v235, v235, v222
    v_add_f32 v236, v236, v211
    v_add_f32 v237, v237, v215
    v_add_f32 v238, v238, v219
    v_add_f32 v239, v239, v223
    s_waitcnt lgkmcnt(1)
    buffer_store_dwordx4 v[80:83], v21, s[4:7], s67 offen offset:2048 sc1
    s_waitcnt lgkmcnt(0)
    buffer_store_dwordx4 v[84:87], v21, s[4:7], s68 offen offset:2048 sc1
    buffer_store_dwordx4 v[224:227], v23, s[4:7], s90 offen sc1
    s_addk_i32 s90, 4096
    buffer_store_dwordx4 v[228:231], v23, s[4:7], s90 offen sc1
    s_addk_i32 s90, 4096
    buffer_store_dwordx4 v[232:235], v23, s[4:7], s90 offen sc1
    s_addk_i32 s90, 4096
    buffer_store_dwordx4 v[236:239], v23, s[4:7], s90 offen sc1
POLL_PH:
    v_cmp_ne_u32 vcc, s83, v27
    s_nop 0
    s_cbranch_vccnz SPIN_PH
POLLOK_PH:
    s_waitcnt vmcnt(6)
    buffer_load_dwordx4 v[104:107], v22, s[40:43], s93 offen sc1
    s_addk_i32 s93, 4096
    buffer_load_dwordx4 v[108:111], v22, s[40:43], s93 offen sc1
    s_addk_i32 s93, 4096
    buffer_load_dwordx4 v[112:115], v22, s[40:43], s93 offen sc1
    s_addk_i32 s93, 4096
    buffer_load_dwordx4 v[116:119], v22, s[40:43], s93 offen sc1
    s_addk_i32 s93, 4096
    buffer_load_dwordx4 v[120:123], v22, s[40:43], s93 offen sc1
    s_addk_i32 s93, 4096
    buffer_load_dwordx4 v[124:127], v22, s[40:43], s93 offen sc1
    s_addk_i32 s93, 4096
    buffer_load_dwordx4 v[128:131], v22, s[40:43], s93 offen sc1
    s_add_u32 s93, s93, 204800
    s_waitcnt vmcnt(6)
    v_mfma_f32_16x16x32_bf16 v[96:99], v[70:73], v[104:107], v[96:99]
    v_mfma_f32_16x16x32_bf16 v[100:103], v[68:71], v[104:107], v[100:103]
    s_waitcnt vmcnt(5)
    v_mfma_f32_16x16x32_bf16 v[96:99], v[70:73], v[108:111], v[96:99]
    v_mfma_f32_16x16x32_bf16 v[100:103], v[68:71], v[108:111], v[100:103]
    s_waitcnt vmcnt(4)
    v_mfma_f32_16x16x32_bf16 v[96:99], v[70:73], v[112:115], v[96:99]
    v_mfma_f32_16x16x32_bf16 v[100:103], v[68:71], v[112:115], v[100:103]
    s_waitcnt vmcnt(3)
    v_mfma_f32_16x16x32_bf16 v[96:99], v[70:73], v[116:119], v[96:99]
    v_mfma_f32_16x16x32_bf16 v[100:103], v[68:71], v[116:119], v[100:103]
    s_waitcnt vmcnt(2)
    v_mfma_f32_16x16x32_bf16 v[96:99], v[70:73], v[120:123], v[96:99]
    v_mfma_f32_16x16x32_bf16 v[100:103], v[68:71], v[120:123], v[100:103]
    s_waitcnt vmcnt(1)
    v_mfma_f32_16x16x32_bf16 v[96:99], v[70:73], v[124:127], v[96:99]
    v_mfma_f32_16x16x32_bf16 v[100:103], v[68:71], v[124:127], v[100:103]
    s_waitcnt vmcnt(0)
    v_mfma_f32_16x16x32_bf16 v[96:99], v[70:73], v[128:131], v[96:99]
    v_mfma_f32_16x16x32_bf16 v[100:103], v[68:71], v[128:131], v[100:103]
PH_done:
    s_nop 6
    ds_write_b128 v29, v[96:99] offset:0
    ds_write_b128 v29, v[100:103] offset:64
    s_lshl_b32 s67, s64, 19
    s_sub_u32 s67, 7864320, s67
    s_add_u32 s67, s67, s91
    s_add_u32 s68, s67, 32768
    s_waitcnt lgkmcnt(0)
    ds_read_b128 v[144:147], v28 offset:0
    ds_read_b128 v[148:151], v28 offset:1152
    s_waitcnt lgkmcnt(1)
    buffer_store_dwordx4 v[144:147], v21, s[4:7], s67 offen offset:2048 sc1
    s_waitcnt lgkmcnt(0)
    buffer_store_dwordx4 v[148:151], v21, s[4:7], s68 offen offset:2048 sc1
PH_fin:
KA_end:
    s_endpgm
ATT_I7:
    s_waitcnt vmcnt(0)
    s_barrier
    buffer_store_dword v25, v24, s[48:51], s60 offen offset:0 sc1
    s_add_u32 s79, s99, s96
    s_add_u32 m0, s24, 0
    s_nop 0
    buffer_load_dwordx4 v21, s[32:35], s79 offen lds
    s_addk_i32 m0, 1024
    s_nop 0
    buffer_load_dwordx4 v23, s[32:35], s79 offen lds
    s_addk_i32 m0, 896
    s_nop 0
    buffer_load_dwordx4 v21, s[32:35], s79 offen offset:128 lds
    s_addk_i32 m0, 1024
    s_nop 0
    buffer_load_dwordx4 v23, s[32:35], s79 offen offset:128 lds
    s_add_u32 s99, s99, 65536
    s_and_b32 s99, s99, 524287
    s_add_u32 s79, s99, s96
    s_addk_i32 m0, 13440
    s_nop 0
    buffer_load_dwordx4 v21, s[32:35], s79 offen lds
    s_addk_i32 m0, 1024
    s_nop 0
    buffer_load_dwordx4 v23, s[32:35], s79 offen lds
    s_addk_i32 m0, 896
    s_nop 0
    buffer_load_dwordx4 v21, s[32:35], s79 offen offset:128 lds
    s_addk_i32 m0, 1024
    s_nop 0
    buffer_load_dwordx4 v23, s[32:35], s79 offen offset:128 lds
    s_branch ATT_S2
SPIN_PH:
    s_add_u32 s3, s3, 1
    s_cmp_gt_u32 s3, 0x100000
    s_cbranch_scc1 POLLOK_PH
    s_sleep 2
    buffer_load_dword v27, v26, s[40:43], s61 offen sc1
    s_waitcnt vmcnt(0)
    s_branch POLL_PH
SPIN_A:
    s_add_u32 s3, s3, 1
    s_cmp_gt_u32 s3, 0x100000
    s_cbranch_scc1 POLLOK_A
    s_sleep 2
    buffer_load_dword v27, v26, s[48:51], s61 offen sc1
    s_waitcnt vmcnt(0)
    s_branch POLL_A
SPIN_PL:
    s_add_u32 s3, s3, 1
    s_cmp_gt_u32 s3, 0x100000
    s_cbranch_scc1 POLLOK_PL
    s_sleep 2
    buffer_load_dword v27, v26, s[48:51], s61 offen sc1
    s_waitcnt vmcnt(0)
    s_branch POLL_PL
SPIN_B:
    s_add_u32 s3, s3, 1
    s_cmp_gt_u32 s3, 0x100000
    s_cbranch_scc1 POLLOK_B
    s_sleep 2
    buffer_load_dword v27, v26, s[48:51], 0 offen sc1
    s_waitcnt vmcnt(0)
    s_branch POLL_B
SPIN_KV:
    s_add_u32 s3, s3, 1
    s_cmp_gt_u32 s3, 0x100000
    s_cbranch_scc1 POLLOK_KV
    s_sleep 2
    buffer_load_dword v91, v90, s[48:51], s61 offen sc1
    s_waitcnt vmcnt(0)
    s_branch POLL_KV
SPIN_E:
    s_add_u32 s3, s3, 1
    s_cmp_gt_u32 s3, 0x100000
    s_cbranch_scc1 POLLOK_E
    s_sleep 2
    buffer_load_dword v91, v90, s[48:51], s61 offen sc1
    s_waitcnt vmcnt(0)
    s_branch POLL_E
SPIN_Z:
    s_add_u32 s3, s3, 1
    s_cmp_gt_u32 s3, 0x100000
    s_cbranch_scc1 POLLOK_Z
    s_sleep 2
    buffer_load_dword v91, v90, s[56:59], 0 offen sc1
    s_waitcnt vmcnt(0)
    s_branch POLL_Z
KA_codeend:
FIX_DL_0:
    s_waitcnt vmcnt(0) lgkmcnt(0)
    s_call_b64 s[88:89], FIXS_0_0_1
    s_call_b64 s[88:89], FIXO_0_0
    s_call_b64 s[88:89], FIXS_0_1_1
    s_call_b64 s[88:89], FIXO_0_1
    s_call_b64 s[88:89], FIXS_1_0_1
    s_call_b64 s[88:89], FIXO_1_0
    s_call_b64 s[88:89], FIXS_1_1_1
    s_call_b64 s[88:89], FIXO_1_1
    v_mfma_f32_16x16x32_bf16 v[220:223], a[240:243], v[168:171], v[216:219]
    v_mfma_f32_16x16x32_bf16 v[220:223], a[244:247], v[172:175], v[220:223]
    v_mfma_f32_16x16x32_bf16 v[220:223], a[248:251], v[184:187], v[220:223]
    v_mfma_f32_16x16x32_bf16 v[220:223], a[252:255], v[188:191], v[220:223]
    s_nop 7
    s_branch FIX_DL_0_ret
FIX_DL_1:
    s_waitcnt vmcnt(0) lgkmcnt(0)
    s_call_b64 s[88:89], FIXS_0_0_0
    s_call_b64 s[88:89], FIXO_0_0
    s_call_b64 s[88:89], FIXS_0_1_0
    s_call_b64 s[88:89], FIXO_0_1
    s_call_b64 s[88:89], FIXS_1_0_0
    s_call_b64 s[88:89], FIXO_1_0
    s_call_b64 s[88:89], FIXS_1_1_0
    s_call_b64 s[88:89], FIXO_1_1
    v_mfma_f32_16x16x32_bf16 v[216:219], a[240:243], v[160:163], v[220:223]
    v_mfma_f32_16x16x32_bf16 v[216:219], a[244:247], v[164:167], v[216:219]
    v_mfma_f32_16x16x32_bf16 v[216:219], a[248:251], v[176:179], v[216:219]
    v_mfma_f32_16x16x32_bf16 v[216:219], a[252:255], v[180:183], v[216:219]
    s_nop 7
    s_branch FIX_DL_1_ret
FIX_D1_0:
    s_waitcnt vmcnt(0) lgkmcnt(0)
    s_call_b64 s[88:89], FIXS_0_0_1
    s_call_b64 s[88:89], FIXO_0_0
    s_call_b64 s[88:89], FIXS_0_1_1
    s_call_b64 s[88:89], FIXO_0_1
    s_call_b64 s[88:89], FIXS_1_0_1
    s_call_b64 s[88:89], FIXO_1_0
    s_call_b64 s[88:89], FIXS_1_1_1
    s_call_b64 s[88:89], FIXO_1_1
    v_mfma_f32_16x16x32_bf16 v[220:223], a[240:243], v[168:171], v[216:219]
    v_mfma_f32_16x16x32_bf16 v[220:223], a[244:247], v[172:175], v[220:223]
    v_mfma_f32_16x16x32_bf16 v[220:223], a[248:251], v[184:187], v[220:223]
    v_mfma_f32_16x16x32_bf16 v[220:223], a[252:255], v[188:191], v[220:223]
    s_nop 7
    s_branch FIX_D1_0_ret
FIX_D1_1:
    s_waitcnt vmcnt(0) lgkmcnt(0)
    s_call_b64 s[88:89], FIXS_0_0_0
    s_call_b64 s[88:89], FIXO_0_0
    s_call_b64 s[88:89], FIXS_0_1_0
    s_call_b64 s[88:89], FIXO_0_1
    s_call_b64 s[88:89], FIXS_1_0_0
    s_call_b64 s[88:89], FIXO_1_0
    s_call_b64 s[88:89], FIXS_1_1_0
    s_call_b64 s[88:89], FIXO_1_1
    v_mfma_f32_16x16x32_bf16 v[216:219], a[240:243], v[160:163], v[220:223]
    v_mfma_f32_16x16x32_bf16 v[216:219], a[244:247], v[164:167], v[216:219]
    v_mfma_f32_16x16x32_bf16 v[216:219], a[248:251], v[176:179], v[216:219]
    v_mfma_f32_16x16x32_bf16 v[216:219], a[252:255], v[180:183], v[216:219]
    s_nop 7
    s_branch FIX_D1_1_ret
FIX_D2_0:
    s_waitcnt vmcnt(0) lgkmcnt(0)
    s_call_b64 s[88:89], FIXS_0_0_1
    s_call_b64 s[88:89], FIXO_0_0
    s_call_b64 s[88:89], FIXS_0_1_1
    s_call_b64 s[88:89], FIXO_0_1
    s_call_b64 s[88:89], FIXS_1_0_1
    s_call_b64 s[88:89], FIXO_1_0
    s_call_b64 s[88:89], FIXS_1_1_1
    s_call_b64 s[88:89], FIXO_1_1
    v_mfma_f32_16x16x32_bf16 v[220:223], a[240:243], v[168:171], v[216:219]
    v_mfma_f32_16x16x32_bf16 v[220:223], a[244:247], v[172:175], v[220:223]
    v_mfma_f32_16x16x32_bf16 v[220:223], a[248:251], v[184:187], v[220:223]
    v_mfma_f32_16x16x32_bf16 v[220:223], a[252:255], v[188:191], v[220:223]
    s_nop 7
    s_branch FIX_D2_0_ret
FIX_D2_1:
    s_waitcnt vmcnt(0) lgkmcnt(0)
    s_call_b64 s[88:89], FIXS_0_1_0
    s_call_b64 s[88:89], FIXO_0_1
    s_call_b64 s[88:89], FIXS_1_0_0
    s_call_b64 s[88:89], FIXO_1_0
    s_call_b64 s[88:89], FIXS_1_1_0
    s_call_b64 s[88:89], FIXO_1_1
    v_mfma_f32_16x16x32_bf16 v[216:219], a[244:247], v[164:167], v[220:223]
    v_mfma_f32_16x16x32_bf16 v[216:219], a[248:251], v[176:179], v[216:219]
    v_mfma_f32_16x16x32_bf16 v[216:219], a[252:255], v[180:183], v[216:219]
    s_nop 7
    s_branch FIX_D2_1_ret
FIX_D3_0:
    s_waitcnt vmcnt(0) lgkmcnt(0)
    s_call_b64 s[88:89], FIXS_0_1_1
    s_call_b64 s[88:89], FIXO_0_1
    s_call_b64 s[88:89], FIXS_1_0_1
    s_call_b64 s[88:89], FIXO_1_0
    s_call_b64 s[88:89], FIXS_1_1_1
    s_call_b64 s[88:89], FIXO_1_1
    v_mfma_f32_16x16x32_bf16 v[220:223], a[244:247], v[172:175], v[216:219]
    v_mfma_f32_16x16x32_bf16 v[220:223], a[248:251], v[184:187], v[220:223]
    v_mfma_f32_16x16x32_bf16 v[220:223], a[252:255], v[188:191], v[220:223]
    s_nop 7
    s_branch FIX_D3_0_ret
FIX_D3_1:
    s_waitcnt vmcnt(0) lgkmcnt(0)
    s_call_b64 s[88:89], FIXS_1_0_0
    s_call_b64 s[88:89], FIXO_1_0
    s_call_b64 s[88:89], FIXS_1_1_0
    s_call_b64 s[88:89], FIXO_1_1
    v_mfma_f32_16x16x32_bf16 v[216:219], a[248:251], v[176:179], v[220:223]
    v_mfma_f32_16x16x32_bf16 v[216:219], a[252:255], v[180:183], v[216:219]
    s_nop 7
    s_branch FIX_D3_1_ret
FIX_SL_0:
    s_waitcnt vmcnt(0) lgkmcnt(0)
    s_call_b64 s[88:89], FIXS_1_0_1
    s_call_b64 s[88:89], FIXO_1_0
    s_call_b64 s[88:89], FIXS_1_1_1
    s_call_b64 s[88:89], FIXO_1_1
    v_mfma_f32_16x16x32_bf16 v[220:223], a[248:251], v[184:187], v[216:219]
    v_mfma_f32_16x16x32_bf16 v[220:223], a[252:255], v[188:191], v[220:223]
    s_nop 7
    s_branch FIX_SL_0_ret
FIX_SL_1:
    s_waitcnt vmcnt(0) lgkmcnt(0)
    s_call_b64 s[88:89], FIXS_1_0_0
    s_call_b64 s[88:89], FIXO_1_0
    s_call_b64 s[88:89], FIXS_1_1_0
    s_call_b64 s[88:89], FIXO_1_1
    v_mfma_f32_16x16x32_bf16 v[216:219], a[248:251], v[176:179], v[220:223]
    v_mfma_f32_16x16x32_bf16 v[216:219], a[252:255], v[180:183], v[216:219]
    s_nop 7
    s_branch FIX_SL_1_ret
FIX_S1_0:
    s_waitcnt vmcnt(0) lgkmcnt(0)
    s_call_b64 s[88:89], FIXS_1_0_1
    s_call_b64 s[88:89], FIXO_1_0
    s_call_b64 s[88:89], FIXS_1_1_1
    s_call_b64 s[88:89], FIXO_1_1
    v_mfma_f32_16x16x32_bf16 v[220:223], a[248:251], v[184:187], v[216:219]
    v_mfma_f32_16x16x32_bf16 v[220:223], a[252:255], v[188:191], v[220:223]
    s_nop 7
    s_branch FIX_S1_0_ret
FIX_S1_1:
    s_waitcnt vmcnt(0) lgkmcnt(0)
    s_call_b64 s[88:89], FIXS_1_0_0
    s_call_b64 s[88:89], FIXO_1_0
    s_call_b64 s[88:89], FIXS_1_1_0
    s_call_b64 s[88:89], FIXO_1_1
    v_mfma_f32_16x16x32_bf16 v[216:219], a[248:251], v[176:179], v[220:223]
    v_mfma_f32_16x16x32_bf16 v[216:219], a[252:255], v[180:183], v[216:219]
    s_nop 7
    s_branch FIX_S1_1_ret
FIX_S2_0:
    s_waitcnt vmcnt(0) lgkmcnt(0)
    s_call_b64 s[88:89], FIXS_1_0_1
    s_call_b64 s[88:89], FIXO_1_0
    s_call_b64 s[88:89], FIXS_1_1_1
    s_call_b64 s[88:89], FIXO_1_1
    v_mfma_f32_16x16x32_bf16 v[220:223], a[248:251], v[184:187], v[216:219]
    v_mfma_f32_16x16x32_bf16 v[220:223], a[252:255], v[188:191], v[220:223]
    s_nop 7
    s_branch FIX_S2_0_ret
FIX_S2_1:
    s_waitcnt vmcnt(0) lgkmcnt(0)
    s_call_b64 s[88:89], FIXS_1_1_0
    s_call_b64 s[88:89], FIXO_1_1
    v_mfma_f32_16x16x32_bf16 v[216:219], a[252:255], v[180:183], v[220:223]
    s_nop 7
    s_branch FIX_S2_1_ret
FIX_S3_0:
    s_waitcnt vmcnt(0) lgkmcnt(0)
    s_call_b64 s[88:89], FIXS_1_1_1
    s_call_b64 s[88:89], FIXO_1_1
    v_mfma_f32_16x16x32_bf16 v[220:223], a[252:255], v[188:191], v[216:219]
    s_nop 7
    s_branch FIX_S3_0_ret
FIXS_0_0_0:
    v_max3_f32 v241, v96, v97, v98
    v_max3_f32 v241, v241, v99, v100
    v_max3_f32 v241, v241, v101, v102
    v_max_f32 v241, v241, v103
    v_mov_b32 v242, v241
    s_nop 1
    v_permlane16_swap_b32 v241, v242
    v_max_f32 v241, v241, v242
    v_mov_b32 v242, v241
    s_nop 1
    v_permlane32_swap_b32 v241, v242
    v_max_f32 v241, v241, v242
    v_add_f32 v241, 0x42c80000, v241
    v_max_f32 v241, 0, v241
    v_ceil_f32 v241, v241
    v_cvt_i32_f32 v243, -v241
    v_sub_f32 v192, v192, v241
    v_sub_f32 v193, v193, v241
    v_sub_f32 v194, v194, v241
    v_sub_f32 v195, v195, v241
    v_sub_f32 v96, v96, v241
    v_sub_f32 v97, v97, v241
    v_sub_f32 v98, v98, v241
    v_sub_f32 v99, v99, v241
    v_sub_f32 v100, v100, v241
    v_sub_f32 v101, v101, v241
    v_sub_f32 v102, v102, v241
    v_sub_f32 v103, v103, v241
    v_sub_f32 v112, v112, v241
    v_sub_f32 v113, v113, v241
    v_sub_f32 v114, v114, v241
    v_sub_f32 v115, v115, v241
    v_sub_f32 v116, v116, v241
    v_sub_f32 v117, v117, v241
    v_sub_f32 v118, v118, v241
    v_sub_f32 v119, v119, v241
    v_ldexp_f32 v220, v220, v243
    v_exp_f32 v228, v96
    v_exp_f32 v229, v97
    v_exp_f32 v230, v98
    v_exp_f32 v231, v99
    v_cvt_pk_bf16_f32 v160, v228, v229
    v_exp_f32 v232, v100
    v_exp_f32 v233, v101
    v_cvt_pk_bf16_f32 v161, v230, v231
    v_exp_f32 v234, v102
    v_exp_f32 v235, v103
    v_cvt_pk_bf16_f32 v162, v232, v233
    v_cvt_pk_bf16_f32 v163, v234, v235
    s_setpc_b64 s[88:89]
FIXS_0_0_1:
    v_max3_f32 v241, v112, v113, v114
    v_max3_f32 v241, v241, v115, v116
    v_max3_f32 v241, v241, v117, v118
    v_max_f32 v241, v241, v119
    v_mov_b32 v242, v241
    s_nop 1
    v_permlane16_swap_b32 v241, v242
    v_max_f32 v241, v241, v242
    v_mov_b32 v242, v241
    s_nop 1
    v_permlane32_swap_b32 v241, v242
    v_max_f32 v241, v241, v242
    v_add_f32 v241, 0x42c80000, v241
    v_max_f32 v241, 0, v241
    v_ceil_f32 v241, v241
    v_cvt_i32_f32 v243, -v241
    v_sub_f32 v192, v192, v241
    v_sub_f32 v193, v193, v241
    v_sub_f32 v194, v194, v241
    v_sub_f32 v195, v195, v241
    v_sub_f32 v112, v112, v241
    v_sub_f32 v113, v113, v241
    v_sub_f32 v114, v114, v241
    v_sub_f32 v115, v115, v241
    v_sub_f32 v116, v116, v241
    v_sub_f32 v117, v117, v241
    v_sub_f32 v118, v118, v241
    v_sub_f32 v119, v119, v241
    v_sub_f32 v96, v96, v241
    v_sub_f32 v97, v97, v241
    v_sub_f32 v98, v98, v241
    v_sub_f32 v99, v99, v241
    v_sub_f32 v100, v100, v241
    v_sub_f32 v101, v101, v241
    v_sub_f32 v102, v102, v241
    v_sub_f32 v103, v103, v241
    v_ldexp_f32 v216, v216, v243
    v_exp_f32 v228, v112
    v_exp_f32 v229, v113
    v_exp_f32 v230, v114
    v_exp_f32 v231, v115
    v_cvt_pk_bf16_f32 v168, v228, v229
    v_exp_f32 v232, v116
    v_exp_f32 v233, v117
    v_cvt_pk_bf16_f32 v169, v230, v231
    v_exp_f32 v234, v118
    v_exp_f32 v235, v119
    v_cvt_pk_bf16_f32 v170, v232, v233
    v_cvt_pk_bf16_f32 v171, v234, v235
    s_setpc_b64 s[88:89]
FIXO_0_0:
    v_accvgpr_read_b32 v228, a0
    v_accvgpr_read_b32 v229, a1
    v_accvgpr_read_b32 v230, a2
    v_accvgpr_read_b32 v231, a3
    v_ldexp_f32 v228, v228, v243
    v_ldexp_f32 v229, v229, v243
    v_ldexp_f32 v230, v230, v243
    v_ldexp_f32 v231, v231, v243
    v_accvgpr_write_b32 a0, v228
    v_accvgpr_write_b32 a1, v229
    v_accvgpr_write_b32 a2, v230
    v_accvgpr_write_b32 a3, v231
    v_accvgpr_read_b32 v228, a8
    v_accvgpr_read_b32 v229, a9
    v_accvgpr_read_b32 v230, a10
    v_accvgpr_read_b32 v231, a11
    v_ldexp_f32 v228, v228, v243
    v_ldexp_f32 v229, v229, v243
    v_ldexp_f32 v230, v230, v243
    v_ldexp_f32 v231, v231, v243
    v_accvgpr_write_b32 a8, v228
    v_accvgpr_write_b32 a9, v229
    v_accvgpr_write_b32 a10, v230
    v_accvgpr_write_b32 a11, v231
    v_accvgpr_read_b32 v228, a16
    v_accvgpr_read_b32 v229, a17
    v_accvgpr_read_b32 v230, a18
    v_accvgpr_read_b32 v231, a19
    v_ldexp_f32 v228, v228, v243
    v_ldexp_f32 v229, v229, v243
    v_ldexp_f32 v230, v230, v243
    v_ldexp_f32 v231, v231, v243
    v_accvgpr_write_b32 a16, v228
    v_accvgpr_write_b32 a17, v229
    v_accvgpr_write_b32 a18, v230
    v_accvgpr_write_b32 a19, v231
    v_accvgpr_read_b32 v228, a24
    v_accvgpr_read_b32 v229, a25
    v_accvgpr_read_b32 v230, a26
    v_accvgpr_read_b32 v231, a27
    v_ldexp_f32 v228, v228, v243
    v_ldexp_f32 v229, v229, v243
    v_ldexp_f32 v230, v230, v243
    v_ldexp_f32 v231, v231, v243
    v_accvgpr_write_b32 a24, v228
    v_accvgpr_write_b32 a25, v229
    v_accvgpr_write_b32 a26, v230
    v_accvgpr_write_b32 a27, v231
    v_accvgpr_read_b32 v228, a32
    v_accvgpr_read_b32 v229, a33
    v_accvgpr_read_b32 v230, a34
    v_accvgpr_read_b32 v231, a35
    v_ldexp_f32 v228, v228, v243
    v_ldexp_f32 v229, v229, v243
    v_ldexp_f32 v230, v230, v243
    v_ldexp_f32 v231, v231, v243
    v_accvgpr_write_b32 a32, v228
    v_accvgpr_write_b32 a33, v229
    v_accvgpr_write_b32 a34, v230
    v_accvgpr_write_b32 a35, v231
    v_accvgpr_read_b32 v228, a40
    v_accvgpr_read_b32 v229, a41
    v_accvgpr_read_b32 v230, a42
    v_accvgpr_read_b32 v231, a43
    v_ldexp_f32 v228, v228, v243
    v_ldexp_f32 v229, v229, v243
    v_ldexp_f32 v230, v230, v243
    v_ldexp_f32 v231, v231, v243
    v_accvgpr_write_b32 a40, v228
    v_accvgpr_write_b32 a41, v229
    v_accvgpr_write_b32 a42, v230
    v_accvgpr_write_b32 a43, v231
    v_accvgpr_read_b32 v228, a48
    v_accvgpr_read_b32 v229, a49
    v_accvgpr_read_b32 v230, a50
    v_accvgpr_read_b32 v231, a51
    v_ldexp_f32 v228, v228, v243
    v_ldexp_f32 v229, v229, v243
    v_ldexp_f32 v230, v230, v243
    v_ldexp_f32 v231, v231, v243
    v_accvgpr_write_b32 a48, v228
    v_accvgpr_write_b32 a49, v229
    v_accvgpr_write_b32 a50, v230
    v_accvgpr_write_b32 a51, v231
    v_accvgpr_read_b32 v228, a56
    v_accvgpr_read_b32 v229, a57
    v_accvgpr_read_b32 v230, a58
    v_accvgpr_read_b32 v231, a59
    v_ldexp_f32 v228, v228, v243
    v_ldexp_f32 v229, v229, v243
    v_ldexp_f32 v230, v230, v243
    v_ldexp_f32 v231, v231, v243
    v_accvgpr_write_b32 a56, v228
    v_accvgpr_write_b32 a57, v229
    v_accvgpr_write_b32 a58, v230
    v_accvgpr_write_b32 a59, v231
    s_setpc_b64 s[88:89]
FIXS_0_1_0:
    v_max3_f32 v241, v104, v105, v106
    v_max3_f32 v241, v241, v107, v108
    v_max3_f32 v241, v241, v109, v110
    v_max_f32 v241, v241, v111
    v_mov_b32 v242, v241
    s_nop 1
    v_permlane16_swap_b32 v241, v242
    v_max_f32 v241, v241, v242
    v_mov_b32 v242, v241
    s_nop 1
    v_permlane32_swap_b32 v241, v242
    v_max_f32 v241, v241, v242
    v_add_f32 v241, 0x42c80000, v241
    v_max_f32 v241, 0, v241
    v_ceil_f32 v241, v241
    v_cvt_i32_f32 v243, -v241
    v_sub_f32 v196, v196, v241
    v_sub_f32 v197, v197, v241
    v_sub_f32 v198, v198, v241
    v_sub_f32 v199, v199, v241
    v_sub_f32 v104, v104, v241
    v_sub_f32 v105, v105, v241
    v_sub_f32 v106, v106, v241
    v_sub_f32 v107, v107, v241
    v_sub_f32 v108, v108, v241
    v_sub_f32 v109, v109, v241
    v_sub_f32 v110, v110, v241
    v_sub_f32 v111, v111, v241
    v_sub_f32 v120, v120, v241
    v_sub_f32 v121, v121, v241
    v_sub_f32 v122, v122, v241
    v_sub_f32 v123, v123, v241
    v_sub_f32 v124, v124, v241
    v_sub_f32 v125, v125, v241
    v_sub_f32 v126, v126, v241
    v_sub_f32 v127, v127, v241
    v_ldexp_f32 v221, v221, v243
    v_exp_f32 v228, v104
    v_exp_f32 v229, v105
    v_exp_f32 v230, v106
    v_exp_f32 v231, v107
    v_cvt_pk_bf16_f32 v164, v228, v229
    v_exp_f32 v232, v108
    v_exp_f32 v233, v109
    v_cvt_pk_bf16_f32 v165, v230, v231
    v_exp_f32 v234, v110
    v_exp_f32 v235, v111
    v_cvt_pk_bf16_f32 v166, v232, v233
    v_cvt_pk_bf16_f32 v167, v234, v235
    s_setpc_b64 s[88:89]
FIXS_0_1_1:
    v_max3_f32 v241, v120, v121, v122
    v_max3_f32 v241, v241, v123, v124
    v_max3_f32 v241, v241, v125, v126
    v_max_f32 v241, v241, v127
    v_mov_b32 v242, v241
    s_nop 1
    v_permlane16_swap_b32 v241, v242
    v_max_f32 v241, v241, v242
    v_mov_b32 v242, v241
    s_nop 1
    v_permlane32_swap_b32 v241, v242
    v_max_f32 v241, v241, v242
    v_add_f32 v241, 0x42c80000, v241
    v_max_f32 v241, 0, v241
    v_ceil_f32 v241, v241
    v_cvt_i32_f32 v243, -v241
    v_sub_f32 v196, v196, v241
    v_sub_f32 v197, v197, v241
    v_sub_f32 v198, v198, v241
    v_sub_f32 v199, v199, v241
    v_sub_f32 v120, v120, v241
    v_sub_f32 v121, v121, v241
    v_sub_f32 v122, v122, v241
    v_sub_f32 v123, v123, v241
    v_sub_f32 v124, v124, v241
    v_sub_f32 v125, v125, v241
    v_sub_f32 v126, v126, v241
    v_sub_f32 v127, v127, v241
    v_sub_f32 v104, v104, v241
    v_sub_f32 v105, v105, v241
    v_sub_f32 v106, v106, v241
    v_sub_f32 v107, v107, v241
    v_sub_f32 v108, v108, v241
    v_sub_f32 v109, v109, v241
    v_sub_f32 v110, v110, v241
    v_sub_f32 v111, v111, v241
    v_ldexp_f32 v217, v217, v243
    v_exp_f32 v228, v120
    v_exp_f32 v229, v121
    v_exp_f32 v230, v122
    v_exp_f32 v231, v123
    v_cvt_pk_bf16_f32 v172, v228, v229
    v_exp_f32 v232, v124
    v_exp_f32 v233, v125
    v_cvt_pk_bf16_f32 v173, v230, v231
    v_exp_f32 v234, v126
    v_exp_f32 v235, v127
    v_cvt_pk_bf16_f32 v174, v232, v233
    v_cvt_pk_bf16_f32 v175, v234, v235
    s_setpc_b64 s[88:89]
FIXO_0_1:
    v_accvgpr_read_b32 v228, a4
    v_accvgpr_read_b32 v229, a5
    v_accvgpr_read_b32 v230, a6
    v_accvgpr_read_b32 v231, a7
    v_ldexp_f32 v228, v228, v243
    v_ldexp_f32 v229, v229, v243
    v_ldexp_f32 v230, v230, v243
    v_ldexp_f32 v231, v231, v243
    v_accvgpr_write_b32 a4, v228
    v_accvgpr_write_b32 a5, v229
    v_accvgpr_write_b32 a6, v230
    v_accvgpr_write_b32 a7, v231
    v_accvgpr_read_b32 v228, a12
    v_accvgpr_read_b32 v229, a13
    v_accvgpr_read_b32 v230, a14
    v_accvgpr_read_b32 v231, a15
    v_ldexp_f32 v228, v228, v243
    v_ldexp_f32 v229, v229, v243
    v_ldexp_f32 v230, v230, v243
    v_ldexp_f32 v231, v231, v243
    v_accvgpr_write_b32 a12, v228
    v_accvgpr_write_b32 a13, v229
    v_accvgpr_write_b32 a14, v230
    v_accvgpr_write_b32 a15, v231
    v_accvgpr_read_b32 v228, a20
    v_accvgpr_read_b32 v229, a21
    v_accvgpr_read_b32 v230, a22
    v_accvgpr_read_b32 v231, a23
    v_ldexp_f32 v228, v228, v243
    v_ldexp_f32 v229, v229, v243
    v_ldexp_f32 v230, v230, v243
    v_ldexp_f32 v231, v231, v243
    v_accvgpr_write_b32 a20, v228
    v_accvgpr_write_b32 a21, v229
    v_accvgpr_write_b32 a22, v230
    v_accvgpr_write_b32 a23, v231
    v_accvgpr_read_b32 v228, a28
    v_accvgpr_read_b32 v229, a29
    v_accvgpr_read_b32 v230, a30
    v_accvgpr_read_b32 v231, a31
    v_ldexp_f32 v228, v228, v243
    v_ldexp_f32 v229, v229, v243
    v_ldexp_f32 v230, v230, v243
    v_ldexp_f32 v231, v231, v243
    v_accvgpr_write_b32 a28, v228
    v_accvgpr_write_b32 a29, v229
    v_accvgpr_write_b32 a30, v230
    v_accvgpr_write_b32 a31, v231
    v_accvgpr_read_b32 v228, a36
    v_accvgpr_read_b32 v229, a37
    v_accvgpr_read_b32 v230, a38
    v_accvgpr_read_b32 v231, a39
    v_ldexp_f32 v228, v228, v243
    v_ldexp_f32 v229, v229, v243
    v_ldexp_f32 v230, v230, v243
    v_ldexp_f32 v231, v231, v243
    v_accvgpr_write_b32 a36, v228
    v_accvgpr_write_b32 a37, v229
    v_accvgpr_write_b32 a38, v230
    v_accvgpr_write_b32 a39, v231
    v_accvgpr_read_b32 v228, a44
    v_accvgpr_read_b32 v229, a45
    v_accvgpr_read_b32 v230, a46
    v_accvgpr_read_b32 v231, a47
    v_ldexp_f32 v228, v228, v243
    v_ldexp_f32 v229, v229, v243
    v_ldexp_f32 v230, v230, v243
    v_ldexp_f32 v231, v231, v243
    v_accvgpr_write_b32 a44, v228
    v_accvgpr_write_b32 a45, v229
    v_accvgpr_write_b32 a46, v230
    v_accvgpr_write_b32 a47, v231
    v_accvgpr_read_b32 v228, a52
    v_accvgpr_read_b32 v229, a53
    v_accvgpr_read_b32 v230, a54
    v_accvgpr_read_b32 v231, a55
    v_ldexp_f32 v228, v228, v243
    v_ldexp_f32 v229, v229, v243
    v_ldexp_f32 v230, v230, v243
    v_ldexp_f32 v231, v231, v243
    v_accvgpr_write_b32 a52, v228
    v_accvgpr_write_b32 a53, v229
    v_accvgpr_write_b32 a54, v230
    v_accvgpr_write_b32 a55, v231
    v_accvgpr_read_b32 v228, a60
    v_accvgpr_read_b32 v229, a61
    v_accvgpr_read_b32 v230, a62
    v_accvgpr_read_b32 v231, a63
    v_ldexp_f32 v228, v228, v243
    v_ldexp_f32 v229, v229, v243
    v_ldexp_f32 v230, v230, v243
    v_ldexp_f32 v231, v231, v243
    v_accvgpr_write_b32 a60, v228
    v_accvgpr_write_b32 a61, v229
    v_accvgpr_write_b32 a62, v230
    v_accvgpr_write_b32 a63, v231
    s_setpc_b64 s[88:89]
FIXS_1_0_0:
    v_max3_f32 v241, v128, v129, v130
    v_max3_f32 v241, v241, v131, v132
    v_max3_f32 v241, v241, v133, v134
    v_max_f32 v241, v241, v135
    v_mov_b32 v242, v241
    s_nop 1
    v_permlane16_swap_b32 v241, v242
    v_max_f32 v241, v241, v242
    v_mov_b32 v242, v241
    s_nop 1
    v_permlane32_swap_b32 v241, v242
    v_max_f32 v241, v241, v242
    v_add_f32 v241, 0x42c80000, v241
    v_max_f32 v241, 0, v241
    v_ceil_f32 v241, v241
    v_cvt_i32_f32 v243, -v241
    v_sub_f32 v208, v208, v241
    v_sub_f32 v209, v209, v241
    v_sub_f32 v210, v210, v241
    v_sub_f32 v211, v211, v241
    v_sub_f32 v128, v128, v241
    v_sub_f32 v129, v129, v241
    v_sub_f32 v130, v130, v241
    v_sub_f32 v131, v131, v241
    v_sub_f32 v132, v132, v241
    v_sub_f32 v133, v133, v241
    v_sub_f32 v134, v134, v241
    v_sub_f32 v135, v135, v241
    v_sub_f32 v144, v144, v241
    v_sub_f32 v145, v145, v241
    v_sub_f32 v146, v146, v241
    v_sub_f32 v147, v147, v241
    v_sub_f32 v148, v148, v241
    v_sub_f32 v149, v149, v241
    v_sub_f32 v150, v150, v241
    v_sub_f32 v151, v151, v241
    v_ldexp_f32 v222, v222, v243
    v_exp_f32 v228, v128
    v_exp_f32 v229, v129
    v_exp_f32 v230, v130
    v_exp_f32 v231, v131
    v_cvt_pk_bf16_f32 v176, v228, v229
    v_exp_f32 v232, v132
    v_exp_f32 v233, v133
    v_cvt_pk_bf16_f32 v177, v230, v231
    v_exp_f32 v234, v134
    v_exp_f32 v235, v135
    v_cvt_pk_bf16_f32 v178, v232, v233
    v_cvt_pk_bf16_f32 v179, v234, v235
    s_setpc_b64 s[88:89]
FIXS_1_0_1:
    v_max3_f32 v241, v144, v145, v146
    v_max3_f32 v241, v241, v147, v148
    v_max3_f32 v241, v241, v149, v150
    v_max_f32 v241, v241, v151
    v_mov_b32 v242, v241
    s_nop 1
    v_permlane16_swap_b32 v241, v242
    v_max_f32 v241, v241, v242
    v_mov_b32 v242, v241
    s_nop 1
    v_permlane32_swap_b32 v241, v242
    v_max_f32 v241, v241, v242
    v_add_f32 v241, 0x42c80000, v241
    v_max_f32 v241, 0, v241
    v_ceil_f32 v241, v241
    v_cvt_i32_f32 v243, -v241
    v_sub_f32 v208, v208, v241
    v_sub_f32 v209, v209, v241
    v_sub_f32 v210, v210, v241
    v_sub_f32 v211, v211, v241
    v_sub_f32 v144, v144, v241
    v_sub_f32 v145, v145, v241
    v_sub_f32 v146, v146, v241
    v_sub_f32 v147, v147, v241
    v_sub_f32 v148, v148, v241
    v_sub_f32 v149, v149, v241
    v_sub_f32 v150, v150, v241
    v_sub_f32 v151, v151, v241
    v_sub_f32 v128, v128, v241
    v_sub_f32 v129, v129, v241
    v_sub_f32 v130, v130, v241
    v_sub_f32 v131, v131, v241
    v_sub_f32 v132, v132, v241
    v_sub_f32 v133, v133, v241
    v_sub_f32 v134, v134, v241
    v_sub_f32 v135, v135, v241
    v_ldexp_f32 v218, v218, v243
    v_exp_f32 v228, v144
    v_exp_f32 v229, v145
    v_exp_f32 v230, v146
    v_exp_f32 v231, v147
    v_cvt_pk_bf16_f32 v184, v228, v229
    v_exp_f32 v232, v148
    v_exp_f32 v233, v149
    v_cvt_pk_bf16_f32 v185, v230, v231
    v_exp_f32 v234, v150
    v_exp_f32 v235, v151
    v_cvt_pk_bf16_f32 v186, v232, v233
    v_cvt_pk_bf16_f32 v187, v234, v235
    s_setpc_b64 s[88:89]
FIXO_1_0:
    v_accvgpr_read_b32 v228, a64
    v_accvgpr_read_b32 v229, a65
    v_accvgpr_read_b32 v230, a66
    v_accvgpr_read_b32 v231, a67
    v_ldexp_f32 v228, v228, v243
    v_ldexp_f32 v229, v229, v243
    v_ldexp_f32 v230, v230, v243
    v_ldexp_f32 v231, v231, v243
    v_accvgpr_write_b32 a64, v228
    v_accvgpr_write_b32 a65, v229
    v_accvgpr_write_b32 a66, v230
    v_accvgpr_write_b32 a67, v231
    v_accvgpr_read_b32 v228, a72
    v_accvgpr_read_b32 v229, a73
    v_accvgpr_read_b32 v230, a74
    v_accvgpr_read_b32 v231, a75
    v_ldexp_f32 v228, v228, v243
    v_ldexp_f32 v229, v229, v243
    v_ldexp_f32 v230, v230, v243
    v_ldexp_f32 v231, v231, v243
    v_accvgpr_write_b32 a72, v228
    v_accvgpr_write_b32 a73, v229
    v_accvgpr_write_b32 a74, v230
    v_accvgpr_write_b32 a75, v231
    v_accvgpr_read_b32 v228, a80
    v_accvgpr_read_b32 v229, a81
    v_accvgpr_read_b32 v230, a82
    v_accvgpr_read_b32 v231, a83
    v_ldexp_f32 v228, v228, v243
    v_ldexp_f32 v229, v229, v243
    v_ldexp_f32 v230, v230, v243
    v_ldexp_f32 v231, v231, v243
    v_accvgpr_write_b32 a80, v228
    v_accvgpr_write_b32 a81, v229
    v_accvgpr_write_b32 a82, v230
    v_accvgpr_write_b32 a83, v231
    v_accvgpr_read_b32 v228, a88
    v_accvgpr_read_b32 v229, a89
    v_accvgpr_read_b32 v230, a90
    v_accvgpr_read_b32 v231, a91
    v_ldexp_f32 v228, v228, v243
    v_ldexp_f32 v229, v229, v243
    v_ldexp_f32 v230, v230, v243
    v_ldexp_f32 v231, v231, v243
    v_accvgpr_write_b32 a88, v228
    v_accvgpr_write_b32 a89, v229
    v_accvgpr_write_b32 a90, v230
    v_accvgpr_write_b32 a91, v231
    v_accvgpr_read_b32 v228, a96
    v_accvgpr_read_b32 v229, a97
    v_accvgpr_read_b32 v230, a98
    v_accvgpr_read_b32 v231, a99
    v_ldexp_f32 v228, v228, v243
    v_ldexp_f32 v229, v229, v243
    v_ldexp_f32 v230, v230, v243
    v_ldexp_f32 v231, v231, v243
    v_accvgpr_write_b32 a96, v228
    v_accvgpr_write_b32 a97, v229
    v_accvgpr_write_b32 a98, v230
    v_accvgpr_write_b32 a99, v231
    v_accvgpr_read_b32 v228, a104
    v_accvgpr_read_b32 v229, a105
    v_accvgpr_read_b32 v230, a106
    v_accvgpr_read_b32 v231, a107
    v_ldexp_f32 v228, v228, v243
    v_ldexp_f32 v229, v229, v243
    v_ldexp_f32 v230, v230, v243
    v_ldexp_f32 v231, v231, v243
    v_accvgpr_write_b32 a104, v228
    v_accvgpr_write_b32 a105, v229
    v_accvgpr_write_b32 a106, v230
    v_accvgpr_write_b32 a107, v231
    v_accvgpr_read_b32 v228, a112
    v_accvgpr_read_b32 v229, a113
    v_accvgpr_read_b32 v230, a114
    v_accvgpr_read_b32 v231, a115
    v_ldexp_f32 v228, v228, v243
    v_ldexp_f32 v229, v229, v243
    v_ldexp_f32 v230, v230, v243
    v_ldexp_f32 v231, v231, v243
    v_accvgpr_write_b32 a112, v228
    v_accvgpr_write_b32 a113, v229
    v_accvgpr_write_b32 a114, v230
    v_accvgpr_write_b32 a115, v231
    v_accvgpr_read_b32 v228, a120
    v_accvgpr_read_b32 v229, a121
    v_accvgpr_read_b32 v230, a122
    v_accvgpr_read_b32 v231, a123
    v_ldexp_f32 v228, v228, v243
    v_ldexp_f32 v229, v229, v243
    v_ldexp_f32 v230, v230, v243
    v_ldexp_f32 v231, v231, v243
    v_accvgpr_write_b32 a120, v228
    v_accvgpr_write_b32 a121, v229
    v_accvgpr_write_b32 a122, v230
    v_accvgpr_write_b32 a123, v231
    s_setpc_b64 s[88:89]
FIXS_1_1_0:
    v_max3_f32 v241, v136, v137, v138
    v_max3_f32 v241, v241, v139, v140
    v_max3_f32 v241, v241, v141, v142
    v_max_f32 v241, v241, v143
    v_mov_b32 v242, v241
    s_nop 1
    v_permlane16_swap_b32 v241, v242
    v_max_f32 v241, v241, v242
    v_mov_b32 v242, v241
    s_nop 1
    v_permlane32_swap_b32 v241, v242
    v_max_f32 v241, v241, v242
    v_add_f32 v241, 0x42c80000, v241
    v_max_f32 v241, 0, v241
    v_ceil_f32 v241, v241
    v_cvt_i32_f32 v243, -v241
    v_sub_f32 v212, v212, v241
    v_sub_f32 v213, v213, v241
    v_sub_f32 v214, v214, v241
    v_sub_f32 v215, v215, v241
    v_sub_f32 v136, v136, v241
    v_sub_f32 v137, v137, v241
    v_sub_f32 v138, v138, v241
    v_sub_f32 v139, v139, v241
    v_sub_f32 v140, v140, v241
    v_sub_f32 v141, v141, v241
    v_sub_f32 v142, v142, v241
    v_sub_f32 v143, v143, v241
    v_sub_f32 v152, v152, v241
    v_sub_f32 v153, v153, v241
    v_sub_f32 v154, v154, v241
    v_sub_f32 v155, v155, v241
    v_sub_f32 v156, v156, v241
    v_sub_f32 v157, v157, v241
    v_sub_f32 v158, v158, v241
    v_sub_f32 v159, v159, v241
    v_ldexp_f32 v223, v223, v243
    v_exp_f32 v228, v136
    v_exp_f32 v229, v137
    v_exp_f32 v230, v138
    v_exp_f32 v231, v139
    v_cvt_pk_bf16_f32 v180, v228, v229
    v_exp_f32 v232, v140
    v_exp_f32 v233, v141
    v_cvt_pk_bf16_f32 v181, v230, v231
    v_exp_f32 v234, v142
    v_exp_f32 v235, v143
    v_cvt_pk_bf16_f32 v182, v232, v233
    v_cvt_pk_bf16_f32 v183, v234, v235
    s_setpc_b64 s[88:89]
FIXS_1_1_1:
    v_max3_f32 v241, v152, v153, v154
    v_max3_f32 v241, v241, v155, v156
    v_max3_f32 v241, v241, v157, v158
    v_max_f32 v241, v241, v159
    v_mov_b32 v242, v241
    s_nop 1
    v_permlane16_swap_b32 v241, v242
    v_max_f32 v241, v241, v242
    v_mov_b32 v242, v241
    s_nop 1
    v_permlane32_swap_b32 v241, v242
    v_max_f32 v241, v241, v242
    v_add_f32 v241, 0x42c80000, v241
    v_max_f32 v241, 0, v241
    v_ceil_f32 v241, v241
    v_cvt_i32_f32 v243, -v241
    v_sub_f32 v212, v212, v241
    v_sub_f32 v213, v213, v241
    v_sub_f32 v214, v214, v241
    v_sub_f32 v215, v215, v241
    v_sub_f32 v152, v152, v241
    v_sub_f32 v153, v153, v241
    v_sub_f32 v154, v154, v241
    v_sub_f32 v155, v155, v241
    v_sub_f32 v156, v156, v241
    v_sub_f32 v157, v157, v241
    v_sub_f32 v158, v158, v241
    v_sub_f32 v159, v159, v241
    v_sub_f32 v136, v136, v241
    v_sub_f32 v137, v137, v241
    v_sub_f32 v138, v138, v241
    v_sub_f32 v139, v139, v241
    v_sub_f32 v140, v140, v241
    v_sub_f32 v141, v141, v241
    v_sub_f32 v142, v142, v241
    v_sub_f32 v143, v143, v241
    v_ldexp_f32 v219, v219, v243
    v_exp_f32 v228, v152
    v_exp_f32 v229, v153
    v_exp_f32 v230, v154
    v_exp_f32 v231, v155
    v_cvt_pk_bf16_f32 v188, v228, v229
    v_exp_f32 v232, v156
    v_exp_f32 v233, v157
    v_cvt_pk_bf16_f32 v189, v230, v231
    v_exp_f32 v234, v158
    v_exp_f32 v235, v159
    v_cvt_pk_bf16_f32 v190, v232, v233
    v_cvt_pk_bf16_f32 v191, v234, v235
    s_setpc_b64 s[88:89]
FIXO_1_1:
    v_accvgpr_read_b32 v228, a68
    v_accvgpr_read_b32 v229, a69
    v_accvgpr_read_b32 v230, a70
    v_accvgpr_read_b32 v231, a71
    v_ldexp_f32 v228, v228, v243
    v_ldexp_f32 v229, v229, v243
    v_ldexp_f32 v230, v230, v243
    v_ldexp_f32 v231, v231, v243
    v_accvgpr_write_b32 a68, v228
    v_accvgpr_write_b32 a69, v229
    v_accvgpr_write_b32 a70, v230
    v_accvgpr_write_b32 a71, v231
    v_accvgpr_read_b32 v228, a76
    v_accvgpr_read_b32 v229, a77
    v_accvgpr_read_b32 v230, a78
    v_accvgpr_read_b32 v231, a79
    v_ldexp_f32 v228, v228, v243
    v_ldexp_f32 v229, v229, v243
    v_ldexp_f32 v230, v230, v243
    v_ldexp_f32 v231, v231, v243
    v_accvgpr_write_b32 a76, v228
    v_accvgpr_write_b32 a77, v229
    v_accvgpr_write_b32 a78, v230
    v_accvgpr_write_b32 a79, v231
    v_accvgpr_read_b32 v228, a84
    v_accvgpr_read_b32 v229, a85
    v_accvgpr_read_b32 v230, a86
    v_accvgpr_read_b32 v231, a87
    v_ldexp_f32 v228, v228, v243
    v_ldexp_f32 v229, v229, v243
    v_ldexp_f32 v230, v230, v243
    v_ldexp_f32 v231, v231, v243
    v_accvgpr_write_b32 a84, v228
    v_accvgpr_write_b32 a85, v229
    v_accvgpr_write_b32 a86, v230
    v_accvgpr_write_b32 a87, v231
    v_accvgpr_read_b32 v228, a92
    v_accvgpr_read_b32 v229, a93
    v_accvgpr_read_b32 v230, a94
    v_accvgpr_read_b32 v231, a95
    v_ldexp_f32 v228, v228, v243
    v_ldexp_f32 v229, v229, v243
    v_ldexp_f32 v230, v230, v243
    v_ldexp_f32 v231, v231, v243
    v_accvgpr_write_b32 a92, v228
    v_accvgpr_write_b32 a93, v229
    v_accvgpr_write_b32 a94, v230
    v_accvgpr_write_b32 a95, v231
    v_accvgpr_read_b32 v228, a100
    v_accvgpr_read_b32 v229, a101
    v_accvgpr_read_b32 v230, a102
    v_accvgpr_read_b32 v231, a103
    v_ldexp_f32 v228, v228, v243
    v_ldexp_f32 v229, v229, v243
    v_ldexp_f32 v230, v230, v243
    v_ldexp_f32 v231, v231, v243
    v_accvgpr_write_b32 a100, v228
    v_accvgpr_write_b32 a101, v229
    v_accvgpr_write_b32 a102, v230
    v_accvgpr_write_b32 a103, v231
    v_accvgpr_read_b32 v228, a108
    v_accvgpr_read_b32 v229, a109
    v_accvgpr_read_b32 v230, a110
    v_accvgpr_read_b32 v231, a111
    v_ldexp_f32 v228, v228, v243
    v_ldexp_f32 v229, v229, v243
    v_ldexp_f32 v230, v230, v243
    v_ldexp_f32 v231, v231, v243
    v_accvgpr_write_b32 a108, v228
    v_accvgpr_write_b32 a109, v229
    v_accvgpr_write_b32 a110, v230
    v_accvgpr_write_b32 a111, v231
    v_accvgpr_read_b32 v228, a116
    v_accvgpr_read_b32 v229, a117
    v_accvgpr_read_b32 v230, a118
    v_accvgpr_read_b32 v231, a119
    v_ldexp_f32 v228, v228, v243
    v_ldexp_f32 v229, v229, v243
    v_ldexp_f32 v230, v230, v243
    v_ldexp_f32 v231, v231, v243
    v_accvgpr_write_b32 a116, v228
    v_accvgpr_write_b32 a117, v229
    v_accvgpr_write_b32 a118, v230
    v_accvgpr_write_b32 a119, v231
    v_accvgpr_read_b32 v228, a124
    v_accvgpr_read_b32 v229, a125
    v_accvgpr_read_b32 v230, a126
    v_accvgpr_read_b32 v231, a127
    v_ldexp_f32 v228, v228, v243
    v_ldexp_f32 v229, v229, v243
    v_ldexp_f32 v230, v230, v243
    v_ldexp_f32 v231, v231, v243
    v_accvgpr_write_b32 a124, v228
    v_accvgpr_write_b32 a125, v229
    v_accvgpr_write_b32 a126, v230
    v_accvgpr_write_b32 a127, v231
    s_setpc_b64 s[88:89]
.section .rodata,"a"
.p2align 6
.amdhsa_kernel concat_heads__ssm_conv_s5__compressed_kv_cla__prompt_kernel
  .amdhsa_next_free_vgpr 512
  .amdhsa_next_free_sgpr 102
  .amdhsa_accum_offset 256
  .amdhsa_group_segment_fixed_size 0
  .amdhsa_kernarg_size 144
  .amdhsa_user_sgpr_count 2
  .amdhsa_user_sgpr_kernarg_segment_ptr 1
  .amdhsa_system_sgpr_workgroup_id_x 1
.end_amdhsa_kernel
```
